```python
import torch

def _softmax(x, axis=-1):
    return torch.softmax(x, dim=axis)
def _gelu(x):
    return torch.nn.functional.gelu(x, approximate="tanh")
def _silu(x):
    return torch.nn.functional.silu(x)
def _sigmoid(x):
    return torch.sigmoid(x)
def _layernorm(x, axis=-1, eps=1e-5):
    m = x.mean(dim=axis, keepdim=True)
    v = x.var(dim=axis, keepdim=True, unbiased=False)
    return (x - m) / torch.sqrt(v + eps)
def _scatter_add(tgt, idx, src, axis=0):
    return tgt.clone().index_add_(axis, idx, src)
def _segment_sum(src, seg, n):
    out = torch.zeros((n,) + src.shape[1:], dtype=src.dtype)
    return out.index_add_(0, seg, src)
def _pad(x, pw):
    flat = tuple(v for pair in reversed(pw) for v in pair)
    return torch.nn.functional.pad(x, flat)

kernel_name = 'concat_heads__mha_block_cached__mha_block_cached__near_ridge'

def setup_inputs():

    _w = (lambda a: (lambda t: t.to(torch.bfloat16) if t.is_floating_point() else t)(torch.as_tensor(a)))
    def _A_setup():
        B, Sq, D = 16, 160, 448
        H, Sk, Dh = 16, 512, 256
        return {
            "x": _w((lambda *s: torch.randn(*s, dtype=torch.bfloat16) * 0.8)(B, Sq, D)),
            "k_cache": _w((lambda *s: torch.randn(*s, dtype=torch.bfloat16) * 0.8)(B, H, Sk, Dh)),
            "v_cache": _w((lambda *s: torch.randn(*s, dtype=torch.bfloat16) * 0.05)(B, H, Sk, Dh)),
            "wq": _w((lambda *s: torch.randn(*s, dtype=torch.bfloat16) * 0.8)(D, H * Dh) * (D ** -0.5)),
            "wo": _w((lambda *s: torch.randn(*s, dtype=torch.bfloat16) * 0.05)(H * Dh, D) * ((H * Dh) ** -0.5)),
        }
    _A_in = _A_setup()

    def _B_setup():
        B, Sq, D = 16, 160, 448
        H, Sk, Dh = 16, 512, 256
        return {
            "x": _w((lambda *s: torch.randn(*s, dtype=torch.bfloat16) * 0.8)(B, Sq, D)),
            "k_cache": _w((lambda *s: torch.randn(*s, dtype=torch.bfloat16) * 0.8)(B, H, Sk, Dh)),
            "v_cache": _w((lambda *s: torch.randn(*s, dtype=torch.bfloat16) * 0.05)(B, H, Sk, Dh)),
            "wq": _w((lambda *s: torch.randn(*s, dtype=torch.bfloat16) * 0.8)(D, H * Dh) * (D ** -0.5)),
            "wo": _w((lambda *s: torch.randn(*s, dtype=torch.bfloat16) * 0.05)(H * Dh, D) * ((H * Dh) ** -0.5)),
        }
    _B_in = _B_setup()

    return {
        "A_x": _A_in["x"],
        "A_k_cache": _A_in["k_cache"],
        "A_v_cache": _A_in["v_cache"],
        "A_wq": _A_in["wq"],
        "A_wo": _A_in["wo"],
        "B_x": _B_in["x"],
        "B_k_cache": _B_in["k_cache"],
        "B_v_cache": _B_in["v_cache"],
        "B_wq": _B_in["wq"],
        "B_wo": _B_in["wo"],
    }

def reference(A_x, A_k_cache, A_v_cache, A_wq, A_wo, B_x, B_k_cache, B_v_cache, B_wq, B_wo):
    def _A_ref(x, k_cache, v_cache, wq, wo):
        B, Sq, D = x.shape
        H, Dh = 16, 256
        q = (lambda x, *d: x.permute(*d))((x @ wq).reshape(B, Sq, H, Dh), 0, 2, 1, 3)
        scores = torch.einsum("bhqd,bhkd->bhqk", q, k_cache) * (Dh ** -0.5)
        p = _softmax(scores, axis=-1)
        o = torch.einsum("bhqk,bhkd->bhqd", p, v_cache)
        return (lambda x, *d: x.permute(*d))(o, 0, 2, 1, 3).reshape(B, Sq, H * Dh) @ wo

    def _B_ref(x, k_cache, v_cache, wq, wo):
        B, Sq, D = x.shape
        H, Dh = 16, 256
        q = (lambda x, *d: x.permute(*d))((x @ wq).reshape(B, Sq, H, Dh), 0, 2, 1, 3)
        scores = torch.einsum("bhqd,bhkd->bhqk", q, k_cache) * (Dh ** -0.5)
        p = _softmax(scores, axis=-1)
        o = torch.einsum("bhqk,bhkd->bhqd", p, v_cache)
        return (lambda x, *d: x.permute(*d))(o, 0, 2, 1, 3).reshape(B, Sq, H * Dh) @ wo

    a = _A_ref(A_x, A_k_cache, A_v_cache, A_wq, A_wo)
    b = _B_ref(B_x, B_k_cache, B_v_cache, B_wq, B_wo)
    return torch.concatenate([a, b], axis=-1)
```

```asm
; @launch grid=(256,1,1) block=(256,1,1) lds=163840
.amdgcn_target "amdgcn-amd-amdhsa--gfx950"
.text
.globl concat_heads__mha_block_cached__mha_block_cached__near_ridge_kernel
.p2align 12
.p2align 8
.type concat_heads__mha_block_cached__mha_block_cached__near_ridge_kernel,@function
concat_heads__mha_block_cached__mha_block_cached__near_ridge_kernel:
    s_cmp_ge_u32 s2, 256
    s_cbranch_scc1 L_end
    s_and_b32 s3, s2, 7
    s_lshr_b32 s4, s2, 3
    s_lshr_b32 s5, s3, 2
    s_mul_i32 s6, s5, 40
    s_add_u32 s30, s0, s6
    s_addc_u32 s31, s1, 0
    s_load_dwordx2 s[8:9], s[30:31], 0
    s_load_dwordx2 s[12:13], s[30:31], 24
    s_load_dwordx2 s[16:17], s[30:31], 8
    s_load_dwordx2 s[20:21], s[30:31], 16
    s_load_dwordx2 s[54:55], s[30:31], 32
    s_load_dwordx2 s[52:53], s[0:1], 96
    s_load_dwordx2 s[98:99], s[0:1], 88
    v_lshrrev_b32 v96, 6, v0
    v_and_b32 v97, 63, v0
    v_lshlrev_b32 v104, 4, v0
    v_readfirstlane_b32 s28, v96
    s_getpc_b64 s[56:57]
    s_mov_b32 s58, 90112
    s_mov_b32 s59, 0x20000
    s_lshl_b32 s42, s4, 12
    buffer_load_dwordx4 a[0:3], v104, s[56:59], s42 offen
    s_and_b32 s7, s3, 3
    s_lshl_b32 s7, s7, 1
    s_and_b32 s6, s4, 1
    s_add_u32 s7, s7, s6
    s_lshr_b32 s6, s4, 1
    s_lshl_b32 s29, s28, 12
    s_lshl_b32 s39, s28, 10
    s_lshl_b32 s32, s7, 9
    v_lshrrev_b32 v98, 5, v97
    v_and_b32 v99, 31, v97
    v_lshrrev_b32 v105, 3, v97
    v_and_b32 v103, 7, v97
    v_bfe_u32 v106, v97, 4, 1
    v_lshl_add_u32 v107, v106, 1, v98
    v_xor_b32 v101, v107, v103
    v_lshlrev_b32 v101, 4, v101
    v_subrev_u32 v101, 0, v101
    v_add_u32 v100, 0, v105
    v_lshl_add_u32 v102, v100, 9, v101
    v_accvgpr_write_b32 a224, v102
    v_lshl_add_u32 v100, v96, 5, v100
    v_mul_u32_u24 v102, 896, v100
    v_add_u32 v4, v102, v101
    v_xor_b32 v101, v107, v103
    v_xor_b32 v101, 4, v101
    v_lshlrev_b32 v101, 4, v101
    v_subrev_u32 v101, 1024, v101
    v_add_u32 v100, 8, v105
    v_lshl_add_u32 v102, v100, 9, v101
    v_accvgpr_write_b32 a225, v102
    v_lshl_add_u32 v100, v96, 5, v100
    v_mul_u32_u24 v102, 896, v100
    v_add_u32 v5, v102, v101
    v_and_b32 v100, 1, v96
    v_lshlrev_b32 v108, 2, v100
    v_xor_b32 v101, v107, v103
    v_xor_b32 v101, v101, v108
    v_lshlrev_b32 v101, 4, v101
    v_lshl_add_u32 v100, v96, 3, v105
    v_add_u32 v100, 128, v100
    v_mul_u32_u24 v102, 896, v100
    v_add_u32 v6, v102, v101
    v_accvgpr_write_b32 a230, v6
    v_lshrrev_b32 v109, 1, v96
    v_add3_u32 v100, v108, v98, 0
    v_lshlrev_b32 v101, 1, v100
    v_xor_b32 v101, v101, v99
    v_lshlrev_b32 v101, 4, v101
    v_subrev_u32 v101, 0, v101
    v_lshl_add_u32 v102, v109, 4, v100
    v_lshl_add_u32 v102, v102, 9, v101
    v_accvgpr_write_b32 a226, v102
    v_lshl_add_u32 v102, v108, 2, v98
    v_lshl_add_u32 v102, v109, 3, v102
    v_add_u32 v102, 0, v102
    v_lshl_add_u32 v2, v102, 13, v101
    v_add3_u32 v100, v108, v98, 2
    v_lshlrev_b32 v101, 1, v100
    v_xor_b32 v101, v101, v99
    v_lshlrev_b32 v101, 4, v101
    v_subrev_u32 v101, 1024, v101
    v_lshl_add_u32 v102, v109, 4, v100
    v_lshl_add_u32 v102, v102, 9, v101
    v_accvgpr_write_b32 a227, v102
    v_lshl_add_u32 v102, v108, 2, v98
    v_lshl_add_u32 v102, v109, 3, v102
    v_add_u32 v102, 2, v102
    v_lshl_add_u32 v3, v102, 13, v101
    s_mul_i32 s35, s6, 143360
    s_mov_b32 s10, 143360
    s_mov_b32 s11, 0x20000
    s_mov_b32 s14, 3670016
    s_mov_b32 s15, 0x20000
    s_waitcnt lgkmcnt(0)
    s_add_u32 s8, s8, s35
    s_addc_u32 s9, s9, 0
    s_add_u32 m0, s29, 32768
    s_movk_i32 s34, 0
    buffer_load_dwordx4 v4, s[8:11], s34 offen offset:0 lds
    buffer_load_dwordx4 v5, s[8:11], s34 offen offset:1024 lds
    s_add_u32 s34, s34, 12288
    buffer_load_dwordx4 v4, s[8:11], s34 offen offset:2048 lds
    buffer_load_dwordx4 v5, s[8:11], s34 offen offset:3072 lds
    s_add_u32 m0, s39, 0
    s_movk_i32 s34, 0
    buffer_load_dwordx4 v6, s[8:11], s34 offen lds
    s_add_u32 m0, s29, 49152
    s_add_u32 s34, s32, 0
    buffer_load_dwordx4 v2, s[12:15], s34 offen offset:0 nt lds
    buffer_load_dwordx4 v3, s[12:15], s34 offen offset:1024 nt lds
    s_add_u32 s34, s34, 30720
    buffer_load_dwordx4 v2, s[12:15], s34 offen offset:2048 nt lds
    buffer_load_dwordx4 v3, s[12:15], s34 offen offset:3072 nt lds
    s_add_u32 m0, s29, 65536
    s_add_u32 s34, s32, 262144
    buffer_load_dwordx4 v2, s[12:15], s34 offen offset:0 nt lds
    buffer_load_dwordx4 v3, s[12:15], s34 offen offset:1024 nt lds
    s_add_u32 s34, s34, 30720
    buffer_load_dwordx4 v2, s[12:15], s34 offen offset:2048 nt lds
    buffer_load_dwordx4 v3, s[12:15], s34 offen offset:3072 nt lds
    s_add_u32 m0, s29, 81920
    s_movk_i32 s34, 128
    buffer_load_dwordx4 v4, s[8:11], s34 offen offset:0 lds
    buffer_load_dwordx4 v5, s[8:11], s34 offen offset:1024 lds
    s_add_u32 s34, s34, 12288
    buffer_load_dwordx4 v4, s[8:11], s34 offen offset:2048 lds
    buffer_load_dwordx4 v5, s[8:11], s34 offen offset:3072 lds
    s_add_u32 m0, s39, 4096
    s_movk_i32 s34, 128
    buffer_load_dwordx4 v6, s[8:11], s34 offen lds
    s_add_u32 m0, s29, 98304
    s_add_u32 s34, s32, 524288
    buffer_load_dwordx4 v2, s[12:15], s34 offen offset:0 nt lds
    buffer_load_dwordx4 v3, s[12:15], s34 offen offset:1024 nt lds
    s_add_u32 s34, s34, 30720
    buffer_load_dwordx4 v2, s[12:15], s34 offen offset:2048 nt lds
    buffer_load_dwordx4 v3, s[12:15], s34 offen offset:3072 nt lds
    s_add_u32 m0, s29, 114688
    s_add_u32 s34, s32, 786432
    buffer_load_dwordx4 v2, s[12:15], s34 offen offset:0 nt lds
    buffer_load_dwordx4 v3, s[12:15], s34 offen offset:1024 nt lds
    s_add_u32 s34, s34, 30720
    buffer_load_dwordx4 v2, s[12:15], s34 offen offset:2048 nt lds
    buffer_load_dwordx4 v3, s[12:15], s34 offen offset:3072 nt lds
    s_lshl_b32 s33, s6, 4
    s_add_u32 s33, s33, s7
    s_lshl_b32 s33, s33, 18
    s_lshl_b32 s26, s28, 14
    s_add_u32 s26, s26, s33
    s_mov_b32 s18, 0x4000000
    s_mov_b32 s19, 0x20000
    s_mov_b32 s22, 0x4000000
    s_mov_b32 s23, 0x20000
    s_add_u32 s42, s42, s39
    s_add_u32 s40, s29, 32768
    s_add_u32 s41, s29, 98304
    s_lshl_b32 s44, s28, 7
    s_lshl_b32 s45, s28, 11
    s_lshl_b32 s46, s28, 2
    s_mov_b32 s36, 0x3db8aa3b
    s_mov_b32 s38, 0
    s_mov_b32 s24, -1
    s_mov_b32 s25, 0
    v_lshlrev_b32 v16, 4, v97
    v_and_b32 v100, 15, v97
    v_bfe_u32 v101, v100, 1, 1
    v_bfe_u32 v102, v100, 2, 1
    v_lshl_add_u32 v101, v101, 1, v102
    v_bfe_u32 v102, v100, 3, 1
    v_lshl_add_u32 v101, v102, 2, v101
    v_xor_b32 v101, v101, v107
    v_lshlrev_b32 v101, 4, v101
    v_lshl_add_u32 v7, v100, 7, v101
    v_lshrrev_b32 v101, 2, v100
    v_and_b32 v102, 3, v100
    v_lshl_add_u32 v110, v106, 2, v101
    v_lshlrev_b32 v110, 5, v110
    v_lshl_add_u32 v110, v102, 3, v110
    v_lshl_add_u32 v111, v106, 3, v101
    v_lshl_add_u32 v102, v98, 2, v111
    v_lshl_add_u32 v102, v102, 9, v110
    s_lshl_b32 s35, s28, 6
    v_xor_b32 v102, s35, v102
    v_accvgpr_write_b32 a229, v102
    v_lshl_add_u32 v102, v98, 4, v111
    v_lshl_add_u32 v102, v102, 9, v110
    v_accvgpr_write_b32 a228, v102
    v_lshlrev_b32 v100, 3, v104
    v_and_b32 v100, 0x3fff, v100
    v_cmp_gt_u32 vcc, 14336, v100
    v_lshrrev_b32 v101, 11, v104
    v_mul_u32_u24 v101, 1835008, v101
    s_mul_i32 s47, s6, 14336
    s_mul_i32 s35, s7, 229376
    s_add_u32 s47, s47, s35
    v_add3_u32 v100, v100, v101, s47
    v_mov_b32 v101, 0x7ffffff0
    v_cndmask_b32 v100, v101, v100, vcc
    v_accvgpr_write_b32 a231, v100
    v_lshrrev_b32 v100, 6, v104
    v_lshlrev_b32 v100, 17, v100
    v_and_b32 v101, 48, v104
    v_lshl_add_u32 v100, v101, 3, v100
    s_lshl_b32 s35, s6, 13
    v_add_u32 v100, s35, v100
    v_accvgpr_write_b32 a232, v100
    s_lshl_b32 s100, s5, 4
    s_add_u32 s100, s100, s6
    s_lshl_b32 s100, s100, 2
    s_mov_b32 s92, s98
    s_mov_b32 s93, s99
    s_mov_b32 s94, 128
    s_mov_b32 s95, 0x20000
    s_lshl_b32 s35, s100, 6
    s_add_u32 s35, s35, 37748736
    s_add_u32 s98, s52, s35
    s_addc_u32 s99, s53, 0
    v_mov_b32 v100, 0
    v_mov_b32 v101, 0
    v_mov_b32 v102, 0
    v_mov_b32 v103, 0
    s_add_u32 s35, s7, s28
    s_cmp_lg_u32 s35, 0
    s_cbranch_scc1 L_nozero
    s_mov_b64 exec, 1
    global_store_dwordx4 v100, v[100:103], s[98:99] sc1
    s_mov_b64 exec, -1
L_nozero:
    s_mov_b64 exec, 0
    s_cmp_eq_u32 s28, 0
    s_cbranch_scc1 A_stub0
    s_cmp_eq_u32 s28, 1
    s_cbranch_scc1 A_stub1
    s_cmp_eq_u32 s28, 2
    s_cbranch_scc1 A_stub2
    s_branch A_stub3
A_back:
    s_mov_b64 exec, -1
    v_accvgpr_read_b32 v8, a228
    v_add_u32 v8, 32768, v8
    v_xor_b32 v9, 32, v8
    v_xor_b32 v10, 64, v8
    v_xor_b32 v11, 96, v8
    v_xor_b32 v12, 128, v8
    v_xor_b32 v13, 160, v8
    v_xor_b32 v14, 192, v8
    v_add_u32 v17, s40, v7
    v_xor_b32 v15, 224, v8
    s_waitcnt vmcnt(17)
    s_barrier
    ds_read_b128 v[32:35], v17 offset:0
    ds_read_b128 v[36:39], v17 offset:2048
    ds_read_b64_tr_b16 a[160:161], v8 offset:16384
    s_add_u32 m0, s29, 131072
    ds_read_b64_tr_b16 a[162:163], v8 offset:18432
    s_movk_i32 s34, 256
    ds_read_b64_tr_b16 a[164:165], v9 offset:16384
    buffer_load_dwordx4 v4, s[8:11], s34 offen offset:0 lds
    ds_read_b64_tr_b16 a[166:167], v9 offset:18432
    ds_read_b64_tr_b16 a[168:169], v10 offset:16384
    ds_read_b64_tr_b16 a[170:171], v10 offset:18432
    ds_read_b64_tr_b16 a[172:173], v11 offset:16384
    ds_read_b64_tr_b16 a[174:175], v11 offset:18432
    ds_read_b64_tr_b16 a[176:177], v12 offset:16384
    ds_read_b64_tr_b16 a[178:179], v12 offset:18432
    ds_read_b64_tr_b16 a[180:181], v13 offset:16384
    buffer_load_dwordx4 v5, s[8:11], s34 offen offset:1024 lds
    ds_read_b64_tr_b16 a[182:183], v13 offset:18432
    s_waitcnt lgkmcnt(10)
    v_mfma_f32_16x16x32_bf16 v[96:99], a[160:163], v[32:35], 0
    ds_read_b64_tr_b16 a[184:185], v14 offset:16384
    v_mfma_f32_16x16x32_bf16 v[104:107], a[160:163], v[36:39], 0
    s_waitcnt lgkmcnt(9)
    ds_read_b64_tr_b16 a[186:187], v14 offset:18432
    ds_read_b128 v[48:51], v7 offset:0
    v_mfma_f32_16x16x32_bf16 v[100:103], a[164:167], v[32:35], 0
    ds_read_b64_tr_b16 a[188:189], v15 offset:16384
    v_mfma_f32_16x16x32_bf16 v[108:111], a[164:167], v[36:39], 0
    s_waitcnt lgkmcnt(8)
    ds_read_b64_tr_b16 a[190:191], v15 offset:18432
    v_xor_b32 v26, s44, v8
    v_mfma_f32_16x16x32_bf16 v[112:115], a[168:171], v[32:35], 0
    ds_read_b64_tr_b16 a[160:161], v26 offset:16384
    ds_read_b128 v[52:55], v7 offset:2048
    v_mfma_f32_16x16x32_bf16 v[120:123], a[168:171], v[36:39], 0
    ds_read_b64_tr_b16 a[162:163], v26 offset:18432
    v_xor_b32 v27, s44, v9
    v_mfma_f32_16x16x32_bf16 v[116:119], a[172:175], v[32:35], 0
    s_add_u32 s34, s34, 12288
    ds_read_b64_tr_b16 a[164:165], v27 offset:16384
    buffer_load_dwordx4 v4, s[8:11], s34 offen offset:2048 lds
    v_mfma_f32_16x16x32_bf16 v[124:127], a[172:175], v[36:39], 0
    s_waitcnt lgkmcnt(9)
    ds_read_b64_tr_b16 a[166:167], v27 offset:18432
    v_xor_b32 v26, s44, v10
    v_xor_b32 v17, 64, v17
    v_mfma_f32_16x16x32_bf16 v[128:131], a[176:179], v[32:35], 0
    ds_read_b64_tr_b16 a[168:169], v26 offset:16384
    v_mfma_f32_16x16x32_bf16 v[136:139], a[176:179], v[36:39], 0
    ds_read_b64_tr_b16 a[170:171], v26 offset:18432
    v_xor_b32 v27, s44, v11
    v_mfma_f32_16x16x32_bf16 v[132:135], a[180:183], v[32:35], 0
    ds_read_b64_tr_b16 a[172:173], v27 offset:16384
    ds_read_b128 v[40:43], v17 offset:0
    v_mfma_f32_16x16x32_bf16 v[140:143], a[180:183], v[36:39], 0
    s_waitcnt lgkmcnt(9)
    ds_read_b64_tr_b16 a[174:175], v27 offset:18432
    v_mfma_f32_16x16x32_bf16 v[144:147], a[184:187], v[32:35], 0
    ds_read_b64_tr_b16 a[176:177], v8 offset:16640
    v_mfma_f32_16x16x32_bf16 v[152:155], a[184:187], v[36:39], 0
    ds_read_b64_tr_b16 a[178:179], v8 offset:18688
    ds_read_b128 v[44:47], v17 offset:2048
    v_mfma_f32_16x16x32_bf16 v[148:151], a[188:191], v[32:35], 0
    ds_read_b64_tr_b16 a[180:181], v9 offset:16640
    buffer_load_dwordx4 v5, s[8:11], s34 offen offset:3072 lds
    v_mfma_f32_16x16x32_bf16 v[156:159], a[188:191], v[36:39], 0
    s_waitcnt lgkmcnt(9)
    ds_read_b64_tr_b16 a[182:183], v9 offset:18688
    v_mfma_f32_16x16x32_bf16 v[224:227], a[160:163], v[48:51], 0
    ds_read_b64_tr_b16 a[184:185], v10 offset:16640
    v_xor_b32 v17, 64, v7
    v_mfma_f32_16x16x32_bf16 v[232:235], a[160:163], v[52:55], 0
    ds_read_b64_tr_b16 a[186:187], v10 offset:18688
    v_mfma_f32_16x16x32_bf16 v[228:231], a[164:167], v[48:51], 0
    ds_read_b64_tr_b16 a[188:189], v11 offset:16640
    v_mfma_f32_16x16x32_bf16 v[236:239], a[164:167], v[52:55], 0
    s_waitcnt lgkmcnt(8)
    ds_read_b64_tr_b16 a[190:191], v11 offset:18688
    ds_read_b128 v[56:59], v17 offset:0
    v_mfma_f32_16x16x32_bf16 v[240:243], a[168:171], v[48:51], 0
    ds_read_b64_tr_b16 a[160:161], v12 offset:16640
    v_mfma_f32_16x16x32_bf16 v[248:251], a[168:171], v[52:55], 0
    s_add_u32 m0, s39, 8192
    ds_read_b64_tr_b16 a[162:163], v12 offset:18688
    v_mfma_f32_16x16x32_bf16 v[244:247], a[172:175], v[48:51], 0
    s_movk_i32 s34, 256
    ds_read_b64_tr_b16 a[164:165], v13 offset:16640
    buffer_load_dwordx4 v6, s[8:11], s34 offen lds
    ds_read_b128 v[60:63], v17 offset:2048
    v_mfma_f32_16x16x32_bf16 v[252:255], a[172:175], v[52:55], 0
    s_waitcnt lgkmcnt(9)
    ds_read_b64_tr_b16 a[166:167], v13 offset:18688
    v_mfma_f32_16x16x32_bf16 v[160:163], a[176:179], v[32:35], 0
    ds_read_b64_tr_b16 a[168:169], v14 offset:16640
    v_mfma_f32_16x16x32_bf16 v[168:171], a[176:179], v[36:39], 0
    ds_read_b64_tr_b16 a[170:171], v14 offset:18688
    v_mfma_f32_16x16x32_bf16 v[164:167], a[180:183], v[32:35], 0
    ds_read_b64_tr_b16 a[172:173], v15 offset:16640
    v_mfma_f32_16x16x32_bf16 v[172:175], a[180:183], v[36:39], 0
    s_waitcnt lgkmcnt(9)
    ds_read_b64_tr_b16 a[174:175], v15 offset:18688
    v_mfma_f32_16x16x32_bf16 v[176:179], a[184:187], v[32:35], 0
    s_waitcnt vmcnt(18)
    s_barrier
    ds_read_b64_tr_b16 a[176:177], v8 offset:32768
    v_mfma_f32_16x16x32_bf16 v[184:187], a[184:187], v[36:39], 0
    s_add_u32 m0, s29, 147456
    ds_read_b64_tr_b16 a[178:179], v8 offset:34816
    v_mfma_f32_16x16x32_bf16 v[180:183], a[188:191], v[32:35], 0
    s_add_u32 s34, s32, 1048576
    ds_read_b64_tr_b16 a[180:181], v9 offset:32768
    buffer_load_dwordx4 v2, s[12:15], s34 offen offset:0 nt lds
    v_mfma_f32_16x16x32_bf16 v[188:191], a[188:191], v[36:39], 0
    s_waitcnt lgkmcnt(7)
    ds_read_b64_tr_b16 a[182:183], v9 offset:34816
    v_mfma_f32_16x16x32_bf16 v[192:195], a[160:163], v[32:35], 0
    ds_read_b64_tr_b16 a[184:185], v10 offset:32768
    v_mfma_f32_16x16x32_bf16 v[200:203], a[160:163], v[36:39], 0
    ds_read_b64_tr_b16 a[186:187], v10 offset:34816
    v_mfma_f32_16x16x32_bf16 v[196:199], a[164:167], v[32:35], 0
    ds_read_b64_tr_b16 a[188:189], v11 offset:32768
    v_mfma_f32_16x16x32_bf16 v[204:207], a[164:167], v[36:39], 0
    s_waitcnt lgkmcnt(7)
    ds_read_b64_tr_b16 a[190:191], v11 offset:34816
    buffer_load_dwordx4 v3, s[12:15], s34 offen offset:1024 nt lds
    v_accvgpr_read_b32 v0, a224
    v_accvgpr_read_b32 v1, a225
    v_mfma_f32_16x16x32_bf16 v[208:211], a[168:171], v[32:35], 0
    s_add_u32 s51, s26, 0
    ds_read_b64_tr_b16 a[160:161], v12 offset:32768
    buffer_load_dwordx4 v[80:83], v0, s[16:19], s51 offen offset:0 nt
    v_mfma_f32_16x16x32_bf16 v[216:219], a[168:171], v[36:39], 0
    ds_read_b64_tr_b16 a[162:163], v12 offset:34816
    v_mfma_f32_16x16x32_bf16 v[212:215], a[172:175], v[32:35], 0
    ds_read_b64_tr_b16 a[164:165], v13 offset:32768
    v_mfma_f32_16x16x32_bf16 v[220:223], a[172:175], v[36:39], 0
    s_waitcnt lgkmcnt(7)
    ds_read_b64_tr_b16 a[166:167], v13 offset:34816
    v_mfma_f32_16x16x32_bf16 v[96:99], a[176:179], v[40:43], v[96:99]
    s_add_u32 s34, s34, 30720
    ds_read_b64_tr_b16 a[168:169], v14 offset:32768
    buffer_load_dwordx4 v2, s[12:15], s34 offen offset:2048 nt lds
    buffer_load_dwordx4 v[84:87], v1, s[16:19], s51 offen offset:1024 nt
    v_mfma_f32_16x16x32_bf16 v[104:107], a[176:179], v[44:47], v[104:107]
    ds_read_b64_tr_b16 a[170:171], v14 offset:34816
    v_mfma_f32_16x16x32_bf16 v[100:103], a[180:183], v[40:43], v[100:103]
    ds_read_b64_tr_b16 a[172:173], v15 offset:32768
    v_mfma_f32_16x16x32_bf16 v[108:111], a[180:183], v[44:47], v[108:111]
    s_waitcnt lgkmcnt(7)
    ds_read_b64_tr_b16 a[174:175], v15 offset:34816
    v_xor_b32 v26, s44, v8
    v_mfma_f32_16x16x32_bf16 v[112:115], a[184:187], v[40:43], v[112:115]
    s_add_u32 s51, s51, 6144
    ds_read_b64_tr_b16 a[176:177], v26 offset:32768
    buffer_load_dwordx4 v[88:91], v0, s[16:19], s51 offen offset:2048 nt
    v_mfma_f32_16x16x32_bf16 v[120:123], a[184:187], v[44:47], v[120:123]
    ds_read_b64_tr_b16 a[178:179], v26 offset:34816
    buffer_load_dwordx4 v3, s[12:15], s34 offen offset:3072 nt lds
    v_xor_b32 v27, s44, v9
    v_mfma_f32_16x16x32_bf16 v[116:119], a[188:191], v[40:43], v[116:119]
    ds_read_b64_tr_b16 a[180:181], v27 offset:32768
    v_mfma_f32_16x16x32_bf16 v[124:127], a[188:191], v[44:47], v[124:127]
    s_waitcnt lgkmcnt(7)
    ds_read_b64_tr_b16 a[182:183], v27 offset:34816
    v_xor_b32 v26, s44, v10
    v_mfma_f32_16x16x32_bf16 v[128:131], a[160:163], v[40:43], v[128:131]
    ds_read_b64_tr_b16 a[184:185], v26 offset:32768
    buffer_load_dwordx4 v[92:95], v1, s[16:19], s51 offen offset:3072 nt
    v_mfma_f32_16x16x32_bf16 v[136:139], a[160:163], v[44:47], v[136:139]
    s_add_u32 m0, s29, 32768
    ds_read_b64_tr_b16 a[186:187], v26 offset:34816
    v_xor_b32 v27, s44, v11
    v_mfma_f32_16x16x32_bf16 v[132:135], a[164:167], v[40:43], v[132:135]
    s_add_u32 s34, s32, 1310720
    ds_read_b64_tr_b16 a[188:189], v27 offset:32768
    buffer_load_dwordx4 v2, s[12:15], s34 offen offset:0 nt lds
    v_mfma_f32_16x16x32_bf16 v[140:143], a[164:167], v[44:47], v[140:143]
    s_waitcnt lgkmcnt(7)
    ds_read_b64_tr_b16 a[190:191], v27 offset:34816
    v_mfma_f32_16x16x32_bf16 v[144:147], a[168:171], v[40:43], v[144:147]
    ds_read_b64_tr_b16 a[160:161], v8 offset:33024
    v_mfma_f32_16x16x32_bf16 v[152:155], a[168:171], v[44:47], v[152:155]
    ds_read_b64_tr_b16 a[162:163], v8 offset:35072
    v_xor_b32 v8, 0x10000, v8
    v_mfma_f32_16x16x32_bf16 v[148:151], a[172:175], v[40:43], v[148:151]
    ds_read_b64_tr_b16 a[164:165], v9 offset:33024
    v_mfma_f32_16x16x32_bf16 v[156:159], a[172:175], v[44:47], v[156:159]
    s_waitcnt lgkmcnt(7)
    ds_read_b64_tr_b16 a[166:167], v9 offset:35072
    buffer_load_dwordx4 v3, s[12:15], s34 offen offset:1024 nt lds
    v_xor_b32 v9, 0x10000, v9
    v_mfma_f32_16x16x32_bf16 v[224:227], a[176:179], v[56:59], v[224:227]
    ds_read_b64_tr_b16 a[168:169], v10 offset:33024
    v_mfma_f32_16x16x32_bf16 v[232:235], a[176:179], v[60:63], v[232:235]
    ds_read_b64_tr_b16 a[170:171], v10 offset:35072
    v_xor_b32 v10, 0x10000, v10
    v_mfma_f32_16x16x32_bf16 v[228:231], a[180:183], v[56:59], v[228:231]
    ds_read_b64_tr_b16 a[172:173], v11 offset:33024
    v_mfma_f32_16x16x32_bf16 v[236:239], a[180:183], v[60:63], v[236:239]
    s_waitcnt lgkmcnt(7)
    ds_read_b64_tr_b16 a[174:175], v11 offset:35072
    v_xor_b32 v11, 0x10000, v11
    v_mfma_f32_16x16x32_bf16 v[240:243], a[184:187], v[56:59], v[240:243]
    s_add_u32 s34, s34, 30720
    ds_read_b64_tr_b16 a[176:177], v12 offset:33024
    buffer_load_dwordx4 v2, s[12:15], s34 offen offset:2048 nt lds
    v_mfma_f32_16x16x32_bf16 v[248:251], a[184:187], v[60:63], v[248:251]
    ds_read_b64_tr_b16 a[178:179], v12 offset:35072
    v_xor_b32 v12, 0x10000, v12
    v_mfma_f32_16x16x32_bf16 v[244:247], a[188:191], v[56:59], v[244:247]
    ds_read_b64_tr_b16 a[180:181], v13 offset:33024
    v_mfma_f32_16x16x32_bf16 v[252:255], a[188:191], v[60:63], v[252:255]
    s_waitcnt lgkmcnt(7)
    ds_read_b64_tr_b16 a[182:183], v13 offset:35072
    v_xor_b32 v13, 0x10000, v13
    v_mfma_f32_16x16x32_bf16 v[160:163], a[160:163], v[40:43], v[160:163]
    ds_read_b64_tr_b16 a[184:185], v14 offset:33024
    v_mfma_f32_16x16x32_bf16 v[168:171], a[160:163], v[44:47], v[168:171]
    ds_read_b64_tr_b16 a[186:187], v14 offset:35072
    buffer_load_dwordx4 v3, s[12:15], s34 offen offset:3072 nt lds
    v_xor_b32 v14, 0x10000, v14
    v_mfma_f32_16x16x32_bf16 v[164:167], a[164:167], v[40:43], v[164:167]
    ds_read_b64_tr_b16 a[188:189], v15 offset:33024
    v_add_u32 v17, s40, v7
    v_mfma_f32_16x16x32_bf16 v[172:175], a[164:167], v[44:47], v[172:175]
    s_waitcnt lgkmcnt(7)
    ds_read_b64_tr_b16 a[190:191], v15 offset:35072
    v_xor_b32 v15, 0x10000, v15
    v_mfma_f32_16x16x32_bf16 v[176:179], a[168:171], v[40:43], v[176:179]
    s_waitcnt vmcnt(21)
    s_barrier
    ds_read_b128 v[32:35], v17 offset:49152
    ds_read_b128 v[36:39], v17 offset:51200
    ds_read_b64_tr_b16 a[160:161], v8 offset:0
    v_mfma_f32_16x16x32_bf16 v[184:187], a[168:171], v[44:47], v[184:187]
    s_add_u32 m0, s29, 49152
    ds_read_b64_tr_b16 a[162:163], v8 offset:2048
    v_mfma_f32_16x16x32_bf16 v[180:183], a[172:175], v[40:43], v[180:183]
    s_movk_i32 s34, 384
    ds_read_b64_tr_b16 a[164:165], v9 offset:0
    buffer_load_dwordx4 v4, s[8:11], s34 offen offset:0 lds
    v_mfma_f32_16x16x32_bf16 v[188:191], a[172:175], v[44:47], v[188:191]
    s_waitcnt lgkmcnt(9)
    ds_read_b64_tr_b16 a[166:167], v9 offset:2048
    v_mfma_f32_16x16x32_bf16 v[192:195], a[176:179], v[40:43], v[192:195]
    ds_read_b64_tr_b16 a[168:169], v10 offset:0
    v_mfma_f32_16x16x32_bf16 v[200:203], a[176:179], v[44:47], v[200:203]
    ds_read_b64_tr_b16 a[170:171], v10 offset:2048
    v_mfma_f32_16x16x32_bf16 v[196:199], a[180:183], v[40:43], v[196:199]
    ds_read_b64_tr_b16 a[172:173], v11 offset:0
    v_mfma_f32_16x16x32_bf16 v[204:207], a[180:183], v[44:47], v[204:207]
    s_waitcnt lgkmcnt(9)
    ds_read_b64_tr_b16 a[174:175], v11 offset:2048
    v_mfma_f32_16x16x32_bf16 v[208:211], a[184:187], v[40:43], v[208:211]
    ds_read_b64_tr_b16 a[176:177], v12 offset:0
    v_mfma_f32_16x16x32_bf16 v[216:219], a[184:187], v[44:47], v[216:219]
    ds_read_b64_tr_b16 a[178:179], v12 offset:2048
    v_mfma_f32_16x16x32_bf16 v[212:215], a[188:191], v[40:43], v[212:215]
    ds_read_b64_tr_b16 a[180:181], v13 offset:0
    buffer_load_dwordx4 v5, s[8:11], s34 offen offset:1024 lds
    v_mfma_f32_16x16x32_bf16 v[220:223], a[188:191], v[44:47], v[220:223]
    s_waitcnt lgkmcnt(7)
    ds_read_b64_tr_b16 a[182:183], v13 offset:2048
    v_mfma_f32_16x16x32_bf16 v[96:99], a[160:163], v[32:35], v[96:99]
    ds_read_b64_tr_b16 a[184:185], v14 offset:0
    v_mfma_f32_16x16x32_bf16 v[104:107], a[160:163], v[36:39], v[104:107]
    ds_read_b64_tr_b16 a[186:187], v14 offset:2048
    ds_read_b128 v[48:51], v7 offset:4096
    v_mfma_f32_16x16x32_bf16 v[100:103], a[164:167], v[32:35], v[100:103]
    ds_read_b64_tr_b16 a[188:189], v15 offset:0
    v_mfma_f32_16x16x32_bf16 v[108:111], a[164:167], v[36:39], v[108:111]
    s_waitcnt lgkmcnt(8)
    ds_read_b64_tr_b16 a[190:191], v15 offset:2048
    v_xor_b32 v26, s44, v8
    v_mfma_f32_16x16x32_bf16 v[112:115], a[168:171], v[32:35], v[112:115]
    ds_read_b64_tr_b16 a[160:161], v26 offset:0
    ds_read_b128 v[52:55], v7 offset:6144
    v_mfma_f32_16x16x32_bf16 v[120:123], a[168:171], v[36:39], v[120:123]
    ds_read_b64_tr_b16 a[162:163], v26 offset:2048
    v_xor_b32 v27, s44, v9
    v_mfma_f32_16x16x32_bf16 v[116:119], a[172:175], v[32:35], v[116:119]
    s_add_u32 s34, s34, 12288
    ds_read_b64_tr_b16 a[164:165], v27 offset:0
    buffer_load_dwordx4 v4, s[8:11], s34 offen offset:2048 lds
    v_mfma_f32_16x16x32_bf16 v[124:127], a[172:175], v[36:39], v[124:127]
    s_waitcnt lgkmcnt(9)
    ds_read_b64_tr_b16 a[166:167], v27 offset:2048
    v_xor_b32 v26, s44, v10
    v_xor_b32 v17, 64, v17
    v_mfma_f32_16x16x32_bf16 v[128:131], a[176:179], v[32:35], v[128:131]
    ds_read_b64_tr_b16 a[168:169], v26 offset:0
    v_mfma_f32_16x16x32_bf16 v[136:139], a[176:179], v[36:39], v[136:139]
    ds_read_b64_tr_b16 a[170:171], v26 offset:2048
    v_xor_b32 v27, s44, v11
    v_mfma_f32_16x16x32_bf16 v[132:135], a[180:183], v[32:35], v[132:135]
    ds_read_b64_tr_b16 a[172:173], v27 offset:0
    ds_read_b128 v[40:43], v17 offset:49152
    v_mfma_f32_16x16x32_bf16 v[140:143], a[180:183], v[36:39], v[140:143]
    s_waitcnt lgkmcnt(9)
    ds_read_b64_tr_b16 a[174:175], v27 offset:2048
    v_mfma_f32_16x16x32_bf16 v[144:147], a[184:187], v[32:35], v[144:147]
    ds_read_b64_tr_b16 a[176:177], v8 offset:256
    v_mfma_f32_16x16x32_bf16 v[152:155], a[184:187], v[36:39], v[152:155]
    ds_read_b64_tr_b16 a[178:179], v8 offset:2304
    ds_read_b128 v[44:47], v17 offset:51200
    v_mfma_f32_16x16x32_bf16 v[148:151], a[188:191], v[32:35], v[148:151]
    ds_read_b64_tr_b16 a[180:181], v9 offset:256
    buffer_load_dwordx4 v5, s[8:11], s34 offen offset:3072 lds
    v_mfma_f32_16x16x32_bf16 v[156:159], a[188:191], v[36:39], v[156:159]
    s_waitcnt lgkmcnt(9)
    ds_read_b64_tr_b16 a[182:183], v9 offset:2304
    v_mfma_f32_16x16x32_bf16 v[224:227], a[160:163], v[48:51], v[224:227]
    ds_read_b64_tr_b16 a[184:185], v10 offset:256
    v_xor_b32 v17, 64, v7
    v_mfma_f32_16x16x32_bf16 v[232:235], a[160:163], v[52:55], v[232:235]
    ds_read_b64_tr_b16 a[186:187], v10 offset:2304
    v_mfma_f32_16x16x32_bf16 v[228:231], a[164:167], v[48:51], v[228:231]
    ds_read_b64_tr_b16 a[188:189], v11 offset:256
    v_mfma_f32_16x16x32_bf16 v[236:239], a[164:167], v[52:55], v[236:239]
    s_waitcnt lgkmcnt(8)
    ds_read_b64_tr_b16 a[190:191], v11 offset:2304
    ds_read_b128 v[56:59], v17 offset:4096
    v_mfma_f32_16x16x32_bf16 v[240:243], a[168:171], v[48:51], v[240:243]
    ds_read_b64_tr_b16 a[160:161], v12 offset:256
    v_mfma_f32_16x16x32_bf16 v[248:251], a[168:171], v[52:55], v[248:251]
    s_add_u32 m0, s39, 12288
    ds_read_b64_tr_b16 a[162:163], v12 offset:2304
    v_mfma_f32_16x16x32_bf16 v[244:247], a[172:175], v[48:51], v[244:247]
    s_movk_i32 s34, 384
    ds_read_b64_tr_b16 a[164:165], v13 offset:256
    buffer_load_dwordx4 v6, s[8:11], s34 offen lds
    ds_read_b128 v[60:63], v17 offset:6144
    v_mfma_f32_16x16x32_bf16 v[252:255], a[172:175], v[52:55], v[252:255]
    s_waitcnt lgkmcnt(9)
    ds_read_b64_tr_b16 a[166:167], v13 offset:2304
    v_mfma_f32_16x16x32_bf16 v[160:163], a[176:179], v[32:35], v[160:163]
    s_add_u32 s51, s26, 128
    ds_read_b64_tr_b16 a[168:169], v14 offset:256
    buffer_load_dwordx4 a[0:3], v0, s[16:19], s51 offen offset:0 nt
    v_mfma_f32_16x16x32_bf16 v[168:171], a[176:179], v[36:39], v[168:171]
    ds_read_b64_tr_b16 a[170:171], v14 offset:2304
    v_mfma_f32_16x16x32_bf16 v[164:167], a[180:183], v[32:35], v[164:167]
    ds_read_b64_tr_b16 a[172:173], v15 offset:256
    v_mfma_f32_16x16x32_bf16 v[172:175], a[180:183], v[36:39], v[172:175]
    s_waitcnt lgkmcnt(9)
    ds_read_b64_tr_b16 a[174:175], v15 offset:2304
    v_mfma_f32_16x16x32_bf16 v[176:179], a[184:187], v[32:35], v[176:179]
    s_waitcnt vmcnt(23)
    s_barrier
A_stub0:
    s_cbranch_execz A_stub4
    ds_read_b64_tr_b16 a[176:177], v8 offset:16384
    buffer_load_dwordx4 a[4:7], v1, s[16:19], s51 offen offset:1024 nt
    v_mfma_f32_16x16x32_bf16 v[184:187], a[184:187], v[36:39], v[184:187]
    s_add_u32 m0, s29, 65536
    ds_read_b64_tr_b16 a[178:179], v8 offset:18432
    v_mfma_f32_16x16x32_bf16 v[180:183], a[188:191], v[32:35], v[180:183]
    s_add_u32 s34, s32, 1572864
    ds_read_b64_tr_b16 a[180:181], v9 offset:16384
    buffer_load_dwordx4 v2, s[12:15], s34 offen offset:0 nt lds
    v_mfma_f32_16x16x32_bf16 v[188:191], a[188:191], v[36:39], v[188:191]
    s_waitcnt lgkmcnt(7)
    ds_read_b64_tr_b16 a[182:183], v9 offset:18432
    v_mfma_f32_16x16x32_bf16 v[192:195], a[160:163], v[32:35], v[192:195]
    s_add_u32 s51, s51, 6144
    ds_read_b64_tr_b16 a[184:185], v10 offset:16384
    buffer_load_dwordx4 a[8:11], v0, s[16:19], s51 offen offset:2048 nt
    v_mfma_f32_16x16x32_bf16 v[200:203], a[160:163], v[36:39], v[200:203]
    ds_read_b64_tr_b16 a[186:187], v10 offset:18432
    v_mfma_f32_16x16x32_bf16 v[196:199], a[164:167], v[32:35], v[196:199]
    ds_read_b64_tr_b16 a[188:189], v11 offset:16384
    v_mfma_f32_16x16x32_bf16 v[204:207], a[164:167], v[36:39], v[204:207]
    s_waitcnt lgkmcnt(7)
    ds_read_b64_tr_b16 a[190:191], v11 offset:18432
    buffer_load_dwordx4 v3, s[12:15], s34 offen offset:1024 nt lds
    v_mfma_f32_16x16x32_bf16 v[208:211], a[168:171], v[32:35], v[208:211]
    ds_read_b64_tr_b16 a[160:161], v12 offset:16384
    buffer_load_dwordx4 a[12:15], v1, s[16:19], s51 offen offset:3072 nt
    v_mfma_f32_16x16x32_bf16 v[216:219], a[168:171], v[36:39], v[216:219]
    ds_read_b64_tr_b16 a[162:163], v12 offset:18432
    v_mfma_f32_16x16x32_bf16 v[212:215], a[172:175], v[32:35], v[212:215]
    ds_read_b64_tr_b16 a[164:165], v13 offset:16384
    v_mfma_f32_16x16x32_bf16 v[220:223], a[172:175], v[36:39], v[220:223]
    s_waitcnt lgkmcnt(7)
    ds_read_b64_tr_b16 a[166:167], v13 offset:18432
    v_mfma_f32_16x16x32_bf16 v[96:99], a[176:179], v[40:43], v[96:99]
    s_add_u32 s34, s34, 30720
    ds_read_b64_tr_b16 a[168:169], v14 offset:16384
    buffer_load_dwordx4 v2, s[12:15], s34 offen offset:2048 nt lds
    v_mfma_f32_16x16x32_bf16 v[104:107], a[176:179], v[44:47], v[104:107]
    ds_read_b64_tr_b16 a[170:171], v14 offset:18432
    v_mfma_f32_16x16x32_bf16 v[100:103], a[180:183], v[40:43], v[100:103]
    ds_read_b64_tr_b16 a[172:173], v15 offset:16384
    v_mfma_f32_16x16x32_bf16 v[108:111], a[180:183], v[44:47], v[108:111]
    s_waitcnt lgkmcnt(7)
    ds_read_b64_tr_b16 a[174:175], v15 offset:18432
    v_xor_b32 v26, s44, v8
    v_mfma_f32_16x16x32_bf16 v[112:115], a[184:187], v[40:43], v[112:115]
    ds_read_b64_tr_b16 a[176:177], v26 offset:16384
    v_mfma_f32_16x16x32_bf16 v[120:123], a[184:187], v[44:47], v[120:123]
    ds_read_b64_tr_b16 a[178:179], v26 offset:18432
    buffer_load_dwordx4 v3, s[12:15], s34 offen offset:3072 nt lds
    v_xor_b32 v27, s44, v9
    v_mfma_f32_16x16x32_bf16 v[116:119], a[188:191], v[40:43], v[116:119]
    ds_read_b64_tr_b16 a[180:181], v27 offset:16384
    v_mfma_f32_16x16x32_bf16 v[124:127], a[188:191], v[44:47], v[124:127]
    s_waitcnt lgkmcnt(7)
    ds_read_b64_tr_b16 a[182:183], v27 offset:18432
    v_xor_b32 v26, s44, v10
    v_mfma_f32_16x16x32_bf16 v[128:131], a[160:163], v[40:43], v[128:131]
    ds_read_b64_tr_b16 a[184:185], v26 offset:16384
    v_mfma_f32_16x16x32_bf16 v[136:139], a[160:163], v[44:47], v[136:139]
    s_add_u32 m0, s29, 81920
    ds_read_b64_tr_b16 a[186:187], v26 offset:18432
    v_xor_b32 v27, s44, v11
    v_mfma_f32_16x16x32_bf16 v[132:135], a[164:167], v[40:43], v[132:135]
    s_add_u32 s34, s32, 1835008
    ds_read_b64_tr_b16 a[188:189], v27 offset:16384
    buffer_load_dwordx4 v2, s[12:15], s34 offen offset:0 nt lds
    v_mfma_f32_16x16x32_bf16 v[140:143], a[164:167], v[44:47], v[140:143]
    s_waitcnt lgkmcnt(7)
    ds_read_b64_tr_b16 a[190:191], v27 offset:18432
    v_mfma_f32_16x16x32_bf16 v[144:147], a[168:171], v[40:43], v[144:147]
    ds_read_b64_tr_b16 a[160:161], v8 offset:16640
    v_mfma_f32_16x16x32_bf16 v[152:155], a[168:171], v[44:47], v[152:155]
    ds_read_b64_tr_b16 a[162:163], v8 offset:18688
    v_mfma_f32_16x16x32_bf16 v[148:151], a[172:175], v[40:43], v[148:151]
    ds_read_b64_tr_b16 a[164:165], v9 offset:16640
    v_mfma_f32_16x16x32_bf16 v[156:159], a[172:175], v[44:47], v[156:159]
    s_waitcnt lgkmcnt(7)
    ds_read_b64_tr_b16 a[166:167], v9 offset:18688
    buffer_load_dwordx4 v3, s[12:15], s34 offen offset:1024 nt lds
    v_mfma_f32_16x16x32_bf16 v[224:227], a[176:179], v[56:59], v[224:227]
    ds_read_b64_tr_b16 a[168:169], v10 offset:16640
    v_mfma_f32_16x16x32_bf16 v[232:235], a[176:179], v[60:63], v[232:235]
    ds_read_b64_tr_b16 a[170:171], v10 offset:18688
    v_mfma_f32_16x16x32_bf16 v[228:231], a[180:183], v[56:59], v[228:231]
    ds_read_b64_tr_b16 a[172:173], v11 offset:16640
    v_mfma_f32_16x16x32_bf16 v[236:239], a[180:183], v[60:63], v[236:239]
    s_waitcnt lgkmcnt(7)
    ds_read_b64_tr_b16 a[174:175], v11 offset:18688
    v_mfma_f32_16x16x32_bf16 v[240:243], a[184:187], v[56:59], v[240:243]
    s_add_u32 s34, s34, 30720
    ds_read_b64_tr_b16 a[176:177], v12 offset:16640
    buffer_load_dwordx4 v2, s[12:15], s34 offen offset:2048 nt lds
    v_mfma_f32_16x16x32_bf16 v[248:251], a[184:187], v[60:63], v[248:251]
    ds_read_b64_tr_b16 a[178:179], v12 offset:18688
    v_mfma_f32_16x16x32_bf16 v[244:247], a[188:191], v[56:59], v[244:247]
    ds_read_b64_tr_b16 a[180:181], v13 offset:16640
    v_mfma_f32_16x16x32_bf16 v[252:255], a[188:191], v[60:63], v[252:255]
    s_waitcnt lgkmcnt(7)
    ds_read_b64_tr_b16 a[182:183], v13 offset:18688
    v_mfma_f32_16x16x32_bf16 v[160:163], a[160:163], v[40:43], v[160:163]
    ds_read_b64_tr_b16 a[184:185], v14 offset:16640
    v_mfma_f32_16x16x32_bf16 v[168:171], a[160:163], v[44:47], v[168:171]
    ds_read_b64_tr_b16 a[186:187], v14 offset:18688
    buffer_load_dwordx4 v3, s[12:15], s34 offen offset:3072 nt lds
    v_mfma_f32_16x16x32_bf16 v[164:167], a[164:167], v[40:43], v[164:167]
    ds_read_b64_tr_b16 a[188:189], v15 offset:16640
    v_add_u32 v17, s41, v7
    v_mfma_f32_16x16x32_bf16 v[172:175], a[164:167], v[44:47], v[172:175]
    s_waitcnt lgkmcnt(7)
    ds_read_b64_tr_b16 a[190:191], v15 offset:18688
    v_mfma_f32_16x16x32_bf16 v[176:179], a[168:171], v[40:43], v[176:179]
    s_waitcnt vmcnt(22)
    s_barrier
    ds_read_b128 v[32:35], v17 offset:32768
    ds_read_b128 v[36:39], v17 offset:34816
    ds_read_b64_tr_b16 a[160:161], v8 offset:49152
    v_mfma_f32_16x16x32_bf16 v[184:187], a[168:171], v[44:47], v[184:187]
    s_add_u32 m0, s29, 98304
    ds_read_b64_tr_b16 a[162:163], v8 offset:51200
    v_mfma_f32_16x16x32_bf16 v[180:183], a[172:175], v[40:43], v[180:183]
    s_movk_i32 s34, 512
    ds_read_b64_tr_b16 a[164:165], v9 offset:49152
    buffer_load_dwordx4 v4, s[8:11], s34 offen offset:0 lds
    v_mfma_f32_16x16x32_bf16 v[188:191], a[172:175], v[44:47], v[188:191]
    s_waitcnt lgkmcnt(9)
    ds_read_b64_tr_b16 a[166:167], v9 offset:51200
    v_mfma_f32_16x16x32_bf16 v[192:195], a[176:179], v[40:43], v[192:195]
    ds_read_b64_tr_b16 a[168:169], v10 offset:49152
    v_mfma_f32_16x16x32_bf16 v[200:203], a[176:179], v[44:47], v[200:203]
    ds_read_b64_tr_b16 a[170:171], v10 offset:51200
    v_mfma_f32_16x16x32_bf16 v[196:199], a[180:183], v[40:43], v[196:199]
    ds_read_b64_tr_b16 a[172:173], v11 offset:49152
    v_mfma_f32_16x16x32_bf16 v[204:207], a[180:183], v[44:47], v[204:207]
    s_waitcnt lgkmcnt(9)
    ds_read_b64_tr_b16 a[174:175], v11 offset:51200
    v_mfma_f32_16x16x32_bf16 v[208:211], a[184:187], v[40:43], v[208:211]
    ds_read_b64_tr_b16 a[176:177], v12 offset:49152
    v_mfma_f32_16x16x32_bf16 v[216:219], a[184:187], v[44:47], v[216:219]
    ds_read_b64_tr_b16 a[178:179], v12 offset:51200
    v_mfma_f32_16x16x32_bf16 v[212:215], a[188:191], v[40:43], v[212:215]
    ds_read_b64_tr_b16 a[180:181], v13 offset:49152
    buffer_load_dwordx4 v5, s[8:11], s34 offen offset:1024 lds
    v_mfma_f32_16x16x32_bf16 v[220:223], a[188:191], v[44:47], v[220:223]
    s_waitcnt lgkmcnt(7)
    ds_read_b64_tr_b16 a[182:183], v13 offset:51200
    v_mfma_f32_16x16x32_bf16 v[96:99], a[160:163], v[32:35], v[96:99]
    ds_read_b64_tr_b16 a[184:185], v14 offset:49152
    v_mfma_f32_16x16x32_bf16 v[104:107], a[160:163], v[36:39], v[104:107]
    ds_read_b64_tr_b16 a[186:187], v14 offset:51200
    ds_read_b128 v[48:51], v7 offset:8192
    v_mfma_f32_16x16x32_bf16 v[100:103], a[164:167], v[32:35], v[100:103]
    ds_read_b64_tr_b16 a[188:189], v15 offset:49152
    v_mfma_f32_16x16x32_bf16 v[108:111], a[164:167], v[36:39], v[108:111]
    s_waitcnt lgkmcnt(8)
    ds_read_b64_tr_b16 a[190:191], v15 offset:51200
    v_xor_b32 v26, s44, v8
    v_mfma_f32_16x16x32_bf16 v[112:115], a[168:171], v[32:35], v[112:115]
    ds_read_b64_tr_b16 a[160:161], v26 offset:49152
    ds_read_b128 v[52:55], v7 offset:10240
    v_mfma_f32_16x16x32_bf16 v[120:123], a[168:171], v[36:39], v[120:123]
    ds_read_b64_tr_b16 a[162:163], v26 offset:51200
    v_xor_b32 v27, s44, v9
    v_mfma_f32_16x16x32_bf16 v[116:119], a[172:175], v[32:35], v[116:119]
    s_add_u32 s34, s34, 12288
    ds_read_b64_tr_b16 a[164:165], v27 offset:49152
    buffer_load_dwordx4 v4, s[8:11], s34 offen offset:2048 lds
    v_mfma_f32_16x16x32_bf16 v[124:127], a[172:175], v[36:39], v[124:127]
    s_waitcnt lgkmcnt(9)
    ds_read_b64_tr_b16 a[166:167], v27 offset:51200
    v_xor_b32 v26, s44, v10
    v_xor_b32 v17, 64, v17
    v_mfma_f32_16x16x32_bf16 v[128:131], a[176:179], v[32:35], v[128:131]
    s_add_u32 s51, s26, 256
    ds_read_b64_tr_b16 a[168:169], v26 offset:49152
    buffer_load_dwordx4 a[16:19], v0, s[16:19], s51 offen offset:0 nt
    v_mfma_f32_16x16x32_bf16 v[136:139], a[176:179], v[36:39], v[136:139]
    ds_read_b64_tr_b16 a[170:171], v26 offset:51200
    v_xor_b32 v27, s44, v11
    v_mfma_f32_16x16x32_bf16 v[132:135], a[180:183], v[32:35], v[132:135]
    ds_read_b64_tr_b16 a[172:173], v27 offset:49152
    ds_read_b128 v[40:43], v17 offset:32768
    v_mfma_f32_16x16x32_bf16 v[140:143], a[180:183], v[36:39], v[140:143]
    s_waitcnt lgkmcnt(9)
    ds_read_b64_tr_b16 a[174:175], v27 offset:51200
    v_mfma_f32_16x16x32_bf16 v[144:147], a[184:187], v[32:35], v[144:147]
    ds_read_b64_tr_b16 a[176:177], v8 offset:49408
    buffer_load_dwordx4 a[20:23], v1, s[16:19], s51 offen offset:1024 nt
    v_mfma_f32_16x16x32_bf16 v[152:155], a[184:187], v[36:39], v[152:155]
    ds_read_b64_tr_b16 a[178:179], v8 offset:51456
    ds_read_b128 v[44:47], v17 offset:34816
    v_xor_b32 v8, 0x10000, v8
    v_mfma_f32_16x16x32_bf16 v[148:151], a[188:191], v[32:35], v[148:151]
    ds_read_b64_tr_b16 a[180:181], v9 offset:49408
    buffer_load_dwordx4 v5, s[8:11], s34 offen offset:3072 lds
    v_mfma_f32_16x16x32_bf16 v[156:159], a[188:191], v[36:39], v[156:159]
    s_waitcnt lgkmcnt(9)
    ds_read_b64_tr_b16 a[182:183], v9 offset:51456
    v_xor_b32 v9, 0x10000, v9
    v_mfma_f32_16x16x32_bf16 v[224:227], a[160:163], v[48:51], v[224:227]
    s_add_u32 s51, s51, 6144
    ds_read_b64_tr_b16 a[184:185], v10 offset:49408
    buffer_load_dwordx4 a[24:27], v0, s[16:19], s51 offen offset:2048 nt
    v_xor_b32 v17, 64, v7
    v_mfma_f32_16x16x32_bf16 v[232:235], a[160:163], v[52:55], v[232:235]
    ds_read_b64_tr_b16 a[186:187], v10 offset:51456
    v_xor_b32 v10, 0x10000, v10
    v_mfma_f32_16x16x32_bf16 v[228:231], a[164:167], v[48:51], v[228:231]
    ds_read_b64_tr_b16 a[188:189], v11 offset:49408
    v_mfma_f32_16x16x32_bf16 v[236:239], a[164:167], v[52:55], v[236:239]
    s_waitcnt lgkmcnt(8)
    ds_read_b64_tr_b16 a[190:191], v11 offset:51456
    ds_read_b128 v[56:59], v17 offset:8192
    v_xor_b32 v11, 0x10000, v11
    v_mfma_f32_16x16x32_bf16 v[240:243], a[168:171], v[48:51], v[240:243]
    ds_read_b64_tr_b16 a[160:161], v12 offset:49408
    buffer_load_dwordx4 a[28:31], v1, s[16:19], s51 offen offset:3072 nt
    v_mfma_f32_16x16x32_bf16 v[248:251], a[168:171], v[52:55], v[248:251]
    s_add_u32 m0, s39, 16384
    ds_read_b64_tr_b16 a[162:163], v12 offset:51456
    v_xor_b32 v12, 0x10000, v12
    v_mfma_f32_16x16x32_bf16 v[244:247], a[172:175], v[48:51], v[244:247]
    s_movk_i32 s34, 512
    ds_read_b64_tr_b16 a[164:165], v13 offset:49408
    buffer_load_dwordx4 v6, s[8:11], s34 offen lds
    ds_read_b128 v[60:63], v17 offset:10240
    v_mfma_f32_16x16x32_bf16 v[252:255], a[172:175], v[52:55], v[252:255]
    s_waitcnt lgkmcnt(9)
    ds_read_b64_tr_b16 a[166:167], v13 offset:51456
    v_xor_b32 v13, 0x10000, v13
    v_mfma_f32_16x16x32_bf16 v[160:163], a[176:179], v[32:35], v[160:163]
    ds_read_b64_tr_b16 a[168:169], v14 offset:49408
    v_mfma_f32_16x16x32_bf16 v[168:171], a[176:179], v[36:39], v[168:171]
    ds_read_b64_tr_b16 a[170:171], v14 offset:51456
    v_xor_b32 v14, 0x10000, v14
    v_mfma_f32_16x16x32_bf16 v[164:167], a[180:183], v[32:35], v[164:167]
    ds_read_b64_tr_b16 a[172:173], v15 offset:49408
    v_mfma_f32_16x16x32_bf16 v[172:175], a[180:183], v[36:39], v[172:175]
    s_waitcnt lgkmcnt(9)
    ds_read_b64_tr_b16 a[174:175], v15 offset:51456
    v_xor_b32 v15, 0x10000, v15
    v_mfma_f32_16x16x32_bf16 v[176:179], a[184:187], v[32:35], v[176:179]
    s_waitcnt vmcnt(26)
    s_barrier
    ds_read_b64_tr_b16 a[176:177], v8 offset:0
    v_mfma_f32_16x16x32_bf16 v[184:187], a[184:187], v[36:39], v[184:187]
    s_add_u32 m0, s29, 114688
    ds_read_b64_tr_b16 a[178:179], v8 offset:2048
    v_mfma_f32_16x16x32_bf16 v[180:183], a[188:191], v[32:35], v[180:183]
    s_add_u32 s34, s32, 2097152
    ds_read_b64_tr_b16 a[180:181], v9 offset:0
    buffer_load_dwordx4 v2, s[12:15], s34 offen offset:0 nt lds
    v_mfma_f32_16x16x32_bf16 v[188:191], a[188:191], v[36:39], v[188:191]
    s_waitcnt lgkmcnt(7)
    ds_read_b64_tr_b16 a[182:183], v9 offset:2048
    v_mfma_f32_16x16x32_bf16 v[192:195], a[160:163], v[32:35], v[192:195]
    ds_read_b64_tr_b16 a[184:185], v10 offset:0
    v_mfma_f32_16x16x32_bf16 v[200:203], a[160:163], v[36:39], v[200:203]
    ds_read_b64_tr_b16 a[186:187], v10 offset:2048
    v_mfma_f32_16x16x32_bf16 v[196:199], a[164:167], v[32:35], v[196:199]
    ds_read_b64_tr_b16 a[188:189], v11 offset:0
    v_mfma_f32_16x16x32_bf16 v[204:207], a[164:167], v[36:39], v[204:207]
    s_waitcnt lgkmcnt(7)
    ds_read_b64_tr_b16 a[190:191], v11 offset:2048
    buffer_load_dwordx4 v3, s[12:15], s34 offen offset:1024 nt lds
    v_mfma_f32_16x16x32_bf16 v[208:211], a[168:171], v[32:35], v[208:211]
    ds_read_b64_tr_b16 a[160:161], v12 offset:0
    v_mfma_f32_16x16x32_bf16 v[216:219], a[168:171], v[36:39], v[216:219]
    ds_read_b64_tr_b16 a[162:163], v12 offset:2048
    v_mfma_f32_16x16x32_bf16 v[212:215], a[172:175], v[32:35], v[212:215]
    ds_read_b64_tr_b16 a[164:165], v13 offset:0
    v_mfma_f32_16x16x32_bf16 v[220:223], a[172:175], v[36:39], v[220:223]
    s_waitcnt lgkmcnt(7)
    ds_read_b64_tr_b16 a[166:167], v13 offset:2048
    v_mfma_f32_16x16x32_bf16 v[96:99], a[176:179], v[40:43], v[96:99]
    s_add_u32 s34, s34, 30720
    ds_read_b64_tr_b16 a[168:169], v14 offset:0
    buffer_load_dwordx4 v2, s[12:15], s34 offen offset:2048 nt lds
    v_mfma_f32_16x16x32_bf16 v[104:107], a[176:179], v[44:47], v[104:107]
    ds_read_b64_tr_b16 a[170:171], v14 offset:2048
    v_mfma_f32_16x16x32_bf16 v[100:103], a[180:183], v[40:43], v[100:103]
    ds_read_b64_tr_b16 a[172:173], v15 offset:0
    v_mfma_f32_16x16x32_bf16 v[108:111], a[180:183], v[44:47], v[108:111]
    s_waitcnt lgkmcnt(7)
    ds_read_b64_tr_b16 a[174:175], v15 offset:2048
    v_xor_b32 v26, s44, v8
    v_mfma_f32_16x16x32_bf16 v[112:115], a[184:187], v[40:43], v[112:115]
    ds_read_b64_tr_b16 a[176:177], v26 offset:0
    v_mfma_f32_16x16x32_bf16 v[120:123], a[184:187], v[44:47], v[120:123]
    ds_read_b64_tr_b16 a[178:179], v26 offset:2048
    buffer_load_dwordx4 v3, s[12:15], s34 offen offset:3072 nt lds
    v_xor_b32 v27, s44, v9
    v_mfma_f32_16x16x32_bf16 v[116:119], a[188:191], v[40:43], v[116:119]
    ds_read_b64_tr_b16 a[180:181], v27 offset:0
    v_mfma_f32_16x16x32_bf16 v[124:127], a[188:191], v[44:47], v[124:127]
    s_waitcnt lgkmcnt(7)
    ds_read_b64_tr_b16 a[182:183], v27 offset:2048
    v_xor_b32 v26, s44, v10
    v_mfma_f32_16x16x32_bf16 v[128:131], a[160:163], v[40:43], v[128:131]
    ds_read_b64_tr_b16 a[184:185], v26 offset:0
    v_mfma_f32_16x16x32_bf16 v[136:139], a[160:163], v[44:47], v[136:139]
    s_add_u32 m0, s29, 131072
    ds_read_b64_tr_b16 a[186:187], v26 offset:2048
    v_xor_b32 v27, s44, v11
    v_mfma_f32_16x16x32_bf16 v[132:135], a[164:167], v[40:43], v[132:135]
    s_add_u32 s34, s32, 2359296
    ds_read_b64_tr_b16 a[188:189], v27 offset:0
    buffer_load_dwordx4 v2, s[12:15], s34 offen offset:0 nt lds
    v_mfma_f32_16x16x32_bf16 v[140:143], a[164:167], v[44:47], v[140:143]
    s_waitcnt lgkmcnt(7)
    ds_read_b64_tr_b16 a[190:191], v27 offset:2048
    v_mfma_f32_16x16x32_bf16 v[144:147], a[168:171], v[40:43], v[144:147]
    ds_read_b64_tr_b16 a[160:161], v8 offset:256
    v_mfma_f32_16x16x32_bf16 v[152:155], a[168:171], v[44:47], v[152:155]
    ds_read_b64_tr_b16 a[162:163], v8 offset:2304
    v_mfma_f32_16x16x32_bf16 v[148:151], a[172:175], v[40:43], v[148:151]
    ds_read_b64_tr_b16 a[164:165], v9 offset:256
    v_mfma_f32_16x16x32_bf16 v[156:159], a[172:175], v[44:47], v[156:159]
    s_waitcnt lgkmcnt(7)
    ds_read_b64_tr_b16 a[166:167], v9 offset:2304
    buffer_load_dwordx4 v3, s[12:15], s34 offen offset:1024 nt lds
    v_mfma_f32_16x16x32_bf16 v[224:227], a[176:179], v[56:59], v[224:227]
    ds_read_b64_tr_b16 a[168:169], v10 offset:256
    v_mfma_f32_16x16x32_bf16 v[232:235], a[176:179], v[60:63], v[232:235]
    ds_read_b64_tr_b16 a[170:171], v10 offset:2304
    v_mfma_f32_16x16x32_bf16 v[228:231], a[180:183], v[56:59], v[228:231]
    ds_read_b64_tr_b16 a[172:173], v11 offset:256
    v_mfma_f32_16x16x32_bf16 v[236:239], a[180:183], v[60:63], v[236:239]
    s_waitcnt lgkmcnt(7)
    ds_read_b64_tr_b16 a[174:175], v11 offset:2304
    v_mfma_f32_16x16x32_bf16 v[240:243], a[184:187], v[56:59], v[240:243]
    s_add_u32 s34, s34, 30720
    ds_read_b64_tr_b16 a[176:177], v12 offset:256
    buffer_load_dwordx4 v2, s[12:15], s34 offen offset:2048 nt lds
    v_mfma_f32_16x16x32_bf16 v[248:251], a[184:187], v[60:63], v[248:251]
    ds_read_b64_tr_b16 a[178:179], v12 offset:2304
    v_mfma_f32_16x16x32_bf16 v[244:247], a[188:191], v[56:59], v[244:247]
    ds_read_b64_tr_b16 a[180:181], v13 offset:256
    v_mfma_f32_16x16x32_bf16 v[252:255], a[188:191], v[60:63], v[252:255]
    s_waitcnt lgkmcnt(7)
    ds_read_b64_tr_b16 a[182:183], v13 offset:2304
    v_mfma_f32_16x16x32_bf16 v[160:163], a[160:163], v[40:43], v[160:163]
    ds_read_b64_tr_b16 a[184:185], v14 offset:256
    v_mfma_f32_16x16x32_bf16 v[168:171], a[160:163], v[44:47], v[168:171]
    ds_read_b64_tr_b16 a[186:187], v14 offset:2304
    buffer_load_dwordx4 v3, s[12:15], s34 offen offset:3072 nt lds
    v_mfma_f32_16x16x32_bf16 v[164:167], a[164:167], v[40:43], v[164:167]
    ds_read_b64_tr_b16 a[188:189], v15 offset:256
    v_add_u32 v17, s40, v7
    v_mfma_f32_16x16x32_bf16 v[172:175], a[164:167], v[44:47], v[172:175]
    s_waitcnt lgkmcnt(7)
    ds_read_b64_tr_b16 a[190:191], v15 offset:2304
    v_mfma_f32_16x16x32_bf16 v[176:179], a[168:171], v[40:43], v[176:179]
    s_waitcnt vmcnt(21)
    s_barrier
    ds_read_b128 v[32:35], v17 offset:16384
    ds_read_b128 v[36:39], v17 offset:18432
    ds_read_b64_tr_b16 a[160:161], v8 offset:32768
    v_mfma_f32_16x16x32_bf16 v[184:187], a[168:171], v[44:47], v[184:187]
    s_add_u32 m0, s29, 147456
    ds_read_b64_tr_b16 a[162:163], v8 offset:34816
    v_mfma_f32_16x16x32_bf16 v[180:183], a[172:175], v[40:43], v[180:183]
    s_movk_i32 s34, 640
    ds_read_b64_tr_b16 a[164:165], v9 offset:32768
    buffer_load_dwordx4 v4, s[8:11], s34 offen offset:0 lds
    v_mfma_f32_16x16x32_bf16 v[188:191], a[172:175], v[44:47], v[188:191]
    s_waitcnt lgkmcnt(9)
    ds_read_b64_tr_b16 a[166:167], v9 offset:34816
    v_mfma_f32_16x16x32_bf16 v[192:195], a[176:179], v[40:43], v[192:195]
    s_add_u32 s51, s26, 384
    ds_read_b64_tr_b16 a[168:169], v10 offset:32768
    buffer_load_dwordx4 a[32:35], v0, s[16:19], s51 offen offset:0 nt
    v_mfma_f32_16x16x32_bf16 v[200:203], a[176:179], v[44:47], v[200:203]
    ds_read_b64_tr_b16 a[170:171], v10 offset:34816
    v_mfma_f32_16x16x32_bf16 v[196:199], a[180:183], v[40:43], v[196:199]
    ds_read_b64_tr_b16 a[172:173], v11 offset:32768
    v_mfma_f32_16x16x32_bf16 v[204:207], a[180:183], v[44:47], v[204:207]
    s_waitcnt lgkmcnt(9)
    ds_read_b64_tr_b16 a[174:175], v11 offset:34816
    v_mfma_f32_16x16x32_bf16 v[208:211], a[184:187], v[40:43], v[208:211]
    ds_read_b64_tr_b16 a[176:177], v12 offset:32768
    buffer_load_dwordx4 a[36:39], v1, s[16:19], s51 offen offset:1024 nt
    v_mfma_f32_16x16x32_bf16 v[216:219], a[184:187], v[44:47], v[216:219]
    ds_read_b64_tr_b16 a[178:179], v12 offset:34816
    v_mfma_f32_16x16x32_bf16 v[212:215], a[188:191], v[40:43], v[212:215]
    ds_read_b64_tr_b16 a[180:181], v13 offset:32768
    buffer_load_dwordx4 v5, s[8:11], s34 offen offset:1024 lds
    v_mfma_f32_16x16x32_bf16 v[220:223], a[188:191], v[44:47], v[220:223]
    s_waitcnt lgkmcnt(7)
    ds_read_b64_tr_b16 a[182:183], v13 offset:34816
    v_mfma_f32_16x16x32_bf16 v[96:99], a[160:163], v[32:35], v[96:99]
    s_add_u32 s51, s51, 6144
    ds_read_b64_tr_b16 a[184:185], v14 offset:32768
    buffer_load_dwordx4 a[40:43], v0, s[16:19], s51 offen offset:2048 nt
    v_mfma_f32_16x16x32_bf16 v[104:107], a[160:163], v[36:39], v[104:107]
    ds_read_b64_tr_b16 a[186:187], v14 offset:34816
    ds_read_b128 v[48:51], v7 offset:12288
    v_mfma_f32_16x16x32_bf16 v[100:103], a[164:167], v[32:35], v[100:103]
    ds_read_b64_tr_b16 a[188:189], v15 offset:32768
    v_mfma_f32_16x16x32_bf16 v[108:111], a[164:167], v[36:39], v[108:111]
    s_waitcnt lgkmcnt(8)
    ds_read_b64_tr_b16 a[190:191], v15 offset:34816
    v_xor_b32 v26, s44, v8
    v_mfma_f32_16x16x32_bf16 v[112:115], a[168:171], v[32:35], v[112:115]
    ds_read_b64_tr_b16 a[160:161], v26 offset:32768
    buffer_load_dwordx4 a[44:47], v1, s[16:19], s51 offen offset:3072 nt
    ds_read_b128 v[52:55], v7 offset:14336
    v_mfma_f32_16x16x32_bf16 v[120:123], a[168:171], v[36:39], v[120:123]
    ds_read_b64_tr_b16 a[162:163], v26 offset:34816
    v_xor_b32 v27, s44, v9
    v_mfma_f32_16x16x32_bf16 v[116:119], a[172:175], v[32:35], v[116:119]
    s_add_u32 s34, s34, 12288
    ds_read_b64_tr_b16 a[164:165], v27 offset:32768
    buffer_load_dwordx4 v4, s[8:11], s34 offen offset:2048 lds
    v_mfma_f32_16x16x32_bf16 v[124:127], a[172:175], v[36:39], v[124:127]
    s_waitcnt lgkmcnt(9)
    ds_read_b64_tr_b16 a[166:167], v27 offset:34816
    v_xor_b32 v26, s44, v10
    v_xor_b32 v17, 64, v17
    v_mfma_f32_16x16x32_bf16 v[128:131], a[176:179], v[32:35], v[128:131]
    ds_read_b64_tr_b16 a[168:169], v26 offset:32768
    v_mfma_f32_16x16x32_bf16 v[136:139], a[176:179], v[36:39], v[136:139]
    ds_read_b64_tr_b16 a[170:171], v26 offset:34816
    v_xor_b32 v27, s44, v11
    v_mfma_f32_16x16x32_bf16 v[132:135], a[180:183], v[32:35], v[132:135]
    ds_read_b64_tr_b16 a[172:173], v27 offset:32768
    ds_read_b128 v[40:43], v17 offset:16384
    v_mfma_f32_16x16x32_bf16 v[140:143], a[180:183], v[36:39], v[140:143]
    s_waitcnt lgkmcnt(9)
    ds_read_b64_tr_b16 a[174:175], v27 offset:34816
    v_mfma_f32_16x16x32_bf16 v[144:147], a[184:187], v[32:35], v[144:147]
    ds_read_b64_tr_b16 a[176:177], v8 offset:33024
    v_mfma_f32_16x16x32_bf16 v[152:155], a[184:187], v[36:39], v[152:155]
    ds_read_b64_tr_b16 a[178:179], v8 offset:35072
    ds_read_b128 v[44:47], v17 offset:18432
    v_mfma_f32_16x16x32_bf16 v[148:151], a[188:191], v[32:35], v[148:151]
    ds_read_b64_tr_b16 a[180:181], v9 offset:33024
    buffer_load_dwordx4 v5, s[8:11], s34 offen offset:3072 lds
    v_mfma_f32_16x16x32_bf16 v[156:159], a[188:191], v[36:39], v[156:159]
    s_waitcnt lgkmcnt(9)
    ds_read_b64_tr_b16 a[182:183], v9 offset:35072
    v_mfma_f32_16x16x32_bf16 v[224:227], a[160:163], v[48:51], v[224:227]
    ds_read_b64_tr_b16 a[184:185], v10 offset:33024
    v_xor_b32 v17, 64, v7
    v_mfma_f32_16x16x32_bf16 v[232:235], a[160:163], v[52:55], v[232:235]
    ds_read_b64_tr_b16 a[186:187], v10 offset:35072
    v_mfma_f32_16x16x32_bf16 v[228:231], a[164:167], v[48:51], v[228:231]
    ds_read_b64_tr_b16 a[188:189], v11 offset:33024
    v_mfma_f32_16x16x32_bf16 v[236:239], a[164:167], v[52:55], v[236:239]
    s_waitcnt lgkmcnt(8)
    ds_read_b64_tr_b16 a[190:191], v11 offset:35072
    ds_read_b128 v[56:59], v17 offset:12288
    v_mfma_f32_16x16x32_bf16 v[240:243], a[168:171], v[48:51], v[240:243]
    ds_read_b64_tr_b16 a[160:161], v12 offset:33024
    v_mfma_f32_16x16x32_bf16 v[248:251], a[168:171], v[52:55], v[248:251]
    s_add_u32 m0, s39, 20480
    ds_read_b64_tr_b16 a[162:163], v12 offset:35072
    v_mfma_f32_16x16x32_bf16 v[244:247], a[172:175], v[48:51], v[244:247]
    s_movk_i32 s34, 640
    ds_read_b64_tr_b16 a[164:165], v13 offset:33024
    buffer_load_dwordx4 v6, s[8:11], s34 offen lds
    ds_read_b128 v[60:63], v17 offset:14336
    v_mfma_f32_16x16x32_bf16 v[252:255], a[172:175], v[52:55], v[252:255]
    s_waitcnt lgkmcnt(9)
    ds_read_b64_tr_b16 a[166:167], v13 offset:35072
    v_mfma_f32_16x16x32_bf16 v[160:163], a[176:179], v[32:35], v[160:163]
    ds_read_b64_tr_b16 a[168:169], v14 offset:33024
    v_mfma_f32_16x16x32_bf16 v[168:171], a[176:179], v[36:39], v[168:171]
    ds_read_b64_tr_b16 a[170:171], v14 offset:35072
    v_mfma_f32_16x16x32_bf16 v[164:167], a[180:183], v[32:35], v[164:167]
    ds_read_b64_tr_b16 a[172:173], v15 offset:33024
    v_mfma_f32_16x16x32_bf16 v[172:175], a[180:183], v[36:39], v[172:175]
    s_waitcnt lgkmcnt(9)
    ds_read_b64_tr_b16 a[174:175], v15 offset:35072
    v_mfma_f32_16x16x32_bf16 v[176:179], a[184:187], v[32:35], v[176:179]
    s_waitcnt vmcnt(26)
    s_barrier
    ds_read_b64_tr_b16 a[176:177], v8 offset:49152
    v_mfma_f32_16x16x32_bf16 v[184:187], a[184:187], v[36:39], v[184:187]
    s_add_u32 m0, s29, 32768
    ds_read_b64_tr_b16 a[178:179], v8 offset:51200
    v_mfma_f32_16x16x32_bf16 v[180:183], a[188:191], v[32:35], v[180:183]
    s_add_u32 s34, s32, 2621440
    ds_read_b64_tr_b16 a[180:181], v9 offset:49152
    buffer_load_dwordx4 v2, s[12:15], s34 offen offset:0 nt lds
    v_mfma_f32_16x16x32_bf16 v[188:191], a[188:191], v[36:39], v[188:191]
    s_waitcnt lgkmcnt(7)
    ds_read_b64_tr_b16 a[182:183], v9 offset:51200
    v_mfma_f32_16x16x32_bf16 v[192:195], a[160:163], v[32:35], v[192:195]
    ds_read_b64_tr_b16 a[184:185], v10 offset:49152
    v_mfma_f32_16x16x32_bf16 v[200:203], a[160:163], v[36:39], v[200:203]
    ds_read_b64_tr_b16 a[186:187], v10 offset:51200
    v_mfma_f32_16x16x32_bf16 v[196:199], a[164:167], v[32:35], v[196:199]
    ds_read_b64_tr_b16 a[188:189], v11 offset:49152
    v_mfma_f32_16x16x32_bf16 v[204:207], a[164:167], v[36:39], v[204:207]
    s_waitcnt lgkmcnt(7)
    ds_read_b64_tr_b16 a[190:191], v11 offset:51200
    buffer_load_dwordx4 v3, s[12:15], s34 offen offset:1024 nt lds
    v_mfma_f32_16x16x32_bf16 v[208:211], a[168:171], v[32:35], v[208:211]
    ds_read_b64_tr_b16 a[160:161], v12 offset:49152
    v_mfma_f32_16x16x32_bf16 v[216:219], a[168:171], v[36:39], v[216:219]
    ds_read_b64_tr_b16 a[162:163], v12 offset:51200
    v_mfma_f32_16x16x32_bf16 v[212:215], a[172:175], v[32:35], v[212:215]
    ds_read_b64_tr_b16 a[164:165], v13 offset:49152
    v_mfma_f32_16x16x32_bf16 v[220:223], a[172:175], v[36:39], v[220:223]
    s_waitcnt lgkmcnt(7)
    ds_read_b64_tr_b16 a[166:167], v13 offset:51200
    v_mfma_f32_16x16x32_bf16 v[96:99], a[176:179], v[40:43], v[96:99]
    s_add_u32 s34, s34, 30720
    ds_read_b64_tr_b16 a[168:169], v14 offset:49152
    buffer_load_dwordx4 v2, s[12:15], s34 offen offset:2048 nt lds
    v_mfma_f32_16x16x32_bf16 v[104:107], a[176:179], v[44:47], v[104:107]
    ds_read_b64_tr_b16 a[170:171], v14 offset:51200
    v_mfma_f32_16x16x32_bf16 v[100:103], a[180:183], v[40:43], v[100:103]
    ds_read_b64_tr_b16 a[172:173], v15 offset:49152
    v_mfma_f32_16x16x32_bf16 v[108:111], a[180:183], v[44:47], v[108:111]
    s_waitcnt lgkmcnt(7)
    ds_read_b64_tr_b16 a[174:175], v15 offset:51200
    v_xor_b32 v26, s44, v8
    v_mfma_f32_16x16x32_bf16 v[112:115], a[184:187], v[40:43], v[112:115]
    ds_read_b64_tr_b16 a[176:177], v26 offset:49152
    v_mfma_f32_16x16x32_bf16 v[120:123], a[184:187], v[44:47], v[120:123]
    ds_read_b64_tr_b16 a[178:179], v26 offset:51200
    buffer_load_dwordx4 v3, s[12:15], s34 offen offset:3072 nt lds
    v_xor_b32 v27, s44, v9
    v_mfma_f32_16x16x32_bf16 v[116:119], a[188:191], v[40:43], v[116:119]
    ds_read_b64_tr_b16 a[180:181], v27 offset:49152
    v_mfma_f32_16x16x32_bf16 v[124:127], a[188:191], v[44:47], v[124:127]
    s_waitcnt lgkmcnt(7)
    ds_read_b64_tr_b16 a[182:183], v27 offset:51200
    v_xor_b32 v26, s44, v10
    v_mfma_f32_16x16x32_bf16 v[128:131], a[160:163], v[40:43], v[128:131]
    ds_read_b64_tr_b16 a[184:185], v26 offset:49152
    v_mfma_f32_16x16x32_bf16 v[136:139], a[160:163], v[44:47], v[136:139]
    s_add_u32 m0, s29, 49152
    ds_read_b64_tr_b16 a[186:187], v26 offset:51200
    v_xor_b32 v27, s44, v11
    v_mfma_f32_16x16x32_bf16 v[132:135], a[164:167], v[40:43], v[132:135]
    s_add_u32 s34, s32, 2883584
    ds_read_b64_tr_b16 a[188:189], v27 offset:49152
    buffer_load_dwordx4 v2, s[12:15], s34 offen offset:0 nt lds
    v_mfma_f32_16x16x32_bf16 v[140:143], a[164:167], v[44:47], v[140:143]
    s_waitcnt lgkmcnt(7)
    ds_read_b64_tr_b16 a[190:191], v27 offset:51200
    v_mfma_f32_16x16x32_bf16 v[144:147], a[168:171], v[40:43], v[144:147]
    ds_read_b64_tr_b16 a[160:161], v8 offset:49408
    v_mfma_f32_16x16x32_bf16 v[152:155], a[168:171], v[44:47], v[152:155]
    ds_read_b64_tr_b16 a[162:163], v8 offset:51456
    v_xor_b32 v8, 0x10000, v8
    v_mfma_f32_16x16x32_bf16 v[148:151], a[172:175], v[40:43], v[148:151]
    ds_read_b64_tr_b16 a[164:165], v9 offset:49408
    v_mfma_f32_16x16x32_bf16 v[156:159], a[172:175], v[44:47], v[156:159]
    s_waitcnt lgkmcnt(7)
A_stub1:
    s_cbranch_execz A_stub5
    ds_read_b64_tr_b16 a[166:167], v9 offset:51456
    buffer_load_dwordx4 v3, s[12:15], s34 offen offset:1024 nt lds
    v_xor_b32 v9, 0x10000, v9
    v_mfma_f32_16x16x32_bf16 v[224:227], a[176:179], v[56:59], v[224:227]
    ds_read_b64_tr_b16 a[168:169], v10 offset:49408
    v_mfma_f32_16x16x32_bf16 v[232:235], a[176:179], v[60:63], v[232:235]
    ds_read_b64_tr_b16 a[170:171], v10 offset:51456
    v_xor_b32 v10, 0x10000, v10
    v_mfma_f32_16x16x32_bf16 v[228:231], a[180:183], v[56:59], v[228:231]
    ds_read_b64_tr_b16 a[172:173], v11 offset:49408
    v_mfma_f32_16x16x32_bf16 v[236:239], a[180:183], v[60:63], v[236:239]
    s_waitcnt lgkmcnt(7)
    ds_read_b64_tr_b16 a[174:175], v11 offset:51456
    v_xor_b32 v11, 0x10000, v11
    v_mfma_f32_16x16x32_bf16 v[240:243], a[184:187], v[56:59], v[240:243]
    s_add_u32 s34, s34, 30720
    ds_read_b64_tr_b16 a[176:177], v12 offset:49408
    buffer_load_dwordx4 v2, s[12:15], s34 offen offset:2048 nt lds
    v_mfma_f32_16x16x32_bf16 v[248:251], a[184:187], v[60:63], v[248:251]
    ds_read_b64_tr_b16 a[178:179], v12 offset:51456
    v_xor_b32 v12, 0x10000, v12
    v_mfma_f32_16x16x32_bf16 v[244:247], a[188:191], v[56:59], v[244:247]
    ds_read_b64_tr_b16 a[180:181], v13 offset:49408
    v_mfma_f32_16x16x32_bf16 v[252:255], a[188:191], v[60:63], v[252:255]
    s_waitcnt lgkmcnt(7)
    ds_read_b64_tr_b16 a[182:183], v13 offset:51456
    v_xor_b32 v13, 0x10000, v13
    v_mfma_f32_16x16x32_bf16 v[160:163], a[160:163], v[40:43], v[160:163]
    s_add_u32 s51, s26, 65536
    ds_read_b64_tr_b16 a[184:185], v14 offset:49408
    buffer_load_dwordx4 a[48:51], v0, s[16:19], s51 offen offset:0 nt
    v_mfma_f32_16x16x32_bf16 v[168:171], a[160:163], v[44:47], v[168:171]
    ds_read_b64_tr_b16 a[186:187], v14 offset:51456
    buffer_load_dwordx4 v3, s[12:15], s34 offen offset:3072 nt lds
    v_xor_b32 v14, 0x10000, v14
    v_mfma_f32_16x16x32_bf16 v[164:167], a[164:167], v[40:43], v[164:167]
    ds_read_b64_tr_b16 a[188:189], v15 offset:49408
    v_add_u32 v17, s41, v7
    v_mfma_f32_16x16x32_bf16 v[172:175], a[164:167], v[44:47], v[172:175]
    s_waitcnt lgkmcnt(7)
    ds_read_b64_tr_b16 a[190:191], v15 offset:51456
    v_xor_b32 v15, 0x10000, v15
    v_mfma_f32_16x16x32_bf16 v[176:179], a[168:171], v[40:43], v[176:179]
    s_waitcnt vmcnt(22)
    s_barrier
    ds_read_b128 v[32:35], v17 offset:0
    ds_read_b128 v[36:39], v17 offset:2048
    ds_read_b64_tr_b16 a[160:161], v8 offset:16384
    buffer_load_dwordx4 a[52:55], v1, s[16:19], s51 offen offset:1024 nt
    v_mfma_f32_16x16x32_bf16 v[184:187], a[168:171], v[44:47], v[184:187]
    s_add_u32 m0, s29, 65536
    ds_read_b64_tr_b16 a[162:163], v8 offset:18432
    v_mfma_f32_16x16x32_bf16 v[180:183], a[172:175], v[40:43], v[180:183]
    s_movk_i32 s34, 768
    ds_read_b64_tr_b16 a[164:165], v9 offset:16384
    buffer_load_dwordx4 v4, s[8:11], s34 offen offset:0 lds
    v_mfma_f32_16x16x32_bf16 v[188:191], a[172:175], v[44:47], v[188:191]
    s_waitcnt lgkmcnt(9)
    ds_read_b64_tr_b16 a[166:167], v9 offset:18432
    v_mfma_f32_16x16x32_bf16 v[192:195], a[176:179], v[40:43], v[192:195]
    s_add_u32 s51, s51, 6144
    ds_read_b64_tr_b16 a[168:169], v10 offset:16384
    buffer_load_dwordx4 a[56:59], v0, s[16:19], s51 offen offset:2048 nt
    v_mfma_f32_16x16x32_bf16 v[200:203], a[176:179], v[44:47], v[200:203]
    ds_read_b64_tr_b16 a[170:171], v10 offset:18432
    v_mfma_f32_16x16x32_bf16 v[196:199], a[180:183], v[40:43], v[196:199]
    ds_read_b64_tr_b16 a[172:173], v11 offset:16384
    v_mfma_f32_16x16x32_bf16 v[204:207], a[180:183], v[44:47], v[204:207]
    s_waitcnt lgkmcnt(9)
    ds_read_b64_tr_b16 a[174:175], v11 offset:18432
    v_mfma_f32_16x16x32_bf16 v[208:211], a[184:187], v[40:43], v[208:211]
    ds_read_b64_tr_b16 a[176:177], v12 offset:16384
    buffer_load_dwordx4 a[60:63], v1, s[16:19], s51 offen offset:3072 nt
    v_mfma_f32_16x16x32_bf16 v[216:219], a[184:187], v[44:47], v[216:219]
    ds_read_b64_tr_b16 a[178:179], v12 offset:18432
    v_mfma_f32_16x16x32_bf16 v[212:215], a[188:191], v[40:43], v[212:215]
    ds_read_b64_tr_b16 a[180:181], v13 offset:16384
    buffer_load_dwordx4 v5, s[8:11], s34 offen offset:1024 lds
    v_mfma_f32_16x16x32_bf16 v[220:223], a[188:191], v[44:47], v[220:223]
    s_waitcnt lgkmcnt(7)
    ds_read_b64_tr_b16 a[182:183], v13 offset:18432
    v_mfma_f32_16x16x32_bf16 v[96:99], a[160:163], v[32:35], v[96:99]
    ds_read_b64_tr_b16 a[184:185], v14 offset:16384
    v_mfma_f32_16x16x32_bf16 v[104:107], a[160:163], v[36:39], v[104:107]
    ds_read_b64_tr_b16 a[186:187], v14 offset:18432
    ds_read_b128 v[48:51], v7 offset:16384
    v_mfma_f32_16x16x32_bf16 v[100:103], a[164:167], v[32:35], v[100:103]
    ds_read_b64_tr_b16 a[188:189], v15 offset:16384
    v_mfma_f32_16x16x32_bf16 v[108:111], a[164:167], v[36:39], v[108:111]
    s_waitcnt lgkmcnt(8)
    ds_read_b64_tr_b16 a[190:191], v15 offset:18432
    v_xor_b32 v26, s44, v8
    v_mfma_f32_16x16x32_bf16 v[112:115], a[168:171], v[32:35], v[112:115]
    ds_read_b64_tr_b16 a[160:161], v26 offset:16384
    ds_read_b128 v[52:55], v7 offset:18432
    v_mfma_f32_16x16x32_bf16 v[120:123], a[168:171], v[36:39], v[120:123]
    ds_read_b64_tr_b16 a[162:163], v26 offset:18432
    v_xor_b32 v27, s44, v9
    v_mfma_f32_16x16x32_bf16 v[116:119], a[172:175], v[32:35], v[116:119]
    s_add_u32 s34, s34, 12288
    ds_read_b64_tr_b16 a[164:165], v27 offset:16384
    buffer_load_dwordx4 v4, s[8:11], s34 offen offset:2048 lds
    v_mfma_f32_16x16x32_bf16 v[124:127], a[172:175], v[36:39], v[124:127]
    s_waitcnt lgkmcnt(9)
    ds_read_b64_tr_b16 a[166:167], v27 offset:18432
    v_xor_b32 v26, s44, v10
    v_xor_b32 v17, 64, v17
    v_mfma_f32_16x16x32_bf16 v[128:131], a[176:179], v[32:35], v[128:131]
    ds_read_b64_tr_b16 a[168:169], v26 offset:16384
    v_mfma_f32_16x16x32_bf16 v[136:139], a[176:179], v[36:39], v[136:139]
    ds_read_b64_tr_b16 a[170:171], v26 offset:18432
    v_xor_b32 v27, s44, v11
    v_mfma_f32_16x16x32_bf16 v[132:135], a[180:183], v[32:35], v[132:135]
    ds_read_b64_tr_b16 a[172:173], v27 offset:16384
    ds_read_b128 v[40:43], v17 offset:0
    v_mfma_f32_16x16x32_bf16 v[140:143], a[180:183], v[36:39], v[140:143]
    s_waitcnt lgkmcnt(9)
    ds_read_b64_tr_b16 a[174:175], v27 offset:18432
    v_mfma_f32_16x16x32_bf16 v[144:147], a[184:187], v[32:35], v[144:147]
    ds_read_b64_tr_b16 a[176:177], v8 offset:16640
    v_mfma_f32_16x16x32_bf16 v[152:155], a[184:187], v[36:39], v[152:155]
    ds_read_b64_tr_b16 a[178:179], v8 offset:18688
    ds_read_b128 v[44:47], v17 offset:2048
    v_mfma_f32_16x16x32_bf16 v[148:151], a[188:191], v[32:35], v[148:151]
    ds_read_b64_tr_b16 a[180:181], v9 offset:16640
    buffer_load_dwordx4 v5, s[8:11], s34 offen offset:3072 lds
    v_mfma_f32_16x16x32_bf16 v[156:159], a[188:191], v[36:39], v[156:159]
    s_waitcnt lgkmcnt(9)
    ds_read_b64_tr_b16 a[182:183], v9 offset:18688
    v_mfma_f32_16x16x32_bf16 v[224:227], a[160:163], v[48:51], v[224:227]
    ds_read_b64_tr_b16 a[184:185], v10 offset:16640
    v_xor_b32 v17, 64, v7
    v_mfma_f32_16x16x32_bf16 v[232:235], a[160:163], v[52:55], v[232:235]
    ds_read_b64_tr_b16 a[186:187], v10 offset:18688
    v_mfma_f32_16x16x32_bf16 v[228:231], a[164:167], v[48:51], v[228:231]
    ds_read_b64_tr_b16 a[188:189], v11 offset:16640
    v_mfma_f32_16x16x32_bf16 v[236:239], a[164:167], v[52:55], v[236:239]
    s_waitcnt lgkmcnt(8)
    ds_read_b64_tr_b16 a[190:191], v11 offset:18688
    ds_read_b128 v[56:59], v17 offset:16384
    v_mfma_f32_16x16x32_bf16 v[240:243], a[168:171], v[48:51], v[240:243]
    ds_read_b64_tr_b16 a[160:161], v12 offset:16640
    v_mfma_f32_16x16x32_bf16 v[248:251], a[168:171], v[52:55], v[248:251]
    s_add_u32 m0, s39, 24576
    ds_read_b64_tr_b16 a[162:163], v12 offset:18688
    v_mfma_f32_16x16x32_bf16 v[244:247], a[172:175], v[48:51], v[244:247]
    s_movk_i32 s34, 768
    ds_read_b64_tr_b16 a[164:165], v13 offset:16640
    buffer_load_dwordx4 v6, s[8:11], s34 offen lds
    ds_read_b128 v[60:63], v17 offset:18432
    v_mfma_f32_16x16x32_bf16 v[252:255], a[172:175], v[52:55], v[252:255]
    s_waitcnt lgkmcnt(9)
    ds_read_b64_tr_b16 a[166:167], v13 offset:18688
    v_mfma_f32_16x16x32_bf16 v[160:163], a[176:179], v[32:35], v[160:163]
    ds_read_b64_tr_b16 a[168:169], v14 offset:16640
    v_mfma_f32_16x16x32_bf16 v[168:171], a[176:179], v[36:39], v[168:171]
    ds_read_b64_tr_b16 a[170:171], v14 offset:18688
    v_mfma_f32_16x16x32_bf16 v[164:167], a[180:183], v[32:35], v[164:167]
    ds_read_b64_tr_b16 a[172:173], v15 offset:16640
    v_mfma_f32_16x16x32_bf16 v[172:175], a[180:183], v[36:39], v[172:175]
    s_waitcnt lgkmcnt(9)
    ds_read_b64_tr_b16 a[174:175], v15 offset:18688
    v_mfma_f32_16x16x32_bf16 v[176:179], a[184:187], v[32:35], v[176:179]
    s_waitcnt vmcnt(26)
    s_barrier
    ds_read_b64_tr_b16 a[176:177], v8 offset:32768
    v_mfma_f32_16x16x32_bf16 v[184:187], a[184:187], v[36:39], v[184:187]
    s_add_u32 m0, s29, 81920
    ds_read_b64_tr_b16 a[178:179], v8 offset:34816
    v_mfma_f32_16x16x32_bf16 v[180:183], a[188:191], v[32:35], v[180:183]
    s_add_u32 s34, s32, 3145728
    ds_read_b64_tr_b16 a[180:181], v9 offset:32768
    buffer_load_dwordx4 v2, s[12:15], s34 offen offset:0 nt lds
    v_mfma_f32_16x16x32_bf16 v[188:191], a[188:191], v[36:39], v[188:191]
    s_waitcnt lgkmcnt(7)
    ds_read_b64_tr_b16 a[182:183], v9 offset:34816
    v_mfma_f32_16x16x32_bf16 v[192:195], a[160:163], v[32:35], v[192:195]
    ds_read_b64_tr_b16 a[184:185], v10 offset:32768
    v_mfma_f32_16x16x32_bf16 v[200:203], a[160:163], v[36:39], v[200:203]
    ds_read_b64_tr_b16 a[186:187], v10 offset:34816
    v_mfma_f32_16x16x32_bf16 v[196:199], a[164:167], v[32:35], v[196:199]
    ds_read_b64_tr_b16 a[188:189], v11 offset:32768
    v_mfma_f32_16x16x32_bf16 v[204:207], a[164:167], v[36:39], v[204:207]
    s_waitcnt lgkmcnt(7)
    ds_read_b64_tr_b16 a[190:191], v11 offset:34816
    buffer_load_dwordx4 v3, s[12:15], s34 offen offset:1024 nt lds
    v_mfma_f32_16x16x32_bf16 v[208:211], a[168:171], v[32:35], v[208:211]
    ds_read_b64_tr_b16 a[160:161], v12 offset:32768
    v_mfma_f32_16x16x32_bf16 v[216:219], a[168:171], v[36:39], v[216:219]
    ds_read_b64_tr_b16 a[162:163], v12 offset:34816
    v_mfma_f32_16x16x32_bf16 v[212:215], a[172:175], v[32:35], v[212:215]
    ds_read_b64_tr_b16 a[164:165], v13 offset:32768
    v_mfma_f32_16x16x32_bf16 v[220:223], a[172:175], v[36:39], v[220:223]
    s_waitcnt lgkmcnt(7)
    ds_read_b64_tr_b16 a[166:167], v13 offset:34816
    v_mfma_f32_16x16x32_bf16 v[96:99], a[176:179], v[40:43], v[96:99]
    s_add_u32 s34, s34, 30720
    ds_read_b64_tr_b16 a[168:169], v14 offset:32768
    buffer_load_dwordx4 v2, s[12:15], s34 offen offset:2048 nt lds
    v_mfma_f32_16x16x32_bf16 v[104:107], a[176:179], v[44:47], v[104:107]
    ds_read_b64_tr_b16 a[170:171], v14 offset:34816
    v_mfma_f32_16x16x32_bf16 v[100:103], a[180:183], v[40:43], v[100:103]
    ds_read_b64_tr_b16 a[172:173], v15 offset:32768
    v_mfma_f32_16x16x32_bf16 v[108:111], a[180:183], v[44:47], v[108:111]
    s_waitcnt lgkmcnt(7)
    ds_read_b64_tr_b16 a[174:175], v15 offset:34816
    v_xor_b32 v26, s44, v8
    v_mfma_f32_16x16x32_bf16 v[112:115], a[184:187], v[40:43], v[112:115]
    ds_read_b64_tr_b16 a[176:177], v26 offset:32768
    v_mfma_f32_16x16x32_bf16 v[120:123], a[184:187], v[44:47], v[120:123]
    ds_read_b64_tr_b16 a[178:179], v26 offset:34816
    buffer_load_dwordx4 v3, s[12:15], s34 offen offset:3072 nt lds
    v_xor_b32 v27, s44, v9
    v_mfma_f32_16x16x32_bf16 v[116:119], a[188:191], v[40:43], v[116:119]
    ds_read_b64_tr_b16 a[180:181], v27 offset:32768
    v_mfma_f32_16x16x32_bf16 v[124:127], a[188:191], v[44:47], v[124:127]
    s_waitcnt lgkmcnt(7)
    ds_read_b64_tr_b16 a[182:183], v27 offset:34816
    v_xor_b32 v26, s44, v10
    v_mfma_f32_16x16x32_bf16 v[128:131], a[160:163], v[40:43], v[128:131]
    ds_read_b64_tr_b16 a[184:185], v26 offset:32768
    v_mfma_f32_16x16x32_bf16 v[136:139], a[160:163], v[44:47], v[136:139]
    s_add_u32 m0, s29, 98304
    ds_read_b64_tr_b16 a[186:187], v26 offset:34816
    v_xor_b32 v27, s44, v11
    v_mfma_f32_16x16x32_bf16 v[132:135], a[164:167], v[40:43], v[132:135]
    s_add_u32 s34, s32, 3407872
    ds_read_b64_tr_b16 a[188:189], v27 offset:32768
    buffer_load_dwordx4 v2, s[12:15], s34 offen offset:0 nt lds
    v_mfma_f32_16x16x32_bf16 v[140:143], a[164:167], v[44:47], v[140:143]
    s_waitcnt lgkmcnt(7)
    ds_read_b64_tr_b16 a[190:191], v27 offset:34816
    v_mfma_f32_16x16x32_bf16 v[144:147], a[168:171], v[40:43], v[144:147]
    ds_read_b64_tr_b16 a[160:161], v8 offset:33024
    v_mfma_f32_16x16x32_bf16 v[152:155], a[168:171], v[44:47], v[152:155]
    ds_read_b64_tr_b16 a[162:163], v8 offset:35072
    v_xor_b32 v8, 0x10000, v8
    v_mfma_f32_16x16x32_bf16 v[148:151], a[172:175], v[40:43], v[148:151]
    ds_read_b64_tr_b16 a[164:165], v9 offset:33024
    v_mfma_f32_16x16x32_bf16 v[156:159], a[172:175], v[44:47], v[156:159]
    s_waitcnt lgkmcnt(7)
    ds_read_b64_tr_b16 a[166:167], v9 offset:35072
    buffer_load_dwordx4 v3, s[12:15], s34 offen offset:1024 nt lds
    v_xor_b32 v9, 0x10000, v9
    v_mfma_f32_16x16x32_bf16 v[224:227], a[176:179], v[56:59], v[224:227]
    ds_read_b64_tr_b16 a[168:169], v10 offset:33024
    v_mfma_f32_16x16x32_bf16 v[232:235], a[176:179], v[60:63], v[232:235]
    ds_read_b64_tr_b16 a[170:171], v10 offset:35072
    v_xor_b32 v10, 0x10000, v10
    v_mfma_f32_16x16x32_bf16 v[228:231], a[180:183], v[56:59], v[228:231]
    ds_read_b64_tr_b16 a[172:173], v11 offset:33024
    v_mfma_f32_16x16x32_bf16 v[236:239], a[180:183], v[60:63], v[236:239]
    s_waitcnt lgkmcnt(7)
    ds_read_b64_tr_b16 a[174:175], v11 offset:35072
    v_xor_b32 v11, 0x10000, v11
    v_mfma_f32_16x16x32_bf16 v[240:243], a[184:187], v[56:59], v[240:243]
    s_add_u32 s34, s34, 30720
    ds_read_b64_tr_b16 a[176:177], v12 offset:33024
    buffer_load_dwordx4 v2, s[12:15], s34 offen offset:2048 nt lds
    v_mfma_f32_16x16x32_bf16 v[248:251], a[184:187], v[60:63], v[248:251]
    ds_read_b64_tr_b16 a[178:179], v12 offset:35072
    v_xor_b32 v12, 0x10000, v12
    v_mfma_f32_16x16x32_bf16 v[244:247], a[188:191], v[56:59], v[244:247]
    ds_read_b64_tr_b16 a[180:181], v13 offset:33024
    v_mfma_f32_16x16x32_bf16 v[252:255], a[188:191], v[60:63], v[252:255]
    s_waitcnt lgkmcnt(7)
    ds_read_b64_tr_b16 a[182:183], v13 offset:35072
    v_xor_b32 v13, 0x10000, v13
    v_mfma_f32_16x16x32_bf16 v[160:163], a[160:163], v[40:43], v[160:163]
    ds_read_b64_tr_b16 a[184:185], v14 offset:33024
    v_mfma_f32_16x16x32_bf16 v[168:171], a[160:163], v[44:47], v[168:171]
    s_add_u32 s51, s26, 65664
    ds_read_b64_tr_b16 a[186:187], v14 offset:35072
    buffer_load_dwordx4 v3, s[12:15], s34 offen offset:3072 nt lds
    buffer_load_dwordx4 a[64:67], v0, s[16:19], s51 offen offset:0 nt
    v_xor_b32 v14, 0x10000, v14
    v_mfma_f32_16x16x32_bf16 v[164:167], a[164:167], v[40:43], v[164:167]
    ds_read_b64_tr_b16 a[188:189], v15 offset:33024
    v_add_u32 v17, s41, v7
    v_mfma_f32_16x16x32_bf16 v[172:175], a[164:167], v[44:47], v[172:175]
    s_waitcnt lgkmcnt(7)
    ds_read_b64_tr_b16 a[190:191], v15 offset:35072
    v_xor_b32 v15, 0x10000, v15
    v_mfma_f32_16x16x32_bf16 v[176:179], a[168:171], v[40:43], v[176:179]
    s_waitcnt vmcnt(22)
    s_barrier
    ds_read_b128 v[32:35], v17 offset:49152
    ds_read_b128 v[36:39], v17 offset:51200
    ds_read_b64_tr_b16 a[160:161], v8 offset:0
    v_mfma_f32_16x16x32_bf16 v[184:187], a[168:171], v[44:47], v[184:187]
    ds_read_b64_tr_b16 a[162:163], v8 offset:2048
    buffer_load_dwordx4 a[68:71], v1, s[16:19], s51 offen offset:1024 nt
    v_add_u32 v31, s41, v16
    v_mfma_f32_16x16x32_bf16 v[180:183], a[172:175], v[40:43], v[180:183]
    ds_read_b64_tr_b16 a[164:165], v9 offset:0
    ds_write_b128 v31, v[80:83] offset:16384
    v_mfma_f32_16x16x32_bf16 v[188:191], a[172:175], v[44:47], v[188:191]
    s_waitcnt lgkmcnt(10)
    ds_read_b64_tr_b16 a[166:167], v9 offset:2048
    v_mfma_f32_16x16x32_bf16 v[192:195], a[176:179], v[40:43], v[192:195]
    ds_read_b64_tr_b16 a[168:169], v10 offset:0
    v_mfma_f32_16x16x32_bf16 v[200:203], a[176:179], v[44:47], v[200:203]
    s_add_u32 s51, s51, 6144
    ds_read_b64_tr_b16 a[170:171], v10 offset:2048
    buffer_load_dwordx4 a[72:75], v0, s[16:19], s51 offen offset:2048 nt
    v_mfma_f32_16x16x32_bf16 v[196:199], a[180:183], v[40:43], v[196:199]
    ds_read_b64_tr_b16 a[172:173], v11 offset:0
    v_mfma_f32_16x16x32_bf16 v[204:207], a[180:183], v[44:47], v[204:207]
    s_waitcnt lgkmcnt(10)
    ds_read_b64_tr_b16 a[174:175], v11 offset:2048
    v_mfma_f32_16x16x32_bf16 v[208:211], a[184:187], v[40:43], v[208:211]
    ds_read_b64_tr_b16 a[176:177], v12 offset:0
    v_mfma_f32_16x16x32_bf16 v[216:219], a[184:187], v[44:47], v[216:219]
    ds_read_b64_tr_b16 a[178:179], v12 offset:2048
    buffer_load_dwordx4 a[76:79], v1, s[16:19], s51 offen offset:3072 nt
    v_mfma_f32_16x16x32_bf16 v[212:215], a[188:191], v[40:43], v[212:215]
    ds_read_b64_tr_b16 a[180:181], v13 offset:0
    ds_write_b128 v31, v[84:87] offset:17408
    v_mfma_f32_16x16x32_bf16 v[220:223], a[188:191], v[44:47], v[220:223]
    s_waitcnt lgkmcnt(8)
    ds_read_b64_tr_b16 a[182:183], v13 offset:2048
    v_mfma_f32_16x16x32_bf16 v[96:99], a[160:163], v[32:35], v[96:99]
    ds_read_b64_tr_b16 a[184:185], v14 offset:0
    buffer_load_dword a233, v16, s[56:59], s42 offen
    v_mfma_f32_16x16x32_bf16 v[104:107], a[160:163], v[36:39], v[104:107]
    ds_read_b64_tr_b16 a[186:187], v14 offset:2048
    ds_read_b128 v[48:51], v7 offset:20480
    v_mfma_f32_16x16x32_bf16 v[100:103], a[164:167], v[32:35], v[100:103]
    ds_read_b64_tr_b16 a[188:189], v15 offset:0
    v_mfma_f32_16x16x32_bf16 v[108:111], a[164:167], v[36:39], v[108:111]
    s_waitcnt lgkmcnt(9)
    ds_read_b64_tr_b16 a[190:191], v15 offset:2048
    v_xor_b32 v26, s44, v8
    v_accvgpr_read_b32 v28, a232
    v_mfma_f32_16x16x32_bf16 v[112:115], a[168:171], v[32:35], v[112:115]
    s_add_u32 s32, s32, 4096
    ds_read_b64_tr_b16 a[160:161], v26 offset:0
    buffer_load_dword a233, v28, s[12:15], s32 offen
    ds_read_b128 v[52:55], v7 offset:22528
    v_mfma_f32_16x16x32_bf16 v[120:123], a[168:171], v[36:39], v[120:123]
    ds_read_b64_tr_b16 a[162:163], v26 offset:2048
    v_xor_b32 v27, s44, v9
    v_mfma_f32_16x16x32_bf16 v[116:119], a[172:175], v[32:35], v[116:119]
    ds_read_b64_tr_b16 a[164:165], v27 offset:0
    ds_write_b128 v31, v[88:91] offset:18432
    v_mfma_f32_16x16x32_bf16 v[124:127], a[172:175], v[36:39], v[124:127]
    s_waitcnt lgkmcnt(10)
    ds_read_b64_tr_b16 a[166:167], v27 offset:2048
    v_xor_b32 v26, s44, v10
    v_xor_b32 v17, 64, v17
    v_mfma_f32_16x16x32_bf16 v[128:131], a[176:179], v[32:35], v[128:131]
    ds_read_b64_tr_b16 a[168:169], v26 offset:0
    v_mfma_f32_16x16x32_bf16 v[136:139], a[176:179], v[36:39], v[136:139]
    ds_read_b64_tr_b16 a[170:171], v26 offset:2048
    v_xor_b32 v27, s44, v11
    v_mfma_f32_16x16x32_bf16 v[132:135], a[180:183], v[32:35], v[132:135]
    ds_read_b64_tr_b16 a[172:173], v27 offset:0
    ds_read_b128 v[40:43], v17 offset:49152
    v_mfma_f32_16x16x32_bf16 v[140:143], a[180:183], v[36:39], v[140:143]
    s_waitcnt lgkmcnt(10)
    ds_read_b64_tr_b16 a[174:175], v27 offset:2048
    v_mfma_f32_16x16x32_bf16 v[144:147], a[184:187], v[32:35], v[144:147]
    ds_read_b64_tr_b16 a[176:177], v8 offset:256
    v_mfma_f32_16x16x32_bf16 v[152:155], a[184:187], v[36:39], v[152:155]
    ds_read_b64_tr_b16 a[178:179], v8 offset:2304
    ds_read_b128 v[44:47], v17 offset:51200
    v_mfma_f32_16x16x32_bf16 v[148:151], a[188:191], v[32:35], v[148:151]
    ds_read_b64_tr_b16 a[180:181], v9 offset:256
    ds_write_b128 v31, v[92:95] offset:19456
    v_mfma_f32_16x16x32_bf16 v[156:159], a[188:191], v[36:39], v[156:159]
    s_waitcnt lgkmcnt(10)
    ds_read_b64_tr_b16 a[182:183], v9 offset:2304
    v_mfma_f32_16x16x32_bf16 v[224:227], a[160:163], v[48:51], v[224:227]
    ds_read_b64_tr_b16 a[184:185], v10 offset:256
    v_xor_b32 v17, 64, v7
    v_mfma_f32_16x16x32_bf16 v[232:235], a[160:163], v[52:55], v[232:235]
    ds_read_b64_tr_b16 a[186:187], v10 offset:2304
    v_mfma_f32_16x16x32_bf16 v[228:231], a[164:167], v[48:51], v[228:231]
    ds_read_b64_tr_b16 a[188:189], v11 offset:256
    v_mfma_f32_16x16x32_bf16 v[236:239], a[164:167], v[52:55], v[236:239]
    s_waitcnt lgkmcnt(9)
    ds_read_b64_tr_b16 a[190:191], v11 offset:2304
    ds_read_b128 v[56:59], v17 offset:20480
    v_mfma_f32_16x16x32_bf16 v[240:243], a[168:171], v[48:51], v[240:243]
    ds_read_b64_tr_b16 a[160:161], v12 offset:256
    v_mfma_f32_16x16x32_bf16 v[248:251], a[168:171], v[52:55], v[248:251]
    ds_read_b64_tr_b16 a[162:163], v12 offset:2304
    v_mfma_f32_16x16x32_bf16 v[244:247], a[172:175], v[48:51], v[244:247]
    ds_read_b64_tr_b16 a[164:165], v13 offset:256
    ds_read_b128 v[60:63], v17 offset:22528
    v_mfma_f32_16x16x32_bf16 v[252:255], a[172:175], v[52:55], v[252:255]
    s_waitcnt lgkmcnt(9)
    ds_read_b64_tr_b16 a[166:167], v13 offset:2304
    v_mfma_f32_16x16x32_bf16 v[160:163], a[176:179], v[32:35], v[160:163]
    ds_read_b64_tr_b16 a[168:169], v14 offset:256
    v_mfma_f32_16x16x32_bf16 v[168:171], a[176:179], v[36:39], v[168:171]
    ds_read_b64_tr_b16 a[170:171], v14 offset:2304
    v_mfma_f32_16x16x32_bf16 v[164:167], a[180:183], v[32:35], v[164:167]
    ds_read_b64_tr_b16 a[172:173], v15 offset:256
    v_mfma_f32_16x16x32_bf16 v[172:175], a[180:183], v[36:39], v[172:175]
    s_waitcnt lgkmcnt(9)
    ds_read_b64_tr_b16 a[174:175], v15 offset:2304
    v_mfma_f32_16x16x32_bf16 v[176:179], a[184:187], v[32:35], v[176:179]
    s_waitcnt vmcnt(22)
    s_barrier
    ds_read_b64_tr_b16 a[176:177], v8 offset:16384
    v_mfma_f32_16x16x32_bf16 v[184:187], a[184:187], v[36:39], v[184:187]
    ds_read_b64_tr_b16 a[178:179], v8 offset:18432
    v_add_u32 v31, s41, v16
    v_mfma_f32_16x16x32_bf16 v[180:183], a[188:191], v[32:35], v[180:183]
    ds_read_b64_tr_b16 a[180:181], v9 offset:16384
    ds_write_b128 v31, a[0:3] offset:32768
    v_mfma_f32_16x16x32_bf16 v[188:191], a[188:191], v[36:39], v[188:191]
    s_waitcnt lgkmcnt(8)
    ds_read_b64_tr_b16 a[182:183], v9 offset:18432
    v_mfma_f32_16x16x32_bf16 v[192:195], a[160:163], v[32:35], v[192:195]
    ds_read_b64_tr_b16 a[184:185], v10 offset:16384
    v_mfma_f32_16x16x32_bf16 v[200:203], a[160:163], v[36:39], v[200:203]
    ds_read_b64_tr_b16 a[186:187], v10 offset:18432
    v_mfma_f32_16x16x32_bf16 v[196:199], a[164:167], v[32:35], v[196:199]
    ds_read_b64_tr_b16 a[188:189], v11 offset:16384
    v_mfma_f32_16x16x32_bf16 v[204:207], a[164:167], v[36:39], v[204:207]
    s_waitcnt lgkmcnt(8)
    ds_read_b64_tr_b16 a[190:191], v11 offset:18432
    ds_write_b128 v31, a[4:7] offset:33792
    v_mfma_f32_16x16x32_bf16 v[208:211], a[168:171], v[32:35], v[208:211]
    ds_read_b64_tr_b16 a[160:161], v12 offset:16384
    v_mfma_f32_16x16x32_bf16 v[216:219], a[168:171], v[36:39], v[216:219]
    ds_read_b64_tr_b16 a[162:163], v12 offset:18432
    v_mfma_f32_16x16x32_bf16 v[212:215], a[172:175], v[32:35], v[212:215]
    ds_read_b64_tr_b16 a[164:165], v13 offset:16384
    v_mfma_f32_16x16x32_bf16 v[220:223], a[172:175], v[36:39], v[220:223]
    s_waitcnt lgkmcnt(8)
    ds_read_b64_tr_b16 a[166:167], v13 offset:18432
    v_mfma_f32_16x16x32_bf16 v[96:99], a[176:179], v[40:43], v[96:99]
    ds_read_b64_tr_b16 a[168:169], v14 offset:16384
    ds_write_b128 v31, a[8:11] offset:34816
    v_mfma_f32_16x16x32_bf16 v[104:107], a[176:179], v[44:47], v[104:107]
    ds_read_b64_tr_b16 a[170:171], v14 offset:18432
    v_mfma_f32_16x16x32_bf16 v[100:103], a[180:183], v[40:43], v[100:103]
    ds_read_b64_tr_b16 a[172:173], v15 offset:16384
    v_mfma_f32_16x16x32_bf16 v[108:111], a[180:183], v[44:47], v[108:111]
    s_waitcnt lgkmcnt(9)
    ds_read_b64_tr_b16 a[174:175], v15 offset:18432
    v_xor_b32 v26, s44, v8
    v_mfma_f32_16x16x32_bf16 v[112:115], a[184:187], v[40:43], v[112:115]
    ds_read_b64_tr_b16 a[176:177], v26 offset:16384
    v_mfma_f32_16x16x32_bf16 v[120:123], a[184:187], v[44:47], v[120:123]
    ds_read_b64_tr_b16 a[178:179], v26 offset:18432
    ds_write_b128 v31, a[12:15] offset:35840
    v_xor_b32 v27, s44, v9
    v_mfma_f32_16x16x32_bf16 v[116:119], a[188:191], v[40:43], v[116:119]
    ds_read_b64_tr_b16 a[180:181], v27 offset:16384
    v_mfma_f32_16x16x32_bf16 v[124:127], a[188:191], v[44:47], v[124:127]
    s_waitcnt lgkmcnt(9)
    ds_read_b64_tr_b16 a[182:183], v27 offset:18432
    v_xor_b32 v26, s44, v10
    v_mfma_f32_16x16x32_bf16 v[128:131], a[160:163], v[40:43], v[128:131]
    ds_read_b64_tr_b16 a[184:185], v26 offset:16384
    v_mfma_f32_16x16x32_bf16 v[136:139], a[160:163], v[44:47], v[136:139]
    ds_read_b64_tr_b16 a[186:187], v26 offset:18432
    v_xor_b32 v27, s44, v11
    v_add_u32 v31, s41, v16
    v_mfma_f32_16x16x32_bf16 v[132:135], a[164:167], v[40:43], v[132:135]
    ds_read_b64_tr_b16 a[188:189], v27 offset:16384
    ds_write_b128 v31, a[16:19] offset:49152
    v_mfma_f32_16x16x32_bf16 v[140:143], a[164:167], v[44:47], v[140:143]
    s_waitcnt lgkmcnt(9)
    ds_read_b64_tr_b16 a[190:191], v27 offset:18432
    v_mfma_f32_16x16x32_bf16 v[144:147], a[168:171], v[40:43], v[144:147]
    ds_read_b64_tr_b16 a[160:161], v8 offset:16640
    v_mfma_f32_16x16x32_bf16 v[152:155], a[168:171], v[44:47], v[152:155]
    ds_read_b64_tr_b16 a[162:163], v8 offset:18688
    v_mfma_f32_16x16x32_bf16 v[148:151], a[172:175], v[40:43], v[148:151]
    ds_read_b64_tr_b16 a[164:165], v9 offset:16640
    v_mfma_f32_16x16x32_bf16 v[156:159], a[172:175], v[44:47], v[156:159]
    s_waitcnt lgkmcnt(8)
    ds_read_b64_tr_b16 a[166:167], v9 offset:18688
    ds_write_b128 v31, a[20:23] offset:50176
    v_mfma_f32_16x16x32_bf16 v[224:227], a[176:179], v[56:59], v[224:227]
    ds_read_b64_tr_b16 a[168:169], v10 offset:16640
    v_mfma_f32_16x16x32_bf16 v[232:235], a[176:179], v[60:63], v[232:235]
    ds_read_b64_tr_b16 a[170:171], v10 offset:18688
    v_mfma_f32_16x16x32_bf16 v[228:231], a[180:183], v[56:59], v[228:231]
    ds_read_b64_tr_b16 a[172:173], v11 offset:16640
    v_mfma_f32_16x16x32_bf16 v[236:239], a[180:183], v[60:63], v[236:239]
    s_waitcnt lgkmcnt(8)
    ds_read_b64_tr_b16 a[174:175], v11 offset:18688
    v_mfma_f32_16x16x32_bf16 v[240:243], a[184:187], v[56:59], v[240:243]
    ds_read_b64_tr_b16 a[176:177], v12 offset:16640
    ds_write_b128 v31, a[24:27] offset:51200
    v_mfma_f32_16x16x32_bf16 v[248:251], a[184:187], v[60:63], v[248:251]
    ds_read_b64_tr_b16 a[178:179], v12 offset:18688
    v_mfma_f32_16x16x32_bf16 v[244:247], a[188:191], v[56:59], v[244:247]
    ds_read_b64_tr_b16 a[180:181], v13 offset:16640
    v_mfma_f32_16x16x32_bf16 v[252:255], a[188:191], v[60:63], v[252:255]
    s_waitcnt lgkmcnt(9)
    ds_read_b64_tr_b16 a[182:183], v13 offset:18688
    v_mfma_f32_16x16x32_bf16 v[160:163], a[160:163], v[40:43], v[160:163]
    ds_read_b64_tr_b16 a[184:185], v14 offset:16640
    v_mfma_f32_16x16x32_bf16 v[168:171], a[160:163], v[44:47], v[168:171]
    ds_read_b64_tr_b16 a[186:187], v14 offset:18688
    ds_write_b128 v31, a[28:31] offset:52224
    v_mfma_f32_16x16x32_bf16 v[164:167], a[164:167], v[40:43], v[164:167]
    ds_read_b64_tr_b16 a[188:189], v15 offset:16640
    v_add_u32 v17, s40, v7
    v_mfma_f32_16x16x32_bf16 v[172:175], a[164:167], v[44:47], v[172:175]
    s_waitcnt lgkmcnt(9)
    ds_read_b64_tr_b16 a[190:191], v15 offset:18688
    v_mfma_f32_16x16x32_bf16 v[176:179], a[168:171], v[40:43], v[176:179]
    s_waitcnt vmcnt(10) lgkmcnt(2)
    s_barrier
    ds_read_b128 v[32:35], v17 offset:32768
    ds_read_b128 v[36:39], v17 offset:34816
    ds_read_b64_tr_b16 a[160:161], v8 offset:49152
    v_mfma_f32_16x16x32_bf16 v[184:187], a[168:171], v[44:47], v[184:187]
    ds_read_b64_tr_b16 a[162:163], v8 offset:51200
    v_add_u32 v31, s40, v16
    v_mfma_f32_16x16x32_bf16 v[180:183], a[172:175], v[40:43], v[180:183]
    ds_read_b64_tr_b16 a[164:165], v9 offset:49152
    ds_write_b128 v31, a[32:35] offset:0
    v_mfma_f32_16x16x32_bf16 v[188:191], a[172:175], v[44:47], v[188:191]
    ds_read_b64_tr_b16 a[166:167], v9 offset:51200
    v_mfma_f32_16x16x32_bf16 v[192:195], a[176:179], v[40:43], v[192:195]
    ds_read_b64_tr_b16 a[168:169], v10 offset:49152
    v_mfma_f32_16x16x32_bf16 v[200:203], a[176:179], v[44:47], v[200:203]
    ds_read_b64_tr_b16 a[170:171], v10 offset:51200
    v_mfma_f32_16x16x32_bf16 v[196:199], a[180:183], v[40:43], v[196:199]
    ds_read_b64_tr_b16 a[172:173], v11 offset:49152
    v_mfma_f32_16x16x32_bf16 v[204:207], a[180:183], v[44:47], v[204:207]
    s_waitcnt lgkmcnt(10)
    ds_read_b64_tr_b16 a[174:175], v11 offset:51200
    v_mfma_f32_16x16x32_bf16 v[208:211], a[184:187], v[40:43], v[208:211]
    ds_read_b64_tr_b16 a[176:177], v12 offset:49152
    v_mfma_f32_16x16x32_bf16 v[216:219], a[184:187], v[44:47], v[216:219]
    ds_read_b64_tr_b16 a[178:179], v12 offset:51200
    v_mfma_f32_16x16x32_bf16 v[212:215], a[188:191], v[40:43], v[212:215]
    ds_read_b64_tr_b16 a[180:181], v13 offset:49152
    ds_write_b128 v31, a[36:39] offset:1024
    v_mfma_f32_16x16x32_bf16 v[220:223], a[188:191], v[44:47], v[220:223]
    s_waitcnt lgkmcnt(8)
    ds_read_b64_tr_b16 a[182:183], v13 offset:51200
    v_mfma_f32_16x16x32_bf16 v[96:99], a[160:163], v[32:35], v[96:99]
    ds_read_b64_tr_b16 a[184:185], v14 offset:49152
    v_mfma_f32_16x16x32_bf16 v[104:107], a[160:163], v[36:39], v[104:107]
    ds_read_b64_tr_b16 a[186:187], v14 offset:51200
    ds_read_b128 v[48:51], v7 offset:24576
    v_mfma_f32_16x16x32_bf16 v[100:103], a[164:167], v[32:35], v[100:103]
    ds_read_b64_tr_b16 a[188:189], v15 offset:49152
    v_mfma_f32_16x16x32_bf16 v[108:111], a[164:167], v[36:39], v[108:111]
    s_waitcnt lgkmcnt(9)
    ds_read_b64_tr_b16 a[190:191], v15 offset:51200
    v_xor_b32 v26, s44, v8
    v_mfma_f32_16x16x32_bf16 v[112:115], a[168:171], v[32:35], v[112:115]
    s_nop 0
A_stub2:
    s_cbranch_execz A_stub6
    ds_read_b64_tr_b16 a[160:161], v26 offset:49152
    ds_read_b128 v[52:55], v7 offset:26624
    v_mfma_f32_16x16x32_bf16 v[120:123], a[168:171], v[36:39], v[120:123]
    ds_read_b64_tr_b16 a[162:163], v26 offset:51200
    v_xor_b32 v27, s44, v9
    v_mfma_f32_16x16x32_bf16 v[116:119], a[172:175], v[32:35], v[116:119]
    ds_read_b64_tr_b16 a[164:165], v27 offset:49152
    ds_write_b128 v31, a[40:43] offset:2048
    v_mfma_f32_16x16x32_bf16 v[124:127], a[172:175], v[36:39], v[124:127]
    s_waitcnt lgkmcnt(10)
    ds_read_b64_tr_b16 a[166:167], v27 offset:51200
    v_xor_b32 v26, s44, v10
    v_xor_b32 v17, 64, v17
    v_mfma_f32_16x16x32_bf16 v[128:131], a[176:179], v[32:35], v[128:131]
    ds_read_b64_tr_b16 a[168:169], v26 offset:49152
    v_mfma_f32_16x16x32_bf16 v[136:139], a[176:179], v[36:39], v[136:139]
    ds_read_b64_tr_b16 a[170:171], v26 offset:51200
    v_xor_b32 v27, s44, v11
    v_mfma_f32_16x16x32_bf16 v[132:135], a[180:183], v[32:35], v[132:135]
    ds_read_b64_tr_b16 a[172:173], v27 offset:49152
    ds_read_b128 v[40:43], v17 offset:32768
    v_mfma_f32_16x16x32_bf16 v[140:143], a[180:183], v[36:39], v[140:143]
    s_waitcnt lgkmcnt(10)
    ds_read_b64_tr_b16 a[174:175], v27 offset:51200
    v_mfma_f32_16x16x32_bf16 v[144:147], a[184:187], v[32:35], v[144:147]
    ds_read_b64_tr_b16 a[176:177], v8 offset:49408
    v_mfma_f32_16x16x32_bf16 v[152:155], a[184:187], v[36:39], v[152:155]
    ds_read_b64_tr_b16 a[178:179], v8 offset:51456
    ds_read_b128 v[44:47], v17 offset:34816
    v_xor_b32 v8, 0x10000, v8
    v_mfma_f32_16x16x32_bf16 v[148:151], a[188:191], v[32:35], v[148:151]
    ds_read_b64_tr_b16 a[180:181], v9 offset:49408
    ds_write_b128 v31, a[44:47] offset:3072
    v_mfma_f32_16x16x32_bf16 v[156:159], a[188:191], v[36:39], v[156:159]
    s_waitcnt lgkmcnt(10)
    ds_read_b64_tr_b16 a[182:183], v9 offset:51456
    v_xor_b32 v9, 0x10000, v9
    v_mfma_f32_16x16x32_bf16 v[224:227], a[160:163], v[48:51], v[224:227]
    ds_read_b64_tr_b16 a[184:185], v10 offset:49408
    v_xor_b32 v17, 64, v7
    v_mfma_f32_16x16x32_bf16 v[232:235], a[160:163], v[52:55], v[232:235]
    ds_read_b64_tr_b16 a[186:187], v10 offset:51456
    v_xor_b32 v10, 0x10000, v10
    v_mfma_f32_16x16x32_bf16 v[228:231], a[164:167], v[48:51], v[228:231]
    ds_read_b64_tr_b16 a[188:189], v11 offset:49408
    v_mfma_f32_16x16x32_bf16 v[236:239], a[164:167], v[52:55], v[236:239]
    s_waitcnt lgkmcnt(9)
    ds_read_b64_tr_b16 a[190:191], v11 offset:51456
    ds_read_b128 v[56:59], v17 offset:24576
    v_xor_b32 v11, 0x10000, v11
    v_mfma_f32_16x16x32_bf16 v[240:243], a[168:171], v[48:51], v[240:243]
    ds_read_b64_tr_b16 a[160:161], v12 offset:49408
    v_mfma_f32_16x16x32_bf16 v[248:251], a[168:171], v[52:55], v[248:251]
    ds_read_b64_tr_b16 a[162:163], v12 offset:51456
    v_xor_b32 v12, 0x10000, v12
    v_mfma_f32_16x16x32_bf16 v[244:247], a[172:175], v[48:51], v[244:247]
    ds_read_b64_tr_b16 a[164:165], v13 offset:49408
    ds_read_b128 v[60:63], v17 offset:26624
    v_mfma_f32_16x16x32_bf16 v[252:255], a[172:175], v[52:55], v[252:255]
    s_waitcnt lgkmcnt(9)
    ds_read_b64_tr_b16 a[166:167], v13 offset:51456
    v_xor_b32 v13, 0x10000, v13
    v_mfma_f32_16x16x32_bf16 v[160:163], a[176:179], v[32:35], v[160:163]
    ds_read_b64_tr_b16 a[168:169], v14 offset:49408
    v_mfma_f32_16x16x32_bf16 v[168:171], a[176:179], v[36:39], v[168:171]
    ds_read_b64_tr_b16 a[170:171], v14 offset:51456
    v_xor_b32 v14, 0x10000, v14
    v_mfma_f32_16x16x32_bf16 v[164:167], a[180:183], v[32:35], v[164:167]
    ds_read_b64_tr_b16 a[172:173], v15 offset:49408
    v_mfma_f32_16x16x32_bf16 v[172:175], a[180:183], v[36:39], v[172:175]
    s_waitcnt lgkmcnt(9)
    ds_read_b64_tr_b16 a[174:175], v15 offset:51456
    v_xor_b32 v15, 0x10000, v15
    v_xor_b32 v26, s44, v8
    v_mfma_f32_16x16x32_bf16 v[176:179], a[184:187], v[32:35], v[176:179]
    s_waitcnt vmcnt(6)
    s_barrier
    ds_read_b64_tr_b16 a[176:177], v26 offset:0
    v_mfma_f32_16x16x32_bf16 v[184:187], a[184:187], v[36:39], v[184:187]
    ds_read_b64_tr_b16 a[178:179], v26 offset:2048
    v_xor_b32 v27, s44, v9
    v_add_u32 v31, s40, v16
    v_mfma_f32_16x16x32_bf16 v[180:183], a[188:191], v[32:35], v[180:183]
    ds_read_b64_tr_b16 a[180:181], v27 offset:0
    ds_write_b128 v31, a[48:51] offset:16384
    s_add_u32 s35, s7, s28
    s_cmp_lg_u32 s35, 0
    s_cbranch_scc1 L_noarm
    s_waitcnt vmcnt(0)
    v_mov_b32 v28, s100
    v_mov_b32 v29, 1
    s_mov_b64 exec, 1
    buffer_atomic_add v29, v28, s[92:95], 0 offen sc1
    s_mov_b64 exec, -1
L_noarm:
    v_mfma_f32_16x16x32_bf16 v[188:191], a[188:191], v[36:39], v[188:191]
    s_waitcnt lgkmcnt(8)
    ds_read_b64_tr_b16 a[182:183], v27 offset:2048
    v_xor_b32 v26, s44, v10
    v_mfma_f32_16x16x32_bf16 v[192:195], a[160:163], v[32:35], v[192:195]
    ds_read_b64_tr_b16 a[184:185], v26 offset:0
    v_mfma_f32_16x16x32_bf16 v[200:203], a[160:163], v[36:39], v[200:203]
    ds_read_b64_tr_b16 a[186:187], v26 offset:2048
    v_xor_b32 v27, s44, v11
    v_mfma_f32_16x16x32_bf16 v[196:199], a[164:167], v[32:35], v[196:199]
    ds_read_b64_tr_b16 a[188:189], v27 offset:0
    v_mfma_f32_16x16x32_bf16 v[204:207], a[164:167], v[36:39], v[204:207]
    s_waitcnt lgkmcnt(8)
    ds_read_b64_tr_b16 a[190:191], v27 offset:2048
    v_mfma_f32_16x16x32_bf16 v[208:211], a[168:171], v[32:35], v[208:211]
    ds_read_b64_tr_b16 a[160:161], v8 offset:0
    ds_write_b128 v31, a[52:55] offset:17408
    v_mfma_f32_16x16x32_bf16 v[216:219], a[168:171], v[36:39], v[216:219]
    ds_read_b64_tr_b16 a[162:163], v8 offset:2048
    v_mfma_f32_16x16x32_bf16 v[212:215], a[172:175], v[32:35], v[212:215]
    ds_read_b64_tr_b16 a[164:165], v9 offset:0
    v_mfma_f32_16x16x32_bf16 v[220:223], a[172:175], v[36:39], v[220:223]
    s_waitcnt lgkmcnt(8)
    ds_read_b64_tr_b16 a[166:167], v9 offset:2048
    v_mfma_f32_16x16x32_bf16 v[224:227], a[176:179], v[56:59], v[224:227]
    ds_read_b64_tr_b16 a[168:169], v10 offset:0
    v_mfma_f32_16x16x32_bf16 v[232:235], a[176:179], v[60:63], v[232:235]
    ds_read_b64_tr_b16 a[170:171], v10 offset:2048
    v_mfma_f32_16x16x32_bf16 v[228:231], a[180:183], v[56:59], v[228:231]
    ds_read_b64_tr_b16 a[172:173], v11 offset:0
    ds_write_b128 v31, a[56:59] offset:18432
    v_mfma_f32_16x16x32_bf16 v[236:239], a[180:183], v[60:63], v[236:239]
    s_waitcnt lgkmcnt(9)
    ds_read_b64_tr_b16 a[174:175], v11 offset:2048
    v_mfma_f32_16x16x32_bf16 v[240:243], a[184:187], v[56:59], v[240:243]
    ds_read_b64_tr_b16 a[176:177], v12 offset:0
    v_mfma_f32_16x16x32_bf16 v[248:251], a[184:187], v[60:63], v[248:251]
    ds_read_b64_tr_b16 a[178:179], v12 offset:2048
    v_mfma_f32_16x16x32_bf16 v[244:247], a[188:191], v[56:59], v[244:247]
    ds_read_b64_tr_b16 a[180:181], v13 offset:0
    v_mfma_f32_16x16x32_bf16 v[252:255], a[188:191], v[60:63], v[252:255]
    s_waitcnt lgkmcnt(8)
    ds_read_b64_tr_b16 a[182:183], v13 offset:2048
    v_mfma_f32_16x16x32_bf16 v[96:99], a[160:163], v[40:43], v[96:99]
    ds_read_b64_tr_b16 a[184:185], v14 offset:0
    ds_write_b128 v31, a[60:63] offset:19456
    v_mfma_f32_16x16x32_bf16 v[104:107], a[160:163], v[44:47], v[104:107]
    ds_read_b64_tr_b16 a[186:187], v14 offset:2048
    v_mfma_f32_16x16x32_bf16 v[100:103], a[164:167], v[40:43], v[100:103]
    ds_read_b64_tr_b16 a[188:189], v15 offset:0
    v_add_u32 v28, s29, v16
    v_cvt_pk_bf16_f32 v224, v224, v225
    v_cvt_pk_bf16_f32 v225, v226, v227
    v_mfma_f32_16x16x32_bf16 v[108:111], a[164:167], v[44:47], v[108:111]
    s_waitcnt lgkmcnt(8)
    ds_read_b64_tr_b16 a[190:191], v15 offset:2048
    v_cvt_pk_bf16_f32 v226, v228, v229
    v_cvt_pk_bf16_f32 v227, v230, v231
    v_cvt_pk_bf16_f32 v232, v232, v233
    v_cvt_pk_bf16_f32 v233, v234, v235
    v_mfma_f32_16x16x32_bf16 v[112:115], a[168:171], v[40:43], v[112:115]
    ds_read_b64_tr_b16 a[160:161], v8 offset:256
    v_cvt_pk_bf16_f32 v234, v236, v237
    v_cvt_pk_bf16_f32 v235, v238, v239
    v_cvt_pk_bf16_f32 v240, v240, v241
    v_mfma_f32_16x16x32_bf16 v[120:123], a[168:171], v[44:47], v[120:123]
    ds_read_b64_tr_b16 a[162:163], v8 offset:2304
    v_add_u32 v8, 98304, v7
    v_add_u32 v31, s40, v16
    v_cvt_pk_bf16_f32 v241, v242, v243
    v_mfma_f32_16x16x32_bf16 v[116:119], a[172:175], v[40:43], v[116:119]
    ds_read_b64_tr_b16 a[164:165], v9 offset:256
    s_waitcnt vmcnt(2)
    ds_write_b128 v31, a[64:67] offset:32768
    v_mfma_f32_16x16x32_bf16 v[124:127], a[172:175], v[44:47], v[124:127]
    s_waitcnt lgkmcnt(9)
    ds_read_b64_tr_b16 a[166:167], v9 offset:2304
    v_xor_b32 v9, 64, v8
    v_cvt_pk_bf16_f32 v242, v244, v245
    v_cvt_pk_bf16_f32 v243, v246, v247
    v_mfma_f32_16x16x32_bf16 v[128:131], a[176:179], v[40:43], v[128:131]
    ds_read_b64_tr_b16 a[168:169], v10 offset:256
    v_cvt_pk_bf16_f32 v248, v248, v249
    v_cvt_pk_bf16_f32 v249, v250, v251
    v_cvt_pk_bf16_f32 v250, v252, v253
    v_cvt_pk_bf16_f32 v251, v254, v255
    v_mfma_f32_16x16x32_bf16 v[136:139], a[176:179], v[44:47], v[136:139]
    ds_read_b64_tr_b16 a[170:171], v10 offset:2304
    v_add_u32 v10, s29, v8
    v_permlane16_swap_b32 v224, v226
    v_permlane16_swap_b32 v225, v227
    v_cvt_pk_bf16_f32 v96, v96, v97
    v_cvt_pk_bf16_f32 v97, v98, v99
    v_mfma_f32_16x16x32_bf16 v[132:135], a[180:183], v[40:43], v[132:135]
    ds_read_b64_tr_b16 a[172:173], v11 offset:256
    ds_write_b128 v28, v[224:227] offset:0
    v_mfma_f32_16x16x32_bf16 v[140:143], a[180:183], v[44:47], v[140:143]
    s_waitcnt lgkmcnt(9)
    ds_read_b64_tr_b16 a[174:175], v11 offset:2304
    v_add_u32 v11, s29, v9
    v_permlane16_swap_b32 v232, v234
    v_permlane16_swap_b32 v233, v235
    v_cvt_pk_bf16_f32 v98, v100, v101
    v_mfma_f32_16x16x32_bf16 v[144:147], a[184:187], v[40:43], v[144:147]
    ds_read_b64_tr_b16 a[176:177], v12 offset:256
    ds_write_b128 v31, a[68:71] offset:33792
    v_cvt_pk_bf16_f32 v99, v102, v103
    v_mfma_f32_16x16x32_bf16 v[152:155], a[184:187], v[44:47], v[152:155]
    ds_read_b64_tr_b16 a[178:179], v12 offset:2304
    ds_write_b128 v28, v[232:235] offset:1024
    v_mfma_f32_16x16x32_bf16 v[148:151], a[188:191], v[40:43], v[148:151]
    ds_read_b64_tr_b16 a[180:181], v13 offset:256
    v_permlane16_swap_b32 v240, v242
    v_permlane16_swap_b32 v241, v243
    v_cvt_pk_bf16_f32 v104, v104, v105
    v_cvt_pk_bf16_f32 v105, v106, v107
    v_cvt_pk_bf16_f32 v106, v108, v109
    v_mfma_f32_16x16x32_bf16 v[156:159], a[188:191], v[44:47], v[156:159]
    s_waitcnt lgkmcnt(10)
    ds_read_b64_tr_b16 a[182:183], v13 offset:2304
    ds_write_b128 v28, v[240:243] offset:2048
    v_mfma_f32_16x16x32_bf16 v[160:163], a[160:163], v[40:43], v[160:163]
    ds_read_b64_tr_b16 a[184:185], v14 offset:256
    v_permlane16_swap_b32 v248, v250
    v_permlane16_swap_b32 v249, v251
    v_cvt_pk_bf16_f32 v107, v110, v111
    v_permlane16_swap_b32 v96, v98
    v_mfma_f32_16x16x32_bf16 v[168:171], a[160:163], v[44:47], v[168:171]
    ds_read_b64_tr_b16 a[186:187], v14 offset:2304
    ds_write_b128 v28, v[248:251] offset:3072
    v_permlane16_swap_b32 v97, v99
    v_mfma_f32_16x16x32_bf16 v[164:167], a[164:167], v[40:43], v[164:167]
    ds_read_b64_tr_b16 a[188:189], v15 offset:256
    ds_write_b128 v31, a[72:75] offset:34816
    v_mfma_f32_16x16x32_bf16 v[172:175], a[164:167], v[44:47], v[172:175]
    s_waitcnt lgkmcnt(12)
    ds_read_b64_tr_b16 a[190:191], v15 offset:2304
    v_accvgpr_write_b32 a0, v96
    v_accvgpr_write_b32 a1, v97
    v_accvgpr_write_b32 a2, v98
    v_accvgpr_write_b32 a3, v99
    v_permlane16_swap_b32 v104, v106
    v_mfma_f32_16x16x32_bf16 v[176:179], a[168:171], v[40:43], v[176:179]
    s_waitcnt lgkmcnt(1)
    s_barrier
    ds_read_b128 a[160:163], v8 offset:16384
    v_mfma_f32_16x16x32_bf16 v[184:187], a[168:171], v[44:47], v[184:187]
    v_permlane16_swap_b32 v105, v107
    v_accvgpr_write_b32 a4, v104
    v_accvgpr_write_b32 a5, v105
    v_accvgpr_write_b32 a6, v106
    v_accvgpr_write_b32 a7, v107
    v_mfma_f32_16x16x32_bf16 v[180:183], a[172:175], v[40:43], v[180:183]
    ds_read_b128 a[164:167], v9 offset:16384
    v_cvt_pk_bf16_f32 v112, v112, v113
    v_cvt_pk_bf16_f32 v113, v114, v115
    v_mfma_f32_16x16x32_bf16 v[188:191], a[172:175], v[44:47], v[188:191]
    v_cvt_pk_bf16_f32 v114, v116, v117
    v_cvt_pk_bf16_f32 v115, v118, v119
    v_mfma_f32_16x16x32_bf16 v[192:195], a[176:179], v[40:43], v[192:195]
    ds_read_b128 a[168:171], v8 offset:18432
    ds_write_b128 v31, a[76:79] offset:35840
    v_mfma_f32_16x16x32_bf16 v[200:203], a[176:179], v[44:47], v[200:203]
    v_cvt_pk_bf16_f32 v120, v120, v121
    v_cvt_pk_bf16_f32 v121, v122, v123
    v_cvt_pk_bf16_f32 v122, v124, v125
    v_mfma_f32_16x16x32_bf16 v[196:199], a[180:183], v[40:43], v[196:199]
    ds_read_b128 a[172:175], v9 offset:18432
    v_cvt_pk_bf16_f32 v123, v126, v127
    v_permlane16_swap_b32 v112, v114
    v_mfma_f32_16x16x32_bf16 v[204:207], a[180:183], v[44:47], v[204:207]
    s_waitcnt lgkmcnt(5)
    v_permlane16_swap_b32 v113, v115
    v_accvgpr_write_b32 a8, v112
    v_mfma_f32_16x16x32_bf16 v[208:211], a[184:187], v[40:43], v[208:211]
    ds_read_b128 a[176:179], v8 offset:20480
    v_accvgpr_write_b32 a9, v113
    v_accvgpr_write_b32 a10, v114
    v_mfma_f32_16x16x32_bf16 v[216:219], a[184:187], v[44:47], v[216:219]
    s_add_u32 m0, s29, 81920
    v_accvgpr_write_b32 a11, v115
    v_permlane16_swap_b32 v120, v122
    v_permlane16_swap_b32 v121, v123
    v_mfma_f32_16x16x32_bf16 v[212:215], a[188:191], v[40:43], v[212:215]
    s_add_u32 s34, s26, 65792
    ds_read_b128 a[180:183], v9 offset:20480
    v_accvgpr_write_b32 a12, v120
    v_mfma_f32_16x16x32_bf16 v[220:223], a[188:191], v[44:47], v[220:223]
    s_waitcnt lgkmcnt(5)
    v_accvgpr_write_b32 a13, v121
    v_accvgpr_write_b32 a14, v122
    v_accvgpr_write_b32 a15, v123
L_kv:
    v_mfma_f32_16x16x32_bf16 v[32:35], a[160:163], a[0:3], 0
    s_waitcnt vmcnt(4)
    ds_read_b128 a[184:187], v8 offset:22528
    buffer_load_dwordx4 v0, s[16:19], s34 offen offset:0 nt lds
    s_mov_b32 s37, 0
    v_mfma_f32_16x16x32_bf16 v[40:43], a[160:163], a[4:7], 0
    v_cvt_pk_bf16_f32 v128, v128, v129
    v_cvt_pk_bf16_f32 v129, v130, v131
    v_mfma_f32_16x16x32_bf16 v[32:35], a[164:167], a[8:11], v[32:35]
    ds_read_b128 a[188:191], v9 offset:22528
    v_cvt_pk_bf16_f32 v130, v132, v133
    v_mfma_f32_16x16x32_bf16 v[40:43], a[164:167], a[12:15], v[40:43]
    s_waitcnt lgkmcnt(4)
    v_cvt_pk_bf16_f32 v131, v134, v135
    v_mfma_f32_16x16x32_bf16 v[36:39], a[168:171], a[0:3], 0
    ds_read_b128 a[160:163], v8 offset:24576
    ds_read_b128 a[64:67], v16 offset:0
    v_mfma_f32_16x16x32_bf16 v[44:47], a[168:171], a[4:7], 0
    v_cvt_pk_bf16_f32 v136, v136, v137
    v_cvt_pk_bf16_f32 v137, v138, v139
    v_mfma_f32_16x16x32_bf16 v[36:39], a[172:175], a[8:11], v[36:39]
    ds_read_b128 a[164:167], v9 offset:24576
    v_cvt_pk_bf16_f32 v138, v140, v141
    v_mfma_f32_16x16x32_bf16 v[44:47], a[172:175], a[12:15], v[44:47]
    s_waitcnt lgkmcnt(5)
    v_cvt_pk_bf16_f32 v139, v142, v143
    v_permlane16_swap_b32 v128, v130
    v_mfma_f32_16x16x32_bf16 v[48:51], a[176:179], a[0:3], 0
    ds_read_b128 a[168:171], v8 offset:26624
    ds_read_b128 a[68:71], v16 offset:1024
    v_mfma_f32_16x16x32_bf16 v[56:59], a[176:179], a[4:7], 0
    v_permlane16_swap_b32 v129, v131
    v_accvgpr_write_b32 a16, v128
    v_mfma_f32_16x16x32_bf16 v[48:51], a[180:183], a[8:11], v[48:51]
    s_waitcnt vmcnt(4)
    ds_read_b128 a[172:175], v9 offset:26624
    v_mfma_f32_16x16x32_bf16 v[56:59], a[180:183], a[12:15], v[56:59]
    s_waitcnt lgkmcnt(6)
    buffer_load_dwordx4 v1, s[16:19], s34 offen offset:1024 nt lds
    v_mfma_f32_16x16x32_bf16 v[52:55], a[184:187], a[0:3], 0
    ds_read_b128 a[176:179], v8 offset:28672
    ds_read_b128 a[72:75], v16 offset:2048
    v_mfma_f32_16x16x32_bf16 v[60:63], a[184:187], a[4:7], 0
    v_accvgpr_write_b32 a17, v129
    v_accvgpr_write_b32 a18, v130
    v_mfma_f32_16x16x32_bf16 v[52:55], a[188:191], a[8:11], v[52:55]
    ds_read_b128 a[180:183], v9 offset:28672
    v_accvgpr_write_b32 a19, v131
    v_mfma_f32_16x16x32_bf16 v[60:63], a[188:191], a[12:15], v[60:63]
    s_waitcnt lgkmcnt(6)
    v_permlane16_swap_b32 v136, v138
    v_permlane16_swap_b32 v137, v139
    v_mfma_f32_16x16x32_bf16 v[64:67], a[160:163], a[0:3], 0
    ds_read_b128 a[184:187], v8 offset:30720
    ds_read_b128 a[76:79], v16 offset:3072
    v_mfma_f32_16x16x32_bf16 v[72:75], a[160:163], a[4:7], 0
    v_accvgpr_write_b32 a20, v136
    v_accvgpr_write_b32 a21, v137
    v_mfma_f32_16x16x32_bf16 v[64:67], a[164:167], a[8:11], v[64:67]
    ds_read_b128 a[188:191], v9 offset:30720
    v_mfma_f32_16x16x32_bf16 v[72:75], a[164:167], a[12:15], v[72:75]
    s_waitcnt lgkmcnt(6)
    v_accvgpr_write_b32 a22, v138
    v_accvgpr_write_b32 a23, v139
    v_mfma_f32_16x16x32_bf16 v[68:71], a[168:171], a[0:3], 0
    ds_read_b128 a[160:163], v10 offset:16384
    v_cvt_pk_bf16_f32 v144, v144, v145
    v_mfma_f32_16x16x32_bf16 v[76:79], a[168:171], a[4:7], 0
    s_add_u32 s34, s34, 6144
    v_cvt_pk_bf16_f32 v145, v146, v147
    v_cvt_pk_bf16_f32 v146, v148, v149
    v_mfma_f32_16x16x32_bf16 v[68:71], a[172:175], a[8:11], v[68:71]
    s_waitcnt vmcnt(3)
    ds_read_b128 a[164:167], v11 offset:16384
    buffer_load_dwordx4 v0, s[16:19], s34 offen offset:2048 nt lds
    v_mfma_f32_16x16x32_bf16 v[76:79], a[172:175], a[12:15], v[76:79]
    s_waitcnt lgkmcnt(5)
    v_cvt_pk_bf16_f32 v147, v150, v151
    v_mfma_f32_16x16x32_bf16 v[80:83], a[176:179], a[0:3], 0
    ds_read_b128 a[168:171], v10 offset:18432
    v_cvt_pk_bf16_f32 v152, v152, v153
    v_mfma_f32_16x16x32_bf16 v[88:91], a[176:179], a[4:7], 0
    v_cvt_pk_bf16_f32 v153, v154, v155
    v_cvt_pk_bf16_f32 v154, v156, v157
    v_mfma_f32_16x16x32_bf16 v[80:83], a[180:183], a[8:11], v[80:83]
    ds_read_b128 a[172:175], v11 offset:18432
    v_cvt_pk_bf16_f32 v155, v158, v159
    v_mfma_f32_16x16x32_bf16 v[88:91], a[180:183], a[12:15], v[88:91]
    s_waitcnt lgkmcnt(4)
    v_permlane16_swap_b32 v144, v146
    v_permlane16_swap_b32 v145, v147
    v_mfma_f32_16x16x32_bf16 v[84:87], a[184:187], a[0:3], 0
    s_barrier
    ds_read_b128 a[176:179], v8 offset:32768
    v_mfma_f32_16x16x32_bf16 v[92:95], a[184:187], a[4:7], 0
    v_accvgpr_write_b32 a24, v144
    v_mfma_f32_16x16x32_bf16 v[84:87], a[188:191], a[8:11], v[84:87]
    ds_read_b128 a[180:183], v9 offset:32768
    v_accvgpr_write_b32 a25, v145
    v_mfma_f32_16x16x32_bf16 v[92:95], a[188:191], a[12:15], v[92:95]
    s_waitcnt lgkmcnt(4)
    v_accvgpr_write_b32 a26, v146
    v_accvgpr_write_b32 a27, v147
    v_mfma_f32_16x16x32_bf16 v[224:227], a[160:163], a[64:67], 0
    ds_read_b128 a[184:187], v8 offset:34816
    v_permlane16_swap_b32 v152, v154
    v_mfma_f32_16x16x32_bf16 v[232:235], a[160:163], a[68:71], 0
    s_waitcnt vmcnt(3)
    buffer_load_dwordx4 v1, s[16:19], s34 offen offset:3072 nt lds
    v_mfma_f32_16x16x32_bf16 v[224:227], a[164:167], a[72:75], v[224:227]
    ds_read_b128 a[188:191], v9 offset:34816
    v_permlane16_swap_b32 v153, v155
    v_mfma_f32_16x16x32_bf16 v[232:235], a[164:167], a[76:79], v[232:235]
    s_waitcnt lgkmcnt(4)
    v_accvgpr_write_b32 a28, v152
    v_mfma_f32_16x16x32_bf16 v[228:231], a[168:171], a[64:67], 0
    ds_read_b128 a[160:163], v8 offset:36864
    v_accvgpr_write_b32 a29, v153
    v_mfma_f32_16x16x32_bf16 v[236:239], a[168:171], a[68:71], 0
    v_accvgpr_write_b32 a30, v154
    v_accvgpr_write_b32 a31, v155
    v_mfma_f32_16x16x32_bf16 v[228:231], a[172:175], a[72:75], v[228:231]
    ds_read_b128 a[164:167], v9 offset:36864
    v_mfma_f32_16x16x32_bf16 v[236:239], a[172:175], a[76:79], v[236:239]
    s_waitcnt lgkmcnt(4)
    v_mfma_f32_16x16x32_bf16 v[32:35], a[176:179], a[16:19], v[32:35]
    ds_read_b128 a[168:171], v8 offset:38912
    v_cvt_pk_bf16_f32 v160, v160, v161
    v_mfma_f32_16x16x32_bf16 v[40:43], a[176:179], a[20:23], v[40:43]
    v_cvt_pk_bf16_f32 v161, v162, v163
    v_mfma_f32_16x16x32_bf16 v[32:35], a[180:183], a[24:27], v[32:35]
    s_add_u32 m0, s29, 98304
    ds_read_b128 a[172:175], v9 offset:38912
    v_cvt_pk_bf16_f32 v162, v164, v165
    v_mfma_f32_16x16x32_bf16 v[40:43], a[180:183], a[28:31], v[40:43]
    s_waitcnt lgkmcnt(4)
    v_cvt_pk_bf16_f32 v163, v166, v167
    v_cvt_pk_bf16_f32 v168, v168, v169
    v_mfma_f32_16x16x32_bf16 v[36:39], a[184:187], a[16:19], v[36:39]
    s_add_u32 s34, s26, 65920
    ds_read_b128 a[176:179], v8 offset:40960
    ds_read_b128 a[80:83], v16 offset:4096
    v_mfma_f32_16x16x32_bf16 v[44:47], a[184:187], a[20:23], v[44:47]
    s_waitcnt vmcnt(4)
    buffer_load_dwordx4 v0, s[16:19], s34 offen offset:0 nt lds
    v_mfma_f32_16x16x32_bf16 v[36:39], a[188:191], a[24:27], v[36:39]
    ds_read_b128 a[180:183], v9 offset:40960
    v_cvt_pk_bf16_f32 v169, v170, v171
    v_mfma_f32_16x16x32_bf16 v[44:47], a[188:191], a[28:31], v[44:47]
    s_waitcnt lgkmcnt(5)
    v_cvt_pk_bf16_f32 v170, v172, v173
    v_mfma_f32_16x16x32_bf16 v[48:51], a[160:163], a[16:19], v[48:51]
    ds_read_b128 a[184:187], v8 offset:43008
    ds_read_b128 a[84:87], v16 offset:5120
    v_mfma_f32_16x16x32_bf16 v[56:59], a[160:163], a[20:23], v[56:59]
    v_cvt_pk_bf16_f32 v171, v174, v175
    v_permlane16_swap_b32 v160, v162
    v_mfma_f32_16x16x32_bf16 v[48:51], a[164:167], a[24:27], v[48:51]
    ds_read_b128 a[188:191], v9 offset:43008
    v_permlane16_swap_b32 v161, v163
    v_mfma_f32_16x16x32_bf16 v[56:59], a[164:167], a[28:31], v[56:59]
    s_waitcnt lgkmcnt(6)
    v_accvgpr_write_b32 a32, v160
    v_accvgpr_write_b32 a33, v161
    v_mfma_f32_16x16x32_bf16 v[52:55], a[168:171], a[16:19], v[52:55]
    ds_read_b128 a[160:163], v8 offset:45056
    ds_read_b128 a[88:91], v16 offset:6144
    v_mfma_f32_16x16x32_bf16 v[60:63], a[168:171], a[20:23], v[60:63]
    v_accvgpr_write_b32 a34, v162
    v_mfma_f32_16x16x32_bf16 v[52:55], a[172:175], a[24:27], v[52:55]
    ds_read_b128 a[164:167], v9 offset:45056
    v_accvgpr_write_b32 a35, v163
    v_mfma_f32_16x16x32_bf16 v[60:63], a[172:175], a[28:31], v[60:63]
    s_waitcnt lgkmcnt(6)
    v_permlane16_swap_b32 v168, v170
    v_permlane16_swap_b32 v169, v171
    v_mfma_f32_16x16x32_bf16 v[64:67], a[176:179], a[16:19], v[64:67]
    s_waitcnt vmcnt(4)
    ds_read_b128 a[168:171], v8 offset:47104
    buffer_load_dwordx4 v1, s[16:19], s34 offen offset:1024 nt lds
    ds_read_b128 a[92:95], v16 offset:7168
    v_mfma_f32_16x16x32_bf16 v[72:75], a[176:179], a[20:23], v[72:75]
    v_accvgpr_write_b32 a36, v168
    v_accvgpr_write_b32 a37, v169
    v_mfma_f32_16x16x32_bf16 v[64:67], a[180:183], a[24:27], v[64:67]
    ds_read_b128 a[172:175], v9 offset:47104
    v_mfma_f32_16x16x32_bf16 v[72:75], a[180:183], a[28:31], v[72:75]
    s_waitcnt lgkmcnt(6)
    v_accvgpr_write_b32 a38, v170
    v_accvgpr_write_b32 a39, v171
    v_mfma_f32_16x16x32_bf16 v[68:71], a[184:187], a[16:19], v[68:71]
    ds_read_b128 a[176:179], v10 offset:32768
    v_cvt_pk_bf16_f32 v176, v176, v177
    v_mfma_f32_16x16x32_bf16 v[76:79], a[184:187], a[20:23], v[76:79]
    v_cvt_pk_bf16_f32 v177, v178, v179
    v_cvt_pk_bf16_f32 v178, v180, v181
    v_mfma_f32_16x16x32_bf16 v[68:71], a[188:191], a[24:27], v[68:71]
    ds_read_b128 a[180:183], v11 offset:32768
    v_mfma_f32_16x16x32_bf16 v[76:79], a[188:191], a[28:31], v[76:79]
    s_waitcnt lgkmcnt(5)
    v_cvt_pk_bf16_f32 v179, v182, v183
    v_cvt_pk_bf16_f32 v184, v184, v185
    v_mfma_f32_16x16x32_bf16 v[80:83], a[160:163], a[16:19], v[80:83]
    ds_read_b128 a[184:187], v10 offset:34816
    v_cvt_pk_bf16_f32 v185, v186, v187
    v_mfma_f32_16x16x32_bf16 v[88:91], a[160:163], a[20:23], v[88:91]
    s_add_u32 s34, s34, 6144
    v_cvt_pk_bf16_f32 v186, v188, v189
    v_cvt_pk_bf16_f32 v187, v190, v191
    v_mfma_f32_16x16x32_bf16 v[80:83], a[164:167], a[24:27], v[80:83]
    s_waitcnt vmcnt(3)
    ds_read_b128 a[188:191], v11 offset:34816
    v_mfma_f32_16x16x32_bf16 v[88:91], a[164:167], a[28:31], v[88:91]
    s_waitcnt lgkmcnt(4)
    buffer_load_dwordx4 v0, s[16:19], s34 offen offset:2048 nt lds
    v_mfma_f32_16x16x32_bf16 v[84:87], a[168:171], a[16:19], v[84:87]
    s_barrier
    ds_read_b128 a[160:163], v8 offset:49152
    v_mfma_f32_16x16x32_bf16 v[92:95], a[168:171], a[20:23], v[92:95]
    v_permlane16_swap_b32 v176, v178
    v_permlane16_swap_b32 v177, v179
    v_mfma_f32_16x16x32_bf16 v[84:87], a[172:175], a[24:27], v[84:87]
    ds_read_b128 a[164:167], v9 offset:49152
    v_accvgpr_write_b32 a40, v176
    v_mfma_f32_16x16x32_bf16 v[92:95], a[172:175], a[28:31], v[92:95]
    s_waitcnt lgkmcnt(4)
    v_accvgpr_write_b32 a41, v177
    v_accvgpr_write_b32 a42, v178
    v_mfma_f32_16x16x32_bf16 v[224:227], a[176:179], a[80:83], v[224:227]
    ds_read_b128 a[168:171], v8 offset:51200
    v_mfma_f32_16x16x32_bf16 v[232:235], a[176:179], a[84:87], v[232:235]
    v_accvgpr_write_b32 a43, v179
    v_permlane16_swap_b32 v184, v186
    v_mfma_f32_16x16x32_bf16 v[224:227], a[180:183], a[88:91], v[224:227]
    ds_read_b128 a[172:175], v9 offset:51200
    v_permlane16_swap_b32 v185, v187
    v_mfma_f32_16x16x32_bf16 v[232:235], a[180:183], a[92:95], v[232:235]
    s_waitcnt lgkmcnt(4)
    v_accvgpr_write_b32 a44, v184
    v_accvgpr_write_b32 a45, v185
    v_mfma_f32_16x16x32_bf16 v[228:231], a[184:187], a[80:83], v[228:231]
    ds_read_b128 a[176:179], v8 offset:53248
    v_mfma_f32_16x16x32_bf16 v[236:239], a[184:187], a[84:87], v[236:239]
    v_accvgpr_write_b32 a46, v186
    v_accvgpr_write_b32 a47, v187
    v_mfma_f32_16x16x32_bf16 v[228:231], a[188:191], a[88:91], v[228:231]
    s_waitcnt vmcnt(3)
    ds_read_b128 a[180:183], v9 offset:53248
    buffer_load_dwordx4 v1, s[16:19], s34 offen offset:3072 nt lds
    v_mfma_f32_16x16x32_bf16 v[236:239], a[188:191], a[92:95], v[236:239]
    s_waitcnt lgkmcnt(4)
    v_mfma_f32_16x16x32_bf16 v[32:35], a[160:163], a[32:35], v[32:35]
    ds_read_b128 a[184:187], v8 offset:55296
    v_cvt_pk_bf16_f32 v192, v192, v193
    v_mfma_f32_16x16x32_bf16 v[40:43], a[160:163], a[36:39], v[40:43]
    v_cvt_pk_bf16_f32 v193, v194, v195
    v_cvt_pk_bf16_f32 v194, v196, v197
    v_mfma_f32_16x16x32_bf16 v[32:35], a[164:167], a[40:43], v[32:35]
    ds_read_b128 a[188:191], v9 offset:55296
    v_mfma_f32_16x16x32_bf16 v[40:43], a[164:167], a[44:47], v[40:43]
    s_waitcnt lgkmcnt(4)
    v_cvt_pk_bf16_f32 v195, v198, v199
    v_cvt_pk_bf16_f32 v200, v200, v201
    v_mfma_f32_16x16x32_bf16 v[36:39], a[168:171], a[32:35], v[36:39]
    ds_read_b128 a[160:163], v8 offset:57344
    ds_read_b128 a[96:99], v16 offset:8192
    v_mfma_f32_16x16x32_bf16 v[44:47], a[168:171], a[36:39], v[44:47]
    v_cvt_pk_bf16_f32 v201, v202, v203
    v_cvt_pk_bf16_f32 v202, v204, v205
    v_mfma_f32_16x16x32_bf16 v[36:39], a[172:175], a[40:43], v[36:39]
    ds_read_b128 a[164:167], v9 offset:57344
    v_cvt_pk_bf16_f32 v203, v206, v207
    v_mfma_f32_16x16x32_bf16 v[44:47], a[172:175], a[44:47], v[44:47]
    s_waitcnt lgkmcnt(5)
    v_permlane16_swap_b32 v192, v194
    v_permlane16_swap_b32 v193, v195
    v_mfma_f32_16x16x32_bf16 v[48:51], a[176:179], a[32:35], v[48:51]
    s_add_u32 m0, s29, 114688
    ds_read_b128 a[168:171], v8 offset:59392
    ds_read_b128 a[100:103], v16 offset:9216
    v_mfma_f32_16x16x32_bf16 v[56:59], a[176:179], a[36:39], v[56:59]
    s_add_u32 s34, s26, 131072
A_stub3:
    s_cbranch_execz A_stub7
    v_accvgpr_write_b32 a48, v192
    v_accvgpr_write_b32 a49, v193
    v_mfma_f32_16x16x32_bf16 v[48:51], a[180:183], a[40:43], v[48:51]
    s_waitcnt vmcnt(4)
    ds_read_b128 a[172:175], v9 offset:59392
    buffer_load_dwordx4 v0, s[16:19], s34 offen offset:0 nt lds
    v_mfma_f32_16x16x32_bf16 v[56:59], a[180:183], a[44:47], v[56:59]
    s_waitcnt lgkmcnt(6)
    v_accvgpr_write_b32 a50, v194
    v_mfma_f32_16x16x32_bf16 v[52:55], a[184:187], a[32:35], v[52:55]
    ds_read_b128 a[176:179], v8 offset:61440
    ds_read_b128 a[104:107], v16 offset:10240
    v_mfma_f32_16x16x32_bf16 v[60:63], a[184:187], a[36:39], v[60:63]
    v_accvgpr_write_b32 a51, v195
    v_permlane16_swap_b32 v200, v202
    v_mfma_f32_16x16x32_bf16 v[52:55], a[188:191], a[40:43], v[52:55]
    ds_read_b128 a[180:183], v9 offset:61440
    v_permlane16_swap_b32 v201, v203
    v_mfma_f32_16x16x32_bf16 v[60:63], a[188:191], a[44:47], v[60:63]
    s_waitcnt lgkmcnt(6)
    v_accvgpr_write_b32 a52, v200
    v_accvgpr_write_b32 a53, v201
    v_mfma_f32_16x16x32_bf16 v[64:67], a[160:163], a[32:35], v[64:67]
    ds_read_b128 a[184:187], v8 offset:63488
    ds_read_b128 a[108:111], v16 offset:11264
    v_xor_b32 v8, 0x10000, v8
    v_mfma_f32_16x16x32_bf16 v[72:75], a[160:163], a[36:39], v[72:75]
    v_accvgpr_write_b32 a54, v202
    v_accvgpr_write_b32 a55, v203
    v_mfma_f32_16x16x32_bf16 v[64:67], a[164:167], a[40:43], v[64:67]
    ds_read_b128 a[188:191], v9 offset:63488
    v_xor_b32 v9, 0x10000, v9
    v_mfma_f32_16x16x32_bf16 v[72:75], a[164:167], a[44:47], v[72:75]
    s_waitcnt lgkmcnt(6)
    v_cvt_pk_bf16_f32 v208, v208, v209
    v_mfma_f32_16x16x32_bf16 v[68:71], a[168:171], a[32:35], v[68:71]
    ds_read_b128 a[160:163], v10 offset:49152
    v_cvt_pk_bf16_f32 v209, v210, v211
    v_mfma_f32_16x16x32_bf16 v[76:79], a[168:171], a[36:39], v[76:79]
    s_waitcnt vmcnt(4)
    buffer_load_dwordx4 v1, s[16:19], s34 offen offset:1024 nt lds
    v_mfma_f32_16x16x32_bf16 v[68:71], a[172:175], a[40:43], v[68:71]
    ds_read_b128 a[164:167], v11 offset:49152
    v_cvt_pk_bf16_f32 v210, v212, v213
    v_mfma_f32_16x16x32_bf16 v[76:79], a[172:175], a[44:47], v[76:79]
    s_waitcnt lgkmcnt(5)
    v_cvt_pk_bf16_f32 v211, v214, v215
    v_cvt_pk_bf16_f32 v216, v216, v217
    v_mfma_f32_16x16x32_bf16 v[80:83], a[176:179], a[32:35], v[80:83]
    ds_read_b128 a[168:171], v10 offset:51200
    v_xor_b32 v10, 0x10000, v10
    v_mfma_f32_16x16x32_bf16 v[88:91], a[176:179], a[36:39], v[88:91]
    v_cvt_pk_bf16_f32 v217, v218, v219
    v_cvt_pk_bf16_f32 v218, v220, v221
    v_mfma_f32_16x16x32_bf16 v[80:83], a[180:183], a[40:43], v[80:83]
    ds_read_b128 a[172:175], v11 offset:51200
    v_xor_b32 v11, 0x10000, v11
    v_mfma_f32_16x16x32_bf16 v[88:91], a[180:183], a[44:47], v[88:91]
    s_waitcnt lgkmcnt(4)
    v_cvt_pk_bf16_f32 v219, v222, v223
    v_mfma_f32_16x16x32_bf16 v[84:87], a[184:187], a[32:35], v[84:87]
    s_barrier
    ds_read_b128 a[176:179], v8 offset:0
    v_mfma_f32_16x16x32_bf16 v[92:95], a[184:187], a[36:39], v[92:95]
    v_permlane16_swap_b32 v208, v210
    v_permlane16_swap_b32 v209, v211
    v_mfma_f32_16x16x32_bf16 v[84:87], a[188:191], a[40:43], v[84:87]
    s_add_u32 s34, s34, 6144
    ds_read_b128 a[180:183], v9 offset:0
    v_accvgpr_write_b32 a56, v208
    v_mfma_f32_16x16x32_bf16 v[92:95], a[188:191], a[44:47], v[92:95]
    s_waitcnt lgkmcnt(4)
    v_accvgpr_write_b32 a57, v209
    v_accvgpr_write_b32 a58, v210
    v_mfma_f32_16x16x32_bf16 v[224:227], a[160:163], a[96:99], v[224:227]
    s_waitcnt vmcnt(3)
    ds_read_b128 a[184:187], v8 offset:2048
    buffer_load_dwordx4 v0, s[16:19], s34 offen offset:2048 nt lds
    v_mfma_f32_16x16x32_bf16 v[232:235], a[160:163], a[100:103], v[232:235]
    v_accvgpr_write_b32 a59, v211
    v_permlane16_swap_b32 v216, v218
    v_mfma_f32_16x16x32_bf16 v[224:227], a[164:167], a[104:107], v[224:227]
    ds_read_b128 a[188:191], v9 offset:2048
    v_permlane16_swap_b32 v217, v219
    v_mfma_f32_16x16x32_bf16 v[232:235], a[164:167], a[108:111], v[232:235]
    s_waitcnt lgkmcnt(4)
    v_accvgpr_write_b32 a60, v216
    v_mfma_f32_16x16x32_bf16 v[228:231], a[168:171], a[96:99], v[228:231]
    ds_read_b128 a[160:163], v8 offset:4096
    v_accvgpr_write_b32 a61, v217
    v_mfma_f32_16x16x32_bf16 v[236:239], a[168:171], a[100:103], v[236:239]
    v_accvgpr_write_b32 a62, v218
    v_accvgpr_write_b32 a63, v219
    v_mfma_f32_16x16x32_bf16 v[228:231], a[172:175], a[104:107], v[228:231]
    ds_read_b128 a[164:167], v9 offset:4096
    v_mfma_f32_16x16x32_bf16 v[236:239], a[172:175], a[108:111], v[236:239]
    s_waitcnt lgkmcnt(4)
    v_mfma_f32_16x16x32_bf16 v[32:35], a[176:179], a[48:51], v[32:35]
    ds_read_b128 a[168:171], v8 offset:6144
    v_mfma_f32_16x16x32_bf16 v[40:43], a[176:179], a[52:55], v[40:43]
    v_mfma_f32_16x16x32_bf16 v[32:35], a[180:183], a[56:59], v[32:35]
    s_waitcnt vmcnt(3)
    ds_read_b128 a[172:175], v9 offset:6144
    v_mfma_f32_16x16x32_bf16 v[40:43], a[180:183], a[60:63], v[40:43]
    s_waitcnt lgkmcnt(4)
    buffer_load_dwordx4 v1, s[16:19], s34 offen offset:3072 nt lds
    v_mfma_f32_16x16x32_bf16 v[36:39], a[184:187], a[48:51], v[36:39]
    ds_read_b128 a[176:179], v8 offset:8192
    ds_read_b128 a[112:115], v16 offset:12288
    v_mfma_f32_16x16x32_bf16 v[44:47], a[184:187], a[52:55], v[44:47]
    v_mfma_f32_16x16x32_bf16 v[36:39], a[188:191], a[56:59], v[36:39]
    ds_read_b128 a[180:183], v9 offset:8192
    v_mfma_f32_16x16x32_bf16 v[44:47], a[188:191], a[60:63], v[44:47]
    s_waitcnt lgkmcnt(5)
    v_mfma_f32_16x16x32_bf16 v[48:51], a[160:163], a[48:51], v[48:51]
    ds_read_b128 a[184:187], v8 offset:10240
    ds_read_b128 a[116:119], v16 offset:13312
    v_mfma_f32_16x16x32_bf16 v[56:59], a[160:163], a[52:55], v[56:59]
    v_mfma_f32_16x16x32_bf16 v[48:51], a[164:167], a[56:59], v[48:51]
    ds_read_b128 a[188:191], v9 offset:10240
    v_mfma_f32_16x16x32_bf16 v[56:59], a[164:167], a[60:63], v[56:59]
    s_waitcnt lgkmcnt(6)
    v_mfma_f32_16x16x32_bf16 v[52:55], a[168:171], a[48:51], v[52:55]
    s_add_u32 m0, s29, 131072
    ds_read_b128 a[160:163], v8 offset:12288
    ds_read_b128 a[120:123], v16 offset:14336
    v_mfma_f32_16x16x32_bf16 v[60:63], a[168:171], a[52:55], v[60:63]
    s_add_u32 s34, s26, 131200
    v_mfma_f32_16x16x32_bf16 v[52:55], a[172:175], a[56:59], v[52:55]
    s_waitcnt vmcnt(4)
    ds_read_b128 a[164:167], v9 offset:12288
    buffer_load_dwordx4 v0, s[16:19], s34 offen offset:0 nt lds
    v_mfma_f32_16x16x32_bf16 v[60:63], a[172:175], a[60:63], v[60:63]
    s_waitcnt lgkmcnt(6)
    v_mfma_f32_16x16x32_bf16 v[64:67], a[176:179], a[48:51], v[64:67]
    ds_read_b128 a[168:171], v8 offset:14336
    ds_read_b128 a[124:127], v16 offset:15360
    v_mfma_f32_16x16x32_bf16 v[72:75], a[176:179], a[52:55], v[72:75]
    v_mfma_f32_16x16x32_bf16 v[64:67], a[180:183], a[56:59], v[64:67]
    ds_read_b128 a[172:175], v9 offset:14336
    v_mfma_f32_16x16x32_bf16 v[72:75], a[180:183], a[60:63], v[72:75]
    s_waitcnt lgkmcnt(6)
    v_mfma_f32_16x16x32_bf16 v[68:71], a[184:187], a[48:51], v[68:71]
    ds_read_b128 a[176:179], v10 offset:0
    v_mfma_f32_16x16x32_bf16 v[76:79], a[184:187], a[52:55], v[76:79]
    v_mfma_f32_16x16x32_bf16 v[68:71], a[188:191], a[56:59], v[68:71]
    ds_read_b128 a[180:183], v11 offset:0
    v_mfma_f32_16x16x32_bf16 v[76:79], a[188:191], a[60:63], v[76:79]
    s_waitcnt lgkmcnt(5)
    v_mfma_f32_16x16x32_bf16 v[80:83], a[160:163], a[48:51], v[80:83]
    ds_read_b128 a[184:187], v10 offset:2048
    v_mfma_f32_16x16x32_bf16 v[88:91], a[160:163], a[52:55], v[88:91]
    s_waitcnt vmcnt(4)
    buffer_load_dwordx4 v1, s[16:19], s34 offen offset:1024 nt lds
    v_mfma_f32_16x16x32_bf16 v[80:83], a[164:167], a[56:59], v[80:83]
    ds_read_b128 a[188:191], v11 offset:2048
    v_mfma_f32_16x16x32_bf16 v[88:91], a[164:167], a[60:63], v[88:91]
    s_waitcnt lgkmcnt(4)
    v_mfma_f32_16x16x32_bf16 v[84:87], a[168:171], a[48:51], v[84:87]
    s_barrier
    ds_read_b128 a[160:163], v8 offset:16384
    v_mfma_f32_16x16x32_bf16 v[92:95], a[168:171], a[52:55], v[92:95]
    v_mfma_f32_16x16x32_bf16 v[84:87], a[172:175], a[56:59], v[84:87]
    ds_read_b128 a[164:167], v9 offset:16384
    v_mfma_f32_16x16x32_bf16 v[92:95], a[172:175], a[60:63], v[92:95]
    s_waitcnt lgkmcnt(4)
    v_mfma_f32_16x16x32_bf16 v[224:227], a[176:179], a[112:115], v[224:227]
    ds_read_b128 a[168:171], v8 offset:18432
    v_mfma_f32_16x16x32_bf16 v[232:235], a[176:179], a[116:119], v[232:235]
    v_mfma_f32_16x16x32_bf16 v[224:227], a[180:183], a[120:123], v[224:227]
    s_add_u32 s34, s34, 6144
    ds_read_b128 a[172:175], v9 offset:18432
    v_mfma_f32_16x16x32_bf16 v[232:235], a[180:183], a[124:127], v[232:235]
    s_waitcnt lgkmcnt(4)
    v_mfma_f32_16x16x32_bf16 v[228:231], a[184:187], a[112:115], v[228:231]
    s_waitcnt vmcnt(3)
    ds_read_b128 a[176:179], v8 offset:20480
    buffer_load_dwordx4 v0, s[16:19], s34 offen offset:2048 nt lds
    v_mfma_f32_16x16x32_bf16 v[236:239], a[184:187], a[116:119], v[236:239]
    v_mfma_f32_16x16x32_bf16 v[228:231], a[188:191], a[120:123], v[228:231]
    ds_read_b128 a[180:183], v9 offset:20480
    v_mfma_f32_16x16x32_bf16 v[236:239], a[188:191], a[124:127], v[236:239]
    s_waitcnt lgkmcnt(4)
    v_mfma_f32_16x16x32_bf16 v[96:99], a[160:163], a[0:3], 0
    ds_read_b128 a[184:187], v8 offset:22528
    v_max3_f32 v26, v32, v33, v34
    v_max3_f32 v27, v40, v41, v42
    v_max3_f32 v26, v26, v35, v36
    v_mfma_f32_16x16x32_bf16 v[104:107], a[160:163], a[4:7], 0
    v_max3_f32 v27, v27, v43, v44
    v_max3_f32 v26, v26, v37, v38
    v_max3_f32 v27, v27, v45, v46
    v_mfma_f32_16x16x32_bf16 v[96:99], a[164:167], a[8:11], v[96:99]
    ds_read_b128 a[188:191], v9 offset:22528
    v_max3_f32 v26, v26, v39, v48
    v_max3_f32 v27, v27, v47, v56
    v_max3_f32 v26, v26, v49, v50
    v_mfma_f32_16x16x32_bf16 v[104:107], a[164:167], a[12:15], v[104:107]
    s_waitcnt lgkmcnt(4)
    v_max3_f32 v27, v27, v57, v58
    v_max3_f32 v26, v26, v51, v52
    v_max3_f32 v27, v27, v59, v60
    v_max3_f32 v26, v26, v53, v54
    v_mfma_f32_16x16x32_bf16 v[100:103], a[168:171], a[0:3], 0
    ds_read_b128 a[160:163], v8 offset:24576
    v_max3_f32 v27, v27, v61, v62
    v_max3_f32 v26, v26, v55, v64
    v_mfma_f32_16x16x32_bf16 v[108:111], a[168:171], a[4:7], 0
    v_max3_f32 v27, v27, v63, v72
    v_max3_f32 v26, v26, v65, v66
    v_max3_f32 v27, v27, v73, v74
    v_max3_f32 v26, v26, v67, v68
    v_mfma_f32_16x16x32_bf16 v[100:103], a[172:175], a[8:11], v[100:103]
    s_waitcnt vmcnt(3)
    ds_read_b128 a[164:167], v9 offset:24576
    v_max3_f32 v28, v224, v225, v226
    v_max3_f32 v27, v27, v75, v76
    v_max3_f32 v26, v26, v69, v70
    v_mfma_f32_16x16x32_bf16 v[108:111], a[172:175], a[12:15], v[108:111]
    s_waitcnt lgkmcnt(4)
    buffer_load_dwordx4 v1, s[16:19], s34 offen offset:3072 nt lds
    v_max3_f32 v27, v27, v77, v78
    v_mfma_f32_16x16x32_bf16 v[112:115], a[176:179], a[0:3], 0
    ds_read_b128 a[168:171], v8 offset:26624
    v_max3_f32 v29, v232, v233, v234
    v_max3_f32 v26, v26, v71, v80
    v_mfma_f32_16x16x32_bf16 v[120:123], a[176:179], a[4:7], 0
    v_max3_f32 v28, v28, v227, v228
    v_max3_f32 v29, v29, v235, v236
    v_max3_f32 v27, v27, v79, v88
    v_max3_f32 v26, v26, v81, v82
    v_mfma_f32_16x16x32_bf16 v[112:115], a[180:183], a[8:11], v[112:115]
    ds_read_b128 a[172:175], v9 offset:26624
    v_max3_f32 v28, v28, v229, v230
    v_max3_f32 v27, v27, v89, v90
    v_max3_f32 v26, v26, v83, v84
    v_mfma_f32_16x16x32_bf16 v[120:123], a[180:183], a[12:15], v[120:123]
    s_waitcnt lgkmcnt(4)
    v_max3_f32 v29, v29, v237, v238
    v_max3_f32 v27, v27, v91, v92
    v_max3_f32 v26, v26, v85, v86
    v_mfma_f32_16x16x32_bf16 v[116:119], a[184:187], a[0:3], 0
    ds_read_b128 a[176:179], v8 offset:28672
    v_max_f32 v28, v28, v231
    v_max3_f32 v27, v27, v93, v94
    v_max_f32 v26, v26, v87
    v_mfma_f32_16x16x32_bf16 v[124:127], a[184:187], a[4:7], 0
    v_max_f32 v29, v29, v239
    s_nop 1
    v_permlane32_swap_b32 v28, v29
    v_max_f32 v28, v28, v29
    v_max_f32 v27, v27, v95
    v_mfma_f32_16x16x32_bf16 v[116:119], a[188:191], a[8:11], v[116:119]
    ds_read_b128 a[180:183], v9 offset:28672
    v_permlane32_swap_b32 v26, v27
    v_max_f32 v26, v26, v27
    v_mfma_f32_16x16x32_bf16 v[124:127], a[188:191], a[12:15], v[124:127]
    s_waitcnt lgkmcnt(4)
    v_mov_b32 v29, v28
    v_mov_b32 v27, v26
    s_nop 1
    v_permlane16_swap_b32 v26, v27
    v_max_f32 v26, v26, v27
    v_mfma_f32_16x16x32_bf16 v[128:131], a[160:163], a[0:3], 0
    s_add_u32 m0, s29, 147456
    ds_read_b128 a[184:187], v8 offset:30720
    v_permlane16_swap_b32 v28, v29
    v_max_f32 v28, v28, v29
    v_mfma_f32_16x16x32_bf16 v[136:139], a[160:163], a[4:7], 0
    s_add_u32 s34, s26, 131328
    v_add_u32 v30, s46, v16
    v_mul_f32 v18, s36, v26
    v_ceil_f32 v18, v18
    v_mov_b32 v19, v18
    v_mfma_f32_16x16x32_bf16 v[128:131], a[164:167], a[8:11], v[128:131]
    s_waitcnt vmcnt(4)
    ds_read_b128 a[188:191], v9 offset:30720
    ds_write_b32 v30, v28 offset:0
    v_accvgpr_write_b32 a234, 0
    v_mfma_f32_16x16x32_bf16 v[136:139], a[164:167], a[12:15], v[136:139]
    s_waitcnt lgkmcnt(5)
    buffer_load_dwordx4 v0, s[16:19], s34 offen offset:0 nt lds
    v_permlane32_swap_b32 v18, v19
    v_mfma_f32_16x16x32_bf16 v[132:135], a[168:171], a[0:3], 0
    ds_read_b128 a[160:163], v10 offset:16384
    v_fma_f32 v32, v32, s36, -v18
    v_fma_f32 v33, v33, s36, -v18
    v_mfma_f32_16x16x32_bf16 v[140:143], a[168:171], a[4:7], 0
    ds_write_b32 v30, v28 offset:2048
    v_exp_f32 v32, v32
    v_mfma_f32_16x16x32_bf16 v[132:135], a[172:175], a[8:11], v[132:135]
    ds_read_b128 a[164:167], v11 offset:16384
    ds_write_b32 v30, v28 offset:4096
    v_mfma_f32_16x16x32_bf16 v[140:143], a[172:175], a[12:15], v[140:143]
    s_waitcnt lgkmcnt(7)
    ds_write_b32 v30, v28 offset:6144
    v_exp_f32 v33, v33
    v_mfma_f32_16x16x32_bf16 v[144:147], a[176:179], a[0:3], 0
    ds_read_b128 a[168:171], v10 offset:18432
    v_fma_f32 v34, v34, s36, -v18
    v_fma_f32 v35, v35, s36, -v18
    v_mfma_f32_16x16x32_bf16 v[152:155], a[176:179], a[4:7], 0
    v_exp_f32 v34, v34
    v_add_f32 v22, v32, v33
    v_exp_f32 v35, v35
    v_mfma_f32_16x16x32_bf16 v[144:147], a[180:183], a[8:11], v[144:147]
    ds_read_b128 a[172:175], v11 offset:18432
    v_cvt_pk_bf16_f32 v160, v32, v33
    v_fma_f32 v36, v36, s36, -v18
    v_mfma_f32_16x16x32_bf16 v[152:155], a[180:183], a[12:15], v[152:155]
    s_waitcnt lgkmcnt(8)
    v_fma_f32 v37, v37, s36, -v18
    v_exp_f32 v36, v36
    v_mfma_f32_16x16x32_bf16 v[148:151], a[184:187], a[0:3], 0
    s_waitcnt lgkmcnt(2)
    s_barrier
    ds_read_b128 a[176:179], v8 offset:32768
    v_mfma_f32_16x16x32_bf16 v[156:159], a[184:187], a[4:7], 0
    v_add_f32 v22, v22, v34
    v_exp_f32 v37, v37
    v_add_f32 v22, v22, v35
    v_mfma_f32_16x16x32_bf16 v[148:151], a[188:191], a[8:11], v[148:151]
    s_waitcnt vmcnt(4)
    ds_read_b128 a[180:183], v9 offset:32768
    buffer_load_dwordx4 v1, s[16:19], s34 offen offset:1024 nt lds
    v_mfma_f32_16x16x32_bf16 v[156:159], a[188:191], a[12:15], v[156:159]
    v_cvt_pk_bf16_f32 v161, v34, v35
    v_fma_f32 v38, v38, s36, -v18
    v_fma_f32 v39, v39, s36, -v18
    v_mfma_f32_16x16x32_bf16 v[240:243], a[160:163], a[64:67], 0
    ds_read_b128 a[184:187], v8 offset:34816
    v_exp_f32 v38, v38
    v_add_f32 v22, v22, v36
    v_mfma_f32_16x16x32_bf16 v[248:251], a[160:163], a[68:71], 0
    v_exp_f32 v39, v39
    v_add_f32 v22, v22, v37
    v_cvt_pk_bf16_f32 v162, v36, v37
    v_mfma_f32_16x16x32_bf16 v[240:243], a[164:167], a[72:75], v[240:243]
    ds_read_b128 a[188:191], v9 offset:34816
    v_fma_f32 v40, v40, s36, -v19
    v_fma_f32 v41, v41, s36, -v19
    v_mfma_f32_16x16x32_bf16 v[248:251], a[164:167], a[76:79], v[248:251]
    s_waitcnt lgkmcnt(4)
    v_exp_f32 v40, v40
    v_add_f32 v22, v22, v38
    v_mfma_f32_16x16x32_bf16 v[244:247], a[168:171], a[64:67], 0
    ds_read_b128 a[160:163], v8 offset:36864
    v_exp_f32 v41, v41
    v_add_f32 v22, v22, v39
    v_mfma_f32_16x16x32_bf16 v[252:255], a[168:171], a[68:71], 0
    v_cvt_pk_bf16_f32 v163, v38, v39
    v_fma_f32 v42, v42, s36, -v19
    v_fma_f32 v43, v43, s36, -v19
    v_exp_f32 v42, v42
    v_mfma_f32_16x16x32_bf16 v[244:247], a[172:175], a[72:75], v[244:247]
    ds_read_b128 a[164:167], v9 offset:36864
    v_add_f32 v23, v40, v41
    v_mfma_f32_16x16x32_bf16 v[252:255], a[172:175], a[76:79], v[252:255]
    s_waitcnt lgkmcnt(4)
    v_exp_f32 v43, v43
    v_cvt_pk_bf16_f32 v164, v40, v41
    v_fma_f32 v44, v44, s36, -v19
    v_mfma_f32_16x16x32_bf16 v[96:99], a[176:179], a[16:19], v[96:99]
    s_add_u32 s34, s34, 6144
    ds_read_b128 a[168:171], v8 offset:38912
    v_fma_f32 v45, v45, s36, -v19
    v_exp_f32 v44, v44
    v_mfma_f32_16x16x32_bf16 v[104:107], a[176:179], a[20:23], v[104:107]
    s_waitcnt vmcnt(3)
    buffer_load_dwordx4 v0, s[16:19], s34 offen offset:2048 nt lds
    v_add_f32 v23, v23, v42
    v_mfma_f32_16x16x32_bf16 v[96:99], a[180:183], a[24:27], v[96:99]
    ds_read_b128 a[172:175], v9 offset:38912
    v_exp_f32 v45, v45
    v_mfma_f32_16x16x32_bf16 v[104:107], a[180:183], a[28:31], v[104:107]
    s_waitcnt lgkmcnt(4)
    v_add_f32 v23, v23, v43
    v_cvt_pk_bf16_f32 v165, v42, v43
    v_fma_f32 v46, v46, s36, -v19
    v_fma_f32 v47, v47, s36, -v19
    v_mfma_f32_16x16x32_bf16 v[100:103], a[184:187], a[16:19], v[100:103]
    ds_read_b128 a[176:179], v8 offset:40960
    v_exp_f32 v46, v46
    v_mfma_f32_16x16x32_bf16 v[108:111], a[184:187], a[20:23], v[108:111]
    v_add_u32 v26, s45, v16
    v_add_f32 v23, v23, v44
    v_exp_f32 v47, v47
    v_mfma_f32_16x16x32_bf16 v[100:103], a[188:191], a[24:27], v[100:103]
    ds_read_b128 a[180:183], v9 offset:40960
    v_add_f32 v23, v23, v45
    v_cvt_pk_bf16_f32 v166, v44, v45
    v_fma_f32 v48, v48, s36, -v18
    v_mfma_f32_16x16x32_bf16 v[108:111], a[188:191], a[28:31], v[108:111]
    s_waitcnt lgkmcnt(4)
    ds_read_b128 v[28:31], v26 offset:0
    v_fma_f32 v49, v49, s36, -v18
    v_exp_f32 v48, v48
    v_mfma_f32_16x16x32_bf16 v[112:115], a[160:163], a[16:19], v[112:115]
    ds_read_b128 a[184:187], v8 offset:43008
    v_add_f32 v23, v23, v46
    v_mfma_f32_16x16x32_bf16 v[120:123], a[160:163], a[20:23], v[120:123]
    v_exp_f32 v49, v49
    v_add_f32 v23, v23, v47
    v_cvt_pk_bf16_f32 v167, v46, v47
    v_mfma_f32_16x16x32_bf16 v[112:115], a[164:167], a[24:27], v[112:115]
    ds_read_b128 a[188:191], v9 offset:43008
    v_fma_f32 v50, v50, s36, -v18
    v_fma_f32 v51, v51, s36, -v18
    v_mfma_f32_16x16x32_bf16 v[120:123], a[164:167], a[28:31], v[120:123]
    s_waitcnt lgkmcnt(5)
    v_exp_f32 v50, v50
    v_add_f32 v22, v22, v48
    v_exp_f32 v51, v51
    v_mfma_f32_16x16x32_bf16 v[116:119], a[168:171], a[16:19], v[116:119]
    s_waitcnt vmcnt(3)
    ds_read_b128 a[160:163], v8 offset:45056
    buffer_load_dwordx4 v1, s[16:19], s34 offen offset:3072 nt lds
    v_mfma_f32_16x16x32_bf16 v[124:127], a[168:171], a[20:23], v[124:127]
    v_add_f32 v22, v22, v49
    v_cvt_pk_bf16_f32 v168, v48, v49
    v_fma_f32 v52, v52, s36, -v18
    v_mfma_f32_16x16x32_bf16 v[116:119], a[172:175], a[24:27], v[116:119]
    ds_read_b128 a[164:167], v9 offset:45056
    v_fma_f32 v53, v53, s36, -v18
    v_exp_f32 v52, v52
    v_mfma_f32_16x16x32_bf16 v[124:127], a[172:175], a[28:31], v[124:127]
    s_waitcnt lgkmcnt(5)
    v_add_f32 v22, v22, v50
    v_exp_f32 v53, v53
    v_mfma_f32_16x16x32_bf16 v[128:131], a[176:179], a[16:19], v[128:131]
    ds_read_b128 a[168:171], v8 offset:47104
    v_add_f32 v22, v22, v51
    v_cvt_pk_bf16_f32 v169, v50, v51
    v_fma_f32 v54, v54, s36, -v18
    v_mfma_f32_16x16x32_bf16 v[136:139], a[176:179], a[20:23], v[136:139]
    s_waitcnt lgkmcnt(5)
    v_max3_f32 v26, v28, v29, v30
    v_max_f32 v26, v26, v31
    v_fma_f32 v55, v55, s36, -v18
    v_mfma_f32_16x16x32_bf16 v[128:131], a[180:183], a[24:27], v[128:131]
    ds_read_b128 a[172:175], v9 offset:47104
    v_mul_f32 v20, s36, v26
    v_ceil_f32 v20, v20
    v_mfma_f32_16x16x32_bf16 v[136:139], a[180:183], a[28:31], v[136:139]
    s_waitcnt lgkmcnt(4)
    v_mov_b32 v21, v20
    v_exp_f32 v54, v54
    v_add_f32 v22, v22, v52
    v_mfma_f32_16x16x32_bf16 v[132:135], a[184:187], a[16:19], v[132:135]
    ds_read_b128 a[176:179], v10 offset:32768
    v_accvgpr_write_b32 a235, 0
    v_exp_f32 v55, v55
    v_mfma_f32_16x16x32_bf16 v[140:143], a[184:187], a[20:23], v[140:143]
    s_add_u32 m0, s29, 32768
    v_permlane32_swap_b32 v20, v21
    v_fma_f32 v224, v224, s36, -v20
    v_add_f32 v22, v22, v53
    v_mfma_f32_16x16x32_bf16 v[132:135], a[188:191], a[24:27], v[132:135]
    s_add_u32 s34, s26, 131456
    ds_read_b128 a[180:183], v11 offset:32768
    v_fma_f32 v225, v225, s36, -v20
    v_cvt_pk_bf16_f32 v170, v52, v53
    v_fma_f32 v56, v56, s36, -v19
    v_mfma_f32_16x16x32_bf16 v[140:143], a[188:191], a[28:31], v[140:143]
    s_waitcnt lgkmcnt(4)
    v_exp_f32 v224, v224
    v_fma_f32 v57, v57, s36, -v19
    v_mfma_f32_16x16x32_bf16 v[144:147], a[160:163], a[16:19], v[144:147]
    s_waitcnt vmcnt(4)
    ds_read_b128 a[184:187], v10 offset:34816
    buffer_load_dwordx4 v0, s[16:19], s34 offen offset:0 nt lds
    v_mfma_f32_16x16x32_bf16 v[152:155], a[160:163], a[20:23], v[152:155]
    v_exp_f32 v225, v225
    v_exp_f32 v56, v56
    v_mfma_f32_16x16x32_bf16 v[144:147], a[164:167], a[24:27], v[144:147]
    ds_read_b128 a[188:191], v11 offset:34816
    v_add_f32 v22, v22, v54
    v_exp_f32 v57, v57
    v_mfma_f32_16x16x32_bf16 v[152:155], a[164:167], a[28:31], v[152:155]
    s_waitcnt lgkmcnt(4)
    v_fma_f32 v226, v226, s36, -v20
    v_fma_f32 v227, v227, s36, -v20
    v_add_f32 v22, v22, v55
    v_mfma_f32_16x16x32_bf16 v[148:151], a[168:171], a[16:19], v[148:151]
    s_waitcnt vmcnt(17)
    s_barrier
    ds_read_b128 a[160:163], v8 offset:49152
    v_mfma_f32_16x16x32_bf16 v[156:159], a[168:171], a[20:23], v[156:159]
    v_exp_f32 v226, v226
    v_cvt_pk_bf16_f32 v171, v54, v55
    v_fma_f32 v58, v58, s36, -v19
    v_mfma_f32_16x16x32_bf16 v[148:151], a[172:175], a[24:27], v[148:151]
    ds_read_b128 a[164:167], v9 offset:49152
    v_add_f32 v24, v224, v225
    v_fma_f32 v59, v59, s36, -v19
    v_mfma_f32_16x16x32_bf16 v[156:159], a[172:175], a[28:31], v[156:159]
    s_waitcnt lgkmcnt(4)
    v_exp_f32 v227, v227
    v_exp_f32 v58, v58
    v_mfma_f32_16x16x32_bf16 v[240:243], a[176:179], a[80:83], v[240:243]
    ds_read_b128 a[168:171], v8 offset:51200
    v_cvt_pk_bf16_f32 v224, v224, v225
    v_add_f32 v23, v23, v56
    v_mfma_f32_16x16x32_bf16 v[248:251], a[176:179], a[84:87], v[248:251]
    v_fma_f32 v228, v228, s36, -v20
    v_exp_f32 v59, v59
    v_add_f32 v23, v23, v57
    v_mfma_f32_16x16x32_bf16 v[240:243], a[180:183], a[88:91], v[240:243]
    s_waitcnt vmcnt(4)
    ds_read_b128 a[172:175], v9 offset:51200
    v_fma_f32 v229, v229, s36, -v20
    v_cvt_pk_bf16_f32 v172, v56, v57
    v_fma_f32 v60, v60, s36, -v19
    v_mfma_f32_16x16x32_bf16 v[248:251], a[180:183], a[92:95], v[248:251]
    s_waitcnt lgkmcnt(4)
    buffer_load_dwordx4 v1, s[16:19], s34 offen offset:1024 nt lds
    v_fma_f32 v61, v61, s36, -v19
    v_mfma_f32_16x16x32_bf16 v[244:247], a[184:187], a[80:83], v[244:247]
    ds_read_b128 a[176:179], v8 offset:53248
    v_exp_f32 v228, v228
    v_mfma_f32_16x16x32_bf16 v[252:255], a[184:187], a[84:87], v[252:255]
    v_add_f32 v24, v24, v226
    v_exp_f32 v60, v60
    v_add_f32 v23, v23, v58
    v_mfma_f32_16x16x32_bf16 v[244:247], a[188:191], a[88:91], v[244:247]
    ds_read_b128 a[180:183], v9 offset:53248
    v_exp_f32 v61, v61
    v_mfma_f32_16x16x32_bf16 v[252:255], a[188:191], a[92:95], v[252:255]
    s_waitcnt lgkmcnt(4)
    v_exp_f32 v229, v229
    v_add_f32 v24, v24, v227
    v_add_f32 v23, v23, v59
    v_mfma_f32_16x16x32_bf16 v[96:99], a[160:163], a[32:35], v[96:99]
    ds_read_b128 a[184:187], v8 offset:55296
    v_cvt_pk_bf16_f32 v173, v58, v59
    v_fma_f32 v62, v62, s36, -v19
    v_fma_f32 v63, v63, s36, -v19
    v_mfma_f32_16x16x32_bf16 v[104:107], a[160:163], a[36:39], v[104:107]
    v_cvt_pk_bf16_f32 v225, v226, v227
    v_fma_f32 v230, v230, s36, -v20
    v_exp_f32 v62, v62
    v_mfma_f32_16x16x32_bf16 v[96:99], a[164:167], a[40:43], v[96:99]
    ds_read_b128 a[188:191], v9 offset:55296
    v_fma_f32 v231, v231, s36, -v20
    v_add_f32 v23, v23, v60
    v_mfma_f32_16x16x32_bf16 v[104:107], a[164:167], a[44:47], v[104:107]
    s_waitcnt lgkmcnt(4)
    v_exp_f32 v230, v230
    v_exp_f32 v63, v63
    v_mfma_f32_16x16x32_bf16 v[100:103], a[168:171], a[32:35], v[100:103]
    ds_read_b128 a[160:163], v8 offset:57344
    v_add_f32 v24, v24, v228
    v_add_f32 v23, v23, v61
    v_mfma_f32_16x16x32_bf16 v[108:111], a[168:171], a[36:39], v[108:111]
    s_add_u32 s34, s34, 6144
    v_exp_f32 v231, v231
    v_cvt_pk_bf16_f32 v174, v60, v61
    v_mfma_f32_16x16x32_bf16 v[100:103], a[172:175], a[40:43], v[100:103]
    s_waitcnt vmcnt(3)
    ds_read_b128 a[164:167], v9 offset:57344
    buffer_load_dwordx4 v0, s[16:19], s34 offen offset:2048 nt lds
    v_mfma_f32_16x16x32_bf16 v[108:111], a[172:175], a[44:47], v[108:111]
    s_waitcnt lgkmcnt(4)
    v_add_f32 v24, v24, v229
    v_fma_f32 v64, v64, s36, -v18
    v_fma_f32 v65, v65, s36, -v18
    v_exp_f32 v64, v64
    v_mfma_f32_16x16x32_bf16 v[112:115], a[176:179], a[32:35], v[112:115]
    ds_read_b128 a[168:171], v8 offset:59392
    v_cvt_pk_bf16_f32 v226, v228, v229
    v_add_f32 v23, v23, v62
    v_mfma_f32_16x16x32_bf16 v[120:123], a[176:179], a[36:39], v[120:123]
    v_fma_f32 v232, v232, s36, -v21
    v_fma_f32 v233, v233, s36, -v21
    v_exp_f32 v65, v65
    v_mfma_f32_16x16x32_bf16 v[112:115], a[180:183], a[40:43], v[112:115]
    ds_read_b128 a[172:175], v9 offset:59392
    v_exp_f32 v232, v232
    v_mfma_f32_16x16x32_bf16 v[120:123], a[180:183], a[44:47], v[120:123]
    s_waitcnt lgkmcnt(4)
    v_add_f32 v24, v24, v230
    v_add_f32 v23, v23, v63
    v_cvt_pk_bf16_f32 v175, v62, v63
    v_mfma_f32_16x16x32_bf16 v[116:119], a[184:187], a[32:35], v[116:119]
    ds_read_b128 a[176:179], v8 offset:61440
    v_fma_f32 v66, v66, s36, -v18
    v_fma_f32 v67, v67, s36, -v18
    v_mfma_f32_16x16x32_bf16 v[124:127], a[184:187], a[36:39], v[124:127]
    v_exp_f32 v233, v233
    v_add_f32 v24, v24, v231
    v_exp_f32 v66, v66
    v_mfma_f32_16x16x32_bf16 v[116:119], a[188:191], a[40:43], v[116:119]
    ds_read_b128 a[180:183], v9 offset:61440
    v_add_f32 v22, v22, v64
    v_mfma_f32_16x16x32_bf16 v[124:127], a[188:191], a[44:47], v[124:127]
    s_waitcnt lgkmcnt(4)
    v_cvt_pk_bf16_f32 v227, v230, v231
    v_fma_f32 v234, v234, s36, -v21
    v_exp_f32 v67, v67
    v_mfma_f32_16x16x32_bf16 v[128:131], a[160:163], a[32:35], v[128:131]
    ds_read_b128 a[184:187], v8 offset:63488
    s_nop 0
A_stub4:
    s_cbranch_execz A_stub8
    v_xor_b32 v8, 0x10000, v8
    v_add_f32 v22, v22, v65
    v_cvt_pk_bf16_f32 v176, v64, v65
    v_mfma_f32_16x16x32_bf16 v[136:139], a[160:163], a[36:39], v[136:139]
    s_waitcnt vmcnt(3)
    buffer_load_dwordx4 v1, s[16:19], s34 offen offset:3072 nt lds
    v_fma_f32 v68, v68, s36, -v18
    v_mfma_f32_16x16x32_bf16 v[128:131], a[164:167], a[40:43], v[128:131]
    ds_read_b128 a[188:191], v9 offset:63488
    v_xor_b32 v9, 0x10000, v9
    v_fma_f32 v69, v69, s36, -v18
    v_mfma_f32_16x16x32_bf16 v[136:139], a[164:167], a[44:47], v[136:139]
    s_waitcnt lgkmcnt(4)
    v_fma_f32 v235, v235, s36, -v21
    v_exp_f32 v234, v234
    v_exp_f32 v68, v68
    v_mfma_f32_16x16x32_bf16 v[132:135], a[168:171], a[32:35], v[132:135]
    ds_read_b128 a[160:163], v10 offset:49152
    v_add_f32 v22, v22, v66
    v_mfma_f32_16x16x32_bf16 v[140:143], a[168:171], a[36:39], v[140:143]
    v_add_f32 v25, v232, v233
    v_exp_f32 v69, v69
    v_add_f32 v22, v22, v67
    v_mfma_f32_16x16x32_bf16 v[132:135], a[172:175], a[40:43], v[132:135]
    ds_read_b128 a[164:167], v11 offset:49152
    v_exp_f32 v235, v235
    v_cvt_pk_bf16_f32 v177, v66, v67
    v_mfma_f32_16x16x32_bf16 v[140:143], a[172:175], a[44:47], v[140:143]
    s_waitcnt lgkmcnt(4)
    v_cvt_pk_bf16_f32 v228, v232, v233
    v_fma_f32 v70, v70, s36, -v18
    v_fma_f32 v71, v71, s36, -v18
    v_mfma_f32_16x16x32_bf16 v[144:147], a[176:179], a[32:35], v[144:147]
    ds_read_b128 a[168:171], v10 offset:51200
    v_xor_b32 v10, 0x10000, v10
    v_exp_f32 v70, v70
    v_mfma_f32_16x16x32_bf16 v[152:155], a[176:179], a[36:39], v[152:155]
    v_fma_f32 v236, v236, s36, -v21
    v_fma_f32 v237, v237, s36, -v21
    v_add_f32 v22, v22, v68
    v_mfma_f32_16x16x32_bf16 v[144:147], a[180:183], a[40:43], v[144:147]
    ds_read_b128 a[172:175], v11 offset:51200
    v_xor_b32 v11, 0x10000, v11
    v_exp_f32 v71, v71
    v_mfma_f32_16x16x32_bf16 v[152:155], a[180:183], a[44:47], v[152:155]
    s_waitcnt lgkmcnt(4)
    v_exp_f32 v236, v236
    v_add_f32 v22, v22, v69
    v_cvt_pk_bf16_f32 v178, v68, v69
    v_mfma_f32_16x16x32_bf16 v[148:151], a[184:187], a[32:35], v[148:151]
    s_add_u32 m0, s29, 65536
    s_waitcnt vmcnt(16)
    s_barrier
    ds_read_b128 a[176:179], v8 offset:0
    v_mfma_f32_16x16x32_bf16 v[156:159], a[184:187], a[36:39], v[156:159]
    s_add_u32 s34, s26, 196608
    v_add_f32 v25, v25, v234
    v_fma_f32 v72, v72, s36, -v19
    v_fma_f32 v73, v73, s36, -v19
    v_mfma_f32_16x16x32_bf16 v[148:151], a[188:191], a[40:43], v[148:151]
    s_waitcnt vmcnt(4)
    ds_read_b128 a[180:183], v9 offset:0
    buffer_load_dwordx4 v0, s[16:19], s34 offen offset:0 nt lds
    v_mfma_f32_16x16x32_bf16 v[156:159], a[188:191], a[44:47], v[156:159]
    s_waitcnt lgkmcnt(4)
    v_exp_f32 v237, v237
    v_add_f32 v25, v25, v235
    v_mfma_f32_16x16x32_bf16 v[240:243], a[160:163], a[96:99], v[240:243]
    ds_read_b128 a[184:187], v8 offset:2048
    v_cvt_pk_bf16_f32 v229, v234, v235
    v_exp_f32 v72, v72
    v_mfma_f32_16x16x32_bf16 v[248:251], a[160:163], a[100:103], v[248:251]
    v_fma_f32 v238, v238, s36, -v21
    v_add_f32 v22, v22, v70
    v_exp_f32 v73, v73
    v_mfma_f32_16x16x32_bf16 v[240:243], a[164:167], a[104:107], v[240:243]
    ds_read_b128 a[188:191], v9 offset:2048
    v_fma_f32 v239, v239, s36, -v21
    v_add_f32 v22, v22, v71
    v_cvt_pk_bf16_f32 v179, v70, v71
    v_mfma_f32_16x16x32_bf16 v[248:251], a[164:167], a[108:111], v[248:251]
    s_waitcnt lgkmcnt(4)
    v_exp_f32 v238, v238
    v_fma_f32 v74, v74, s36, -v19
    v_mfma_f32_16x16x32_bf16 v[244:247], a[168:171], a[96:99], v[244:247]
    ds_read_b128 a[160:163], v8 offset:4096
    v_add_f32 v25, v25, v236
    v_fma_f32 v75, v75, s36, -v19
    v_mfma_f32_16x16x32_bf16 v[252:255], a[168:171], a[100:103], v[252:255]
    v_exp_f32 v239, v239
    v_exp_f32 v74, v74
    v_mfma_f32_16x16x32_bf16 v[244:247], a[172:175], a[104:107], v[244:247]
    ds_read_b128 a[164:167], v9 offset:4096
    v_add_f32 v25, v25, v237
    v_add_f32 v23, v23, v72
    v_mfma_f32_16x16x32_bf16 v[252:255], a[172:175], a[108:111], v[252:255]
    s_waitcnt lgkmcnt(4)
    v_cvt_pk_bf16_f32 v230, v236, v237
    v_exp_f32 v75, v75
    v_add_f32 v23, v23, v73
    v_mfma_f32_16x16x32_bf16 v[96:99], a[176:179], a[48:51], v[96:99]
    ds_read_b128 a[168:171], v8 offset:6144
    v_add_f32 v25, v25, v238
    v_cvt_pk_bf16_f32 v180, v72, v73
    v_fma_f32 v76, v76, s36, -v19
    v_mfma_f32_16x16x32_bf16 v[104:107], a[176:179], a[52:55], v[104:107]
    s_waitcnt vmcnt(4)
    buffer_load_dwordx4 v1, s[16:19], s34 offen offset:1024 nt lds
    v_fma_f32 v77, v77, s36, -v19
    v_mfma_f32_16x16x32_bf16 v[96:99], a[180:183], a[56:59], v[96:99]
    ds_read_b128 a[172:175], v9 offset:6144
    v_add_f32 v25, v25, v239
    v_exp_f32 v76, v76
    v_mfma_f32_16x16x32_bf16 v[104:107], a[180:183], a[60:63], v[104:107]
    s_waitcnt lgkmcnt(4)
    v_cvt_pk_bf16_f32 v231, v238, v239
    v_add_u32 v28, s45, v16
    v_add_f32 v23, v23, v74
    v_mfma_f32_16x16x32_bf16 v[100:103], a[184:187], a[48:51], v[100:103]
    ds_read_b128 a[176:179], v8 offset:8192
    v_exp_f32 v77, v77
    v_add_f32 v23, v23, v75
    v_mfma_f32_16x16x32_bf16 v[108:111], a[184:187], a[52:55], v[108:111]
    ds_write_b128 v28, v[224:227] offset:0
    v_mfma_f32_16x16x32_bf16 v[100:103], a[188:191], a[56:59], v[100:103]
    ds_read_b128 a[180:183], v9 offset:8192
    v_cvt_pk_bf16_f32 v181, v74, v75
    v_fma_f32 v78, v78, s36, -v19
    v_mfma_f32_16x16x32_bf16 v[108:111], a[188:191], a[60:63], v[108:111]
    s_waitcnt lgkmcnt(5)
    v_fma_f32 v79, v79, s36, -v19
    v_exp_f32 v78, v78
    v_add_f32 v23, v23, v76
    v_mfma_f32_16x16x32_bf16 v[112:115], a[160:163], a[48:51], v[112:115]
    ds_read_b128 a[184:187], v8 offset:10240
    ds_write_b128 v28, v[228:231] offset:1024
    v_mfma_f32_16x16x32_bf16 v[120:123], a[160:163], a[52:55], v[120:123]
    v_exp_f32 v79, v79
    v_add_f32 v23, v23, v77
    v_mfma_f32_16x16x32_bf16 v[112:115], a[164:167], a[56:59], v[112:115]
    s_add_u32 s34, s34, 6144
    ds_read_b128 a[188:191], v9 offset:10240
    v_cvt_pk_bf16_f32 v182, v76, v77
    v_fma_f32 v80, v80, s36, -v18
    v_fma_f32 v81, v81, s36, -v18
    v_mfma_f32_16x16x32_bf16 v[120:123], a[164:167], a[60:63], v[120:123]
    s_waitcnt lgkmcnt(6)
    v_exp_f32 v80, v80
    v_add_f32 v23, v23, v78
    v_mfma_f32_16x16x32_bf16 v[116:119], a[168:171], a[48:51], v[116:119]
    s_waitcnt vmcnt(3)
    ds_read_b128 a[160:163], v8 offset:12288
    buffer_load_dwordx4 v0, s[16:19], s34 offen offset:2048 nt lds
    v_mfma_f32_16x16x32_bf16 v[124:127], a[168:171], a[52:55], v[124:127]
    v_exp_f32 v81, v81
    v_add_f32 v23, v23, v79
    v_cvt_pk_bf16_f32 v183, v78, v79
    v_mfma_f32_16x16x32_bf16 v[116:119], a[172:175], a[56:59], v[116:119]
    ds_read_b128 a[164:167], v9 offset:12288
    v_fma_f32 v82, v82, s36, -v18
    v_fma_f32 v83, v83, s36, -v18
    v_mfma_f32_16x16x32_bf16 v[124:127], a[172:175], a[60:63], v[124:127]
    s_waitcnt lgkmcnt(5)
    v_exp_f32 v82, v82
    v_add_f32 v22, v22, v80
    v_exp_f32 v83, v83
    v_mfma_f32_16x16x32_bf16 v[128:131], a[176:179], a[48:51], v[128:131]
    ds_read_b128 a[168:171], v8 offset:14336
    v_add_f32 v22, v22, v81
    v_cvt_pk_bf16_f32 v184, v80, v81
    v_mfma_f32_16x16x32_bf16 v[136:139], a[176:179], a[52:55], v[136:139]
    v_fma_f32 v84, v84, s36, -v18
    v_fma_f32 v85, v85, s36, -v18
    v_exp_f32 v84, v84
    v_mfma_f32_16x16x32_bf16 v[128:131], a[180:183], a[56:59], v[128:131]
    ds_read_b128 a[172:175], v9 offset:14336
    v_add_f32 v22, v22, v82
    v_mfma_f32_16x16x32_bf16 v[136:139], a[180:183], a[60:63], v[136:139]
    s_waitcnt lgkmcnt(4)
    v_exp_f32 v85, v85
    v_add_f32 v22, v22, v83
    v_cvt_pk_bf16_f32 v185, v82, v83
    v_mfma_f32_16x16x32_bf16 v[132:135], a[184:187], a[48:51], v[132:135]
    ds_read_b128 a[176:179], v10 offset:0
    v_fma_f32 v86, v86, s36, -v18
    v_fma_f32 v87, v87, s36, -v18
    v_exp_f32 v86, v86
    v_mfma_f32_16x16x32_bf16 v[140:143], a[184:187], a[52:55], v[140:143]
    v_add_f32 v22, v22, v84
    v_exp_f32 v87, v87
    v_mfma_f32_16x16x32_bf16 v[132:135], a[188:191], a[56:59], v[132:135]
    s_waitcnt vmcnt(3)
    ds_read_b128 a[180:183], v11 offset:0
    v_add_f32 v22, v22, v85
    v_cvt_pk_bf16_f32 v186, v84, v85
    v_mfma_f32_16x16x32_bf16 v[140:143], a[188:191], a[60:63], v[140:143]
    s_waitcnt lgkmcnt(4)
    buffer_load_dwordx4 v1, s[16:19], s34 offen offset:3072 nt lds
    v_fma_f32 v88, v88, s36, -v19
    v_mfma_f32_16x16x32_bf16 v[144:147], a[160:163], a[48:51], v[144:147]
    ds_read_b128 a[184:187], v10 offset:2048
    v_fma_f32 v89, v89, s36, -v19
    v_exp_f32 v88, v88
    v_mfma_f32_16x16x32_bf16 v[152:155], a[160:163], a[52:55], v[152:155]
    v_add_f32 v22, v22, v86
    v_exp_f32 v89, v89
    v_mfma_f32_16x16x32_bf16 v[144:147], a[164:167], a[56:59], v[144:147]
    ds_read_b128 a[188:191], v11 offset:2048
    v_add_f32 v22, v22, v87
    v_cvt_pk_bf16_f32 v187, v86, v87
    v_fma_f32 v90, v90, s36, -v19
    v_mfma_f32_16x16x32_bf16 v[152:155], a[164:167], a[60:63], v[152:155]
    s_waitcnt lgkmcnt(4)
    v_fma_f32 v91, v91, s36, -v19
    v_exp_f32 v90, v90
    v_mfma_f32_16x16x32_bf16 v[148:151], a[168:171], a[48:51], v[148:151]
    s_waitcnt vmcnt(16)
    s_barrier
    ds_read_b128 a[160:163], v8 offset:16384
    v_mfma_f32_16x16x32_bf16 v[156:159], a[168:171], a[52:55], v[156:159]
    v_add_f32 v23, v23, v88
    v_exp_f32 v91, v91
    v_add_f32 v23, v23, v89
    v_mfma_f32_16x16x32_bf16 v[148:151], a[172:175], a[56:59], v[148:151]
    ds_read_b128 a[164:167], v9 offset:16384
    v_cvt_pk_bf16_f32 v188, v88, v89
    v_fma_f32 v92, v92, s36, -v19
    v_fma_f32 v93, v93, s36, -v19
    v_mfma_f32_16x16x32_bf16 v[156:159], a[172:175], a[60:63], v[156:159]
    s_waitcnt lgkmcnt(4)
    v_exp_f32 v92, v92
    v_add_f32 v23, v23, v90
    v_mfma_f32_16x16x32_bf16 v[240:243], a[176:179], a[112:115], v[240:243]
    s_add_u32 m0, s29, 81920
    ds_read_b128 a[168:171], v8 offset:18432
    v_exp_f32 v93, v93
    v_add_f32 v23, v23, v91
    v_mfma_f32_16x16x32_bf16 v[248:251], a[176:179], a[116:119], v[248:251]
    s_add_u32 s34, s26, 196736
    v_cvt_pk_bf16_f32 v189, v90, v91
    v_fma_f32 v94, v94, s36, -v19
    v_fma_f32 v95, v95, s36, -v19
    v_mfma_f32_16x16x32_bf16 v[240:243], a[180:183], a[120:123], v[240:243]
    s_waitcnt vmcnt(4)
    ds_read_b128 a[172:175], v9 offset:18432
    buffer_load_dwordx4 v0, s[16:19], s34 offen offset:0 nt lds
    v_mfma_f32_16x16x32_bf16 v[248:251], a[180:183], a[124:127], v[248:251]
    s_waitcnt lgkmcnt(4)
    v_exp_f32 v94, v94
    v_add_f32 v23, v23, v92
    v_mfma_f32_16x16x32_bf16 v[244:247], a[184:187], a[112:115], v[244:247]
    ds_read_b128 a[176:179], v8 offset:20480
    v_exp_f32 v95, v95
    v_add_f32 v23, v23, v93
    v_mfma_f32_16x16x32_bf16 v[252:255], a[184:187], a[116:119], v[252:255]
    v_cvt_pk_bf16_f32 v190, v92, v93
    v_add_f32 v23, v23, v94
    v_add_f32 v23, v23, v95
    v_cvt_pk_bf16_f32 v191, v94, v95
    v_mfma_f32_16x16x32_bf16 v[244:247], a[188:191], a[120:123], v[244:247]
    ds_read_b128 a[180:183], v9 offset:20480
    v_mfma_f32_16x16x32_bf16 v[252:255], a[188:191], a[124:127], v[252:255]
    s_waitcnt lgkmcnt(4)
    v_mfma_f32_16x16x32_bf16 v[32:35], a[160:163], a[0:3], 0
    ds_read_b128 a[184:187], v8 offset:22528
    v_max3_f32 v26, v96, v97, v98
    v_max3_f32 v27, v104, v105, v106
    v_max3_f32 v26, v26, v99, v100
    v_mfma_f32_16x16x32_bf16 v[40:43], a[160:163], a[4:7], 0
    v_max3_f32 v27, v27, v107, v108
    v_max3_f32 v26, v26, v101, v102
    v_max3_f32 v27, v27, v109, v110
    v_mfma_f32_16x16x32_bf16 v[32:35], a[164:167], a[8:11], v[32:35]
    ds_read_b128 a[188:191], v9 offset:22528
    v_max3_f32 v26, v26, v103, v112
    v_max3_f32 v27, v27, v111, v120
    v_max3_f32 v26, v26, v113, v114
    v_mfma_f32_16x16x32_bf16 v[40:43], a[164:167], a[12:15], v[40:43]
    s_waitcnt lgkmcnt(4)
    v_max3_f32 v27, v27, v121, v122
    v_max3_f32 v26, v26, v115, v116
    v_max3_f32 v27, v27, v123, v124
    v_mfma_f32_16x16x32_bf16 v[36:39], a[168:171], a[0:3], 0
    ds_read_b128 a[160:163], v8 offset:24576
    v_max3_f32 v26, v26, v117, v118
    v_max3_f32 v27, v27, v125, v126
    v_max3_f32 v26, v26, v119, v128
    v_mfma_f32_16x16x32_bf16 v[44:47], a[168:171], a[4:7], 0
    s_waitcnt vmcnt(4)
    buffer_load_dwordx4 v1, s[16:19], s34 offen offset:1024 nt lds
    v_max3_f32 v27, v27, v127, v136
    v_mfma_f32_16x16x32_bf16 v[36:39], a[172:175], a[8:11], v[36:39]
    ds_read_b128 a[164:167], v9 offset:24576
    v_max3_f32 v28, v240, v241, v242
    v_max3_f32 v26, v26, v129, v130
    v_max3_f32 v27, v27, v137, v138
    v_mfma_f32_16x16x32_bf16 v[44:47], a[172:175], a[12:15], v[44:47]
    s_waitcnt lgkmcnt(4)
    v_max3_f32 v29, v248, v249, v250
    v_max3_f32 v26, v26, v131, v132
    v_max3_f32 v27, v27, v139, v140
    v_mfma_f32_16x16x32_bf16 v[48:51], a[176:179], a[0:3], 0
    ds_read_b128 a[168:171], v8 offset:26624
    v_max3_f32 v28, v28, v243, v244
    v_max3_f32 v26, v26, v133, v134
    v_max3_f32 v27, v27, v141, v142
    v_mfma_f32_16x16x32_bf16 v[56:59], a[176:179], a[4:7], 0
    v_max3_f32 v29, v29, v251, v252
    v_max3_f32 v28, v28, v245, v246
    v_max3_f32 v26, v26, v135, v144
    v_max3_f32 v27, v27, v143, v152
    v_mfma_f32_16x16x32_bf16 v[48:51], a[180:183], a[8:11], v[48:51]
    ds_read_b128 a[172:175], v9 offset:26624
    v_max3_f32 v29, v29, v253, v254
    v_max3_f32 v26, v26, v145, v146
    v_mfma_f32_16x16x32_bf16 v[56:59], a[180:183], a[12:15], v[56:59]
    s_waitcnt lgkmcnt(4)
    v_max_f32 v28, v28, v247
    v_max3_f32 v27, v27, v153, v154
    v_max3_f32 v26, v26, v147, v148
    v_max3_f32 v27, v27, v155, v156
    v_mfma_f32_16x16x32_bf16 v[52:55], a[184:187], a[0:3], 0
    ds_read_b128 a[176:179], v8 offset:28672
    v_max_f32 v29, v29, v255
    v_max3_f32 v26, v26, v149, v150
    v_mfma_f32_16x16x32_bf16 v[60:63], a[184:187], a[4:7], 0
    v_permlane32_swap_b32 v28, v29
    v_max_f32 v28, v28, v29
    v_max3_f32 v27, v27, v157, v158
    v_max_f32 v26, v26, v151
    v_mfma_f32_16x16x32_bf16 v[52:55], a[188:191], a[8:11], v[52:55]
    s_add_u32 s34, s34, 6144
    ds_read_b128 a[180:183], v9 offset:28672
    v_mov_b32 v29, v28
    v_max_f32 v27, v27, v159
    v_mfma_f32_16x16x32_bf16 v[60:63], a[188:191], a[12:15], v[60:63]
    s_waitcnt lgkmcnt(4)
    v_permlane16_swap_b32 v28, v29
    v_max_f32 v28, v28, v29
    v_permlane32_swap_b32 v26, v27
    v_max_f32 v26, v26, v27
    v_mfma_f32_16x16x32_bf16 v[64:67], a[160:163], a[0:3], 0
    s_waitcnt vmcnt(3)
    ds_read_b128 a[184:187], v8 offset:30720
    buffer_load_dwordx4 v0, s[16:19], s34 offen offset:2048 nt lds
    v_mfma_f32_16x16x32_bf16 v[72:75], a[160:163], a[4:7], 0
    v_add_u32 v30, s46, v16
    v_mov_b32 v27, v26
    s_nop 1
    v_permlane16_swap_b32 v26, v27
    v_max_f32 v26, v26, v27
    v_mfma_f32_16x16x32_bf16 v[64:67], a[164:167], a[8:11], v[64:67]
    ds_read_b128 a[188:191], v9 offset:30720
    v_cndmask_b32 v27, v19, v18, s[24:25]
    v_fma_f32 v27, v26, s36, -v27
    v_cmp_lt_f32 vcc, 0x41200000, v27
    s_cbranch_vccnz L_rare_o1
L_rare_o1_back:
    v_mfma_f32_16x16x32_bf16 v[72:75], a[164:167], a[12:15], v[72:75]
    s_waitcnt lgkmcnt(4)
    ds_write_b32 v30, v28 offset:8192
    v_mfma_f32_16x16x32_bf16 v[68:71], a[168:171], a[0:3], 0
    ds_read_b128 a[160:163], v10 offset:16384
    ds_write_b32 v30, v28 offset:10240
    v_fma_f32 v96, v96, s36, -v18
    v_mfma_f32_16x16x32_bf16 v[76:79], a[168:171], a[4:7], 0
    v_fma_f32 v97, v97, s36, -v18
    v_exp_f32 v96, v96
    v_mfma_f32_16x16x32_bf16 v[68:71], a[172:175], a[8:11], v[68:71]
    ds_read_b128 a[164:167], v11 offset:16384
    ds_write_b32 v30, v28 offset:12288
    v_mfma_f32_16x16x32_bf16 v[76:79], a[172:175], a[12:15], v[76:79]
    s_waitcnt lgkmcnt(7)
    ds_write_b32 v30, v28 offset:14336
    v_exp_f32 v97, v97
    v_mfma_f32_16x16x32_bf16 v[80:83], a[176:179], a[0:3], 0
    ds_read_b128 a[168:171], v10 offset:18432
    v_fma_f32 v98, v98, s36, -v18
    v_fma_f32 v99, v99, s36, -v18
    v_mfma_f32_16x16x32_bf16 v[88:91], a[176:179], a[4:7], 0
    v_exp_f32 v98, v98
    v_add_f32 v22, v22, v96
    v_exp_f32 v99, v99
    v_mfma_f32_16x16x32_bf16 v[80:83], a[180:183], a[8:11], v[80:83]
    s_waitcnt vmcnt(3)
    ds_read_b128 a[172:175], v11 offset:18432
    v_add_f32 v22, v22, v97
    v_cvt_pk_bf16_f32 v192, v96, v97
    v_mfma_f32_16x16x32_bf16 v[88:91], a[180:183], a[12:15], v[88:91]
    s_waitcnt lgkmcnt(8)
    buffer_load_dwordx4 v1, s[16:19], s34 offen offset:3072 nt lds
    v_fma_f32 v100, v100, s36, -v18
    v_mfma_f32_16x16x32_bf16 v[84:87], a[184:187], a[0:3], 0
    s_waitcnt vmcnt(16) lgkmcnt(2)
    s_barrier
    ds_read_b128 a[176:179], v8 offset:32768
    v_mfma_f32_16x16x32_bf16 v[92:95], a[184:187], a[4:7], 0
    v_fma_f32 v101, v101, s36, -v18
    v_exp_f32 v100, v100
    v_add_f32 v22, v22, v98
    v_mfma_f32_16x16x32_bf16 v[84:87], a[188:191], a[8:11], v[84:87]
    ds_read_b128 a[180:183], v9 offset:32768
    v_exp_f32 v101, v101
    v_mfma_f32_16x16x32_bf16 v[92:95], a[188:191], a[12:15], v[92:95]
    v_add_f32 v22, v22, v99
    v_cvt_pk_bf16_f32 v193, v98, v99
    v_fma_f32 v102, v102, s36, -v18
    v_fma_f32 v103, v103, s36, -v18
    v_mfma_f32_16x16x32_bf16 v[224:227], a[160:163], a[64:67], 0
    ds_read_b128 a[184:187], v8 offset:34816
    v_exp_f32 v102, v102
    v_add_f32 v22, v22, v100
    v_mfma_f32_16x16x32_bf16 v[232:235], a[160:163], a[68:71], 0
    v_exp_f32 v103, v103
    v_add_f32 v22, v22, v101
    v_mfma_f32_16x16x32_bf16 v[224:227], a[164:167], a[72:75], v[224:227]
    ds_read_b128 a[188:191], v9 offset:34816
    v_cvt_pk_bf16_f32 v194, v100, v101
    v_fma_f32 v104, v104, s36, -v19
    v_fma_f32 v105, v105, s36, -v19
    v_mfma_f32_16x16x32_bf16 v[232:235], a[164:167], a[76:79], v[232:235]
    s_waitcnt lgkmcnt(4)
    v_exp_f32 v104, v104
    v_add_f32 v22, v22, v102
    v_mfma_f32_16x16x32_bf16 v[228:231], a[168:171], a[64:67], 0
    s_add_u32 m0, s29, 98304
    ds_read_b128 a[160:163], v8 offset:36864
    v_exp_f32 v105, v105
    v_add_f32 v22, v22, v103
    v_mfma_f32_16x16x32_bf16 v[236:239], a[168:171], a[68:71], 0
    s_add_u32 s34, s26, 196864
    v_cvt_pk_bf16_f32 v195, v102, v103
    v_fma_f32 v106, v106, s36, -v19
    v_fma_f32 v107, v107, s36, -v19
    v_mfma_f32_16x16x32_bf16 v[228:231], a[172:175], a[72:75], v[228:231]
    s_waitcnt vmcnt(4)
    ds_read_b128 a[164:167], v9 offset:36864
    buffer_load_dwordx4 v0, s[16:19], s34 offen offset:0 nt lds
    v_mfma_f32_16x16x32_bf16 v[236:239], a[172:175], a[76:79], v[236:239]
    s_waitcnt lgkmcnt(4)
    v_exp_f32 v106, v106
    v_add_f32 v23, v23, v104
    v_exp_f32 v107, v107
    v_mfma_f32_16x16x32_bf16 v[32:35], a[176:179], a[16:19], v[32:35]
    ds_read_b128 a[168:171], v8 offset:38912
    v_add_f32 v23, v23, v105
    v_cvt_pk_bf16_f32 v196, v104, v105
    v_mfma_f32_16x16x32_bf16 v[40:43], a[176:179], a[20:23], v[40:43]
    v_fma_f32 v108, v108, s36, -v19
    v_fma_f32 v109, v109, s36, -v19
    v_exp_f32 v108, v108
    v_mfma_f32_16x16x32_bf16 v[32:35], a[180:183], a[24:27], v[32:35]
    ds_read_b128 a[172:175], v9 offset:38912
    v_add_f32 v23, v23, v106
    v_exp_f32 v109, v109
    v_mfma_f32_16x16x32_bf16 v[40:43], a[180:183], a[28:31], v[40:43]
    s_waitcnt lgkmcnt(4)
    v_add_f32 v23, v23, v107
    v_cvt_pk_bf16_f32 v197, v106, v107
    v_fma_f32 v110, v110, s36, -v19
    v_mfma_f32_16x16x32_bf16 v[36:39], a[184:187], a[16:19], v[36:39]
    ds_read_b128 a[176:179], v8 offset:40960
    v_fma_f32 v111, v111, s36, -v19
    v_exp_f32 v110, v110
    v_mfma_f32_16x16x32_bf16 v[44:47], a[184:187], a[20:23], v[44:47]
    v_add_u32 v26, s45, v16
    v_add_f32 v23, v23, v108
    v_mfma_f32_16x16x32_bf16 v[36:39], a[188:191], a[24:27], v[36:39]
    ds_read_b128 a[180:183], v9 offset:40960
    v_exp_f32 v111, v111
    v_add_f32 v23, v23, v109
    v_mfma_f32_16x16x32_bf16 v[44:47], a[188:191], a[28:31], v[44:47]
    s_waitcnt lgkmcnt(4)
    ds_read_b128 v[28:31], v26 offset:8192
    v_cvt_pk_bf16_f32 v198, v108, v109
    v_fma_f32 v112, v112, s36, -v18
    v_fma_f32 v113, v113, s36, -v18
    v_mfma_f32_16x16x32_bf16 v[48:51], a[160:163], a[16:19], v[48:51]
    ds_read_b128 a[184:187], v8 offset:43008
    v_exp_f32 v112, v112
    v_add_f32 v23, v23, v110
    v_mfma_f32_16x16x32_bf16 v[56:59], a[160:163], a[20:23], v[56:59]
    s_waitcnt vmcnt(4)
    buffer_load_dwordx4 v1, s[16:19], s34 offen offset:1024 nt lds
    v_mfma_f32_16x16x32_bf16 v[48:51], a[164:167], a[24:27], v[48:51]
    ds_read_b128 a[188:191], v9 offset:43008
    v_exp_f32 v113, v113
    v_add_f32 v23, v23, v111
    v_mfma_f32_16x16x32_bf16 v[56:59], a[164:167], a[28:31], v[56:59]
    s_waitcnt lgkmcnt(5)
    v_cvt_pk_bf16_f32 v199, v110, v111
    v_fma_f32 v114, v114, s36, -v18
    v_fma_f32 v115, v115, s36, -v18
    v_mfma_f32_16x16x32_bf16 v[52:55], a[168:171], a[16:19], v[52:55]
    ds_read_b128 a[160:163], v8 offset:45056
    v_exp_f32 v114, v114
    v_add_f32 v22, v22, v112
    v_mfma_f32_16x16x32_bf16 v[60:63], a[168:171], a[20:23], v[60:63]
    v_exp_f32 v115, v115
    v_add_f32 v22, v22, v113
    v_cvt_pk_bf16_f32 v200, v112, v113
    v_mfma_f32_16x16x32_bf16 v[52:55], a[172:175], a[24:27], v[52:55]
    ds_read_b128 a[164:167], v9 offset:45056
    v_fma_f32 v116, v116, s36, -v18
    v_fma_f32 v117, v117, s36, -v18
    v_mfma_f32_16x16x32_bf16 v[60:63], a[172:175], a[28:31], v[60:63]
    s_waitcnt lgkmcnt(5)
    v_exp_f32 v116, v116
    v_add_f32 v22, v22, v114
    v_exp_f32 v117, v117
    v_mfma_f32_16x16x32_bf16 v[64:67], a[176:179], a[16:19], v[64:67]
    ds_read_b128 a[168:171], v8 offset:47104
    v_add_f32 v22, v22, v115
    v_cvt_pk_bf16_f32 v201, v114, v115
    v_mfma_f32_16x16x32_bf16 v[72:75], a[176:179], a[20:23], v[72:75]
    s_waitcnt lgkmcnt(5)
    v_max3_f32 v26, v28, v29, v30
    v_max_f32 v26, v26, v31
    v_fma_f32 v118, v118, s36, -v18
    v_fma_f32 v119, v119, s36, -v18
    v_mfma_f32_16x16x32_bf16 v[64:67], a[180:183], a[24:27], v[64:67]
    s_add_u32 s34, s34, 6144
    ds_read_b128 a[172:175], v9 offset:47104
    v_exp_f32 v118, v118
    v_mfma_f32_16x16x32_bf16 v[72:75], a[180:183], a[28:31], v[72:75]
    s_waitcnt lgkmcnt(4)
    v_cndmask_b32 v27, v21, v20, s[24:25]
    v_fma_f32 v27, v26, s36, -v27
    v_cmp_lt_f32 vcc, 0x41200000, v27
    s_cbranch_vccnz L_rare_x1
L_rare_x1_back:
    v_mfma_f32_16x16x32_bf16 v[68:71], a[184:187], a[16:19], v[68:71]
    s_waitcnt vmcnt(3)
    ds_read_b128 a[176:179], v10 offset:32768
    buffer_load_dwordx4 v0, s[16:19], s34 offen offset:2048 nt lds
    v_mfma_f32_16x16x32_bf16 v[76:79], a[184:187], a[20:23], v[76:79]
    v_fma_f32 v240, v240, s36, -v20
    v_fma_f32 v241, v241, s36, -v20
    v_add_f32 v22, v22, v116
    v_mfma_f32_16x16x32_bf16 v[68:71], a[188:191], a[24:27], v[68:71]
    ds_read_b128 a[180:183], v11 offset:32768
    v_exp_f32 v119, v119
    v_add_f32 v22, v22, v117
    v_mfma_f32_16x16x32_bf16 v[76:79], a[188:191], a[28:31], v[76:79]
    s_waitcnt lgkmcnt(4)
    v_exp_f32 v240, v240
    v_cvt_pk_bf16_f32 v202, v116, v117
    v_fma_f32 v120, v120, s36, -v19
    v_mfma_f32_16x16x32_bf16 v[80:83], a[160:163], a[16:19], v[80:83]
    ds_read_b128 a[184:187], v10 offset:34816
    v_exp_f32 v241, v241
    v_fma_f32 v121, v121, s36, -v19
    v_mfma_f32_16x16x32_bf16 v[88:91], a[160:163], a[20:23], v[88:91]
    v_fma_f32 v242, v242, s36, -v20
    v_exp_f32 v120, v120
    v_mfma_f32_16x16x32_bf16 v[80:83], a[164:167], a[24:27], v[80:83]
    ds_read_b128 a[188:191], v11 offset:34816
    v_fma_f32 v243, v243, s36, -v20
    v_add_f32 v22, v22, v118
    v_mfma_f32_16x16x32_bf16 v[88:91], a[164:167], a[28:31], v[88:91]
    s_waitcnt lgkmcnt(4)
    v_exp_f32 v242, v242
    v_exp_f32 v121, v121
    v_mfma_f32_16x16x32_bf16 v[84:87], a[168:171], a[16:19], v[84:87]
    s_waitcnt vmcnt(15)
    s_barrier
    ds_read_b128 a[160:163], v8 offset:49152
    v_mfma_f32_16x16x32_bf16 v[92:95], a[168:171], a[20:23], v[92:95]
    v_add_f32 v24, v24, v240
    v_add_f32 v22, v22, v119
    v_cvt_pk_bf16_f32 v203, v118, v119
    v_fma_f32 v122, v122, s36, -v19
    v_mfma_f32_16x16x32_bf16 v[84:87], a[172:175], a[24:27], v[84:87]
    s_waitcnt vmcnt(3)
    ds_read_b128 a[164:167], v9 offset:49152
    v_exp_f32 v243, v243
    v_fma_f32 v123, v123, s36, -v19
    v_mfma_f32_16x16x32_bf16 v[92:95], a[172:175], a[28:31], v[92:95]
    s_waitcnt lgkmcnt(4)
    buffer_load_dwordx4 v1, s[16:19], s34 offen offset:3072 nt lds
    v_mfma_f32_16x16x32_bf16 v[224:227], a[176:179], a[80:83], v[224:227]
    ds_read_b128 a[168:171], v8 offset:51200
    v_add_f32 v24, v24, v241
    v_exp_f32 v122, v122
    v_mfma_f32_16x16x32_bf16 v[232:235], a[176:179], a[84:87], v[232:235]
    v_cvt_pk_bf16_f32 v240, v240, v241
    v_fma_f32 v244, v244, s36, -v20
    v_add_f32 v23, v23, v120
    v_mfma_f32_16x16x32_bf16 v[224:227], a[180:183], a[88:91], v[224:227]
    ds_read_b128 a[172:175], v9 offset:51200
    v_exp_f32 v123, v123
    v_add_f32 v23, v23, v121
    v_mfma_f32_16x16x32_bf16 v[232:235], a[180:183], a[92:95], v[232:235]
    s_waitcnt lgkmcnt(4)
    v_fma_f32 v245, v245, s36, -v20
    v_exp_f32 v244, v244
    v_cvt_pk_bf16_f32 v204, v120, v121
    v_mfma_f32_16x16x32_bf16 v[228:231], a[184:187], a[80:83], v[228:231]
    ds_read_b128 a[176:179], v8 offset:53248
    v_fma_f32 v124, v124, s36, -v19
    v_fma_f32 v125, v125, s36, -v19
    v_mfma_f32_16x16x32_bf16 v[236:239], a[184:187], a[84:87], v[236:239]
    v_add_f32 v24, v24, v242
    v_exp_f32 v245, v245
    v_exp_f32 v124, v124
    v_mfma_f32_16x16x32_bf16 v[228:231], a[188:191], a[88:91], v[228:231]
    ds_read_b128 a[180:183], v9 offset:53248
    v_add_f32 v23, v23, v122
    v_mfma_f32_16x16x32_bf16 v[236:239], a[188:191], a[92:95], v[236:239]
    s_waitcnt lgkmcnt(4)
    v_add_f32 v24, v24, v243
    v_cvt_pk_bf16_f32 v241, v242, v243
    v_exp_f32 v125, v125
    v_mfma_f32_16x16x32_bf16 v[32:35], a[160:163], a[32:35], v[32:35]
    s_add_u32 m0, s29, 114688
    ds_read_b128 a[184:187], v8 offset:55296
    v_fma_f32 v246, v246, s36, -v20
    v_add_f32 v23, v23, v123
    v_cvt_pk_bf16_f32 v205, v122, v123
    v_mfma_f32_16x16x32_bf16 v[40:43], a[160:163], a[36:39], v[40:43]
    s_add_u32 s34, s26, 196992
    v_fma_f32 v247, v247, s36, -v20
    s_nop 0
A_stub5:
    s_cbranch_execz A_stub9
    v_fma_f32 v126, v126, s36, -v19
    v_fma_f32 v127, v127, s36, -v19
    v_mfma_f32_16x16x32_bf16 v[32:35], a[164:167], a[40:43], v[32:35]
    s_waitcnt vmcnt(4)
    ds_read_b128 a[188:191], v9 offset:55296
    v_exp_f32 v246, v246
    v_exp_f32 v126, v126
    v_mfma_f32_16x16x32_bf16 v[40:43], a[164:167], a[44:47], v[40:43]
    s_waitcnt lgkmcnt(4)
    buffer_load_dwordx4 v0, s[16:19], s34 offen offset:0 nt lds
    v_mfma_f32_16x16x32_bf16 v[36:39], a[168:171], a[32:35], v[36:39]
    ds_read_b128 a[160:163], v8 offset:57344
    v_add_f32 v24, v24, v244
    v_add_f32 v23, v23, v124
    v_mfma_f32_16x16x32_bf16 v[44:47], a[168:171], a[36:39], v[44:47]
    v_exp_f32 v247, v247
    v_exp_f32 v127, v127
    v_add_f32 v23, v23, v125
    v_mfma_f32_16x16x32_bf16 v[36:39], a[172:175], a[40:43], v[36:39]
    ds_read_b128 a[164:167], v9 offset:57344
    v_cvt_pk_bf16_f32 v206, v124, v125
    v_fma_f32 v128, v128, s36, -v18
    v_mfma_f32_16x16x32_bf16 v[44:47], a[172:175], a[44:47], v[44:47]
    s_waitcnt lgkmcnt(4)
    v_add_f32 v24, v24, v245
    v_cvt_pk_bf16_f32 v242, v244, v245
    v_fma_f32 v129, v129, s36, -v18
    v_mfma_f32_16x16x32_bf16 v[48:51], a[176:179], a[32:35], v[48:51]
    ds_read_b128 a[168:171], v8 offset:59392
    v_fma_f32 v248, v248, s36, -v21
    v_exp_f32 v128, v128
    v_mfma_f32_16x16x32_bf16 v[56:59], a[176:179], a[36:39], v[56:59]
    v_fma_f32 v249, v249, s36, -v21
    v_exp_f32 v248, v248
    v_add_f32 v23, v23, v126
    v_mfma_f32_16x16x32_bf16 v[48:51], a[180:183], a[40:43], v[48:51]
    ds_read_b128 a[172:175], v9 offset:59392
    v_exp_f32 v129, v129
    v_mfma_f32_16x16x32_bf16 v[56:59], a[180:183], a[44:47], v[56:59]
    s_waitcnt lgkmcnt(4)
    v_add_f32 v24, v24, v246
    v_add_f32 v23, v23, v127
    v_cvt_pk_bf16_f32 v207, v126, v127
    v_fma_f32 v130, v130, s36, -v18
    v_mfma_f32_16x16x32_bf16 v[52:55], a[184:187], a[32:35], v[52:55]
    ds_read_b128 a[176:179], v8 offset:61440
    v_exp_f32 v249, v249
    v_fma_f32 v131, v131, s36, -v18
    v_mfma_f32_16x16x32_bf16 v[60:63], a[184:187], a[36:39], v[60:63]
    v_add_f32 v24, v24, v247
    v_cvt_pk_bf16_f32 v243, v246, v247
    v_exp_f32 v130, v130
    v_mfma_f32_16x16x32_bf16 v[52:55], a[188:191], a[40:43], v[52:55]
    s_waitcnt vmcnt(4)
    ds_read_b128 a[180:183], v9 offset:61440
    buffer_load_dwordx4 v1, s[16:19], s34 offen offset:1024 nt lds
    v_mfma_f32_16x16x32_bf16 v[60:63], a[188:191], a[44:47], v[60:63]
    s_waitcnt lgkmcnt(4)
    v_fma_f32 v250, v250, s36, -v21
    v_fma_f32 v251, v251, s36, -v21
    v_add_f32 v22, v22, v128
    v_mfma_f32_16x16x32_bf16 v[64:67], a[160:163], a[32:35], v[64:67]
    ds_read_b128 a[184:187], v8 offset:63488
    v_xor_b32 v8, 0x10000, v8
    v_exp_f32 v131, v131
    v_mfma_f32_16x16x32_bf16 v[72:75], a[160:163], a[36:39], v[72:75]
    v_exp_f32 v250, v250
    v_add_f32 v22, v22, v129
    v_mfma_f32_16x16x32_bf16 v[64:67], a[164:167], a[40:43], v[64:67]
    ds_read_b128 a[188:191], v9 offset:63488
    v_xor_b32 v9, 0x10000, v9
    v_cvt_pk_bf16_f32 v208, v128, v129
    v_fma_f32 v132, v132, s36, -v18
    v_mfma_f32_16x16x32_bf16 v[72:75], a[164:167], a[44:47], v[72:75]
    s_waitcnt lgkmcnt(4)
    v_add_f32 v25, v25, v248
    v_fma_f32 v133, v133, s36, -v18
    v_exp_f32 v132, v132
    v_mfma_f32_16x16x32_bf16 v[68:71], a[168:171], a[32:35], v[68:71]
    ds_read_b128 a[160:163], v10 offset:49152
    v_exp_f32 v251, v251
    v_mfma_f32_16x16x32_bf16 v[76:79], a[168:171], a[36:39], v[76:79]
    v_add_f32 v25, v25, v249
    v_add_f32 v22, v22, v130
    v_exp_f32 v133, v133
    v_mfma_f32_16x16x32_bf16 v[68:71], a[172:175], a[40:43], v[68:71]
    ds_read_b128 a[164:167], v11 offset:49152
    v_cvt_pk_bf16_f32 v244, v248, v249
    v_add_f32 v22, v22, v131
    v_mfma_f32_16x16x32_bf16 v[76:79], a[172:175], a[44:47], v[76:79]
    s_waitcnt lgkmcnt(4)
    v_fma_f32 v252, v252, s36, -v21
    v_fma_f32 v253, v253, s36, -v21
    v_cvt_pk_bf16_f32 v209, v130, v131
    v_fma_f32 v134, v134, s36, -v18
    v_mfma_f32_16x16x32_bf16 v[80:83], a[176:179], a[32:35], v[80:83]
    s_add_u32 s34, s34, 6144
    ds_read_b128 a[168:171], v10 offset:51200
    v_xor_b32 v10, 0x10000, v10
    v_fma_f32 v135, v135, s36, -v18
    v_mfma_f32_16x16x32_bf16 v[88:91], a[176:179], a[36:39], v[88:91]
    s_waitcnt vmcnt(3)
    buffer_load_dwordx4 v0, s[16:19], s34 offen offset:2048 nt lds
    v_exp_f32 v134, v134
    v_mfma_f32_16x16x32_bf16 v[80:83], a[180:183], a[40:43], v[80:83]
    ds_read_b128 a[172:175], v11 offset:51200
    v_xor_b32 v11, 0x10000, v11
    v_add_f32 v22, v22, v132
    v_mfma_f32_16x16x32_bf16 v[88:91], a[180:183], a[44:47], v[88:91]
    s_waitcnt lgkmcnt(4)
    v_exp_f32 v252, v252
    v_exp_f32 v135, v135
    v_mfma_f32_16x16x32_bf16 v[84:87], a[184:187], a[32:35], v[84:87]
    s_waitcnt vmcnt(15)
    s_barrier
    ds_read_b128 a[176:179], v8 offset:0
    v_mfma_f32_16x16x32_bf16 v[92:95], a[184:187], a[36:39], v[92:95]
    v_add_f32 v25, v25, v250
    v_add_f32 v22, v22, v133
    v_cvt_pk_bf16_f32 v210, v132, v133
    v_mfma_f32_16x16x32_bf16 v[84:87], a[188:191], a[40:43], v[84:87]
    ds_read_b128 a[180:183], v9 offset:0
    v_exp_f32 v253, v253
    v_fma_f32 v136, v136, s36, -v19
    v_mfma_f32_16x16x32_bf16 v[92:95], a[188:191], a[44:47], v[92:95]
    s_waitcnt lgkmcnt(4)
    v_add_f32 v25, v25, v251
    v_cvt_pk_bf16_f32 v245, v250, v251
    v_fma_f32 v137, v137, s36, -v19
    v_mfma_f32_16x16x32_bf16 v[224:227], a[160:163], a[96:99], v[224:227]
    ds_read_b128 a[184:187], v8 offset:2048
    v_exp_f32 v136, v136
    v_add_f32 v22, v22, v134
    v_mfma_f32_16x16x32_bf16 v[232:235], a[160:163], a[100:103], v[232:235]
    v_fma_f32 v254, v254, s36, -v21
    v_fma_f32 v255, v255, s36, -v21
    v_exp_f32 v137, v137
    v_mfma_f32_16x16x32_bf16 v[224:227], a[164:167], a[104:107], v[224:227]
    ds_read_b128 a[188:191], v9 offset:2048
    v_exp_f32 v254, v254
    v_mfma_f32_16x16x32_bf16 v[232:235], a[164:167], a[108:111], v[232:235]
    s_waitcnt lgkmcnt(4)
    v_add_f32 v25, v25, v252
    v_add_f32 v22, v22, v135
    v_cvt_pk_bf16_f32 v211, v134, v135
    v_fma_f32 v138, v138, s36, -v19
    v_mfma_f32_16x16x32_bf16 v[228:231], a[168:171], a[96:99], v[228:231]
    s_waitcnt vmcnt(3)
    ds_read_b128 a[160:163], v8 offset:4096
    buffer_load_dwordx4 v1, s[16:19], s34 offen offset:3072 nt lds
    v_mfma_f32_16x16x32_bf16 v[236:239], a[168:171], a[100:103], v[236:239]
    v_exp_f32 v255, v255
    v_fma_f32 v139, v139, s36, -v19
    v_mfma_f32_16x16x32_bf16 v[228:231], a[172:175], a[104:107], v[228:231]
    ds_read_b128 a[164:167], v9 offset:4096
    v_add_f32 v25, v25, v253
    v_exp_f32 v138, v138
    v_mfma_f32_16x16x32_bf16 v[236:239], a[172:175], a[108:111], v[236:239]
    s_waitcnt lgkmcnt(4)
    v_cvt_pk_bf16_f32 v246, v252, v253
    v_add_f32 v25, v25, v254
    v_add_f32 v23, v23, v136
    v_mfma_f32_16x16x32_bf16 v[32:35], a[176:179], a[48:51], v[32:35]
    ds_read_b128 a[168:171], v8 offset:6144
    v_add_f32 v25, v25, v255
    v_exp_f32 v139, v139
    v_mfma_f32_16x16x32_bf16 v[40:43], a[176:179], a[52:55], v[40:43]
    v_cvt_pk_bf16_f32 v247, v254, v255
    v_add_u32 v28, s45, v16
    v_add_f32 v23, v23, v137
    v_cvt_pk_bf16_f32 v212, v136, v137
    v_mfma_f32_16x16x32_bf16 v[32:35], a[180:183], a[56:59], v[32:35]
    ds_read_b128 a[172:175], v9 offset:6144
    v_fma_f32 v140, v140, s36, -v19
    v_fma_f32 v141, v141, s36, -v19
    v_mfma_f32_16x16x32_bf16 v[40:43], a[180:183], a[60:63], v[40:43]
    s_waitcnt lgkmcnt(4)
    ds_write_b128 v28, v[240:243] offset:8192
    v_mfma_f32_16x16x32_bf16 v[36:39], a[184:187], a[48:51], v[36:39]
    ds_read_b128 a[176:179], v8 offset:8192
    v_exp_f32 v140, v140
    v_add_f32 v23, v23, v138
    v_mfma_f32_16x16x32_bf16 v[44:47], a[184:187], a[52:55], v[44:47]
    s_add_u32 m0, s29, 131072
    v_exp_f32 v141, v141
    v_add_f32 v23, v23, v139
    v_cvt_pk_bf16_f32 v213, v138, v139
    v_mfma_f32_16x16x32_bf16 v[36:39], a[188:191], a[56:59], v[36:39]
    s_add_u32 s34, s33, 0
    ds_read_b128 a[180:183], v9 offset:8192
    ds_write_b128 v28, v[244:247] offset:9216
    v_mfma_f32_16x16x32_bf16 v[44:47], a[188:191], a[60:63], v[44:47]
    s_waitcnt lgkmcnt(6)
    v_accvgpr_read_b32 v0, a226
    v_accvgpr_read_b32 v1, a227
    v_fma_f32 v142, v142, s36, -v19
    v_mfma_f32_16x16x32_bf16 v[48:51], a[160:163], a[48:51], v[48:51]
    s_waitcnt vmcnt(4)
    ds_read_b128 a[184:187], v8 offset:10240
    buffer_load_dwordx4 v0, s[20:23], s34 offen offset:0 nt lds
    v_mfma_f32_16x16x32_bf16 v[56:59], a[160:163], a[52:55], v[56:59]
    v_fma_f32 v143, v143, s36, -v19
    v_exp_f32 v142, v142
    v_add_f32 v23, v23, v140
    v_mfma_f32_16x16x32_bf16 v[48:51], a[164:167], a[56:59], v[48:51]
    ds_read_b128 a[188:191], v9 offset:10240
    v_exp_f32 v143, v143
    v_add_f32 v23, v23, v141
    v_mfma_f32_16x16x32_bf16 v[56:59], a[164:167], a[60:63], v[56:59]
    s_waitcnt lgkmcnt(6)
    v_cvt_pk_bf16_f32 v214, v140, v141
    v_fma_f32 v144, v144, s36, -v18
    v_fma_f32 v145, v145, s36, -v18
    v_mfma_f32_16x16x32_bf16 v[52:55], a[168:171], a[48:51], v[52:55]
    ds_read_b128 a[160:163], v8 offset:12288
    v_exp_f32 v144, v144
    v_add_f32 v23, v23, v142
    v_mfma_f32_16x16x32_bf16 v[60:63], a[168:171], a[52:55], v[60:63]
    v_exp_f32 v145, v145
    v_add_f32 v23, v23, v143
    v_mfma_f32_16x16x32_bf16 v[52:55], a[172:175], a[56:59], v[52:55]
    ds_read_b128 a[164:167], v9 offset:12288
    v_cvt_pk_bf16_f32 v215, v142, v143
    v_fma_f32 v146, v146, s36, -v18
    v_fma_f32 v147, v147, s36, -v18
    v_mfma_f32_16x16x32_bf16 v[60:63], a[172:175], a[60:63], v[60:63]
    s_waitcnt lgkmcnt(5)
    v_exp_f32 v146, v146
    v_add_f32 v22, v22, v144
    v_mfma_f32_16x16x32_bf16 v[64:67], a[176:179], a[48:51], v[64:67]
    ds_read_b128 a[168:171], v8 offset:14336
    v_exp_f32 v147, v147
    v_add_f32 v22, v22, v145
    v_mfma_f32_16x16x32_bf16 v[72:75], a[176:179], a[52:55], v[72:75]
    v_cvt_pk_bf16_f32 v216, v144, v145
    v_fma_f32 v148, v148, s36, -v18
    v_fma_f32 v149, v149, s36, -v18
    v_mfma_f32_16x16x32_bf16 v[64:67], a[180:183], a[56:59], v[64:67]
    s_waitcnt vmcnt(4)
    ds_read_b128 a[172:175], v9 offset:14336
    v_exp_f32 v148, v148
    v_add_f32 v22, v22, v146
    v_mfma_f32_16x16x32_bf16 v[72:75], a[180:183], a[60:63], v[72:75]
    s_waitcnt lgkmcnt(4)
    buffer_load_dwordx4 v1, s[20:23], s34 offen offset:1024 nt lds
    v_exp_f32 v149, v149
    v_mfma_f32_16x16x32_bf16 v[68:71], a[184:187], a[48:51], v[68:71]
    ds_read_b128 a[176:179], v10 offset:0
    v_add_f32 v22, v22, v147
    v_cvt_pk_bf16_f32 v217, v146, v147
    v_mfma_f32_16x16x32_bf16 v[76:79], a[184:187], a[52:55], v[76:79]
    v_fma_f32 v150, v150, s36, -v18
    v_fma_f32 v151, v151, s36, -v18
    v_exp_f32 v150, v150
    v_mfma_f32_16x16x32_bf16 v[68:71], a[188:191], a[56:59], v[68:71]
    ds_read_b128 a[180:183], v11 offset:0
    v_add_f32 v22, v22, v148
    v_exp_f32 v151, v151
    v_mfma_f32_16x16x32_bf16 v[76:79], a[188:191], a[60:63], v[76:79]
    s_waitcnt lgkmcnt(4)
    v_add_f32 v22, v22, v149
    v_cvt_pk_bf16_f32 v218, v148, v149
    v_fma_f32 v152, v152, s36, -v19
    v_mfma_f32_16x16x32_bf16 v[80:83], a[160:163], a[48:51], v[80:83]
    ds_read_b128 a[184:187], v10 offset:2048
    v_fma_f32 v153, v153, s36, -v19
    v_exp_f32 v152, v152
    v_mfma_f32_16x16x32_bf16 v[88:91], a[160:163], a[52:55], v[88:91]
    v_add_f32 v22, v22, v150
    v_exp_f32 v153, v153
    v_mfma_f32_16x16x32_bf16 v[80:83], a[164:167], a[56:59], v[80:83]
    ds_read_b128 a[188:191], v11 offset:2048
    v_add_f32 v22, v22, v151
    v_cvt_pk_bf16_f32 v219, v150, v151
    v_fma_f32 v154, v154, s36, -v19
    v_mfma_f32_16x16x32_bf16 v[88:91], a[164:167], a[60:63], v[88:91]
    s_waitcnt lgkmcnt(4)
    v_fma_f32 v155, v155, s36, -v19
    v_exp_f32 v154, v154
    v_mfma_f32_16x16x32_bf16 v[84:87], a[168:171], a[48:51], v[84:87]
    s_waitcnt vmcnt(14)
    s_barrier
    ds_read_b128 a[160:163], v8 offset:32768
    v_mfma_f32_16x16x32_bf16 v[92:95], a[168:171], a[52:55], v[92:95]
    s_add_u32 s34, s34, 2048
    v_add_f32 v23, v23, v152
    v_exp_f32 v155, v155
    v_add_f32 v23, v23, v153
    v_mfma_f32_16x16x32_bf16 v[84:87], a[172:175], a[56:59], v[84:87]
    s_waitcnt vmcnt(3)
    ds_read_b128 a[164:167], v9 offset:32768
    buffer_load_dwordx4 v0, s[20:23], s34 offen offset:2048 nt lds
    v_mfma_f32_16x16x32_bf16 v[92:95], a[172:175], a[60:63], v[92:95]
    s_waitcnt lgkmcnt(4)
    v_cvt_pk_bf16_f32 v220, v152, v153
    v_fma_f32 v156, v156, s36, -v19
    v_fma_f32 v157, v157, s36, -v19
    v_mfma_f32_16x16x32_bf16 v[224:227], a[176:179], a[112:115], v[224:227]
    ds_read_b128 a[168:171], v8 offset:34816
    v_exp_f32 v156, v156
    v_add_f32 v23, v23, v154
    v_mfma_f32_16x16x32_bf16 v[232:235], a[176:179], a[116:119], v[232:235]
    v_exp_f32 v157, v157
    v_add_f32 v23, v23, v155
    v_cvt_pk_bf16_f32 v221, v154, v155
    v_mfma_f32_16x16x32_bf16 v[224:227], a[180:183], a[120:123], v[224:227]
    ds_read_b128 a[172:175], v9 offset:34816
    v_fma_f32 v158, v158, s36, -v19
    v_fma_f32 v159, v159, s36, -v19
    v_mfma_f32_16x16x32_bf16 v[232:235], a[180:183], a[124:127], v[232:235]
    s_waitcnt lgkmcnt(4)
    v_exp_f32 v158, v158
    v_add_f32 v23, v23, v156
    v_mfma_f32_16x16x32_bf16 v[228:231], a[184:187], a[112:115], v[228:231]
    ds_read_b128 a[176:179], v8 offset:36864
    v_exp_f32 v159, v159
    v_add_f32 v23, v23, v157
    v_mfma_f32_16x16x32_bf16 v[236:239], a[184:187], a[116:119], v[236:239]
    v_cvt_pk_bf16_f32 v222, v156, v157
    v_add_f32 v23, v23, v158
    v_add_f32 v23, v23, v159
    v_cvt_pk_bf16_f32 v223, v158, v159
    v_mfma_f32_16x16x32_bf16 v[228:231], a[188:191], a[120:123], v[228:231]
    ds_read_b128 a[180:183], v9 offset:36864
    v_mfma_f32_16x16x32_bf16 v[236:239], a[188:191], a[124:127], v[236:239]
    s_waitcnt lgkmcnt(4)
    v_mfma_f32_16x16x32_bf16 v[96:99], a[160:163], a[0:3], 0
    ds_read_b128 a[184:187], v8 offset:38912
    v_max3_f32 v26, v32, v33, v34
    v_max3_f32 v27, v40, v41, v42
    v_max3_f32 v26, v26, v35, v36
    v_mfma_f32_16x16x32_bf16 v[104:107], a[160:163], a[4:7], 0
    s_waitcnt vmcnt(3)
    buffer_load_dwordx4 v1, s[20:23], s34 offen offset:3072 nt lds
    v_max3_f32 v27, v27, v43, v44
    v_mfma_f32_16x16x32_bf16 v[96:99], a[164:167], a[8:11], v[96:99]
    ds_read_b128 a[188:191], v9 offset:38912
    v_max3_f32 v26, v26, v37, v38
    v_max3_f32 v27, v27, v45, v46
    v_mfma_f32_16x16x32_bf16 v[104:107], a[164:167], a[12:15], v[104:107]
    s_waitcnt lgkmcnt(4)
    v_max3_f32 v26, v26, v39, v48
    v_max3_f32 v27, v27, v47, v56
    v_max3_f32 v26, v26, v49, v50
    v_max3_f32 v27, v27, v57, v58
    v_mfma_f32_16x16x32_bf16 v[100:103], a[168:171], a[0:3], 0
    ds_read_b128 a[160:163], v8 offset:40960
    v_max3_f32 v26, v26, v51, v52
    v_max3_f32 v27, v27, v59, v60
    v_max3_f32 v26, v26, v53, v54
    v_mfma_f32_16x16x32_bf16 v[108:111], a[168:171], a[4:7], 0
    v_max3_f32 v27, v27, v61, v62
    v_max3_f32 v26, v26, v55, v64
    v_max3_f32 v27, v27, v63, v72
    v_mfma_f32_16x16x32_bf16 v[100:103], a[172:175], a[8:11], v[100:103]
    ds_read_b128 a[164:167], v9 offset:40960
    v_max3_f32 v28, v224, v225, v226
    v_max3_f32 v26, v26, v65, v66
    v_max3_f32 v27, v27, v73, v74
    v_mfma_f32_16x16x32_bf16 v[108:111], a[172:175], a[12:15], v[108:111]
    s_waitcnt lgkmcnt(4)
    v_max3_f32 v29, v232, v233, v234
    v_max3_f32 v28, v28, v227, v228
    v_max3_f32 v26, v26, v67, v68
    v_mfma_f32_16x16x32_bf16 v[112:115], a[176:179], a[0:3], 0
    ds_read_b128 a[168:171], v8 offset:43008
    v_max3_f32 v27, v27, v75, v76
    v_max3_f32 v26, v26, v69, v70
    v_max3_f32 v27, v27, v77, v78
    v_mfma_f32_16x16x32_bf16 v[120:123], a[176:179], a[4:7], 0
    v_max3_f32 v29, v29, v235, v236
    v_max3_f32 v28, v28, v229, v230
    v_max3_f32 v26, v26, v71, v80
    v_max3_f32 v27, v27, v79, v88
    v_mfma_f32_16x16x32_bf16 v[112:115], a[180:183], a[8:11], v[112:115]
    s_add_u32 m0, s29, 147456
    ds_read_b128 a[172:175], v9 offset:43008
    v_max3_f32 v29, v29, v237, v238
    v_max3_f32 v26, v26, v81, v82
    v_mfma_f32_16x16x32_bf16 v[120:123], a[180:183], a[12:15], v[120:123]
    s_waitcnt lgkmcnt(4)
    v_max_f32 v28, v28, v231
    v_max_f32 v29, v29, v239
    v_max3_f32 v27, v27, v89, v90
    v_max3_f32 v26, v26, v83, v84
    v_mfma_f32_16x16x32_bf16 v[116:119], a[184:187], a[0:3], 0
    s_add_u32 s34, s33, 16384
    ds_read_b128 a[176:179], v8 offset:45056
    v_max3_f32 v27, v27, v91, v92
    v_max3_f32 v26, v26, v85, v86
    v_mfma_f32_16x16x32_bf16 v[124:127], a[184:187], a[4:7], 0
    s_waitcnt vmcnt(4)
    buffer_load_dwordx4 v0, s[20:23], s34 offen offset:0 nt lds
    v_max3_f32 v27, v27, v93, v94
    v_mfma_f32_16x16x32_bf16 v[116:119], a[188:191], a[8:11], v[116:119]
    ds_read_b128 a[180:183], v9 offset:45056
    v_permlane32_swap_b32 v28, v29
    v_max_f32 v28, v28, v29
    v_max_f32 v26, v26, v87
    v_mfma_f32_16x16x32_bf16 v[124:127], a[188:191], a[12:15], v[124:127]
    s_waitcnt lgkmcnt(4)
    v_mov_b32 v29, v28
    v_max_f32 v27, v27, v95
    s_nop 1
    v_permlane32_swap_b32 v26, v27
    v_max_f32 v26, v26, v27
    v_mfma_f32_16x16x32_bf16 v[128:131], a[160:163], a[0:3], 0
    ds_read_b128 a[184:187], v8 offset:47104
    v_permlane16_swap_b32 v28, v29
    v_max_f32 v28, v28, v29
    v_mfma_f32_16x16x32_bf16 v[136:139], a[160:163], a[4:7], 0
    v_add_u32 v30, s46, v16
    v_mov_b32 v27, v26
    s_nop 1
    v_permlane16_swap_b32 v26, v27
    v_max_f32 v26, v26, v27
    v_mfma_f32_16x16x32_bf16 v[128:131], a[164:167], a[8:11], v[128:131]
    ds_read_b128 a[188:191], v9 offset:47104
    v_cndmask_b32 v27, v19, v18, s[24:25]
    v_fma_f32 v27, v26, s36, -v27
    v_cmp_lt_f32 vcc, 0x41200000, v27
    s_cbranch_vccnz L_rare_o2
L_rare_o2_back:
    v_mfma_f32_16x16x32_bf16 v[136:139], a[164:167], a[12:15], v[136:139]
    s_waitcnt lgkmcnt(4)
    ds_write_b32 v30, v28 offset:16384
    v_mfma_f32_16x16x32_bf16 v[132:135], a[168:171], a[0:3], 0
    ds_read_b128 a[160:163], v10 offset:32768
    ds_write_b32 v30, v28 offset:18432
    v_fma_f32 v32, v32, s36, -v18
    v_mfma_f32_16x16x32_bf16 v[140:143], a[168:171], a[4:7], 0
    ds_write_b32 v30, v28 offset:20480
    v_fma_f32 v33, v33, s36, -v18
    v_mfma_f32_16x16x32_bf16 v[132:135], a[172:175], a[8:11], v[132:135]
    ds_read_b128 a[164:167], v11 offset:32768
    v_exp_f32 v32, v32
    v_mfma_f32_16x16x32_bf16 v[140:143], a[172:175], a[12:15], v[140:143]
    s_waitcnt lgkmcnt(7)
    ds_write_b32 v30, v28 offset:22528
    v_exp_f32 v33, v33
    v_fma_f32 v34, v34, s36, -v18
    v_mfma_f32_16x16x32_bf16 v[144:147], a[176:179], a[0:3], 0
    s_waitcnt vmcnt(4)
    ds_read_b128 a[168:171], v10 offset:34816
    buffer_load_dwordx4 v1, s[20:23], s34 offen offset:1024 nt lds
    v_mfma_f32_16x16x32_bf16 v[152:155], a[176:179], a[4:7], 0
    v_fma_f32 v35, v35, s36, -v18
    v_exp_f32 v34, v34
    v_mfma_f32_16x16x32_bf16 v[144:147], a[180:183], a[8:11], v[144:147]
    ds_read_b128 a[172:175], v11 offset:34816
    v_add_f32 v22, v22, v32
    v_exp_f32 v35, v35
    v_mfma_f32_16x16x32_bf16 v[152:155], a[180:183], a[12:15], v[152:155]
    s_waitcnt lgkmcnt(8)
    v_add_f32 v22, v22, v33
    v_cvt_pk_bf16_f32 v32, v32, v33
    v_fma_f32 v36, v36, s36, -v18
    v_fma_f32 v37, v37, s36, -v18
    v_mfma_f32_16x16x32_bf16 v[148:151], a[184:187], a[0:3], 0
    s_waitcnt vmcnt(14) lgkmcnt(2)
    s_barrier
    ds_read_b128 a[176:179], v8 offset:49152
    v_mfma_f32_16x16x32_bf16 v[156:159], a[184:187], a[4:7], 0
    v_exp_f32 v36, v36
    v_add_f32 v22, v22, v34
    v_mfma_f32_16x16x32_bf16 v[148:151], a[188:191], a[8:11], v[148:151]
    ds_read_b128 a[180:183], v9 offset:49152
    v_exp_f32 v37, v37
    v_add_f32 v22, v22, v35
    v_mfma_f32_16x16x32_bf16 v[156:159], a[188:191], a[12:15], v[156:159]
    v_cvt_pk_bf16_f32 v33, v34, v35
    v_fma_f32 v38, v38, s36, -v18
    v_fma_f32 v39, v39, s36, -v18
    v_mfma_f32_16x16x32_bf16 v[240:243], a[160:163], a[64:67], 0
    ds_read_b128 a[184:187], v8 offset:51200
    v_exp_f32 v38, v38
    v_add_f32 v22, v22, v36
    v_mfma_f32_16x16x32_bf16 v[248:251], a[160:163], a[68:71], 0
    s_add_u32 s34, s34, 2048
    v_exp_f32 v39, v39
    v_add_f32 v22, v22, v37
    v_cvt_pk_bf16_f32 v34, v36, v37
    v_mfma_f32_16x16x32_bf16 v[240:243], a[164:167], a[72:75], v[240:243]
    s_waitcnt vmcnt(3)
    ds_read_b128 a[188:191], v9 offset:51200
    v_fma_f32 v40, v40, s36, -v19
    v_fma_f32 v41, v41, s36, -v19
    v_mfma_f32_16x16x32_bf16 v[248:251], a[164:167], a[76:79], v[248:251]
    s_waitcnt lgkmcnt(4)
    buffer_load_dwordx4 v0, s[20:23], s34 offen offset:2048 nt lds
    v_exp_f32 v40, v40
    v_mfma_f32_16x16x32_bf16 v[244:247], a[168:171], a[64:67], 0
    ds_read_b128 a[160:163], v8 offset:53248
    v_add_f32 v22, v22, v38
    v_exp_f32 v41, v41
    v_mfma_f32_16x16x32_bf16 v[252:255], a[168:171], a[68:71], 0
    v_add_f32 v22, v22, v39
    v_cvt_pk_bf16_f32 v35, v38, v39
    v_fma_f32 v42, v42, s36, -v19
    v_mfma_f32_16x16x32_bf16 v[244:247], a[172:175], a[72:75], v[244:247]
    ds_read_b128 a[164:167], v9 offset:53248
    v_fma_f32 v43, v43, s36, -v19
    v_exp_f32 v42, v42
    v_mfma_f32_16x16x32_bf16 v[252:255], a[172:175], a[76:79], v[252:255]
    s_waitcnt lgkmcnt(4)
    v_add_f32 v23, v23, v40
    v_exp_f32 v43, v43
    v_mfma_f32_16x16x32_bf16 v[96:99], a[176:179], a[16:19], v[96:99]
    ds_read_b128 a[168:171], v8 offset:55296
    v_add_f32 v23, v23, v41
    v_cvt_pk_bf16_f32 v36, v40, v41
    v_fma_f32 v44, v44, s36, -v19
    v_mfma_f32_16x16x32_bf16 v[104:107], a[176:179], a[20:23], v[104:107]
    v_fma_f32 v45, v45, s36, -v19
    v_exp_f32 v44, v44
    v_add_f32 v23, v23, v42
    v_mfma_f32_16x16x32_bf16 v[96:99], a[180:183], a[24:27], v[96:99]
    ds_read_b128 a[172:175], v9 offset:55296
    v_exp_f32 v45, v45
    v_mfma_f32_16x16x32_bf16 v[104:107], a[180:183], a[28:31], v[104:107]
    s_waitcnt lgkmcnt(4)
    v_add_f32 v23, v23, v43
    v_cvt_pk_bf16_f32 v37, v42, v43
    v_fma_f32 v46, v46, s36, -v19
    v_fma_f32 v47, v47, s36, -v19
    v_mfma_f32_16x16x32_bf16 v[100:103], a[184:187], a[16:19], v[100:103]
    ds_read_b128 a[176:179], v8 offset:57344
    v_exp_f32 v46, v46
    v_add_f32 v23, v23, v44
    v_mfma_f32_16x16x32_bf16 v[108:111], a[184:187], a[20:23], v[108:111]
    v_add_u32 v26, s45, v16
    v_exp_f32 v47, v47
    v_mfma_f32_16x16x32_bf16 v[100:103], a[188:191], a[24:27], v[100:103]
    s_waitcnt vmcnt(3)
    ds_read_b128 a[180:183], v9 offset:57344
    buffer_load_dwordx4 v1, s[20:23], s34 offen offset:3072 nt lds
    v_add_f32 v23, v23, v45
    v_mfma_f32_16x16x32_bf16 v[108:111], a[188:191], a[28:31], v[108:111]
    s_waitcnt lgkmcnt(4)
    ds_read_b128 v[28:31], v26 offset:16384
    v_cvt_pk_bf16_f32 v38, v44, v45
    v_fma_f32 v48, v48, s36, -v18
    v_mfma_f32_16x16x32_bf16 v[112:115], a[160:163], a[16:19], v[112:115]
    ds_read_b128 a[184:187], v8 offset:59392
    v_fma_f32 v49, v49, s36, -v18
    v_exp_f32 v48, v48
    v_mfma_f32_16x16x32_bf16 v[120:123], a[160:163], a[20:23], v[120:123]
    v_add_f32 v23, v23, v46
    v_exp_f32 v49, v49
    v_add_f32 v23, v23, v47
    v_mfma_f32_16x16x32_bf16 v[112:115], a[164:167], a[24:27], v[112:115]
    ds_read_b128 a[188:191], v9 offset:59392
    v_cvt_pk_bf16_f32 v39, v46, v47
    v_fma_f32 v50, v50, s36, -v18
    v_mfma_f32_16x16x32_bf16 v[120:123], a[164:167], a[28:31], v[120:123]
    s_waitcnt lgkmcnt(5)
    v_fma_f32 v51, v51, s36, -v18
    v_exp_f32 v50, v50
    v_add_f32 v22, v22, v48
    v_mfma_f32_16x16x32_bf16 v[116:119], a[168:171], a[16:19], v[116:119]
    ds_read_b128 a[160:163], v8 offset:61440
    v_exp_f32 v51, v51
    v_add_f32 v22, v22, v49
    v_mfma_f32_16x16x32_bf16 v[124:127], a[168:171], a[20:23], v[124:127]
    v_cvt_pk_bf16_f32 v40, v48, v49
    v_fma_f32 v52, v52, s36, -v18
    v_fma_f32 v53, v53, s36, -v18
    v_mfma_f32_16x16x32_bf16 v[116:119], a[172:175], a[24:27], v[116:119]
    ds_read_b128 a[164:167], v9 offset:61440
    v_exp_f32 v52, v52
    v_add_f32 v22, v22, v50
    v_mfma_f32_16x16x32_bf16 v[124:127], a[172:175], a[28:31], v[124:127]
    s_waitcnt lgkmcnt(5)
    v_exp_f32 v53, v53
    v_add_f32 v22, v22, v51
    v_cvt_pk_bf16_f32 v41, v50, v51
    v_mfma_f32_16x16x32_bf16 v[128:131], a[176:179], a[16:19], v[128:131]
    s_add_u32 m0, s29, 32768
    ds_read_b128 a[168:171], v8 offset:63488
    v_xor_b32 v8, 0x10000, v8
    v_fma_f32 v54, v54, s36, -v18
    v_mfma_f32_16x16x32_bf16 v[136:139], a[176:179], a[20:23], v[136:139]
    s_add_u32 s34, s33, 32768
    s_waitcnt lgkmcnt(5)
    v_max3_f32 v26, v28, v29, v30
    v_max_f32 v26, v26, v31
    v_fma_f32 v55, v55, s36, -v18
    v_mfma_f32_16x16x32_bf16 v[128:131], a[180:183], a[24:27], v[128:131]
    s_waitcnt vmcnt(4)
    ds_read_b128 a[172:175], v9 offset:63488
    buffer_load_dwordx4 v0, s[20:23], s34 offen offset:0 nt lds
    v_xor_b32 v9, 0x10000, v9
    v_mfma_f32_16x16x32_bf16 v[136:139], a[180:183], a[28:31], v[136:139]
    s_waitcnt lgkmcnt(4)
    v_exp_f32 v54, v54
    v_add_f32 v22, v22, v52
    v_exp_f32 v55, v55
    v_mfma_f32_16x16x32_bf16 v[132:135], a[184:187], a[16:19], v[132:135]
    ds_read_b128 a[176:179], v10 offset:49152
    v_cndmask_b32 v27, v21, v20, s[24:25]
    v_fma_f32 v27, v26, s36, -v27
    v_cmp_lt_f32 vcc, 0x41200000, v27
    s_cbranch_vccnz L_rare_x2
L_rare_x2_back:
    v_mfma_f32_16x16x32_bf16 v[140:143], a[184:187], a[20:23], v[140:143]
    v_add_f32 v22, v22, v53
    v_cvt_pk_bf16_f32 v42, v52, v53
    v_fma_f32 v56, v56, s36, -v19
    v_mfma_f32_16x16x32_bf16 v[132:135], a[188:191], a[24:27], v[132:135]
    ds_read_b128 a[180:183], v11 offset:49152
    v_fma_f32 v224, v224, s36, -v20
    v_fma_f32 v57, v57, s36, -v19
    v_mfma_f32_16x16x32_bf16 v[140:143], a[188:191], a[28:31], v[140:143]
    s_waitcnt lgkmcnt(4)
    v_fma_f32 v225, v225, s36, -v20
    v_exp_f32 v224, v224
    v_exp_f32 v56, v56
    v_mfma_f32_16x16x32_bf16 v[144:147], a[160:163], a[16:19], v[144:147]
    ds_read_b128 a[184:187], v10 offset:51200
    v_xor_b32 v10, 0x10000, v10
    v_add_f32 v22, v22, v54
    v_mfma_f32_16x16x32_bf16 v[152:155], a[160:163], a[20:23], v[152:155]
    v_exp_f32 v57, v57
    v_add_f32 v22, v22, v55
A_stub6:
    s_cbranch_execz A_stub10
    v_cvt_pk_bf16_f32 v43, v54, v55
    v_mfma_f32_16x16x32_bf16 v[144:147], a[164:167], a[24:27], v[144:147]
    ds_read_b128 a[188:191], v11 offset:51200
    v_xor_b32 v11, 0x10000, v11
    v_fma_f32 v58, v58, s36, -v19
    v_mfma_f32_16x16x32_bf16 v[152:155], a[164:167], a[28:31], v[152:155]
    s_waitcnt lgkmcnt(4)
    v_exp_f32 v225, v225
    v_fma_f32 v226, v226, s36, -v20
    v_fma_f32 v59, v59, s36, -v19
    v_mfma_f32_16x16x32_bf16 v[148:151], a[168:171], a[16:19], v[148:151]
    s_waitcnt vmcnt(13)
    s_barrier
    ds_read_b128 a[160:163], v8 offset:0
    v_mfma_f32_16x16x32_bf16 v[156:159], a[168:171], a[20:23], v[156:159]
    s_waitcnt vmcnt(4)
    buffer_load_dwordx4 v1, s[20:23], s34 offen offset:1024 nt lds
    v_exp_f32 v58, v58
    v_mfma_f32_16x16x32_bf16 v[148:151], a[172:175], a[24:27], v[148:151]
    ds_read_b128 a[164:167], v9 offset:0
    v_fma_f32 v227, v227, s36, -v20
    v_add_f32 v23, v23, v56
    v_mfma_f32_16x16x32_bf16 v[156:159], a[172:175], a[28:31], v[156:159]
    s_waitcnt lgkmcnt(4)
    v_exp_f32 v226, v226
    v_exp_f32 v59, v59
    v_mfma_f32_16x16x32_bf16 v[240:243], a[176:179], a[80:83], v[240:243]
    ds_read_b128 a[168:171], v8 offset:2048
    v_add_f32 v23, v23, v57
    v_cvt_pk_bf16_f32 v44, v56, v57
    v_mfma_f32_16x16x32_bf16 v[248:251], a[176:179], a[84:87], v[248:251]
    v_add_f32 v24, v24, v224
    v_exp_f32 v227, v227
    v_fma_f32 v60, v60, s36, -v19
    v_mfma_f32_16x16x32_bf16 v[240:243], a[180:183], a[88:91], v[240:243]
    ds_read_b128 a[172:175], v9 offset:2048
    v_fma_f32 v61, v61, s36, -v19
    v_exp_f32 v60, v60
    v_mfma_f32_16x16x32_bf16 v[248:251], a[180:183], a[92:95], v[248:251]
    s_waitcnt lgkmcnt(4)
    v_add_f32 v24, v24, v225
    v_cvt_pk_bf16_f32 v224, v224, v225
    v_add_f32 v23, v23, v58
    v_mfma_f32_16x16x32_bf16 v[244:247], a[184:187], a[80:83], v[244:247]
    ds_read_b128 a[176:179], v8 offset:4096
    v_fma_f32 v228, v228, s36, -v20
    v_exp_f32 v61, v61
    v_mfma_f32_16x16x32_bf16 v[252:255], a[184:187], a[84:87], v[252:255]
    v_fma_f32 v229, v229, s36, -v20
    v_add_f32 v23, v23, v59
    v_cvt_pk_bf16_f32 v45, v58, v59
    v_fma_f32 v62, v62, s36, -v19
    v_mfma_f32_16x16x32_bf16 v[244:247], a[188:191], a[88:91], v[244:247]
    s_add_u32 s34, s34, 2048
    ds_read_b128 a[180:183], v9 offset:4096
    v_exp_f32 v228, v228
    v_mfma_f32_16x16x32_bf16 v[252:255], a[188:191], a[92:95], v[252:255]
    s_waitcnt lgkmcnt(4)
    v_add_f32 v24, v24, v226
    v_fma_f32 v63, v63, s36, -v19
    v_exp_f32 v62, v62
    v_mfma_f32_16x16x32_bf16 v[96:99], a[160:163], a[32:35], v[96:99]
    s_waitcnt vmcnt(3)
    ds_read_b128 a[184:187], v8 offset:6144
    buffer_load_dwordx4 v0, s[20:23], s34 offen offset:2048 nt lds
    v_mfma_f32_16x16x32_bf16 v[104:107], a[160:163], a[36:39], v[104:107]
    v_exp_f32 v229, v229
    v_add_f32 v23, v23, v60
    v_mfma_f32_16x16x32_bf16 v[96:99], a[164:167], a[40:43], v[96:99]
    ds_read_b128 a[188:191], v9 offset:6144
    v_add_f32 v24, v24, v227
    v_exp_f32 v63, v63
    v_mfma_f32_16x16x32_bf16 v[104:107], a[164:167], a[44:47], v[104:107]
    s_waitcnt lgkmcnt(4)
    v_cvt_pk_bf16_f32 v225, v226, v227
    v_fma_f32 v230, v230, s36, -v20
    v_add_f32 v23, v23, v61
    v_cvt_pk_bf16_f32 v46, v60, v61
    v_mfma_f32_16x16x32_bf16 v[100:103], a[168:171], a[32:35], v[100:103]
    ds_read_b128 a[160:163], v8 offset:8192
    v_fma_f32 v231, v231, s36, -v20
    v_fma_f32 v64, v64, s36, -v18
    v_fma_f32 v65, v65, s36, -v18
    v_mfma_f32_16x16x32_bf16 v[108:111], a[168:171], a[36:39], v[108:111]
    v_exp_f32 v230, v230
    v_exp_f32 v64, v64
    v_mfma_f32_16x16x32_bf16 v[100:103], a[172:175], a[40:43], v[100:103]
    ds_read_b128 a[164:167], v9 offset:8192
    v_add_f32 v24, v24, v228
    v_add_f32 v23, v23, v62
    v_mfma_f32_16x16x32_bf16 v[108:111], a[172:175], a[44:47], v[108:111]
    s_waitcnt lgkmcnt(4)
    v_exp_f32 v231, v231
    v_exp_f32 v65, v65
    v_mfma_f32_16x16x32_bf16 v[112:115], a[176:179], a[32:35], v[112:115]
    ds_read_b128 a[168:171], v8 offset:10240
    v_add_f32 v23, v23, v63
    v_cvt_pk_bf16_f32 v47, v62, v63
    v_mfma_f32_16x16x32_bf16 v[120:123], a[176:179], a[36:39], v[120:123]
    v_add_f32 v24, v24, v229
    v_cvt_pk_bf16_f32 v226, v228, v229
    v_fma_f32 v66, v66, s36, -v18
    v_fma_f32 v67, v67, s36, -v18
    v_mfma_f32_16x16x32_bf16 v[112:115], a[180:183], a[40:43], v[112:115]
    s_waitcnt vmcnt(3)
    ds_read_b128 a[172:175], v9 offset:10240
    v_fma_f32 v232, v232, s36, -v21
    v_exp_f32 v66, v66
    v_mfma_f32_16x16x32_bf16 v[120:123], a[180:183], a[44:47], v[120:123]
    s_waitcnt lgkmcnt(4)
    buffer_load_dwordx4 v1, s[20:23], s34 offen offset:3072 nt lds
    v_add_f32 v22, v22, v64
    v_mfma_f32_16x16x32_bf16 v[116:119], a[184:187], a[32:35], v[116:119]
    ds_read_b128 a[176:179], v8 offset:12288
    v_fma_f32 v233, v233, s36, -v21
    v_exp_f32 v67, v67
    v_mfma_f32_16x16x32_bf16 v[124:127], a[184:187], a[36:39], v[124:127]
    v_exp_f32 v232, v232
    v_add_f32 v22, v22, v65
    v_mfma_f32_16x16x32_bf16 v[116:119], a[188:191], a[40:43], v[116:119]
    ds_read_b128 a[180:183], v9 offset:12288
    v_add_f32 v24, v24, v230
    v_cvt_pk_bf16_f32 v48, v64, v65
    v_fma_f32 v68, v68, s36, -v18
    v_mfma_f32_16x16x32_bf16 v[124:127], a[188:191], a[44:47], v[124:127]
    s_waitcnt lgkmcnt(4)
    v_exp_f32 v233, v233
    v_fma_f32 v69, v69, s36, -v18
    v_mfma_f32_16x16x32_bf16 v[128:131], a[160:163], a[32:35], v[128:131]
    ds_read_b128 a[184:187], v8 offset:14336
    v_exp_f32 v68, v68
    v_add_f32 v22, v22, v66
    v_mfma_f32_16x16x32_bf16 v[136:139], a[160:163], a[36:39], v[136:139]
    v_add_f32 v24, v24, v231
    v_cvt_pk_bf16_f32 v227, v230, v231
    v_exp_f32 v69, v69
    v_mfma_f32_16x16x32_bf16 v[128:131], a[164:167], a[40:43], v[128:131]
    ds_read_b128 a[188:191], v9 offset:14336
    v_fma_f32 v234, v234, s36, -v21
    v_add_f32 v22, v22, v67
    v_mfma_f32_16x16x32_bf16 v[136:139], a[164:167], a[44:47], v[136:139]
    s_waitcnt lgkmcnt(4)
    v_fma_f32 v235, v235, s36, -v21
    v_cvt_pk_bf16_f32 v49, v66, v67
    v_fma_f32 v70, v70, s36, -v18
    v_fma_f32 v71, v71, s36, -v18
    v_mfma_f32_16x16x32_bf16 v[132:135], a[168:171], a[32:35], v[132:135]
    s_add_u32 m0, s29, 49152
    ds_read_b128 a[160:163], v10 offset:0
    v_exp_f32 v234, v234
    v_mfma_f32_16x16x32_bf16 v[140:143], a[168:171], a[36:39], v[140:143]
    s_add_u32 s34, s33, 49152
    v_add_f32 v25, v25, v232
    v_exp_f32 v70, v70
    v_add_f32 v22, v22, v68
    v_mfma_f32_16x16x32_bf16 v[132:135], a[172:175], a[40:43], v[132:135]
    s_waitcnt vmcnt(4)
    ds_read_b128 a[164:167], v11 offset:0
    buffer_load_dwordx4 v0, s[20:23], s34 offen offset:0 nt lds
    v_mfma_f32_16x16x32_bf16 v[140:143], a[172:175], a[44:47], v[140:143]
    s_waitcnt lgkmcnt(4)
    v_exp_f32 v235, v235
    v_exp_f32 v71, v71
    v_mfma_f32_16x16x32_bf16 v[144:147], a[176:179], a[32:35], v[144:147]
    ds_read_b128 a[168:171], v10 offset:2048
    v_add_f32 v25, v25, v233
    v_add_f32 v22, v22, v69
    v_cvt_pk_bf16_f32 v50, v68, v69
    v_mfma_f32_16x16x32_bf16 v[152:155], a[176:179], a[36:39], v[152:155]
    v_cvt_pk_bf16_f32 v228, v232, v233
    v_fma_f32 v236, v236, s36, -v21
    v_fma_f32 v72, v72, s36, -v19
    v_mfma_f32_16x16x32_bf16 v[144:147], a[180:183], a[40:43], v[144:147]
    ds_read_b128 a[172:175], v11 offset:2048
    v_fma_f32 v237, v237, s36, -v21
    v_fma_f32 v73, v73, s36, -v19
    v_exp_f32 v72, v72
    v_mfma_f32_16x16x32_bf16 v[152:155], a[180:183], a[44:47], v[152:155]
    s_waitcnt lgkmcnt(4)
    v_exp_f32 v236, v236
    v_add_f32 v22, v22, v70
    v_mfma_f32_16x16x32_bf16 v[148:151], a[184:187], a[32:35], v[148:151]
    s_waitcnt vmcnt(13)
    s_barrier
    ds_read_b128 a[176:179], v8 offset:16384
    v_mfma_f32_16x16x32_bf16 v[156:159], a[184:187], a[36:39], v[156:159]
    v_add_f32 v25, v25, v234
    v_exp_f32 v73, v73
    v_mfma_f32_16x16x32_bf16 v[148:151], a[188:191], a[40:43], v[148:151]
    ds_read_b128 a[180:183], v9 offset:16384
    v_exp_f32 v237, v237
    v_add_f32 v22, v22, v71
    v_mfma_f32_16x16x32_bf16 v[156:159], a[188:191], a[44:47], v[156:159]
    s_waitcnt lgkmcnt(4)
    v_add_f32 v25, v25, v235
    v_cvt_pk_bf16_f32 v51, v70, v71
    v_fma_f32 v74, v74, s36, -v19
    v_fma_f32 v75, v75, s36, -v19
    v_mfma_f32_16x16x32_bf16 v[240:243], a[160:163], a[96:99], v[240:243]
    ds_read_b128 a[184:187], v8 offset:18432
    v_cvt_pk_bf16_f32 v229, v234, v235
    v_exp_f32 v74, v74
    v_mfma_f32_16x16x32_bf16 v[248:251], a[160:163], a[100:103], v[248:251]
    s_waitcnt vmcnt(4)
    buffer_load_dwordx4 v1, s[20:23], s34 offen offset:1024 nt lds
    v_add_f32 v23, v23, v72
    v_mfma_f32_16x16x32_bf16 v[240:243], a[164:167], a[104:107], v[240:243]
    ds_read_b128 a[188:191], v9 offset:18432
    v_fma_f32 v238, v238, s36, -v21
    v_exp_f32 v75, v75
    v_mfma_f32_16x16x32_bf16 v[248:251], a[164:167], a[108:111], v[248:251]
    s_waitcnt lgkmcnt(4)
    v_fma_f32 v239, v239, s36, -v21
    v_add_f32 v23, v23, v73
    v_cvt_pk_bf16_f32 v52, v72, v73
    v_mfma_f32_16x16x32_bf16 v[244:247], a[168:171], a[96:99], v[244:247]
    ds_read_b128 a[160:163], v8 offset:20480
    v_exp_f32 v238, v238
    v_fma_f32 v76, v76, s36, -v19
    v_mfma_f32_16x16x32_bf16 v[252:255], a[168:171], a[100:103], v[252:255]
    v_add_f32 v25, v25, v236
    v_fma_f32 v77, v77, s36, -v19
    v_exp_f32 v76, v76
    v_mfma_f32_16x16x32_bf16 v[244:247], a[172:175], a[104:107], v[244:247]
    ds_read_b128 a[164:167], v9 offset:20480
    v_exp_f32 v239, v239
    v_mfma_f32_16x16x32_bf16 v[252:255], a[172:175], a[108:111], v[252:255]
    s_waitcnt lgkmcnt(4)
    v_add_f32 v25, v25, v237
    v_add_f32 v23, v23, v74
    v_exp_f32 v77, v77
    v_mfma_f32_16x16x32_bf16 v[96:99], a[176:179], a[48:51], v[96:99]
    ds_read_b128 a[168:171], v8 offset:22528
    v_cvt_pk_bf16_f32 v230, v236, v237
    v_add_f32 v23, v23, v75
    v_mfma_f32_16x16x32_bf16 v[104:107], a[176:179], a[52:55], v[104:107]
    v_add_f32 v25, v25, v238
    v_add_f32 v25, v25, v239
    v_cvt_pk_bf16_f32 v53, v74, v75
    v_fma_f32 v78, v78, s36, -v19
    v_mfma_f32_16x16x32_bf16 v[96:99], a[180:183], a[56:59], v[96:99]
    s_add_u32 s34, s34, 2048
    ds_read_b128 a[172:175], v9 offset:22528
    v_cvt_pk_bf16_f32 v231, v238, v239
    v_fma_f32 v79, v79, s36, -v19
    v_mfma_f32_16x16x32_bf16 v[104:107], a[180:183], a[60:63], v[104:107]
    s_waitcnt lgkmcnt(4)
    v_add_u32 v28, s45, v16
    v_exp_f32 v78, v78
    v_add_f32 v23, v23, v76
    v_mfma_f32_16x16x32_bf16 v[100:103], a[184:187], a[48:51], v[100:103]
    s_waitcnt vmcnt(3)
    ds_read_b128 a[176:179], v8 offset:24576
    buffer_load_dwordx4 v0, s[20:23], s34 offen offset:2048 nt lds
    v_mfma_f32_16x16x32_bf16 v[108:111], a[184:187], a[52:55], v[108:111]
    ds_write_b128 v28, v[224:227] offset:16384
    v_mfma_f32_16x16x32_bf16 v[100:103], a[188:191], a[56:59], v[100:103]
    ds_read_b128 a[180:183], v9 offset:24576
    v_exp_f32 v79, v79
    v_add_f32 v23, v23, v77
    v_mfma_f32_16x16x32_bf16 v[108:111], a[188:191], a[60:63], v[108:111]
    s_waitcnt lgkmcnt(5)
    v_cvt_pk_bf16_f32 v54, v76, v77
    v_fma_f32 v80, v80, s36, -v18
    v_fma_f32 v81, v81, s36, -v18
    v_mfma_f32_16x16x32_bf16 v[112:115], a[160:163], a[48:51], v[112:115]
    ds_read_b128 a[184:187], v8 offset:26624
    ds_write_b128 v28, v[228:231] offset:17408
    v_mfma_f32_16x16x32_bf16 v[120:123], a[160:163], a[52:55], v[120:123]
    v_exp_f32 v80, v80
    v_add_f32 v23, v23, v78
    v_exp_f32 v81, v81
    v_mfma_f32_16x16x32_bf16 v[112:115], a[164:167], a[56:59], v[112:115]
    ds_read_b128 a[188:191], v9 offset:26624
    v_add_f32 v23, v23, v79
    v_cvt_pk_bf16_f32 v55, v78, v79
    v_mfma_f32_16x16x32_bf16 v[120:123], a[164:167], a[60:63], v[120:123]
    s_waitcnt lgkmcnt(6)
    v_fma_f32 v82, v82, s36, -v18
    v_fma_f32 v83, v83, s36, -v18
    v_exp_f32 v82, v82
    v_mfma_f32_16x16x32_bf16 v[116:119], a[168:171], a[48:51], v[116:119]
    ds_read_b128 a[160:163], v8 offset:28672
    v_add_f32 v22, v22, v80
    v_exp_f32 v83, v83
    v_mfma_f32_16x16x32_bf16 v[124:127], a[168:171], a[52:55], v[124:127]
    v_add_f32 v22, v22, v81
    v_cvt_pk_bf16_f32 v56, v80, v81
    v_fma_f32 v84, v84, s36, -v18
    v_mfma_f32_16x16x32_bf16 v[116:119], a[172:175], a[56:59], v[116:119]
    s_waitcnt vmcnt(3)
    ds_read_b128 a[164:167], v9 offset:28672
    v_fma_f32 v85, v85, s36, -v18
    v_exp_f32 v84, v84
    v_mfma_f32_16x16x32_bf16 v[124:127], a[172:175], a[60:63], v[124:127]
    s_waitcnt lgkmcnt(5)
    buffer_load_dwordx4 v1, s[20:23], s34 offen offset:3072 nt lds
    v_add_f32 v22, v22, v82
    v_mfma_f32_16x16x32_bf16 v[128:131], a[176:179], a[48:51], v[128:131]
    ds_read_b128 a[168:171], v8 offset:30720
    v_accvgpr_read_b32 v8, a229
    v_add_u32 v8, 98304, v8
    v_mfma_f32_16x16x32_bf16 v[136:139], a[176:179], a[52:55], v[136:139]
    v_xor_b32 v12, 128, v8
    v_exp_f32 v85, v85
    v_add_f32 v22, v22, v83
    v_mfma_f32_16x16x32_bf16 v[128:131], a[180:183], a[56:59], v[128:131]
    ds_read_b128 a[172:175], v9 offset:30720
    v_xor_b32 v9, 32, v8
    v_cvt_pk_bf16_f32 v57, v82, v83
    v_fma_f32 v86, v86, s36, -v18
    v_mfma_f32_16x16x32_bf16 v[136:139], a[180:183], a[60:63], v[136:139]
    s_waitcnt lgkmcnt(4)
    v_xor_b32 v13, 160, v8
    v_fma_f32 v87, v87, s36, -v18
    v_exp_f32 v86, v86
    v_mfma_f32_16x16x32_bf16 v[132:135], a[184:187], a[48:51], v[132:135]
    ds_read_b128 a[176:179], v10 offset:16384
    v_xor_b32 v14, 192, v8
    v_add_f32 v22, v22, v84
    v_mfma_f32_16x16x32_bf16 v[140:143], a[184:187], a[52:55], v[140:143]
    v_xor_b32 v15, 224, v8
    v_exp_f32 v87, v87
    v_add_f32 v22, v22, v85
    v_mfma_f32_16x16x32_bf16 v[132:135], a[188:191], a[56:59], v[132:135]
    ds_read_b128 a[180:183], v11 offset:16384
    v_cvt_pk_bf16_f32 v58, v84, v85
    v_fma_f32 v88, v88, s36, -v19
    v_mfma_f32_16x16x32_bf16 v[140:143], a[188:191], a[60:63], v[140:143]
    s_waitcnt lgkmcnt(4)
    v_fma_f32 v89, v89, s36, -v19
    v_exp_f32 v88, v88
    v_add_f32 v22, v22, v86
    v_mfma_f32_16x16x32_bf16 v[144:147], a[160:163], a[48:51], v[144:147]
    s_add_u32 m0, s29, 81920
    ds_read_b128 a[184:187], v10 offset:18432
    ds_read_b128 v[224:227], v16 offset:0
    v_xor_b32 v10, 64, v8
    v_mfma_f32_16x16x32_bf16 v[152:155], a[160:163], a[52:55], v[152:155]
    s_add_u32 s34, s33, 65536
    v_exp_f32 v89, v89
    v_add_f32 v22, v22, v87
    v_cvt_pk_bf16_f32 v59, v86, v87
    v_mfma_f32_16x16x32_bf16 v[144:147], a[164:167], a[56:59], v[144:147]
    s_waitcnt vmcnt(4)
    ds_read_b128 a[188:191], v11 offset:18432
    v_xor_b32 v11, 96, v8
    v_fma_f32 v90, v90, s36, -v19
    v_fma_f32 v91, v91, s36, -v19
    v_mfma_f32_16x16x32_bf16 v[152:155], a[164:167], a[60:63], v[152:155]
    s_waitcnt lgkmcnt(5)
    buffer_load_dwordx4 v0, s[20:23], s34 offen offset:0 nt lds
    v_exp_f32 v90, v90
    v_mfma_f32_16x16x32_bf16 v[148:151], a[168:171], a[48:51], v[148:151]
    s_waitcnt vmcnt(13)
    s_barrier
    ds_read_b64_tr_b16 a[160:161], v8 offset:32768
    v_mfma_f32_16x16x32_bf16 v[156:159], a[168:171], a[52:55], v[156:159]
    ds_read_b64_tr_b16 a[162:163], v8 offset:40960
    ds_read_b128 v[228:231], v16 offset:1024
    v_add_f32 v23, v23, v88
    v_mfma_f32_16x16x32_bf16 v[148:151], a[172:175], a[56:59], v[148:151]
    v_exp_f32 v91, v91
    v_add_f32 v23, v23, v89
    v_mfma_f32_16x16x32_bf16 v[156:159], a[172:175], a[60:63], v[156:159]
    s_waitcnt lgkmcnt(6)
    v_cvt_pk_bf16_f32 v60, v88, v89
    v_fma_f32 v92, v92, s36, -v19
    v_fma_f32 v93, v93, s36, -v19
    v_exp_f32 v92, v92
    v_mfma_f32_16x16x32_bf16 v[240:243], a[176:179], a[112:115], v[240:243]
    ds_read_b64_tr_b16 a[164:165], v9 offset:32768
    v_add_f32 v23, v23, v90
    v_mfma_f32_16x16x32_bf16 v[248:251], a[176:179], a[116:119], v[248:251]
    ds_read_b64_tr_b16 a[166:167], v9 offset:40960
    v_exp_f32 v93, v93
    v_add_f32 v23, v23, v91
    v_mfma_f32_16x16x32_bf16 v[240:243], a[180:183], a[120:123], v[240:243]
    v_cvt_pk_bf16_f32 v61, v90, v91
    v_fma_f32 v94, v94, s36, -v19
    v_fma_f32 v95, v95, s36, -v19
    v_exp_f32 v94, v94
    v_mfma_f32_16x16x32_bf16 v[248:251], a[180:183], a[124:127], v[248:251]
    s_waitcnt lgkmcnt(5)
    v_add_f32 v23, v23, v92
    v_exp_f32 v95, v95
    v_mfma_f32_16x16x32_bf16 v[244:247], a[184:187], a[112:115], v[244:247]
    ds_read_b64_tr_b16 a[168:169], v10 offset:32768
    v_add_f32 v23, v23, v93
    v_cvt_pk_bf16_f32 v62, v92, v93
    v_mfma_f32_16x16x32_bf16 v[252:255], a[184:187], a[116:119], v[252:255]
    ds_read_b64_tr_b16 a[170:171], v10 offset:40960
    v_add_f32 v23, v23, v94
    v_add_f32 v23, v23, v95
    v_cvt_pk_bf16_f32 v63, v94, v95
    v_mfma_f32_16x16x32_bf16 v[244:247], a[188:191], a[120:123], v[244:247]
    s_waitcnt vmcnt(4)
    ds_read_b64_tr_b16 a[172:173], v11 offset:32768
    buffer_load_dwordx4 v1, s[20:23], s34 offen offset:1024 nt lds
    v_mfma_f32_16x16x32_bf16 v[252:255], a[188:191], a[124:127], v[252:255]
    s_waitcnt lgkmcnt(6)
    ds_read_b64_tr_b16 a[174:175], v11 offset:40960
    v_mfma_f32_16x16x32_bf16 a[0:3], a[160:163], v[160:163], 0
    ds_read_b64_tr_b16 a[176:177], v12 offset:32768
    v_max3_f32 v26, v96, v97, v98
    v_max3_f32 v27, v104, v105, v106
    v_mfma_f32_16x16x32_bf16 a[8:11], a[160:163], v[164:167], 0
    ds_read_b64_tr_b16 a[178:179], v12 offset:40960
    v_max3_f32 v26, v26, v99, v100
    v_max3_f32 v27, v27, v107, v108
    v_max3_f32 v26, v26, v101, v102
    v_mfma_f32_16x16x32_bf16 v[64:67], a[160:163], v[224:227], 0
    s_waitcnt lgkmcnt(8)
    ds_read_b64_tr_b16 a[180:181], v13 offset:32768
    v_max3_f32 v27, v27, v109, v110
    v_max3_f32 v26, v26, v103, v112
    v_mfma_f32_16x16x32_bf16 v[72:75], a[160:163], v[228:231], 0
    s_waitcnt lgkmcnt(7)
    ds_read_b64_tr_b16 a[182:183], v13 offset:40960
    v_max3_f32 v27, v27, v111, v120
    v_max3_f32 v26, v26, v113, v114
    v_mfma_f32_16x16x32_bf16 a[4:7], a[164:167], v[160:163], 0
    ds_read_b64_tr_b16 a[184:185], v14 offset:32768
    v_max3_f32 v27, v27, v121, v122
    v_max3_f32 v26, v26, v115, v116
    v_mfma_f32_16x16x32_bf16 a[12:15], a[164:167], v[164:167], 0
    ds_read_b64_tr_b16 a[186:187], v14 offset:40960
    v_max3_f32 v27, v27, v123, v124
    v_max3_f32 v26, v26, v117, v118
    v_max3_f32 v27, v27, v125, v126
    v_mfma_f32_16x16x32_bf16 v[68:71], a[164:167], v[224:227], 0
    ds_read_b64_tr_b16 a[188:189], v15 offset:32768
    v_max3_f32 v28, v240, v241, v242
    v_max3_f32 v26, v26, v119, v128
    v_mfma_f32_16x16x32_bf16 v[76:79], a[164:167], v[228:231], 0
    s_waitcnt lgkmcnt(7)
    ds_read_b64_tr_b16 a[190:191], v15 offset:40960
    v_max3_f32 v29, v248, v249, v250
    v_max3_f32 v27, v27, v127, v136
    v_mfma_f32_16x16x32_bf16 a[16:19], a[168:171], v[160:163], 0
    s_add_u32 s34, s34, 2048
    ds_read_b64_tr_b16 a[160:161], v8 offset:33024
    v_max3_f32 v28, v28, v243, v244
    v_max3_f32 v26, v26, v129, v130
    v_mfma_f32_16x16x32_bf16 a[24:27], a[168:171], v[164:167], 0
    s_waitcnt vmcnt(3)
    ds_read_b64_tr_b16 a[162:163], v8 offset:41216
    buffer_load_dwordx4 v0, s[20:23], s34 offen offset:2048 nt lds
    v_mfma_f32_16x16x32_bf16 a[20:23], a[172:175], v[160:163], 0
    v_max3_f32 v29, v29, v251, v252
    v_max3_f32 v28, v28, v245, v246
    v_max3_f32 v27, v27, v137, v138
    v_max3_f32 v26, v26, v131, v132
    v_mfma_f32_16x16x32_bf16 a[28:31], a[172:175], v[164:167], 0
    s_waitcnt lgkmcnt(6)
    v_max3_f32 v29, v29, v253, v254
    v_max_f32 v28, v28, v247
    v_max_f32 v29, v29, v255
    v_mfma_f32_16x16x32_bf16 a[32:35], a[176:179], v[160:163], 0
    ds_read_b64_tr_b16 a[164:165], v9 offset:33024
    v_max3_f32 v27, v27, v139, v140
    v_max3_f32 v26, v26, v133, v134
    v_mfma_f32_16x16x32_bf16 a[40:43], a[176:179], v[164:167], 0
    ds_read_b64_tr_b16 a[166:167], v9 offset:41216
    v_permlane32_swap_b32 v28, v29
    v_max_f32 v28, v28, v29
    v_mfma_f32_16x16x32_bf16 a[36:39], a[180:183], v[160:163], 0
    v_mov_b32 v29, v28
    v_max3_f32 v27, v27, v141, v142
    v_max3_f32 v26, v26, v135, v144
    v_max3_f32 v27, v27, v143, v152
    v_mfma_f32_16x16x32_bf16 a[44:47], a[180:183], v[164:167], 0
    s_waitcnt lgkmcnt(4)
    v_permlane16_swap_b32 v28, v29
    v_max_f32 v28, v28, v29
    v_add_u32 v30, s46, v16
    v_mfma_f32_16x16x32_bf16 a[48:51], a[184:187], v[160:163], 0
    ds_read_b64_tr_b16 a[168:169], v10 offset:33024
    ds_write_b32 v30, v28 offset:24576
    v_mfma_f32_16x16x32_bf16 a[56:59], a[184:187], v[164:167], 0
    ds_read_b64_tr_b16 a[170:171], v10 offset:41216
    v_max3_f32 v26, v26, v145, v146
    v_max3_f32 v27, v27, v153, v154
    v_mfma_f32_16x16x32_bf16 a[52:55], a[188:191], v[160:163], 0
    ds_read_b64_tr_b16 a[172:173], v11 offset:33024
    ds_write_b32 v30, v28 offset:26624
    v_max3_f32 v26, v26, v147, v148
    v_mfma_f32_16x16x32_bf16 a[60:63], a[188:191], v[164:167], 0
    s_waitcnt lgkmcnt(7)
    ds_read_b64_tr_b16 a[174:175], v11 offset:41216
    v_max3_f32 v27, v27, v155, v156
    v_max3_f32 v26, v26, v149, v150
    v_mfma_f32_16x16x32_bf16 a[64:67], a[160:163], v[160:163], 0
    s_waitcnt vmcnt(3)
    ds_read_b64_tr_b16 a[176:177], v12 offset:33024
    buffer_load_dwordx4 v1, s[20:23], s34 offen offset:3072 nt lds
    v_mfma_f32_16x16x32_bf16 a[72:75], a[160:163], v[164:167], 0
    ds_read_b64_tr_b16 a[178:179], v12 offset:41216
    ds_write_b32 v30, v28 offset:28672
    v_mfma_f32_16x16x32_bf16 v[80:83], a[160:163], v[224:227], 0
    ds_read_b64_tr_b16 a[180:181], v13 offset:33024
    v_max3_f32 v27, v27, v157, v158
    v_max_f32 v26, v26, v151
    v_mfma_f32_16x16x32_bf16 v[88:91], a[160:163], v[228:231], 0
    s_waitcnt lgkmcnt(10)
    ds_read_b64_tr_b16 a[182:183], v13 offset:41216
    ds_write_b32 v30, v28 offset:30720
    v_max_f32 v27, v27, v159
    v_mfma_f32_16x16x32_bf16 a[68:71], a[164:167], v[160:163], 0
    ds_read_b64_tr_b16 a[184:185], v14 offset:33024
    ds_read_b128 v[232:235], v16 offset:2048
    v_mfma_f32_16x16x32_bf16 a[76:79], a[164:167], v[164:167], 0
    ds_read_b64_tr_b16 a[186:187], v14 offset:41216
    v_permlane32_swap_b32 v26, v27
    v_max_f32 v26, v26, v27
    v_mov_b32 v27, v26
    v_mfma_f32_16x16x32_bf16 v[84:87], a[164:167], v[224:227], 0
    ds_read_b64_tr_b16 a[188:189], v15 offset:33024
    v_permlane16_swap_b32 v26, v27
    v_max_f32 v26, v26, v27
    v_mfma_f32_16x16x32_bf16 v[92:95], a[164:167], v[228:231], 0
    s_waitcnt lgkmcnt(10)
    ds_read_b64_tr_b16 a[190:191], v15 offset:41216
    v_cndmask_b32 v27, v19, v18, s[24:25]
    v_fma_f32 v27, v26, s36, -v27
    v_cmp_lt_f32 vcc, 0x41200000, v27
    s_cbranch_vccnz L_rare_o3
L_rare_o3_back:
    v_mfma_f32_16x16x32_bf16 a[80:83], a[168:171], v[160:163], 0
    s_waitcnt vmcnt(12) lgkmcnt(5)
    s_barrier
    ds_read_b64_tr_b16 a[160:161], v8 offset:49152
    v_mfma_f32_16x16x32_bf16 a[88:91], a[168:171], v[164:167], 0
    s_add_u32 m0, s29, 98304
    ds_read_b64_tr_b16 a[162:163], v8 offset:57344
    ds_read_b128 v[236:239], v16 offset:3072
    v_mfma_f32_16x16x32_bf16 a[84:87], a[172:175], v[160:163], 0
    s_add_u32 s34, s33, 81920
    v_fma_f32 v96, v96, s36, -v18
    v_fma_f32 v97, v97, s36, -v18
    v_mfma_f32_16x16x32_bf16 a[92:95], a[172:175], v[164:167], 0
    v_exp_f32 v96, v96
    v_mfma_f32_16x16x32_bf16 a[96:99], a[176:179], v[160:163], 0
    s_waitcnt vmcnt(4)
    ds_read_b64_tr_b16 a[164:165], v9 offset:49152
    buffer_load_dwordx4 v0, s[20:23], s34 offen offset:0 nt lds
    v_mfma_f32_16x16x32_bf16 a[104:107], a[176:179], v[164:167], 0
    ds_read_b64_tr_b16 a[166:167], v9 offset:57344
    v_mfma_f32_16x16x32_bf16 a[100:103], a[180:183], v[160:163], 0
    v_exp_f32 v97, v97
    v_mfma_f32_16x16x32_bf16 a[108:111], a[180:183], v[164:167], 0
    s_waitcnt lgkmcnt(5)
    v_fma_f32 v98, v98, s36, -v18
    v_fma_f32 v99, v99, s36, -v18
    v_mfma_f32_16x16x32_bf16 a[112:115], a[184:187], v[160:163], 0
    ds_read_b64_tr_b16 a[168:169], v10 offset:49152
    v_mfma_f32_16x16x32_bf16 a[120:123], a[184:187], v[164:167], 0
    ds_read_b64_tr_b16 a[170:171], v10 offset:57344
    v_exp_f32 v98, v98
    v_mfma_f32_16x16x32_bf16 a[116:119], a[188:191], v[160:163], 0
    ds_read_b64_tr_b16 a[172:173], v11 offset:49152
    v_mfma_f32_16x16x32_bf16 a[124:127], a[188:191], v[164:167], 0
    s_waitcnt lgkmcnt(6)
    ds_read_b64_tr_b16 a[174:175], v11 offset:57344
    v_add_f32 v22, v22, v96
    v_mfma_f32_16x16x32_bf16 a[0:3], a[160:163], v[168:171], a[0:3]
    ds_read_b64_tr_b16 a[176:177], v12 offset:49152
    v_mfma_f32_16x16x32_bf16 a[8:11], a[160:163], v[172:175], a[8:11]
    ds_read_b64_tr_b16 a[178:179], v12 offset:57344
    v_mfma_f32_16x16x32_bf16 v[64:67], a[160:163], v[232:235], v[64:67]
    s_waitcnt lgkmcnt(8)
    s_waitcnt vmcnt(4)
    ds_read_b64_tr_b16 a[180:181], v13 offset:49152
    v_exp_f32 v99, v99
    v_mfma_f32_16x16x32_bf16 v[72:75], a[160:163], v[236:239], v[72:75]
    s_waitcnt lgkmcnt(7)
    ds_read_b64_tr_b16 a[182:183], v13 offset:57344
    buffer_load_dwordx4 v1, s[20:23], s34 offen offset:1024 nt lds
    v_mfma_f32_16x16x32_bf16 a[4:7], a[164:167], v[168:171], a[4:7]
    ds_read_b64_tr_b16 a[184:185], v14 offset:49152
    v_add_u32 v26, s45, v16
    v_mfma_f32_16x16x32_bf16 a[12:15], a[164:167], v[172:175], a[12:15]
    ds_read_b64_tr_b16 a[186:187], v14 offset:57344
    v_mfma_f32_16x16x32_bf16 v[68:71], a[164:167], v[232:235], v[68:71]
    ds_read_b64_tr_b16 a[188:189], v15 offset:49152
    ds_read_b128 v[28:31], v26 offset:24576
    v_mfma_f32_16x16x32_bf16 v[76:79], a[164:167], v[236:239], v[76:79]
    s_waitcnt lgkmcnt(8)
    ds_read_b64_tr_b16 a[190:191], v15 offset:57344
    v_add_f32 v22, v22, v97
    v_mfma_f32_16x16x32_bf16 a[16:19], a[168:171], v[168:171], a[16:19]
    ds_read_b64_tr_b16 a[160:161], v8 offset:49408
    v_cvt_pk_bf16_f32 v96, v96, v97
    v_mfma_f32_16x16x32_bf16 a[24:27], a[168:171], v[172:175], a[24:27]
    ds_read_b64_tr_b16 a[162:163], v8 offset:57600
    v_xor_b32 v8, 0x10000, v8
    v_mfma_f32_16x16x32_bf16 a[20:23], a[172:175], v[168:171], a[20:23]
    v_fma_f32 v100, v100, s36, -v18
    v_fma_f32 v101, v101, s36, -v18
    v_mfma_f32_16x16x32_bf16 a[28:31], a[172:175], v[172:175], a[28:31]
    s_waitcnt lgkmcnt(7)
    v_exp_f32 v100, v100
    v_mfma_f32_16x16x32_bf16 a[32:35], a[176:179], v[168:171], a[32:35]
    ds_read_b64_tr_b16 a[164:165], v9 offset:49408
    v_mfma_f32_16x16x32_bf16 a[40:43], a[176:179], v[172:175], a[40:43]
    s_add_u32 s34, s34, 2048
    ds_read_b64_tr_b16 a[166:167], v9 offset:57600
    v_xor_b32 v9, 0x10000, v9
    v_mfma_f32_16x16x32_bf16 a[36:39], a[180:183], v[168:171], a[36:39]
    s_waitcnt vmcnt(3)
    s_nop 0
A_stub7:
    s_cbranch_execz A_stub11
    buffer_load_dwordx4 v0, s[20:23], s34 offen offset:2048 nt lds
    v_mfma_f32_16x16x32_bf16 a[44:47], a[180:183], v[172:175], a[44:47]
    s_waitcnt lgkmcnt(4)
    v_add_f32 v22, v22, v98
    v_mfma_f32_16x16x32_bf16 a[48:51], a[184:187], v[168:171], a[48:51]
    ds_read_b64_tr_b16 a[168:169], v10 offset:49408
    v_max3_f32 v26, v28, v29, v30
    v_max_f32 v26, v26, v31
    v_mfma_f32_16x16x32_bf16 a[56:59], a[184:187], v[172:175], a[56:59]
    ds_read_b64_tr_b16 a[170:171], v10 offset:57600
    v_xor_b32 v10, 0x10000, v10
    v_mfma_f32_16x16x32_bf16 a[52:55], a[188:191], v[168:171], a[52:55]
    ds_read_b64_tr_b16 a[172:173], v11 offset:49408
    v_exp_f32 v101, v101
    v_mfma_f32_16x16x32_bf16 a[60:63], a[188:191], v[172:175], a[60:63]
    s_waitcnt lgkmcnt(5)
    ds_read_b64_tr_b16 a[174:175], v11 offset:57600
    v_xor_b32 v11, 0x10000, v11
    v_mfma_f32_16x16x32_bf16 a[64:67], a[160:163], v[168:171], a[64:67]
    ds_read_b64_tr_b16 a[176:177], v12 offset:49408
    v_cndmask_b32 v27, v21, v20, s[24:25]
    v_fma_f32 v27, v26, s36, -v27
    v_cmp_lt_f32 vcc, 0x41200000, v27
    s_cbranch_vccnz L_rare_x3
L_rare_x3_back:
    v_mfma_f32_16x16x32_bf16 a[72:75], a[160:163], v[172:175], a[72:75]
    ds_read_b64_tr_b16 a[178:179], v12 offset:57600
    v_xor_b32 v12, 0x10000, v12
    v_mfma_f32_16x16x32_bf16 v[80:83], a[160:163], v[232:235], v[80:83]
    ds_read_b64_tr_b16 a[180:181], v13 offset:49408
    v_mfma_f32_16x16x32_bf16 v[88:91], a[160:163], v[236:239], v[88:91]
    s_waitcnt lgkmcnt(7)
    ds_read_b64_tr_b16 a[182:183], v13 offset:57600
    v_xor_b32 v13, 0x10000, v13
    v_mfma_f32_16x16x32_bf16 a[68:71], a[164:167], v[168:171], a[68:71]
    ds_read_b64_tr_b16 a[184:185], v14 offset:49408
    ds_read_b128 v[224:227], v16 offset:4096
    v_fma_f32 v240, v240, s36, -v20
    v_mfma_f32_16x16x32_bf16 a[76:79], a[164:167], v[172:175], a[76:79]
    s_waitcnt vmcnt(3)
    ds_read_b64_tr_b16 a[186:187], v14 offset:57600
    buffer_load_dwordx4 v1, s[20:23], s34 offen offset:3072 nt lds
    v_xor_b32 v14, 0x10000, v14
    v_mfma_f32_16x16x32_bf16 v[84:87], a[164:167], v[232:235], v[84:87]
    ds_read_b64_tr_b16 a[188:189], v15 offset:49408
    v_fma_f32 v241, v241, s36, -v20
    v_mfma_f32_16x16x32_bf16 v[92:95], a[164:167], v[236:239], v[92:95]
    s_waitcnt lgkmcnt(8)
    ds_read_b64_tr_b16 a[190:191], v15 offset:57600
    v_xor_b32 v15, 0x10000, v15
    v_mfma_f32_16x16x32_bf16 a[80:83], a[168:171], v[168:171], a[80:83]
    s_waitcnt vmcnt(12)
    s_barrier
    ds_read_b64_tr_b16 a[160:161], v8 offset:0
    v_mfma_f32_16x16x32_bf16 a[88:91], a[168:171], v[172:175], a[88:91]
    ds_read_b64_tr_b16 a[162:163], v8 offset:8192
    ds_read_b128 v[228:231], v16 offset:5120
    v_mfma_f32_16x16x32_bf16 a[84:87], a[172:175], v[168:171], a[84:87]
    v_exp_f32 v240, v240
    v_mfma_f32_16x16x32_bf16 a[92:95], a[172:175], v[172:175], a[92:95]
    s_waitcnt lgkmcnt(8)
    v_exp_f32 v241, v241
    v_fma_f32 v242, v242, s36, -v20
    v_mfma_f32_16x16x32_bf16 a[96:99], a[176:179], v[168:171], a[96:99]
    ds_read_b64_tr_b16 a[164:165], v9 offset:0
    v_fma_f32 v243, v243, s36, -v20
    v_mfma_f32_16x16x32_bf16 a[104:107], a[176:179], v[172:175], a[104:107]
    ds_read_b64_tr_b16 a[166:167], v9 offset:8192
    v_exp_f32 v242, v242
    v_mfma_f32_16x16x32_bf16 a[100:103], a[180:183], v[168:171], a[100:103]
    s_add_u32 m0, s29, 114688
    v_add_f32 v24, v24, v240
    v_add_f32 v22, v22, v99
    v_mfma_f32_16x16x32_bf16 a[108:111], a[180:183], v[172:175], a[108:111]
    s_waitcnt lgkmcnt(5)
    v_exp_f32 v243, v243
    v_add_f32 v24, v24, v241
    v_mfma_f32_16x16x32_bf16 a[112:115], a[184:187], v[168:171], a[112:115]
    s_add_u32 s34, s33, 98304
    ds_read_b64_tr_b16 a[168:169], v10 offset:0
    v_cvt_pk_bf16_f32 v240, v240, v241
    v_mfma_f32_16x16x32_bf16 a[120:123], a[184:187], v[172:175], a[120:123]
    s_waitcnt vmcnt(4)
    ds_read_b64_tr_b16 a[170:171], v10 offset:8192
    buffer_load_dwordx4 v0, s[20:23], s34 offen offset:0 nt lds
    v_mfma_f32_16x16x32_bf16 a[116:119], a[188:191], v[168:171], a[116:119]
    ds_read_b64_tr_b16 a[172:173], v11 offset:0
    v_fma_f32 v244, v244, s36, -v20
    v_fma_f32 v245, v245, s36, -v20
    v_mfma_f32_16x16x32_bf16 a[124:127], a[188:191], v[172:175], a[124:127]
    s_waitcnt lgkmcnt(6)
    ds_read_b64_tr_b16 a[174:175], v11 offset:8192
    v_exp_f32 v244, v244
    v_mfma_f32_16x16x32_bf16 a[0:3], a[160:163], v[176:179], a[0:3]
    ds_read_b64_tr_b16 a[176:177], v12 offset:0
    v_cvt_pk_bf16_f32 v97, v98, v99
    v_mfma_f32_16x16x32_bf16 a[8:11], a[160:163], v[180:183], a[8:11]
    ds_read_b64_tr_b16 a[178:179], v12 offset:8192
    v_add_f32 v24, v24, v242
    v_mfma_f32_16x16x32_bf16 v[64:67], a[160:163], v[224:227], v[64:67]
    s_waitcnt lgkmcnt(8)
    ds_read_b64_tr_b16 a[180:181], v13 offset:0
    v_exp_f32 v245, v245
    v_mfma_f32_16x16x32_bf16 v[72:75], a[160:163], v[228:231], v[72:75]
    s_waitcnt lgkmcnt(7)
    ds_read_b64_tr_b16 a[182:183], v13 offset:8192
    v_add_f32 v24, v24, v243
    v_mfma_f32_16x16x32_bf16 a[4:7], a[164:167], v[176:179], a[4:7]
    ds_read_b64_tr_b16 a[184:185], v14 offset:0
    v_cvt_pk_bf16_f32 v241, v242, v243
    v_mfma_f32_16x16x32_bf16 a[12:15], a[164:167], v[180:183], a[12:15]
    ds_read_b64_tr_b16 a[186:187], v14 offset:8192
    v_fma_f32 v246, v246, s36, -v20
    v_fma_f32 v247, v247, s36, -v20
    v_mfma_f32_16x16x32_bf16 v[68:71], a[164:167], v[224:227], v[68:71]
    ds_read_b64_tr_b16 a[188:189], v15 offset:0
    v_exp_f32 v246, v246
    v_mfma_f32_16x16x32_bf16 v[76:79], a[164:167], v[228:231], v[76:79]
    s_waitcnt lgkmcnt(7)
    ds_read_b64_tr_b16 a[190:191], v15 offset:8192
    v_mfma_f32_16x16x32_bf16 a[16:19], a[168:171], v[176:179], a[16:19]
    s_waitcnt vmcnt(4)
    ds_read_b64_tr_b16 a[160:161], v8 offset:256
    buffer_load_dwordx4 v1, s[20:23], s34 offen offset:1024 nt lds
    v_mfma_f32_16x16x32_bf16 a[24:27], a[168:171], v[180:183], a[24:27]
    ds_read_b64_tr_b16 a[162:163], v8 offset:8448
    v_add_f32 v24, v24, v244
    v_mfma_f32_16x16x32_bf16 a[20:23], a[172:175], v[176:179], a[20:23]
    v_exp_f32 v247, v247
    v_add_f32 v24, v24, v245
    v_mfma_f32_16x16x32_bf16 a[28:31], a[172:175], v[180:183], a[28:31]
    s_waitcnt lgkmcnt(6)
    v_cvt_pk_bf16_f32 v242, v244, v245
    v_fma_f32 v248, v248, s36, -v21
    v_mfma_f32_16x16x32_bf16 a[32:35], a[176:179], v[176:179], a[32:35]
    ds_read_b64_tr_b16 a[164:165], v9 offset:256
    v_fma_f32 v249, v249, s36, -v21
    v_mfma_f32_16x16x32_bf16 a[40:43], a[176:179], v[180:183], a[40:43]
    ds_read_b64_tr_b16 a[166:167], v9 offset:8448
    v_exp_f32 v248, v248
    v_mfma_f32_16x16x32_bf16 a[36:39], a[180:183], v[176:179], a[36:39]
    v_add_f32 v24, v24, v246
    v_exp_f32 v249, v249
    v_mfma_f32_16x16x32_bf16 a[44:47], a[180:183], v[180:183], a[44:47]
    s_waitcnt lgkmcnt(4)
    v_add_f32 v24, v24, v247
    v_fma_f32 v102, v102, s36, -v18
    v_mfma_f32_16x16x32_bf16 a[48:51], a[184:187], v[176:179], a[48:51]
    ds_read_b64_tr_b16 a[168:169], v10 offset:256
    v_cvt_pk_bf16_f32 v243, v246, v247
    v_fma_f32 v250, v250, s36, -v21
    v_mfma_f32_16x16x32_bf16 a[56:59], a[184:187], v[180:183], a[56:59]
    s_add_u32 s34, s34, 2048
    ds_read_b64_tr_b16 a[170:171], v10 offset:8448
    v_fma_f32 v251, v251, s36, -v21
    v_mfma_f32_16x16x32_bf16 a[52:55], a[188:191], v[176:179], a[52:55]
    s_waitcnt vmcnt(3)
    ds_read_b64_tr_b16 a[172:173], v11 offset:256
    v_exp_f32 v250, v250
    v_mfma_f32_16x16x32_bf16 a[60:63], a[188:191], v[180:183], a[60:63]
    s_waitcnt lgkmcnt(5)
    ds_read_b64_tr_b16 a[174:175], v11 offset:8448
    buffer_load_dwordx4 v0, s[20:23], s34 offen offset:2048 nt lds
    v_mfma_f32_16x16x32_bf16 a[64:67], a[160:163], v[176:179], a[64:67]
    ds_read_b64_tr_b16 a[176:177], v12 offset:256
    v_add_f32 v25, v25, v248
    v_mfma_f32_16x16x32_bf16 a[72:75], a[160:163], v[180:183], a[72:75]
    ds_read_b64_tr_b16 a[178:179], v12 offset:8448
    v_fma_f32 v103, v103, s36, -v18
    v_mfma_f32_16x16x32_bf16 v[80:83], a[160:163], v[224:227], v[80:83]
    ds_read_b64_tr_b16 a[180:181], v13 offset:256
    v_exp_f32 v251, v251
    v_mfma_f32_16x16x32_bf16 v[88:91], a[160:163], v[228:231], v[88:91]
    s_waitcnt lgkmcnt(7)
    ds_read_b64_tr_b16 a[182:183], v13 offset:8448
    v_add_f32 v25, v25, v249
    v_mfma_f32_16x16x32_bf16 a[68:71], a[164:167], v[176:179], a[68:71]
    ds_read_b64_tr_b16 a[184:185], v14 offset:256
    ds_read_b128 v[232:235], v16 offset:6144
    v_cvt_pk_bf16_f32 v244, v248, v249
    v_mfma_f32_16x16x32_bf16 a[76:79], a[164:167], v[180:183], a[76:79]
    ds_read_b64_tr_b16 a[186:187], v14 offset:8448
    v_fma_f32 v252, v252, s36, -v21
    v_mfma_f32_16x16x32_bf16 v[84:87], a[164:167], v[224:227], v[84:87]
    ds_read_b64_tr_b16 a[188:189], v15 offset:256
    v_fma_f32 v253, v253, s36, -v21
    v_mfma_f32_16x16x32_bf16 v[92:95], a[164:167], v[228:231], v[92:95]
    s_waitcnt lgkmcnt(8)
    ds_read_b64_tr_b16 a[190:191], v15 offset:8448
    v_exp_f32 v252, v252
    v_mfma_f32_16x16x32_bf16 a[80:83], a[168:171], v[176:179], a[80:83]
    s_waitcnt vmcnt(11)
    s_barrier
    ds_read_b64_tr_b16 a[160:161], v8 offset:16384
    v_mfma_f32_16x16x32_bf16 a[88:91], a[168:171], v[180:183], a[88:91]
    ds_read_b64_tr_b16 a[162:163], v8 offset:24576
    ds_read_b128 v[236:239], v16 offset:7168
    v_mfma_f32_16x16x32_bf16 a[84:87], a[172:175], v[176:179], a[84:87]
    s_waitcnt vmcnt(3)
    buffer_load_dwordx4 v1, s[20:23], s34 offen offset:3072 nt lds
    v_mfma_f32_16x16x32_bf16 a[92:95], a[172:175], v[180:183], a[92:95]
    s_waitcnt lgkmcnt(8)
    v_add_f32 v25, v25, v250
    v_exp_f32 v253, v253
    v_mfma_f32_16x16x32_bf16 a[96:99], a[176:179], v[176:179], a[96:99]
    ds_read_b64_tr_b16 a[164:165], v9 offset:16384
    v_mfma_f32_16x16x32_bf16 a[104:107], a[176:179], v[180:183], a[104:107]
    ds_read_b64_tr_b16 a[166:167], v9 offset:24576
    v_add_f32 v25, v25, v251
    v_cvt_pk_bf16_f32 v245, v250, v251
    v_mfma_f32_16x16x32_bf16 a[100:103], a[180:183], v[176:179], a[100:103]
    v_fma_f32 v254, v254, s36, -v21
    v_fma_f32 v255, v255, s36, -v21
    v_mfma_f32_16x16x32_bf16 a[108:111], a[180:183], v[180:183], a[108:111]
    s_waitcnt lgkmcnt(5)
    v_exp_f32 v254, v254
    v_mfma_f32_16x16x32_bf16 a[112:115], a[184:187], v[176:179], a[112:115]
    ds_read_b64_tr_b16 a[168:169], v10 offset:16384
    v_add_f32 v25, v25, v252
    v_mfma_f32_16x16x32_bf16 a[120:123], a[184:187], v[180:183], a[120:123]
    ds_read_b64_tr_b16 a[170:171], v10 offset:24576
    v_exp_f32 v255, v255
    v_mfma_f32_16x16x32_bf16 a[116:119], a[188:191], v[176:179], a[116:119]
    ds_read_b64_tr_b16 a[172:173], v11 offset:16384
    v_add_f32 v25, v25, v253
    v_mfma_f32_16x16x32_bf16 a[124:127], a[188:191], v[180:183], a[124:127]
    s_waitcnt lgkmcnt(6)
    ds_read_b64_tr_b16 a[174:175], v11 offset:24576
    v_cvt_pk_bf16_f32 v246, v252, v253
    v_mfma_f32_16x16x32_bf16 a[0:3], a[160:163], v[184:187], a[0:3]
    s_add_u32 m0, s29, 131072
    ds_read_b64_tr_b16 a[176:177], v12 offset:16384
    v_add_f32 v25, v25, v254
    v_add_f32 v25, v25, v255
    v_mfma_f32_16x16x32_bf16 a[8:11], a[160:163], v[188:191], a[8:11]
    s_add_u32 s34, s33, 114688
    ds_read_b64_tr_b16 a[178:179], v12 offset:24576
    v_cvt_pk_bf16_f32 v247, v254, v255
    v_mfma_f32_16x16x32_bf16 v[64:67], a[160:163], v[232:235], v[64:67]
    s_waitcnt lgkmcnt(8)
    s_waitcnt vmcnt(4)
    ds_read_b64_tr_b16 a[180:181], v13 offset:16384
    buffer_load_dwordx4 v0, s[20:23], s34 offen offset:0 nt lds
    v_mfma_f32_16x16x32_bf16 v[72:75], a[160:163], v[236:239], v[72:75]
    s_waitcnt lgkmcnt(7)
    ds_read_b64_tr_b16 a[182:183], v13 offset:24576
    v_add_u32 v28, s45, v16
    v_mfma_f32_16x16x32_bf16 a[4:7], a[164:167], v[184:187], a[4:7]
    ds_read_b64_tr_b16 a[184:185], v14 offset:16384
    v_exp_f32 v102, v102
    v_mfma_f32_16x16x32_bf16 a[12:15], a[164:167], v[188:191], a[12:15]
    ds_read_b64_tr_b16 a[186:187], v14 offset:24576
    ds_write_b128 v28, v[240:243] offset:24576
    v_mfma_f32_16x16x32_bf16 v[68:71], a[164:167], v[232:235], v[68:71]
    ds_read_b64_tr_b16 a[188:189], v15 offset:16384
    v_mfma_f32_16x16x32_bf16 v[76:79], a[164:167], v[236:239], v[76:79]
    s_waitcnt lgkmcnt(8)
    ds_read_b64_tr_b16 a[190:191], v15 offset:24576
    v_add_f32 v22, v22, v100
    v_mfma_f32_16x16x32_bf16 a[16:19], a[168:171], v[184:187], a[16:19]
    ds_read_b64_tr_b16 a[160:161], v8 offset:16640
    ds_write_b128 v28, v[244:247] offset:25600
    v_mfma_f32_16x16x32_bf16 a[24:27], a[168:171], v[188:191], a[24:27]
    ds_read_b64_tr_b16 a[162:163], v8 offset:24832
    v_mfma_f32_16x16x32_bf16 a[20:23], a[172:175], v[184:187], a[20:23]
    v_exp_f32 v103, v103
    v_mfma_f32_16x16x32_bf16 a[28:31], a[172:175], v[188:191], a[28:31]
    s_waitcnt lgkmcnt(8)
    v_add_f32 v22, v22, v101
    v_cvt_pk_bf16_f32 v98, v100, v101
    v_mfma_f32_16x16x32_bf16 a[32:35], a[176:179], v[184:187], a[32:35]
    ds_read_b64_tr_b16 a[164:165], v9 offset:16640
    v_fma_f32 v104, v104, s36, -v19
    v_mfma_f32_16x16x32_bf16 a[40:43], a[176:179], v[188:191], a[40:43]
    s_waitcnt vmcnt(4)
    ds_read_b64_tr_b16 a[166:167], v9 offset:24832
    buffer_load_dwordx4 v1, s[20:23], s34 offen offset:1024 nt lds
    v_mfma_f32_16x16x32_bf16 a[36:39], a[180:183], v[184:187], a[36:39]
    v_fma_f32 v105, v105, s36, -v19
    v_mfma_f32_16x16x32_bf16 a[44:47], a[180:183], v[188:191], a[44:47]
    s_waitcnt lgkmcnt(5)
    v_exp_f32 v104, v104
    v_mfma_f32_16x16x32_bf16 a[48:51], a[184:187], v[184:187], a[48:51]
    ds_read_b64_tr_b16 a[168:169], v10 offset:16640
    v_add_f32 v22, v22, v102
    v_mfma_f32_16x16x32_bf16 a[56:59], a[184:187], v[188:191], a[56:59]
    ds_read_b64_tr_b16 a[170:171], v10 offset:24832
    v_mfma_f32_16x16x32_bf16 a[52:55], a[188:191], v[184:187], a[52:55]
    ds_read_b64_tr_b16 a[172:173], v11 offset:16640
    v_exp_f32 v105, v105
    v_mfma_f32_16x16x32_bf16 a[60:63], a[188:191], v[188:191], a[60:63]
    s_waitcnt lgkmcnt(5)
    ds_read_b64_tr_b16 a[174:175], v11 offset:24832
    v_mfma_f32_16x16x32_bf16 a[64:67], a[160:163], v[184:187], a[64:67]
    ds_read_b64_tr_b16 a[176:177], v12 offset:16640
    v_add_f32 v22, v22, v103
    v_mfma_f32_16x16x32_bf16 a[72:75], a[160:163], v[188:191], a[72:75]
    ds_read_b64_tr_b16 a[178:179], v12 offset:24832
    v_mfma_f32_16x16x32_bf16 v[80:83], a[160:163], v[232:235], v[80:83]
    s_add_u32 s34, s34, 2048
    ds_read_b64_tr_b16 a[180:181], v13 offset:16640
    v_cvt_pk_bf16_f32 v99, v102, v103
    v_mfma_f32_16x16x32_bf16 v[88:91], a[160:163], v[236:239], v[88:91]
    s_waitcnt lgkmcnt(7)
    ds_read_b64_tr_b16 a[182:183], v13 offset:24832
    v_fma_f32 v106, v106, s36, -v19
    v_mfma_f32_16x16x32_bf16 a[68:71], a[164:167], v[184:187], a[68:71]
    s_waitcnt vmcnt(3)
    ds_read_b64_tr_b16 a[184:185], v14 offset:16640
    buffer_load_dwordx4 v0, s[20:23], s34 offen offset:2048 nt lds
    ds_read_b128 v[224:227], v16 offset:8192
    v_mfma_f32_16x16x32_bf16 a[76:79], a[164:167], v[188:191], a[76:79]
    ds_read_b64_tr_b16 a[186:187], v14 offset:24832
    v_fma_f32 v107, v107, s36, -v19
    v_mfma_f32_16x16x32_bf16 v[84:87], a[164:167], v[232:235], v[84:87]
    ds_read_b64_tr_b16 a[188:189], v15 offset:16640
    v_mfma_f32_16x16x32_bf16 v[92:95], a[164:167], v[236:239], v[92:95]
    s_waitcnt lgkmcnt(8)
    ds_read_b64_tr_b16 a[190:191], v15 offset:24832
    v_exp_f32 v106, v106
    v_mfma_f32_16x16x32_bf16 a[80:83], a[168:171], v[184:187], a[80:83]
    s_waitcnt vmcnt(11)
    s_barrier
    ds_read_b64_tr_b16 a[160:161], v8 offset:49152
    v_mfma_f32_16x16x32_bf16 a[88:91], a[168:171], v[188:191], a[88:91]
    ds_read_b64_tr_b16 a[162:163], v8 offset:57344
    ds_read_b128 v[228:231], v16 offset:9216
    v_mfma_f32_16x16x32_bf16 a[84:87], a[172:175], v[184:187], a[84:87]
    v_add_f32 v23, v23, v104
    v_mfma_f32_16x16x32_bf16 a[92:95], a[172:175], v[188:191], a[92:95]
    s_waitcnt lgkmcnt(8)
    v_exp_f32 v107, v107
    v_mfma_f32_16x16x32_bf16 a[96:99], a[176:179], v[184:187], a[96:99]
    ds_read_b64_tr_b16 a[164:165], v9 offset:49152
    v_mfma_f32_16x16x32_bf16 a[104:107], a[176:179], v[188:191], a[104:107]
    ds_read_b64_tr_b16 a[166:167], v9 offset:57344
    v_add_f32 v23, v23, v105
    v_mfma_f32_16x16x32_bf16 a[100:103], a[180:183], v[184:187], a[100:103]
    s_waitcnt vmcnt(3)
    v_cvt_pk_bf16_f32 v100, v104, v105
    v_fma_f32 v108, v108, s36, -v19
    v_mfma_f32_16x16x32_bf16 a[108:111], a[180:183], v[188:191], a[108:111]
    s_waitcnt lgkmcnt(5)
    buffer_load_dwordx4 v1, s[20:23], s34 offen offset:3072 nt lds
    v_mfma_f32_16x16x32_bf16 a[112:115], a[184:187], v[184:187], a[112:115]
    ds_read_b64_tr_b16 a[168:169], v10 offset:49152
    v_mfma_f32_16x16x32_bf16 a[120:123], a[184:187], v[188:191], a[120:123]
    ds_read_b64_tr_b16 a[170:171], v10 offset:57344
    v_fma_f32 v109, v109, s36, -v19
    v_mfma_f32_16x16x32_bf16 a[116:119], a[188:191], v[184:187], a[116:119]
    ds_read_b64_tr_b16 a[172:173], v11 offset:49152
    v_mfma_f32_16x16x32_bf16 a[124:127], a[188:191], v[188:191], a[124:127]
    s_waitcnt lgkmcnt(6)
    ds_read_b64_tr_b16 a[174:175], v11 offset:57344
    v_exp_f32 v108, v108
    s_bitcmp1_b32 s37, 1
    s_cbranch_scc0 L_nores1
    s_mov_b32 s50, 0
    s_call_b64 s[48:49], L_rescale
L_nores1:
    v_mfma_f32_16x16x32_bf16 a[0:3], a[160:163], v[192:195], a[0:3]
    ds_read_b64_tr_b16 a[176:177], v12 offset:49152
    v_mfma_f32_16x16x32_bf16 a[8:11], a[160:163], v[196:199], a[8:11]
    ds_read_b64_tr_b16 a[178:179], v12 offset:57344
    v_add_f32 v23, v23, v106
    v_mfma_f32_16x16x32_bf16 v[64:67], a[160:163], v[224:227], v[64:67]
    s_waitcnt lgkmcnt(8)
    ds_read_b64_tr_b16 a[180:181], v13 offset:49152
    v_mfma_f32_16x16x32_bf16 v[72:75], a[160:163], v[228:231], v[72:75]
    s_waitcnt lgkmcnt(7)
    ds_read_b64_tr_b16 a[182:183], v13 offset:57344
    v_exp_f32 v109, v109
    v_mfma_f32_16x16x32_bf16 a[4:7], a[164:167], v[192:195], a[4:7]
    s_add_u32 m0, s29, 147456
    ds_read_b64_tr_b16 a[184:185], v14 offset:49152
    v_mfma_f32_16x16x32_bf16 a[12:15], a[164:167], v[196:199], a[12:15]
    s_add_u32 s34, s33, 131072
    ds_read_b64_tr_b16 a[186:187], v14 offset:57344
    v_add_f32 v23, v23, v107
    v_mfma_f32_16x16x32_bf16 v[68:71], a[164:167], v[224:227], v[68:71]
    s_waitcnt vmcnt(4)
    ds_read_b64_tr_b16 a[188:189], v15 offset:49152
    buffer_load_dwordx4 v0, s[20:23], s34 offen offset:0 nt lds
    v_mfma_f32_16x16x32_bf16 v[76:79], a[164:167], v[228:231], v[76:79]
    s_waitcnt lgkmcnt(7)
    ds_read_b64_tr_b16 a[190:191], v15 offset:57344
    v_cvt_pk_bf16_f32 v101, v106, v107
    v_mfma_f32_16x16x32_bf16 a[16:19], a[168:171], v[192:195], a[16:19]
    ds_read_b64_tr_b16 a[160:161], v8 offset:49408
    v_mfma_f32_16x16x32_bf16 a[24:27], a[168:171], v[196:199], a[24:27]
    ds_read_b64_tr_b16 a[162:163], v8 offset:57600
    v_xor_b32 v8, 0x10000, v8
    v_mfma_f32_16x16x32_bf16 a[20:23], a[172:175], v[192:195], a[20:23]
    v_fma_f32 v110, v110, s36, -v19
    v_fma_f32 v111, v111, s36, -v19
    v_mfma_f32_16x16x32_bf16 a[28:31], a[172:175], v[196:199], a[28:31]
    s_waitcnt lgkmcnt(6)
    v_exp_f32 v110, v110
    v_mfma_f32_16x16x32_bf16 a[32:35], a[176:179], v[192:195], a[32:35]
    ds_read_b64_tr_b16 a[164:165], v9 offset:49408
    v_add_f32 v23, v23, v108
    v_mfma_f32_16x16x32_bf16 a[40:43], a[176:179], v[196:199], a[40:43]
    ds_read_b64_tr_b16 a[166:167], v9 offset:57600
    v_xor_b32 v9, 0x10000, v9
    v_mfma_f32_16x16x32_bf16 a[36:39], a[180:183], v[192:195], a[36:39]
    v_exp_f32 v111, v111
    v_mfma_f32_16x16x32_bf16 a[44:47], a[180:183], v[196:199], a[44:47]
    s_waitcnt lgkmcnt(4)
    v_add_f32 v23, v23, v109
    v_mfma_f32_16x16x32_bf16 a[48:51], a[184:187], v[192:195], a[48:51]
    ds_read_b64_tr_b16 a[168:169], v10 offset:49408
    v_cvt_pk_bf16_f32 v102, v108, v109
    v_mfma_f32_16x16x32_bf16 a[56:59], a[184:187], v[196:199], a[56:59]
    s_waitcnt vmcnt(4)
    ds_read_b64_tr_b16 a[170:171], v10 offset:57600
    buffer_load_dwordx4 v1, s[20:23], s34 offen offset:1024 nt lds
    v_xor_b32 v10, 0x10000, v10
    v_mfma_f32_16x16x32_bf16 a[52:55], a[188:191], v[192:195], a[52:55]
    ds_read_b64_tr_b16 a[172:173], v11 offset:49408
    v_mfma_f32_16x16x32_bf16 a[60:63], a[188:191], v[196:199], a[60:63]
    s_waitcnt lgkmcnt(5)
    ds_read_b64_tr_b16 a[174:175], v11 offset:57600
    v_xor_b32 v11, 0x10000, v11
    v_mfma_f32_16x16x32_bf16 a[64:67], a[160:163], v[192:195], a[64:67]
    ds_read_b64_tr_b16 a[176:177], v12 offset:49408
    v_fma_f32 v112, v112, s36, -v18
    v_mfma_f32_16x16x32_bf16 a[72:75], a[160:163], v[196:199], a[72:75]
    ds_read_b64_tr_b16 a[178:179], v12 offset:57600
    v_xor_b32 v12, 0x10000, v12
    v_mfma_f32_16x16x32_bf16 v[80:83], a[160:163], v[224:227], v[80:83]
    ds_read_b64_tr_b16 a[180:181], v13 offset:49408
    v_fma_f32 v113, v113, s36, -v18
    v_mfma_f32_16x16x32_bf16 v[88:91], a[160:163], v[228:231], v[88:91]
    s_waitcnt lgkmcnt(7)
    ds_read_b64_tr_b16 a[182:183], v13 offset:57600
    v_xor_b32 v13, 0x10000, v13
    v_mfma_f32_16x16x32_bf16 a[68:71], a[164:167], v[192:195], a[68:71]
    ds_read_b64_tr_b16 a[184:185], v14 offset:49408
    ds_read_b128 v[232:235], v16 offset:10240
    v_mfma_f32_16x16x32_bf16 a[76:79], a[164:167], v[196:199], a[76:79]
    ds_read_b64_tr_b16 a[186:187], v14 offset:57600
    v_xor_b32 v14, 0x10000, v14
    v_mfma_f32_16x16x32_bf16 v[84:87], a[164:167], v[224:227], v[84:87]
    s_add_u32 s34, s34, 2048
    ds_read_b64_tr_b16 a[188:189], v15 offset:49408
    v_mfma_f32_16x16x32_bf16 v[92:95], a[164:167], v[228:231], v[92:95]
    s_waitcnt lgkmcnt(8)
    ds_read_b64_tr_b16 a[190:191], v15 offset:57600
    v_xor_b32 v15, 0x10000, v15
    v_mfma_f32_16x16x32_bf16 a[80:83], a[168:171], v[192:195], a[80:83]
    s_waitcnt vmcnt(3)
    s_waitcnt vmcnt(10)
    s_barrier
    ds_read_b64_tr_b16 a[160:161], v8 offset:0
    buffer_load_dwordx4 v0, s[20:23], s34 offen offset:2048 nt lds
    v_mfma_f32_16x16x32_bf16 a[88:91], a[168:171], v[196:199], a[88:91]
    ds_read_b64_tr_b16 a[162:163], v8 offset:8192
    ds_read_b128 v[236:239], v16 offset:11264
    v_mfma_f32_16x16x32_bf16 a[84:87], a[172:175], v[192:195], a[84:87]
    v_exp_f32 v112, v112
    v_mfma_f32_16x16x32_bf16 a[92:95], a[172:175], v[196:199], a[92:95]
    s_waitcnt lgkmcnt(8)
    v_add_f32 v23, v23, v110
    v_exp_f32 v113, v113
    v_mfma_f32_16x16x32_bf16 a[96:99], a[176:179], v[192:195], a[96:99]
    ds_read_b64_tr_b16 a[164:165], v9 offset:0
    v_mfma_f32_16x16x32_bf16 a[104:107], a[176:179], v[196:199], a[104:107]
    ds_read_b64_tr_b16 a[166:167], v9 offset:8192
    v_add_f32 v23, v23, v111
    v_mfma_f32_16x16x32_bf16 a[100:103], a[180:183], v[192:195], a[100:103]
    v_cvt_pk_bf16_f32 v103, v110, v111
    v_mfma_f32_16x16x32_bf16 a[108:111], a[180:183], v[196:199], a[108:111]
    s_waitcnt lgkmcnt(5)
    v_fma_f32 v114, v114, s36, -v18
    v_fma_f32 v115, v115, s36, -v18
    v_mfma_f32_16x16x32_bf16 a[112:115], a[184:187], v[192:195], a[112:115]
    ds_read_b64_tr_b16 a[168:169], v10 offset:0
    v_mfma_f32_16x16x32_bf16 a[120:123], a[184:187], v[196:199], a[120:123]
    ds_read_b64_tr_b16 a[170:171], v10 offset:8192
    v_exp_f32 v114, v114
    v_mfma_f32_16x16x32_bf16 a[116:119], a[188:191], v[192:195], a[116:119]
    s_waitcnt vmcnt(3)
    ds_read_b64_tr_b16 a[172:173], v11 offset:0
    v_mfma_f32_16x16x32_bf16 a[124:127], a[188:191], v[196:199], a[124:127]
    s_waitcnt lgkmcnt(6)
    ds_read_b64_tr_b16 a[174:175], v11 offset:8192
    buffer_load_dwordx4 v1, s[20:23], s34 offen offset:3072 nt lds
    v_mfma_f32_16x16x32_bf16 a[0:3], a[160:163], v[200:203], a[0:3]
    ds_read_b64_tr_b16 a[176:177], v12 offset:0
    v_add_f32 v22, v22, v112
    v_mfma_f32_16x16x32_bf16 a[8:11], a[160:163], v[204:207], a[8:11]
    ds_read_b64_tr_b16 a[178:179], v12 offset:8192
    v_mfma_f32_16x16x32_bf16 v[64:67], a[160:163], v[232:235], v[64:67]
    s_waitcnt lgkmcnt(8)
    ds_read_b64_tr_b16 a[180:181], v13 offset:0
    v_exp_f32 v115, v115
    v_mfma_f32_16x16x32_bf16 v[72:75], a[160:163], v[236:239], v[72:75]
    s_waitcnt lgkmcnt(7)
    ds_read_b64_tr_b16 a[182:183], v13 offset:8192
    v_mfma_f32_16x16x32_bf16 a[4:7], a[164:167], v[200:203], a[4:7]
    ds_read_b64_tr_b16 a[184:185], v14 offset:0
    v_add_f32 v22, v22, v113
    v_mfma_f32_16x16x32_bf16 a[12:15], a[164:167], v[204:207], a[12:15]
    ds_read_b64_tr_b16 a[186:187], v14 offset:8192
    v_cvt_pk_bf16_f32 v104, v112, v113
    v_mfma_f32_16x16x32_bf16 v[68:71], a[164:167], v[232:235], v[68:71]
    ds_read_b64_tr_b16 a[188:189], v15 offset:0
    v_mfma_f32_16x16x32_bf16 v[76:79], a[164:167], v[236:239], v[76:79]
    s_waitcnt lgkmcnt(7)
    ds_read_b64_tr_b16 a[190:191], v15 offset:8192
    v_fma_f32 v116, v116, s36, -v18
    v_mfma_f32_16x16x32_bf16 a[16:19], a[168:171], v[200:203], a[16:19]
    s_add_u32 m0, s29, 32768
    ds_read_b64_tr_b16 a[160:161], v8 offset:256
    v_fma_f32 v117, v117, s36, -v18
    v_mfma_f32_16x16x32_bf16 a[24:27], a[168:171], v[204:207], a[24:27]
    s_add_u32 s34, s33, 147456
    ds_read_b64_tr_b16 a[162:163], v8 offset:8448
    v_mfma_f32_16x16x32_bf16 a[20:23], a[172:175], v[200:203], a[20:23]
    s_waitcnt vmcnt(4)
    v_exp_f32 v116, v116
    v_mfma_f32_16x16x32_bf16 a[28:31], a[172:175], v[204:207], a[28:31]
    s_waitcnt lgkmcnt(6)
    buffer_load_dwordx4 v0, s[20:23], s34 offen offset:0 nt lds
    v_mfma_f32_16x16x32_bf16 a[32:35], a[176:179], v[200:203], a[32:35]
    ds_read_b64_tr_b16 a[164:165], v9 offset:256
    v_add_f32 v22, v22, v114
    v_mfma_f32_16x16x32_bf16 a[40:43], a[176:179], v[204:207], a[40:43]
    ds_read_b64_tr_b16 a[166:167], v9 offset:8448
    v_mfma_f32_16x16x32_bf16 a[36:39], a[180:183], v[200:203], a[36:39]
    v_exp_f32 v117, v117
    v_mfma_f32_16x16x32_bf16 a[44:47], a[180:183], v[204:207], a[44:47]
    s_waitcnt lgkmcnt(4)
    v_add_f32 v22, v22, v115
    v_cvt_pk_bf16_f32 v105, v114, v115
    v_mfma_f32_16x16x32_bf16 a[48:51], a[184:187], v[200:203], a[48:51]
    ds_read_b64_tr_b16 a[168:169], v10 offset:256
    v_fma_f32 v118, v118, s36, -v18
    v_mfma_f32_16x16x32_bf16 a[56:59], a[184:187], v[204:207], a[56:59]
    ds_read_b64_tr_b16 a[170:171], v10 offset:8448
    v_mfma_f32_16x16x32_bf16 a[52:55], a[188:191], v[200:203], a[52:55]
    ds_read_b64_tr_b16 a[172:173], v11 offset:256
    v_fma_f32 v119, v119, s36, -v18
    v_mfma_f32_16x16x32_bf16 a[60:63], a[188:191], v[204:207], a[60:63]
    s_waitcnt lgkmcnt(5)
    ds_read_b64_tr_b16 a[174:175], v11 offset:8448
    v_mfma_f32_16x16x32_bf16 a[64:67], a[160:163], v[200:203], a[64:67]
    ds_read_b64_tr_b16 a[176:177], v12 offset:256
    v_exp_f32 v118, v118
    v_mfma_f32_16x16x32_bf16 a[72:75], a[160:163], v[204:207], a[72:75]
    ds_read_b64_tr_b16 a[178:179], v12 offset:8448
    v_mfma_f32_16x16x32_bf16 v[80:83], a[160:163], v[232:235], v[80:83]
    s_waitcnt vmcnt(4)
    ds_read_b64_tr_b16 a[180:181], v13 offset:256
    buffer_load_dwordx4 v1, s[20:23], s34 offen offset:1024 nt lds
    v_mfma_f32_16x16x32_bf16 v[88:91], a[160:163], v[236:239], v[88:91]
    s_waitcnt lgkmcnt(7)
    ds_read_b64_tr_b16 a[182:183], v13 offset:8448
    v_add_f32 v22, v22, v116
    v_mfma_f32_16x16x32_bf16 a[68:71], a[164:167], v[200:203], a[68:71]
    ds_read_b64_tr_b16 a[184:185], v14 offset:256
    ds_read_b128 v[224:227], v16 offset:12288
    v_mfma_f32_16x16x32_bf16 a[76:79], a[164:167], v[204:207], a[76:79]
    ds_read_b64_tr_b16 a[186:187], v14 offset:8448
    v_mfma_f32_16x16x32_bf16 v[84:87], a[164:167], v[232:235], v[84:87]
    ds_read_b64_tr_b16 a[188:189], v15 offset:256
    v_exp_f32 v119, v119
    v_mfma_f32_16x16x32_bf16 v[92:95], a[164:167], v[236:239], v[92:95]
    s_waitcnt lgkmcnt(8)
    ds_read_b64_tr_b16 a[190:191], v15 offset:8448
    v_mfma_f32_16x16x32_bf16 a[80:83], a[168:171], v[200:203], a[80:83]
    s_waitcnt vmcnt(10)
    s_barrier
    ds_read_b64_tr_b16 a[160:161], v8 offset:16384
    v_mfma_f32_16x16x32_bf16 a[88:91], a[168:171], v[204:207], a[88:91]
    ds_read_b64_tr_b16 a[162:163], v8 offset:24576
    ds_read_b128 v[228:231], v16 offset:13312
    v_mfma_f32_16x16x32_bf16 a[84:87], a[172:175], v[200:203], a[84:87]
    v_add_f32 v22, v22, v117
    v_cvt_pk_bf16_f32 v106, v116, v117
    v_mfma_f32_16x16x32_bf16 a[92:95], a[172:175], v[204:207], a[92:95]
    s_waitcnt lgkmcnt(8)
    v_fma_f32 v120, v120, s36, -v19
    v_fma_f32 v121, v121, s36, -v19
    v_mfma_f32_16x16x32_bf16 a[96:99], a[176:179], v[200:203], a[96:99]
    s_add_u32 s34, s34, 2048
    ds_read_b64_tr_b16 a[164:165], v9 offset:16384
    v_mfma_f32_16x16x32_bf16 a[104:107], a[176:179], v[204:207], a[104:107]
    s_waitcnt vmcnt(3)
    ds_read_b64_tr_b16 a[166:167], v9 offset:24576
A_stub8:
    s_cbranch_execz A_stub12
    buffer_load_dwordx4 v0, s[20:23], s34 offen offset:2048 nt lds
    v_mfma_f32_16x16x32_bf16 a[100:103], a[180:183], v[200:203], a[100:103]
    v_exp_f32 v120, v120
    v_mfma_f32_16x16x32_bf16 a[108:111], a[180:183], v[204:207], a[108:111]
    s_waitcnt lgkmcnt(5)
    v_add_f32 v22, v22, v118
    v_mfma_f32_16x16x32_bf16 a[112:115], a[184:187], v[200:203], a[112:115]
    ds_read_b64_tr_b16 a[168:169], v10 offset:16384
    v_exp_f32 v121, v121
    v_mfma_f32_16x16x32_bf16 a[120:123], a[184:187], v[204:207], a[120:123]
    ds_read_b64_tr_b16 a[170:171], v10 offset:24576
    v_mfma_f32_16x16x32_bf16 a[116:119], a[188:191], v[200:203], a[116:119]
    ds_read_b64_tr_b16 a[172:173], v11 offset:16384
    v_add_f32 v22, v22, v119
    v_mfma_f32_16x16x32_bf16 a[124:127], a[188:191], v[204:207], a[124:127]
    s_waitcnt lgkmcnt(6)
    ds_read_b64_tr_b16 a[174:175], v11 offset:24576
    v_cvt_pk_bf16_f32 v107, v118, v119
    v_mfma_f32_16x16x32_bf16 a[0:3], a[160:163], v[208:211], a[0:3]
    ds_read_b64_tr_b16 a[176:177], v12 offset:16384
    v_fma_f32 v122, v122, s36, -v19
    v_mfma_f32_16x16x32_bf16 a[8:11], a[160:163], v[212:215], a[8:11]
    ds_read_b64_tr_b16 a[178:179], v12 offset:24576
    v_mfma_f32_16x16x32_bf16 v[64:67], a[160:163], v[224:227], v[64:67]
    s_waitcnt lgkmcnt(8)
    ds_read_b64_tr_b16 a[180:181], v13 offset:16384
    v_fma_f32 v123, v123, s36, -v19
    v_mfma_f32_16x16x32_bf16 v[72:75], a[160:163], v[228:231], v[72:75]
    s_waitcnt lgkmcnt(7)
    ds_read_b64_tr_b16 a[182:183], v13 offset:24576
    v_mfma_f32_16x16x32_bf16 a[4:7], a[164:167], v[208:211], a[4:7]
    s_waitcnt vmcnt(3)
    ds_read_b64_tr_b16 a[184:185], v14 offset:16384
    buffer_load_dwordx4 v1, s[20:23], s34 offen offset:3072 nt lds
    v_mfma_f32_16x16x32_bf16 a[12:15], a[164:167], v[212:215], a[12:15]
    ds_read_b64_tr_b16 a[186:187], v14 offset:24576
    v_exp_f32 v122, v122
    v_mfma_f32_16x16x32_bf16 v[68:71], a[164:167], v[224:227], v[68:71]
    ds_read_b64_tr_b16 a[188:189], v15 offset:16384
    v_mfma_f32_16x16x32_bf16 v[76:79], a[164:167], v[228:231], v[76:79]
    s_waitcnt lgkmcnt(7)
    ds_read_b64_tr_b16 a[190:191], v15 offset:24576
    v_add_f32 v23, v23, v120
    v_mfma_f32_16x16x32_bf16 a[16:19], a[168:171], v[208:211], a[16:19]
    ds_read_b64_tr_b16 a[160:161], v8 offset:16640
    v_mfma_f32_16x16x32_bf16 a[24:27], a[168:171], v[212:215], a[24:27]
    ds_read_b64_tr_b16 a[162:163], v8 offset:24832
    v_exp_f32 v123, v123
    v_mfma_f32_16x16x32_bf16 a[20:23], a[172:175], v[208:211], a[20:23]
    v_add_f32 v23, v23, v121
    v_mfma_f32_16x16x32_bf16 a[28:31], a[172:175], v[212:215], a[28:31]
    s_waitcnt lgkmcnt(6)
    v_cvt_pk_bf16_f32 v108, v120, v121
    v_fma_f32 v124, v124, s36, -v19
    v_mfma_f32_16x16x32_bf16 a[32:35], a[176:179], v[208:211], a[32:35]
    ds_read_b64_tr_b16 a[164:165], v9 offset:16640
    v_fma_f32 v125, v125, s36, -v19
    v_mfma_f32_16x16x32_bf16 a[40:43], a[176:179], v[212:215], a[40:43]
    s_add_u32 m0, s29, 49152
    ds_read_b64_tr_b16 a[166:167], v9 offset:24832
    v_mfma_f32_16x16x32_bf16 a[36:39], a[180:183], v[208:211], a[36:39]
    s_add_u32 s34, s33, 163840
    v_exp_f32 v124, v124
    v_mfma_f32_16x16x32_bf16 a[44:47], a[180:183], v[212:215], a[44:47]
    s_waitcnt lgkmcnt(4)
    v_add_f32 v23, v23, v122
    v_mfma_f32_16x16x32_bf16 a[48:51], a[184:187], v[208:211], a[48:51]
    s_waitcnt vmcnt(4)
    ds_read_b64_tr_b16 a[168:169], v10 offset:16640
    buffer_load_dwordx4 v0, s[20:23], s34 offen offset:0 nt lds
    v_mfma_f32_16x16x32_bf16 a[56:59], a[184:187], v[212:215], a[56:59]
    ds_read_b64_tr_b16 a[170:171], v10 offset:24832
    v_exp_f32 v125, v125
    v_mfma_f32_16x16x32_bf16 a[52:55], a[188:191], v[208:211], a[52:55]
    ds_read_b64_tr_b16 a[172:173], v11 offset:16640
    v_mfma_f32_16x16x32_bf16 a[60:63], a[188:191], v[212:215], a[60:63]
    s_waitcnt lgkmcnt(5)
    ds_read_b64_tr_b16 a[174:175], v11 offset:24832
    v_add_f32 v23, v23, v123
    v_mfma_f32_16x16x32_bf16 a[64:67], a[160:163], v[208:211], a[64:67]
    ds_read_b64_tr_b16 a[176:177], v12 offset:16640
    v_cvt_pk_bf16_f32 v109, v122, v123
    v_mfma_f32_16x16x32_bf16 a[72:75], a[160:163], v[212:215], a[72:75]
    ds_read_b64_tr_b16 a[178:179], v12 offset:24832
    v_mfma_f32_16x16x32_bf16 v[80:83], a[160:163], v[224:227], v[80:83]
    ds_read_b64_tr_b16 a[180:181], v13 offset:16640
    v_fma_f32 v126, v126, s36, -v19
    v_mfma_f32_16x16x32_bf16 v[88:91], a[160:163], v[228:231], v[88:91]
    s_waitcnt lgkmcnt(7)
    ds_read_b64_tr_b16 a[182:183], v13 offset:24832
    v_fma_f32 v127, v127, s36, -v19
    v_mfma_f32_16x16x32_bf16 a[68:71], a[164:167], v[208:211], a[68:71]
    ds_read_b64_tr_b16 a[184:185], v14 offset:16640
    ds_read_b128 v[232:235], v16 offset:14336
    v_mfma_f32_16x16x32_bf16 a[76:79], a[164:167], v[212:215], a[76:79]
    ds_read_b64_tr_b16 a[186:187], v14 offset:24832
    v_mfma_f32_16x16x32_bf16 v[84:87], a[164:167], v[224:227], v[84:87]
    s_waitcnt vmcnt(4)
    ds_read_b64_tr_b16 a[188:189], v15 offset:16640
    v_exp_f32 v126, v126
    v_mfma_f32_16x16x32_bf16 v[92:95], a[164:167], v[228:231], v[92:95]
    s_waitcnt lgkmcnt(8)
    ds_read_b64_tr_b16 a[190:191], v15 offset:24832
    buffer_load_dwordx4 v1, s[20:23], s34 offen offset:1024 nt lds
    v_mfma_f32_16x16x32_bf16 a[80:83], a[168:171], v[208:211], a[80:83]
    s_waitcnt vmcnt(10)
    s_barrier
    ds_read_b64_tr_b16 a[160:161], v8 offset:32768
    v_mfma_f32_16x16x32_bf16 a[88:91], a[168:171], v[212:215], a[88:91]
    ds_read_b64_tr_b16 a[162:163], v8 offset:40960
    ds_read_b128 v[236:239], v16 offset:15360
    v_mfma_f32_16x16x32_bf16 a[84:87], a[172:175], v[208:211], a[84:87]
    v_add_f32 v23, v23, v124
    v_mfma_f32_16x16x32_bf16 a[92:95], a[172:175], v[212:215], a[92:95]
    s_waitcnt lgkmcnt(8)
    v_exp_f32 v127, v127
    v_mfma_f32_16x16x32_bf16 a[96:99], a[176:179], v[208:211], a[96:99]
    ds_read_b64_tr_b16 a[164:165], v9 offset:32768
    v_mfma_f32_16x16x32_bf16 a[104:107], a[176:179], v[212:215], a[104:107]
    ds_read_b64_tr_b16 a[166:167], v9 offset:40960
    v_add_f32 v23, v23, v125
    v_mfma_f32_16x16x32_bf16 a[100:103], a[180:183], v[208:211], a[100:103]
    v_cvt_pk_bf16_f32 v110, v124, v125
    v_fma_f32 v128, v128, s36, -v18
    v_mfma_f32_16x16x32_bf16 a[108:111], a[180:183], v[212:215], a[108:111]
    s_waitcnt lgkmcnt(5)
    v_fma_f32 v129, v129, s36, -v18
    v_mfma_f32_16x16x32_bf16 a[112:115], a[184:187], v[208:211], a[112:115]
    ds_read_b64_tr_b16 a[168:169], v10 offset:32768
    v_exp_f32 v128, v128
    v_mfma_f32_16x16x32_bf16 a[120:123], a[184:187], v[212:215], a[120:123]
    s_add_u32 s34, s34, 2048
    ds_read_b64_tr_b16 a[170:171], v10 offset:40960
    v_mfma_f32_16x16x32_bf16 a[116:119], a[188:191], v[208:211], a[116:119]
    s_waitcnt vmcnt(3)
    ds_read_b64_tr_b16 a[172:173], v11 offset:32768
    buffer_load_dwordx4 v0, s[20:23], s34 offen offset:2048 nt lds
    v_mfma_f32_16x16x32_bf16 a[124:127], a[188:191], v[212:215], a[124:127]
    s_waitcnt lgkmcnt(6)
    ds_read_b64_tr_b16 a[174:175], v11 offset:40960
    v_add_f32 v23, v23, v126
    v_mfma_f32_16x16x32_bf16 a[0:3], a[160:163], v[216:219], a[0:3]
    ds_read_b64_tr_b16 a[176:177], v12 offset:32768
    v_mfma_f32_16x16x32_bf16 a[8:11], a[160:163], v[220:223], a[8:11]
    ds_read_b64_tr_b16 a[178:179], v12 offset:40960
    v_exp_f32 v129, v129
    v_mfma_f32_16x16x32_bf16 v[64:67], a[160:163], v[232:235], v[64:67]
    s_waitcnt lgkmcnt(8)
    ds_read_b64_tr_b16 a[180:181], v13 offset:32768
    v_mfma_f32_16x16x32_bf16 v[72:75], a[160:163], v[236:239], v[72:75]
    s_waitcnt lgkmcnt(7)
    ds_read_b64_tr_b16 a[182:183], v13 offset:40960
    v_add_f32 v23, v23, v127
    v_mfma_f32_16x16x32_bf16 a[4:7], a[164:167], v[216:219], a[4:7]
    ds_read_b64_tr_b16 a[184:185], v14 offset:32768
    v_mfma_f32_16x16x32_bf16 a[12:15], a[164:167], v[220:223], a[12:15]
    ds_read_b64_tr_b16 a[186:187], v14 offset:40960
    v_cvt_pk_bf16_f32 v111, v126, v127
    v_mfma_f32_16x16x32_bf16 v[68:71], a[164:167], v[232:235], v[68:71]
    ds_read_b64_tr_b16 a[188:189], v15 offset:32768
    v_fma_f32 v130, v130, s36, -v18
    v_mfma_f32_16x16x32_bf16 v[76:79], a[164:167], v[236:239], v[76:79]
    s_waitcnt lgkmcnt(7)
    ds_read_b64_tr_b16 a[190:191], v15 offset:40960
    v_fma_f32 v131, v131, s36, -v18
    v_mfma_f32_16x16x32_bf16 a[16:19], a[168:171], v[216:219], a[16:19]
    ds_read_b64_tr_b16 a[160:161], v8 offset:33024
    v_mfma_f32_16x16x32_bf16 a[24:27], a[168:171], v[220:223], a[24:27]
    s_waitcnt vmcnt(3)
    ds_read_b64_tr_b16 a[162:163], v8 offset:41216
    buffer_load_dwordx4 v1, s[20:23], s34 offen offset:3072 nt lds
    v_mfma_f32_16x16x32_bf16 a[20:23], a[172:175], v[216:219], a[20:23]
    v_exp_f32 v130, v130
    v_mfma_f32_16x16x32_bf16 a[28:31], a[172:175], v[220:223], a[28:31]
    s_waitcnt lgkmcnt(6)
    v_add_f32 v22, v22, v128
    v_mfma_f32_16x16x32_bf16 a[32:35], a[176:179], v[216:219], a[32:35]
    ds_read_b64_tr_b16 a[164:165], v9 offset:33024
    v_exp_f32 v131, v131
    v_mfma_f32_16x16x32_bf16 a[40:43], a[176:179], v[220:223], a[40:43]
    ds_read_b64_tr_b16 a[166:167], v9 offset:41216
    v_mfma_f32_16x16x32_bf16 a[36:39], a[180:183], v[216:219], a[36:39]
    v_add_f32 v22, v22, v129
    v_cvt_pk_bf16_f32 v112, v128, v129
    v_mfma_f32_16x16x32_bf16 a[44:47], a[180:183], v[220:223], a[44:47]
    s_waitcnt lgkmcnt(4)
    v_fma_f32 v132, v132, s36, -v18
    v_fma_f32 v133, v133, s36, -v18
    v_mfma_f32_16x16x32_bf16 a[48:51], a[184:187], v[216:219], a[48:51]
    ds_read_b64_tr_b16 a[168:169], v10 offset:33024
    v_mfma_f32_16x16x32_bf16 a[56:59], a[184:187], v[220:223], a[56:59]
    ds_read_b64_tr_b16 a[170:171], v10 offset:41216
    v_exp_f32 v132, v132
    v_mfma_f32_16x16x32_bf16 a[52:55], a[188:191], v[216:219], a[52:55]
    s_add_u32 m0, s29, 65536
    ds_read_b64_tr_b16 a[172:173], v11 offset:33024
    v_mfma_f32_16x16x32_bf16 a[60:63], a[188:191], v[220:223], a[60:63]
    s_waitcnt lgkmcnt(5)
    ds_read_b64_tr_b16 a[174:175], v11 offset:41216
    v_mfma_f32_16x16x32_bf16 a[64:67], a[160:163], v[216:219], a[64:67]
    s_add_u32 s34, s33, 180224
    ds_read_b64_tr_b16 a[176:177], v12 offset:33024
    v_add_f32 v22, v22, v130
    v_mfma_f32_16x16x32_bf16 a[72:75], a[160:163], v[220:223], a[72:75]
    s_waitcnt vmcnt(4)
    ds_read_b64_tr_b16 a[178:179], v12 offset:41216
    buffer_load_dwordx4 v0, s[20:23], s34 offen offset:0 nt lds
    v_mfma_f32_16x16x32_bf16 v[80:83], a[160:163], v[232:235], v[80:83]
    ds_read_b64_tr_b16 a[180:181], v13 offset:33024
    v_mfma_f32_16x16x32_bf16 v[88:91], a[160:163], v[236:239], v[88:91]
    s_waitcnt lgkmcnt(7)
    ds_read_b64_tr_b16 a[182:183], v13 offset:41216
    v_exp_f32 v133, v133
    v_mfma_f32_16x16x32_bf16 a[68:71], a[164:167], v[216:219], a[68:71]
    ds_read_b64_tr_b16 a[184:185], v14 offset:33024
    ds_read_b128 v[224:227], v16 offset:16384
    v_mfma_f32_16x16x32_bf16 a[76:79], a[164:167], v[220:223], a[76:79]
    ds_read_b64_tr_b16 a[186:187], v14 offset:41216
    v_mfma_f32_16x16x32_bf16 v[84:87], a[164:167], v[232:235], v[84:87]
    ds_read_b64_tr_b16 a[188:189], v15 offset:33024
    v_add_f32 v22, v22, v131
    v_mfma_f32_16x16x32_bf16 v[92:95], a[164:167], v[236:239], v[92:95]
    s_waitcnt lgkmcnt(8)
    ds_read_b64_tr_b16 a[190:191], v15 offset:41216
    v_cvt_pk_bf16_f32 v113, v130, v131
    v_mfma_f32_16x16x32_bf16 a[80:83], a[168:171], v[216:219], a[80:83]
    s_waitcnt vmcnt(9)
    s_barrier
    ds_read_b64_tr_b16 a[160:161], v8 offset:49152
    v_mfma_f32_16x16x32_bf16 a[88:91], a[168:171], v[220:223], a[88:91]
    ds_read_b64_tr_b16 a[162:163], v8 offset:57344
    ds_read_b128 v[228:231], v16 offset:17408
    v_mfma_f32_16x16x32_bf16 a[84:87], a[172:175], v[216:219], a[84:87]
    v_fma_f32 v134, v134, s36, -v18
    v_fma_f32 v135, v135, s36, -v18
    v_mfma_f32_16x16x32_bf16 a[92:95], a[172:175], v[220:223], a[92:95]
    s_waitcnt lgkmcnt(8)
    v_exp_f32 v134, v134
    v_mfma_f32_16x16x32_bf16 a[96:99], a[176:179], v[216:219], a[96:99]
    s_waitcnt vmcnt(4)
    ds_read_b64_tr_b16 a[164:165], v9 offset:49152
    buffer_load_dwordx4 v1, s[20:23], s34 offen offset:1024 nt lds
    v_mfma_f32_16x16x32_bf16 a[104:107], a[176:179], v[220:223], a[104:107]
    ds_read_b64_tr_b16 a[166:167], v9 offset:57344
    v_mfma_f32_16x16x32_bf16 a[100:103], a[180:183], v[216:219], a[100:103]
    v_add_f32 v22, v22, v132
    v_mfma_f32_16x16x32_bf16 a[108:111], a[180:183], v[220:223], a[108:111]
    s_waitcnt lgkmcnt(5)
    v_exp_f32 v135, v135
    v_mfma_f32_16x16x32_bf16 a[112:115], a[184:187], v[216:219], a[112:115]
    ds_read_b64_tr_b16 a[168:169], v10 offset:49152
    v_add_f32 v22, v22, v133
    v_mfma_f32_16x16x32_bf16 a[120:123], a[184:187], v[220:223], a[120:123]
    ds_read_b64_tr_b16 a[170:171], v10 offset:57344
    v_cvt_pk_bf16_f32 v114, v132, v133
    v_mfma_f32_16x16x32_bf16 a[116:119], a[188:191], v[216:219], a[116:119]
    ds_read_b64_tr_b16 a[172:173], v11 offset:49152
    v_fma_f32 v136, v136, s36, -v19
    v_mfma_f32_16x16x32_bf16 a[124:127], a[188:191], v[220:223], a[124:127]
    s_waitcnt lgkmcnt(6)
    ds_read_b64_tr_b16 a[174:175], v11 offset:57344
    s_bitcmp1_b32 s37, 2
    s_cbranch_scc0 L_nores2
    s_mov_b32 s50, 8
    s_call_b64 s[48:49], L_rescale
L_nores2:
    v_mfma_f32_16x16x32_bf16 a[0:3], a[160:163], v[32:35], a[0:3]
    ds_read_b64_tr_b16 a[176:177], v12 offset:49152
    v_fma_f32 v137, v137, s36, -v19
    v_mfma_f32_16x16x32_bf16 a[8:11], a[160:163], v[36:39], a[8:11]
    s_add_u32 s34, s34, 2048
    ds_read_b64_tr_b16 a[178:179], v12 offset:57344
    v_mfma_f32_16x16x32_bf16 v[64:67], a[160:163], v[224:227], v[64:67]
    s_waitcnt lgkmcnt(8)
    s_waitcnt vmcnt(3)
    ds_read_b64_tr_b16 a[180:181], v13 offset:49152
    v_exp_f32 v136, v136
    v_mfma_f32_16x16x32_bf16 v[72:75], a[160:163], v[228:231], v[72:75]
    s_waitcnt lgkmcnt(7)
    ds_read_b64_tr_b16 a[182:183], v13 offset:57344
    buffer_load_dwordx4 v0, s[20:23], s34 offen offset:2048 nt lds
    v_mfma_f32_16x16x32_bf16 a[4:7], a[164:167], v[32:35], a[4:7]
    ds_read_b64_tr_b16 a[184:185], v14 offset:49152
    v_mfma_f32_16x16x32_bf16 a[12:15], a[164:167], v[36:39], a[12:15]
    ds_read_b64_tr_b16 a[186:187], v14 offset:57344
    v_add_f32 v22, v22, v134
    v_mfma_f32_16x16x32_bf16 v[68:71], a[164:167], v[224:227], v[68:71]
    ds_read_b64_tr_b16 a[188:189], v15 offset:49152
    v_mfma_f32_16x16x32_bf16 v[76:79], a[164:167], v[228:231], v[76:79]
    s_waitcnt lgkmcnt(7)
    ds_read_b64_tr_b16 a[190:191], v15 offset:57344
    v_exp_f32 v137, v137
    v_mfma_f32_16x16x32_bf16 a[16:19], a[168:171], v[32:35], a[16:19]
    ds_read_b64_tr_b16 a[160:161], v8 offset:49408
    v_mfma_f32_16x16x32_bf16 a[24:27], a[168:171], v[36:39], a[24:27]
    ds_read_b64_tr_b16 a[162:163], v8 offset:57600
    v_xor_b32 v8, 0x10000, v8
    v_mfma_f32_16x16x32_bf16 a[20:23], a[172:175], v[32:35], a[20:23]
    v_add_f32 v22, v22, v135
    v_cvt_pk_bf16_f32 v115, v134, v135
    v_mfma_f32_16x16x32_bf16 a[28:31], a[172:175], v[36:39], a[28:31]
    s_waitcnt lgkmcnt(6)
    v_fma_f32 v138, v138, s36, -v19
    v_fma_f32 v139, v139, s36, -v19
    v_mfma_f32_16x16x32_bf16 a[32:35], a[176:179], v[32:35], a[32:35]
    ds_read_b64_tr_b16 a[164:165], v9 offset:49408
    v_mfma_f32_16x16x32_bf16 a[40:43], a[176:179], v[36:39], a[40:43]
    ds_read_b64_tr_b16 a[166:167], v9 offset:57600
    v_xor_b32 v9, 0x10000, v9
    v_mfma_f32_16x16x32_bf16 a[36:39], a[180:183], v[32:35], a[36:39]
    s_waitcnt vmcnt(3)
    buffer_load_dwordx4 v1, s[20:23], s34 offen offset:3072 nt lds
    v_mfma_f32_16x16x32_bf16 a[44:47], a[180:183], v[36:39], a[44:47]
    s_waitcnt lgkmcnt(4)
    v_exp_f32 v138, v138
    v_mfma_f32_16x16x32_bf16 a[48:51], a[184:187], v[32:35], a[48:51]
    ds_read_b64_tr_b16 a[168:169], v10 offset:49408
    v_add_f32 v23, v23, v136
    v_mfma_f32_16x16x32_bf16 a[56:59], a[184:187], v[36:39], a[56:59]
    ds_read_b64_tr_b16 a[170:171], v10 offset:57600
    v_xor_b32 v10, 0x10000, v10
    v_mfma_f32_16x16x32_bf16 a[52:55], a[188:191], v[32:35], a[52:55]
    ds_read_b64_tr_b16 a[172:173], v11 offset:49408
    v_mfma_f32_16x16x32_bf16 a[60:63], a[188:191], v[36:39], a[60:63]
    s_waitcnt lgkmcnt(5)
    ds_read_b64_tr_b16 a[174:175], v11 offset:57600
    v_xor_b32 v11, 0x10000, v11
    v_mfma_f32_16x16x32_bf16 a[64:67], a[160:163], v[32:35], a[64:67]
    ds_read_b64_tr_b16 a[176:177], v12 offset:49408
    v_exp_f32 v139, v139
    v_mfma_f32_16x16x32_bf16 a[72:75], a[160:163], v[36:39], a[72:75]
    ds_read_b64_tr_b16 a[178:179], v12 offset:57600
    v_xor_b32 v12, 0x10000, v12
    v_mfma_f32_16x16x32_bf16 v[80:83], a[160:163], v[224:227], v[80:83]
    ds_read_b64_tr_b16 a[180:181], v13 offset:49408
    v_mfma_f32_16x16x32_bf16 v[88:91], a[160:163], v[228:231], v[88:91]
    s_waitcnt lgkmcnt(7)
    ds_read_b64_tr_b16 a[182:183], v13 offset:57600
    v_xor_b32 v13, 0x10000, v13
    v_mfma_f32_16x16x32_bf16 a[68:71], a[164:167], v[32:35], a[68:71]
    s_add_u32 m0, s29, 98304
    ds_read_b64_tr_b16 a[184:185], v14 offset:49408
    ds_read_b128 v[232:235], v16 offset:18432
    v_mfma_f32_16x16x32_bf16 a[76:79], a[164:167], v[36:39], a[76:79]
    s_add_u32 s34, s33, 196608
    ds_read_b64_tr_b16 a[186:187], v14 offset:57600
    v_xor_b32 v14, 0x10000, v14
    v_mfma_f32_16x16x32_bf16 v[84:87], a[164:167], v[224:227], v[84:87]
    s_waitcnt vmcnt(4)
    ds_read_b64_tr_b16 a[188:189], v15 offset:49408
    buffer_load_dwordx4 v0, s[20:23], s34 offen offset:0 nt lds
    v_mfma_f32_16x16x32_bf16 v[92:95], a[164:167], v[228:231], v[92:95]
    s_waitcnt lgkmcnt(8)
    ds_read_b64_tr_b16 a[190:191], v15 offset:57600
    v_xor_b32 v15, 0x10000, v15
    v_mfma_f32_16x16x32_bf16 a[80:83], a[168:171], v[32:35], a[80:83]
    s_waitcnt vmcnt(9)
    s_barrier
    ds_read_b64_tr_b16 a[160:161], v8 offset:0
    v_mfma_f32_16x16x32_bf16 a[88:91], a[168:171], v[36:39], a[88:91]
    ds_read_b64_tr_b16 a[162:163], v8 offset:8192
    ds_read_b128 v[236:239], v16 offset:19456
    v_mfma_f32_16x16x32_bf16 a[84:87], a[172:175], v[32:35], a[84:87]
    v_add_f32 v23, v23, v137
    v_cvt_pk_bf16_f32 v116, v136, v137
    v_mfma_f32_16x16x32_bf16 a[92:95], a[172:175], v[36:39], a[92:95]
    s_waitcnt lgkmcnt(8)
    v_fma_f32 v140, v140, s36, -v19
    v_mfma_f32_16x16x32_bf16 a[96:99], a[176:179], v[32:35], a[96:99]
    ds_read_b64_tr_b16 a[164:165], v9 offset:0
    v_fma_f32 v141, v141, s36, -v19
    v_mfma_f32_16x16x32_bf16 a[104:107], a[176:179], v[36:39], a[104:107]
    ds_read_b64_tr_b16 a[166:167], v9 offset:8192
    v_mfma_f32_16x16x32_bf16 a[100:103], a[180:183], v[32:35], a[100:103]
    v_exp_f32 v140, v140
    v_add_f32 v23, v23, v138
    v_mfma_f32_16x16x32_bf16 a[108:111], a[180:183], v[36:39], a[108:111]
    s_waitcnt lgkmcnt(5)
    v_exp_f32 v141, v141
    v_mfma_f32_16x16x32_bf16 a[112:115], a[184:187], v[32:35], a[112:115]
    ds_read_b64_tr_b16 a[168:169], v10 offset:0
    v_mfma_f32_16x16x32_bf16 a[120:123], a[184:187], v[36:39], a[120:123]
    s_waitcnt vmcnt(4)
    ds_read_b64_tr_b16 a[170:171], v10 offset:8192
    buffer_load_dwordx4 v1, s[20:23], s34 offen offset:1024 nt lds
    v_mfma_f32_16x16x32_bf16 a[116:119], a[188:191], v[32:35], a[116:119]
    ds_read_b64_tr_b16 a[172:173], v11 offset:0
    v_add_f32 v23, v23, v139
    v_mfma_f32_16x16x32_bf16 a[124:127], a[188:191], v[36:39], a[124:127]
    s_waitcnt lgkmcnt(6)
    ds_read_b64_tr_b16 a[174:175], v11 offset:8192
    v_mfma_f32_16x16x32_bf16 a[0:3], a[160:163], v[40:43], a[0:3]
    ds_read_b64_tr_b16 a[176:177], v12 offset:0
    v_cvt_pk_bf16_f32 v117, v138, v139
    v_mfma_f32_16x16x32_bf16 a[8:11], a[160:163], v[44:47], a[8:11]
    ds_read_b64_tr_b16 a[178:179], v12 offset:8192
    v_fma_f32 v142, v142, s36, -v19
    v_mfma_f32_16x16x32_bf16 v[64:67], a[160:163], v[232:235], v[64:67]
    s_waitcnt lgkmcnt(8)
    ds_read_b64_tr_b16 a[180:181], v13 offset:0
    v_fma_f32 v143, v143, s36, -v19
    v_mfma_f32_16x16x32_bf16 v[72:75], a[160:163], v[236:239], v[72:75]
    s_waitcnt lgkmcnt(7)
    ds_read_b64_tr_b16 a[182:183], v13 offset:8192
    v_mfma_f32_16x16x32_bf16 a[4:7], a[164:167], v[40:43], a[4:7]
    ds_read_b64_tr_b16 a[184:185], v14 offset:0
    v_exp_f32 v142, v142
    v_mfma_f32_16x16x32_bf16 a[12:15], a[164:167], v[44:47], a[12:15]
    ds_read_b64_tr_b16 a[186:187], v14 offset:8192
    v_mfma_f32_16x16x32_bf16 v[68:71], a[164:167], v[232:235], v[68:71]
    s_add_u32 s34, s34, 2048
    ds_read_b64_tr_b16 a[188:189], v15 offset:0
    v_add_f32 v23, v23, v140
    v_mfma_f32_16x16x32_bf16 v[76:79], a[164:167], v[236:239], v[76:79]
    s_waitcnt lgkmcnt(7)
    ds_read_b64_tr_b16 a[190:191], v15 offset:8192
    v_mfma_f32_16x16x32_bf16 a[16:19], a[168:171], v[40:43], a[16:19]
    s_waitcnt vmcnt(3)
    ds_read_b64_tr_b16 a[160:161], v8 offset:256
    buffer_load_dwordx4 v0, s[20:23], s34 offen offset:2048 nt lds
    v_mfma_f32_16x16x32_bf16 a[24:27], a[168:171], v[44:47], a[24:27]
    ds_read_b64_tr_b16 a[162:163], v8 offset:8448
    v_exp_f32 v143, v143
    v_mfma_f32_16x16x32_bf16 a[20:23], a[172:175], v[40:43], a[20:23]
    v_add_f32 v23, v23, v141
    v_mfma_f32_16x16x32_bf16 a[28:31], a[172:175], v[44:47], a[28:31]
    s_waitcnt lgkmcnt(6)
    v_cvt_pk_bf16_f32 v118, v140, v141
    v_mfma_f32_16x16x32_bf16 a[32:35], a[176:179], v[40:43], a[32:35]
    ds_read_b64_tr_b16 a[164:165], v9 offset:256
    v_fma_f32 v144, v144, s36, -v18
    v_mfma_f32_16x16x32_bf16 a[40:43], a[176:179], v[44:47], a[40:43]
    ds_read_b64_tr_b16 a[166:167], v9 offset:8448
    v_fma_f32 v145, v145, s36, -v18
    v_mfma_f32_16x16x32_bf16 a[36:39], a[180:183], v[40:43], a[36:39]
    v_exp_f32 v144, v144
    v_mfma_f32_16x16x32_bf16 a[44:47], a[180:183], v[44:47], a[44:47]
    s_waitcnt lgkmcnt(4)
    v_add_f32 v23, v23, v142
    v_mfma_f32_16x16x32_bf16 a[48:51], a[184:187], v[40:43], a[48:51]
    ds_read_b64_tr_b16 a[168:169], v10 offset:256
    v_exp_f32 v145, v145
    v_mfma_f32_16x16x32_bf16 a[56:59], a[184:187], v[44:47], a[56:59]
    ds_read_b64_tr_b16 a[170:171], v10 offset:8448
    v_mfma_f32_16x16x32_bf16 a[52:55], a[188:191], v[40:43], a[52:55]
    s_waitcnt vmcnt(3)
    ds_read_b64_tr_b16 a[172:173], v11 offset:256
    v_add_f32 v23, v23, v143
    v_mfma_f32_16x16x32_bf16 a[60:63], a[188:191], v[44:47], a[60:63]
    s_waitcnt lgkmcnt(5)
    ds_read_b64_tr_b16 a[174:175], v11 offset:8448
    buffer_load_dwordx4 v1, s[20:23], s34 offen offset:3072 nt lds
    v_mfma_f32_16x16x32_bf16 a[64:67], a[160:163], v[40:43], a[64:67]
    ds_read_b64_tr_b16 a[176:177], v12 offset:256
    v_mfma_f32_16x16x32_bf16 a[72:75], a[160:163], v[44:47], a[72:75]
    ds_read_b64_tr_b16 a[178:179], v12 offset:8448
    v_cvt_pk_bf16_f32 v119, v142, v143
    v_mfma_f32_16x16x32_bf16 v[80:83], a[160:163], v[232:235], v[80:83]
    ds_read_b64_tr_b16 a[180:181], v13 offset:256
    v_fma_f32 v146, v146, s36, -v18
    v_mfma_f32_16x16x32_bf16 v[88:91], a[160:163], v[236:239], v[88:91]
    s_waitcnt lgkmcnt(7)
    ds_read_b64_tr_b16 a[182:183], v13 offset:8448
    v_mfma_f32_16x16x32_bf16 a[68:71], a[164:167], v[40:43], a[68:71]
    ds_read_b64_tr_b16 a[184:185], v14 offset:256
    ds_read_b128 v[224:227], v16 offset:20480
    v_mfma_f32_16x16x32_bf16 a[76:79], a[164:167], v[44:47], a[76:79]
    ds_read_b64_tr_b16 a[186:187], v14 offset:8448
    v_fma_f32 v147, v147, s36, -v18
    v_mfma_f32_16x16x32_bf16 v[84:87], a[164:167], v[232:235], v[84:87]
    ds_read_b64_tr_b16 a[188:189], v15 offset:256
    v_mfma_f32_16x16x32_bf16 v[92:95], a[164:167], v[236:239], v[92:95]
    s_waitcnt lgkmcnt(8)
    ds_read_b64_tr_b16 a[190:191], v15 offset:8448
    v_exp_f32 v146, v146
    v_mfma_f32_16x16x32_bf16 a[80:83], a[168:171], v[40:43], a[80:83]
    s_add_u32 m0, s29, 114688
    s_waitcnt vmcnt(8)
    s_barrier
    ds_read_b64_tr_b16 a[160:161], v8 offset:16384
    v_mfma_f32_16x16x32_bf16 a[88:91], a[168:171], v[44:47], a[88:91]
    s_add_u32 s34, s33, 212992
    ds_read_b64_tr_b16 a[162:163], v8 offset:24576
    ds_read_b128 v[228:231], v16 offset:21504
    v_mfma_f32_16x16x32_bf16 a[84:87], a[172:175], v[40:43], a[84:87]
    s_waitcnt vmcnt(4)
    buffer_load_dwordx4 v0, s[20:23], s34 offen offset:0 nt lds
    v_mfma_f32_16x16x32_bf16 a[92:95], a[172:175], v[44:47], a[92:95]
    s_waitcnt lgkmcnt(8)
    v_add_f32 v22, v22, v144
    v_mfma_f32_16x16x32_bf16 a[96:99], a[176:179], v[40:43], a[96:99]
    ds_read_b64_tr_b16 a[164:165], v9 offset:16384
    v_exp_f32 v147, v147
    v_mfma_f32_16x16x32_bf16 a[104:107], a[176:179], v[44:47], a[104:107]
    ds_read_b64_tr_b16 a[166:167], v9 offset:24576
    v_mfma_f32_16x16x32_bf16 a[100:103], a[180:183], v[40:43], a[100:103]
    v_add_f32 v22, v22, v145
    v_cvt_pk_bf16_f32 v120, v144, v145
    v_mfma_f32_16x16x32_bf16 a[108:111], a[180:183], v[44:47], a[108:111]
    s_waitcnt lgkmcnt(5)
    v_fma_f32 v148, v148, s36, -v18
    v_mfma_f32_16x16x32_bf16 a[112:115], a[184:187], v[40:43], a[112:115]
    ds_read_b64_tr_b16 a[168:169], v10 offset:16384
    v_fma_f32 v149, v149, s36, -v18
    v_mfma_f32_16x16x32_bf16 a[120:123], a[184:187], v[44:47], a[120:123]
    ds_read_b64_tr_b16 a[170:171], v10 offset:24576
    v_mfma_f32_16x16x32_bf16 a[116:119], a[188:191], v[40:43], a[116:119]
    ds_read_b64_tr_b16 a[172:173], v11 offset:16384
    v_exp_f32 v148, v148
    v_mfma_f32_16x16x32_bf16 a[124:127], a[188:191], v[44:47], a[124:127]
    s_waitcnt lgkmcnt(6)
    ds_read_b64_tr_b16 a[174:175], v11 offset:24576
    v_mfma_f32_16x16x32_bf16 a[0:3], a[160:163], v[48:51], a[0:3]
    ds_read_b64_tr_b16 a[176:177], v12 offset:16384
    v_add_f32 v22, v22, v146
    v_mfma_f32_16x16x32_bf16 a[8:11], a[160:163], v[52:55], a[8:11]
    s_waitcnt vmcnt(4)
    ds_read_b64_tr_b16 a[178:179], v12 offset:24576
    buffer_load_dwordx4 v1, s[20:23], s34 offen offset:1024 nt lds
    v_mfma_f32_16x16x32_bf16 v[64:67], a[160:163], v[224:227], v[64:67]
    s_waitcnt lgkmcnt(8)
    ds_read_b64_tr_b16 a[180:181], v13 offset:16384
    v_permlane32_swap_b32 v24, v25
    v_add_f32 v24, v24, v25
    v_mfma_f32_16x16x32_bf16 v[72:75], a[160:163], v[228:231], v[72:75]
    s_waitcnt lgkmcnt(7)
    ds_read_b64_tr_b16 a[182:183], v13 offset:24576
    v_exp_f32 v149, v149
    v_mfma_f32_16x16x32_bf16 a[4:7], a[164:167], v[48:51], a[4:7]
    ds_read_b64_tr_b16 a[184:185], v14 offset:16384
    v_mfma_f32_16x16x32_bf16 a[12:15], a[164:167], v[52:55], a[12:15]
    ds_read_b64_tr_b16 a[186:187], v14 offset:24576
    v_add_f32 v22, v22, v147
    v_mfma_f32_16x16x32_bf16 v[68:71], a[164:167], v[224:227], v[68:71]
    ds_read_b64_tr_b16 a[188:189], v15 offset:16384
    v_mov_b32 v25, v24
    v_mfma_f32_16x16x32_bf16 v[76:79], a[164:167], v[228:231], v[76:79]
    s_waitcnt lgkmcnt(7)
    ds_read_b64_tr_b16 a[190:191], v15 offset:24576
    v_cvt_pk_bf16_f32 v121, v146, v147
    v_mfma_f32_16x16x32_bf16 a[16:19], a[168:171], v[48:51], a[16:19]
    ds_read_b64_tr_b16 a[160:161], v8 offset:16640
    v_fma_f32 v150, v150, s36, -v18
    v_mfma_f32_16x16x32_bf16 a[24:27], a[168:171], v[52:55], a[24:27]
    ds_read_b64_tr_b16 a[162:163], v8 offset:24832
    v_fma_f32 v151, v151, s36, -v18
    v_mfma_f32_16x16x32_bf16 a[20:23], a[172:175], v[48:51], a[20:23]
    s_add_u32 s34, s34, 2048
    v_exp_f32 v150, v150
    v_mfma_f32_16x16x32_bf16 a[28:31], a[172:175], v[52:55], a[28:31]
    s_waitcnt lgkmcnt(6)
    v_add_f32 v22, v22, v148
    v_permlane16_swap_b32 v24, v25
    v_add_f32 v24, v24, v25
    v_mfma_f32_16x16x32_bf16 a[32:35], a[176:179], v[48:51], a[32:35]
    s_waitcnt vmcnt(3)
    ds_read_b64_tr_b16 a[164:165], v9 offset:16640
    buffer_load_dwordx4 v0, s[20:23], s34 offen offset:2048 nt lds
    v_mfma_f32_16x16x32_bf16 a[40:43], a[176:179], v[52:55], a[40:43]
    ds_read_b64_tr_b16 a[166:167], v9 offset:24832
    v_add_u32 v26, s46, v16
    v_mfma_f32_16x16x32_bf16 a[36:39], a[180:183], v[48:51], a[36:39]
    v_exp_f32 v151, v151
    v_add_f32 v22, v22, v149
    v_mfma_f32_16x16x32_bf16 a[44:47], a[180:183], v[52:55], a[44:47]
    s_waitcnt lgkmcnt(4)
    v_cvt_pk_bf16_f32 v122, v148, v149
    v_mfma_f32_16x16x32_bf16 a[48:51], a[184:187], v[48:51], a[48:51]
    ds_read_b64_tr_b16 a[168:169], v10 offset:16640
    v_fma_f32 v152, v152, s36, -v19
    v_mfma_f32_16x16x32_bf16 a[56:59], a[184:187], v[52:55], a[56:59]
    ds_read_b64_tr_b16 a[170:171], v10 offset:24832
    v_fma_f32 v153, v153, s36, -v19
    v_mfma_f32_16x16x32_bf16 a[52:55], a[188:191], v[48:51], a[52:55]
    ds_read_b64_tr_b16 a[172:173], v11 offset:16640
    ds_write_b32 v26, v24 offset:16384
    v_mfma_f32_16x16x32_bf16 a[60:63], a[188:191], v[52:55], a[60:63]
    s_waitcnt lgkmcnt(6)
    ds_read_b64_tr_b16 a[174:175], v11 offset:24832
    v_exp_f32 v152, v152
    v_mfma_f32_16x16x32_bf16 a[64:67], a[160:163], v[48:51], a[64:67]
    ds_read_b64_tr_b16 a[176:177], v12 offset:16640
    v_mfma_f32_16x16x32_bf16 a[72:75], a[160:163], v[52:55], a[72:75]
    ds_read_b64_tr_b16 a[178:179], v12 offset:24832
    v_add_f32 v22, v22, v150
    v_mfma_f32_16x16x32_bf16 v[80:83], a[160:163], v[224:227], v[80:83]
    s_waitcnt vmcnt(3)
    ds_read_b64_tr_b16 a[180:181], v13 offset:16640
    v_mfma_f32_16x16x32_bf16 v[88:91], a[160:163], v[228:231], v[88:91]
A_stub9:
    s_cbranch_execz A_stub13
    s_waitcnt lgkmcnt(8)
    ds_read_b64_tr_b16 a[182:183], v13 offset:24832
    buffer_load_dwordx4 v1, s[20:23], s34 offen offset:3072 nt lds
    v_mfma_f32_16x16x32_bf16 a[68:71], a[164:167], v[48:51], a[68:71]
    ds_read_b64_tr_b16 a[184:185], v14 offset:16640
    ds_read_b128 v[232:235], v16 offset:22528
    v_mfma_f32_16x16x32_bf16 a[76:79], a[164:167], v[52:55], a[76:79]
    ds_read_b64_tr_b16 a[186:187], v14 offset:24832
    v_exp_f32 v153, v153
    v_mfma_f32_16x16x32_bf16 v[84:87], a[164:167], v[224:227], v[84:87]
    ds_read_b64_tr_b16 a[188:189], v15 offset:16640
    v_mfma_f32_16x16x32_bf16 v[92:95], a[164:167], v[228:231], v[92:95]
    s_waitcnt lgkmcnt(8)
    ds_read_b64_tr_b16 a[190:191], v15 offset:24832
    v_add_f32 v22, v22, v151
    v_mfma_f32_16x16x32_bf16 a[80:83], a[168:171], v[48:51], a[80:83]
    s_waitcnt vmcnt(8)
    s_barrier
    ds_read_b64_tr_b16 a[160:161], v8 offset:32768
    v_mfma_f32_16x16x32_bf16 a[88:91], a[168:171], v[52:55], a[88:91]
    ds_read_b64_tr_b16 a[162:163], v8 offset:40960
    ds_read_b128 v[236:239], v16 offset:23552
    v_mfma_f32_16x16x32_bf16 a[84:87], a[172:175], v[48:51], a[84:87]
    v_cvt_pk_bf16_f32 v123, v150, v151
    v_mfma_f32_16x16x32_bf16 a[92:95], a[172:175], v[52:55], a[92:95]
    s_waitcnt lgkmcnt(8)
    v_fma_f32 v154, v154, s36, -v19
    v_fma_f32 v155, v155, s36, -v19
    v_mfma_f32_16x16x32_bf16 a[96:99], a[176:179], v[48:51], a[96:99]
    s_add_u32 m0, s29, 131072
    ds_read_b64_tr_b16 a[164:165], v9 offset:32768
    v_mfma_f32_16x16x32_bf16 a[104:107], a[176:179], v[52:55], a[104:107]
    s_add_u32 s34, s33, 229376
    ds_read_b64_tr_b16 a[166:167], v9 offset:40960
    v_exp_f32 v154, v154
    v_mfma_f32_16x16x32_bf16 a[100:103], a[180:183], v[48:51], a[100:103]
    s_waitcnt vmcnt(4)
    v_add_f32 v23, v23, v152
    v_mfma_f32_16x16x32_bf16 a[108:111], a[180:183], v[52:55], a[108:111]
    s_waitcnt lgkmcnt(5)
    buffer_load_dwordx4 v0, s[20:23], s34 offen offset:0 nt lds
    v_mfma_f32_16x16x32_bf16 a[112:115], a[184:187], v[48:51], a[112:115]
    ds_read_b64_tr_b16 a[168:169], v10 offset:32768
    v_mfma_f32_16x16x32_bf16 a[120:123], a[184:187], v[52:55], a[120:123]
    ds_read_b64_tr_b16 a[170:171], v10 offset:40960
    v_exp_f32 v155, v155
    v_mfma_f32_16x16x32_bf16 a[116:119], a[188:191], v[48:51], a[116:119]
    ds_read_b64_tr_b16 a[172:173], v11 offset:32768
    v_mfma_f32_16x16x32_bf16 a[124:127], a[188:191], v[52:55], a[124:127]
    s_waitcnt lgkmcnt(6)
    ds_read_b64_tr_b16 a[174:175], v11 offset:40960
    v_add_f32 v23, v23, v153
    v_mfma_f32_16x16x32_bf16 a[0:3], a[160:163], v[56:59], a[0:3]
    ds_read_b64_tr_b16 a[176:177], v12 offset:32768
    v_cvt_pk_bf16_f32 v124, v152, v153
    v_mfma_f32_16x16x32_bf16 a[8:11], a[160:163], v[60:63], a[8:11]
    ds_read_b64_tr_b16 a[178:179], v12 offset:40960
    v_fma_f32 v156, v156, s36, -v19
    v_mfma_f32_16x16x32_bf16 v[64:67], a[160:163], v[232:235], v[64:67]
    s_waitcnt lgkmcnt(8)
    ds_read_b64_tr_b16 a[180:181], v13 offset:32768
    v_mfma_f32_16x16x32_bf16 v[72:75], a[160:163], v[236:239], v[72:75]
    s_waitcnt lgkmcnt(7)
    ds_read_b64_tr_b16 a[182:183], v13 offset:40960
    v_fma_f32 v157, v157, s36, -v19
    v_mfma_f32_16x16x32_bf16 a[4:7], a[164:167], v[56:59], a[4:7]
    ds_read_b64_tr_b16 a[184:185], v14 offset:32768
    ds_read_b128 v[28:31], v16 offset:16384
    v_mfma_f32_16x16x32_bf16 a[12:15], a[164:167], v[60:63], a[12:15]
    ds_read_b64_tr_b16 a[186:187], v14 offset:40960
    v_exp_f32 v156, v156
    v_mfma_f32_16x16x32_bf16 v[68:71], a[164:167], v[232:235], v[68:71]
    s_waitcnt vmcnt(4)
    ds_read_b64_tr_b16 a[188:189], v15 offset:32768
    buffer_load_dwordx4 v1, s[20:23], s34 offen offset:1024 nt lds
    v_mfma_f32_16x16x32_bf16 v[76:79], a[164:167], v[236:239], v[76:79]
    s_waitcnt lgkmcnt(8)
    ds_read_b64_tr_b16 a[190:191], v15 offset:40960
    v_mfma_f32_16x16x32_bf16 a[16:19], a[168:171], v[56:59], a[16:19]
    ds_read_b64_tr_b16 a[160:161], v8 offset:33024
    v_add_f32 v23, v23, v154
    v_mfma_f32_16x16x32_bf16 a[24:27], a[168:171], v[60:63], a[24:27]
    ds_read_b64_tr_b16 a[162:163], v8 offset:41216
    v_xor_b32 v8, 0x10000, v8
    v_mfma_f32_16x16x32_bf16 a[20:23], a[172:175], v[56:59], a[20:23]
    v_exp_f32 v157, v157
    v_mfma_f32_16x16x32_bf16 a[28:31], a[172:175], v[60:63], a[28:31]
    s_waitcnt lgkmcnt(7)
    v_add_f32 v23, v23, v155
    v_mfma_f32_16x16x32_bf16 a[32:35], a[176:179], v[56:59], a[32:35]
    ds_read_b64_tr_b16 a[164:165], v9 offset:33024
    v_cvt_pk_bf16_f32 v125, v154, v155
    v_mfma_f32_16x16x32_bf16 a[40:43], a[176:179], v[60:63], a[40:43]
    ds_read_b64_tr_b16 a[166:167], v9 offset:41216
    v_xor_b32 v9, 0x10000, v9
    v_mfma_f32_16x16x32_bf16 a[36:39], a[180:183], v[56:59], a[36:39]
    v_fma_f32 v158, v158, s36, -v19
    v_fma_f32 v159, v159, s36, -v19
    v_mfma_f32_16x16x32_bf16 a[44:47], a[180:183], v[60:63], a[44:47]
    s_waitcnt lgkmcnt(4)
    v_exp_f32 v158, v158
    v_mfma_f32_16x16x32_bf16 a[48:51], a[184:187], v[56:59], a[48:51]
    s_add_u32 s34, s34, 2048
    ds_read_b64_tr_b16 a[168:169], v10 offset:33024
    v_mfma_f32_16x16x32_bf16 a[56:59], a[184:187], v[60:63], a[56:59]
    s_waitcnt vmcnt(3)
    ds_read_b64_tr_b16 a[170:171], v10 offset:41216
    buffer_load_dwordx4 v0, s[20:23], s34 offen offset:2048 nt lds
    v_xor_b32 v10, 0x10000, v10
    v_mfma_f32_16x16x32_bf16 a[52:55], a[188:191], v[56:59], a[52:55]
    ds_read_b64_tr_b16 a[172:173], v11 offset:33024
    v_add_f32 v23, v23, v156
    v_mfma_f32_16x16x32_bf16 a[60:63], a[188:191], v[60:63], a[60:63]
    s_waitcnt lgkmcnt(5)
    ds_read_b64_tr_b16 a[174:175], v11 offset:41216
    v_xor_b32 v11, 0x10000, v11
    v_mfma_f32_16x16x32_bf16 a[64:67], a[160:163], v[56:59], a[64:67]
    ds_read_b64_tr_b16 a[176:177], v12 offset:33024
    v_add_f32 v28, v28, v29
    v_add_f32 v30, v30, v31
    v_add_f32 v24, v28, v30
    v_rcp_f32 v24, v24
    v_mfma_f32_16x16x32_bf16 a[72:75], a[160:163], v[60:63], a[72:75]
    ds_read_b64_tr_b16 a[178:179], v12 offset:41216
    v_xor_b32 v12, 0x10000, v12
    v_mfma_f32_16x16x32_bf16 v[80:83], a[160:163], v[232:235], v[80:83]
    ds_read_b64_tr_b16 a[180:181], v13 offset:33024
    v_exp_f32 v159, v159
    v_mfma_f32_16x16x32_bf16 v[88:91], a[160:163], v[236:239], v[88:91]
    s_waitcnt lgkmcnt(7)
    ds_read_b64_tr_b16 a[182:183], v13 offset:41216
    v_xor_b32 v13, 0x10000, v13
    v_mfma_f32_16x16x32_bf16 a[68:71], a[164:167], v[56:59], a[68:71]
    ds_read_b64_tr_b16 a[184:185], v14 offset:33024
    ds_read_b128 v[224:227], v16 offset:24576
    v_mfma_f32_16x16x32_bf16 a[76:79], a[164:167], v[60:63], a[76:79]
    ds_read_b64_tr_b16 a[186:187], v14 offset:41216
    v_xor_b32 v14, 0x10000, v14
    v_mfma_f32_16x16x32_bf16 v[84:87], a[164:167], v[232:235], v[84:87]
    ds_read_b64_tr_b16 a[188:189], v15 offset:33024
    v_mov_b32 v25, v24
    s_nop 0
    v_mfma_f32_16x16x32_bf16 v[92:95], a[164:167], v[236:239], v[92:95]
    s_waitcnt lgkmcnt(8)
    ds_read_b64_tr_b16 a[190:191], v15 offset:41216
    v_xor_b32 v15, 0x10000, v15
    v_mfma_f32_16x16x32_bf16 a[80:83], a[168:171], v[56:59], a[80:83]
    s_waitcnt vmcnt(3)
    s_waitcnt vmcnt(7)
    s_barrier
    ds_read_b64_tr_b16 a[160:161], v8 offset:0
    buffer_load_dwordx4 v1, s[20:23], s34 offen offset:3072 nt lds
    v_mfma_f32_16x16x32_bf16 a[88:91], a[168:171], v[60:63], a[88:91]
    ds_read_b64_tr_b16 a[162:163], v8 offset:8192
    ds_read_b128 v[228:231], v16 offset:25600
    v_permlane32_swap_b32 v24, v25
    v_mfma_f32_16x16x32_bf16 a[84:87], a[172:175], v[56:59], a[84:87]
    v_add_f32 v23, v23, v157
    v_cvt_pk_bf16_f32 v126, v156, v157
    v_mfma_f32_16x16x32_bf16 a[92:95], a[172:175], v[60:63], a[92:95]
    s_waitcnt lgkmcnt(8)
    v_add_f32 v23, v23, v158
    v_add_f32 v23, v23, v159
    v_mfma_f32_16x16x32_bf16 a[96:99], a[176:179], v[56:59], a[96:99]
    ds_read_b64_tr_b16 a[164:165], v9 offset:0
    v_mfma_f32_16x16x32_bf16 a[104:107], a[176:179], v[60:63], a[104:107]
    ds_read_b64_tr_b16 a[166:167], v9 offset:8192
    v_cvt_pk_bf16_f32 v127, v158, v159
    v_mfma_f32_16x16x32_bf16 a[100:103], a[180:183], v[56:59], a[100:103]
    v_mfma_f32_16x16x32_bf16 a[108:111], a[180:183], v[60:63], a[108:111]
    s_waitcnt lgkmcnt(5)
    v_mfma_f32_16x16x32_bf16 a[112:115], a[184:187], v[56:59], a[112:115]
    ds_read_b64_tr_b16 a[168:169], v10 offset:0
    v_mfma_f32_16x16x32_bf16 a[120:123], a[184:187], v[60:63], a[120:123]
    s_add_u32 m0, s29, 147456
    ds_read_b64_tr_b16 a[170:171], v10 offset:8192
    v_mfma_f32_16x16x32_bf16 a[116:119], a[188:191], v[56:59], a[116:119]
    s_add_u32 s34, s33, 245760
    ds_read_b64_tr_b16 a[172:173], v11 offset:0
    v_mfma_f32_16x16x32_bf16 a[124:127], a[188:191], v[60:63], a[124:127]
    s_waitcnt lgkmcnt(6)
    ds_read_b64_tr_b16 a[174:175], v11 offset:8192
    s_bitcmp1_b32 s37, 3
    s_cbranch_scc0 L_nores3
    s_mov_b32 s50, 16
    s_call_b64 s[48:49], L_rescale
L_nores3:
    v_mfma_f32_16x16x32_bf16 a[0:3], a[160:163], v[96:99], a[0:3]
    s_waitcnt vmcnt(4)
    ds_read_b64_tr_b16 a[176:177], v12 offset:0
    buffer_load_dwordx4 v0, s[20:23], s34 offen offset:0 nt lds
    v_mfma_f32_16x16x32_bf16 a[8:11], a[160:163], v[100:103], a[8:11]
    ds_read_b64_tr_b16 a[178:179], v12 offset:8192
    v_mfma_f32_16x16x32_bf16 v[64:67], a[160:163], v[224:227], v[64:67]
    s_waitcnt lgkmcnt(8)
    ds_read_b64_tr_b16 a[180:181], v13 offset:0
    v_mfma_f32_16x16x32_bf16 v[72:75], a[160:163], v[228:231], v[72:75]
    s_waitcnt lgkmcnt(7)
    ds_read_b64_tr_b16 a[182:183], v13 offset:8192
    v_permlane32_swap_b32 v22, v23
    v_add_f32 v22, v22, v23
    v_mfma_f32_16x16x32_bf16 a[4:7], a[164:167], v[96:99], a[4:7]
    s_waitcnt vmcnt(4)
    ds_read_b64_tr_b16 a[184:185], v14 offset:0
    buffer_load_dwordx4 v1, s[20:23], s34 offen offset:1024 nt lds
    v_mfma_f32_16x16x32_bf16 a[12:15], a[164:167], v[100:103], a[12:15]
    ds_read_b64_tr_b16 a[186:187], v14 offset:8192
    v_mfma_f32_16x16x32_bf16 v[68:71], a[164:167], v[224:227], v[68:71]
    s_add_u32 s34, s34, 2048
    ds_read_b64_tr_b16 a[188:189], v15 offset:0
    v_mfma_f32_16x16x32_bf16 v[76:79], a[164:167], v[228:231], v[76:79]
    s_waitcnt lgkmcnt(7)
    ds_read_b64_tr_b16 a[190:191], v15 offset:8192
    v_mfma_f32_16x16x32_bf16 a[16:19], a[168:171], v[96:99], a[16:19]
    s_waitcnt vmcnt(3)
    ds_read_b64_tr_b16 a[160:161], v8 offset:256
    buffer_load_dwordx4 v0, s[20:23], s34 offen offset:2048 nt lds
    v_mfma_f32_16x16x32_bf16 a[24:27], a[168:171], v[100:103], a[24:27]
    s_add_u32 s33, s33, 2097152
    ds_read_b64_tr_b16 a[162:163], v8 offset:8448
    v_mfma_f32_16x16x32_bf16 a[20:23], a[172:175], v[96:99], a[20:23]
    s_add_u32 s26, s26, 2097152
    v_mov_b32 v23, v22
    v_mfma_f32_16x16x32_bf16 a[28:31], a[172:175], v[100:103], a[28:31]
    s_waitcnt lgkmcnt(6)
    v_permlane16_swap_b32 v22, v23
    v_add_f32 v22, v22, v23
    v_mfma_f32_16x16x32_bf16 a[32:35], a[176:179], v[96:99], a[32:35]
    s_waitcnt vmcnt(3)
    ds_read_b64_tr_b16 a[164:165], v9 offset:256
    buffer_load_dwordx4 v1, s[20:23], s34 offen offset:3072 nt lds
    v_mfma_f32_16x16x32_bf16 a[40:43], a[176:179], v[100:103], a[40:43]
    ds_read_b64_tr_b16 a[166:167], v9 offset:8448
    v_mfma_f32_16x16x32_bf16 a[36:39], a[180:183], v[96:99], a[36:39]
    s_add_u32 m0, s29, 32768
    v_rcp_f32 v22, v22
    v_mfma_f32_16x16x32_bf16 a[44:47], a[180:183], v[100:103], a[44:47]
    s_waitcnt lgkmcnt(4)
    v_mov_b32 v23, v22
    v_mfma_f32_16x16x32_bf16 a[48:51], a[184:187], v[96:99], a[48:51]
    s_movk_i32 s34, 0
    ds_read_b64_tr_b16 a[168:169], v10 offset:256
    buffer_load_dwordx4 v4, s[8:11], s34 offen offset:0 lds
    v_mfma_f32_16x16x32_bf16 a[56:59], a[184:187], v[100:103], a[56:59]
    ds_read_b64_tr_b16 a[170:171], v10 offset:8448
    v_mfma_f32_16x16x32_bf16 a[52:55], a[188:191], v[96:99], a[52:55]
    ds_read_b64_tr_b16 a[172:173], v11 offset:256
    s_nop 0
    v_mfma_f32_16x16x32_bf16 a[60:63], a[188:191], v[100:103], a[60:63]
    s_waitcnt lgkmcnt(5)
    ds_read_b64_tr_b16 a[174:175], v11 offset:8448
    v_mfma_f32_16x16x32_bf16 a[64:67], a[160:163], v[96:99], a[64:67]
    ds_read_b64_tr_b16 a[176:177], v12 offset:256
    buffer_load_dwordx4 v5, s[8:11], s34 offen offset:1024 lds
    v_mfma_f32_16x16x32_bf16 a[72:75], a[160:163], v[100:103], a[72:75]
    ds_read_b64_tr_b16 a[178:179], v12 offset:8448
    v_mfma_f32_16x16x32_bf16 v[80:83], a[160:163], v[224:227], v[80:83]
    ds_read_b64_tr_b16 a[180:181], v13 offset:256
    v_permlane32_swap_b32 v22, v23
    v_mfma_f32_16x16x32_bf16 v[88:91], a[160:163], v[228:231], v[88:91]
    s_waitcnt lgkmcnt(7)
    ds_read_b64_tr_b16 a[182:183], v13 offset:8448
    v_mfma_f32_16x16x32_bf16 a[68:71], a[164:167], v[96:99], a[68:71]
    s_add_u32 s34, s34, 12288
    ds_read_b64_tr_b16 a[184:185], v14 offset:256
    buffer_load_dwordx4 v4, s[8:11], s34 offen offset:2048 lds
    ds_read_b128 v[232:235], v16 offset:26624
    v_mfma_f32_16x16x32_bf16 a[76:79], a[164:167], v[100:103], a[76:79]
    ds_read_b64_tr_b16 a[186:187], v14 offset:8448
    v_mfma_f32_16x16x32_bf16 v[84:87], a[164:167], v[224:227], v[84:87]
    ds_read_b64_tr_b16 a[188:189], v15 offset:256
    v_mfma_f32_16x16x32_bf16 v[92:95], a[164:167], v[228:231], v[92:95]
    s_waitcnt lgkmcnt(8)
    ds_read_b64_tr_b16 a[190:191], v15 offset:8448
    v_mfma_f32_16x16x32_bf16 a[80:83], a[168:171], v[96:99], a[80:83]
    s_waitcnt vmcnt(11)
    s_barrier
    ds_read_b64_tr_b16 a[160:161], v8 offset:16384
    buffer_load_dwordx4 v5, s[8:11], s34 offen offset:3072 lds
    v_mfma_f32_16x16x32_bf16 a[88:91], a[168:171], v[100:103], a[88:91]
    ds_read_b64_tr_b16 a[162:163], v8 offset:24576
    ds_read_b128 v[236:239], v16 offset:27648
    v_mfma_f32_16x16x32_bf16 a[84:87], a[172:175], v[96:99], a[84:87]
    s_add_u32 m0, s39, 0
    v_mfma_f32_16x16x32_bf16 a[92:95], a[172:175], v[100:103], a[92:95]
    s_waitcnt lgkmcnt(8)
    v_mfma_f32_16x16x32_bf16 a[96:99], a[176:179], v[96:99], a[96:99]
    s_movk_i32 s34, 0
    ds_read_b64_tr_b16 a[164:165], v9 offset:16384
    buffer_load_dwordx4 v6, s[8:11], s34 offen lds
    v_mfma_f32_16x16x32_bf16 a[104:107], a[176:179], v[100:103], a[104:107]
    ds_read_b64_tr_b16 a[166:167], v9 offset:24576
    v_mfma_f32_16x16x32_bf16 a[100:103], a[180:183], v[96:99], a[100:103]
    s_add_u32 m0, s29, 49152
    v_mfma_f32_16x16x32_bf16 a[108:111], a[180:183], v[100:103], a[108:111]
    s_waitcnt lgkmcnt(5)
    v_mfma_f32_16x16x32_bf16 a[112:115], a[184:187], v[96:99], a[112:115]
    s_add_u32 s34, s32, 0
    ds_read_b64_tr_b16 a[168:169], v10 offset:16384
    buffer_load_dwordx4 v2, s[12:15], s34 offen offset:0 nt lds
    v_mfma_f32_16x16x32_bf16 a[120:123], a[184:187], v[100:103], a[120:123]
    ds_read_b64_tr_b16 a[170:171], v10 offset:24576
    v_mfma_f32_16x16x32_bf16 a[116:119], a[188:191], v[96:99], a[116:119]
    ds_read_b64_tr_b16 a[172:173], v11 offset:16384
    v_mfma_f32_16x16x32_bf16 a[124:127], a[188:191], v[100:103], a[124:127]
    s_waitcnt lgkmcnt(6)
    ds_read_b64_tr_b16 a[174:175], v11 offset:24576
    v_mfma_f32_16x16x32_bf16 a[0:3], a[160:163], v[104:107], a[0:3]
    ds_read_b64_tr_b16 a[176:177], v12 offset:16384
    buffer_load_dwordx4 v3, s[12:15], s34 offen offset:1024 nt lds
    v_mfma_f32_16x16x32_bf16 a[8:11], a[160:163], v[108:111], a[8:11]
    ds_read_b64_tr_b16 a[178:179], v12 offset:24576
    v_mfma_f32_16x16x32_bf16 v[64:67], a[160:163], v[232:235], v[64:67]
    s_waitcnt lgkmcnt(8)
    ds_read_b64_tr_b16 a[180:181], v13 offset:16384
    v_mfma_f32_16x16x32_bf16 v[72:75], a[160:163], v[236:239], v[72:75]
    s_waitcnt lgkmcnt(7)
    ds_read_b64_tr_b16 a[182:183], v13 offset:24576
    v_mfma_f32_16x16x32_bf16 a[4:7], a[164:167], v[104:107], a[4:7]
    s_add_u32 s34, s34, 30720
    ds_read_b64_tr_b16 a[184:185], v14 offset:16384
    buffer_load_dwordx4 v2, s[12:15], s34 offen offset:2048 nt lds
    v_mfma_f32_16x16x32_bf16 a[12:15], a[164:167], v[108:111], a[12:15]
    ds_read_b64_tr_b16 a[186:187], v14 offset:24576
    v_mfma_f32_16x16x32_bf16 v[68:71], a[164:167], v[232:235], v[68:71]
    ds_read_b64_tr_b16 a[188:189], v15 offset:16384
    v_mfma_f32_16x16x32_bf16 v[76:79], a[164:167], v[236:239], v[76:79]
    s_waitcnt lgkmcnt(7)
    ds_read_b64_tr_b16 a[190:191], v15 offset:24576
    v_mfma_f32_16x16x32_bf16 a[16:19], a[168:171], v[104:107], a[16:19]
    ds_read_b64_tr_b16 a[160:161], v8 offset:16640
    buffer_load_dwordx4 v3, s[12:15], s34 offen offset:3072 nt lds
    v_mfma_f32_16x16x32_bf16 a[24:27], a[168:171], v[108:111], a[24:27]
    ds_read_b64_tr_b16 a[162:163], v8 offset:24832
    v_mfma_f32_16x16x32_bf16 a[20:23], a[172:175], v[104:107], a[20:23]
    s_add_u32 m0, s29, 65536
    v_mfma_f32_16x16x32_bf16 a[28:31], a[172:175], v[108:111], a[28:31]
    s_waitcnt lgkmcnt(6)
    v_mfma_f32_16x16x32_bf16 a[32:35], a[176:179], v[104:107], a[32:35]
    s_add_u32 s34, s32, 262144
    ds_read_b64_tr_b16 a[164:165], v9 offset:16640
    buffer_load_dwordx4 v2, s[12:15], s34 offen offset:0 nt lds
    v_mfma_f32_16x16x32_bf16 a[40:43], a[176:179], v[108:111], a[40:43]
    ds_read_b64_tr_b16 a[166:167], v9 offset:24832
    v_mfma_f32_16x16x32_bf16 a[36:39], a[180:183], v[104:107], a[36:39]
    v_mfma_f32_16x16x32_bf16 a[44:47], a[180:183], v[108:111], a[44:47]
    s_waitcnt lgkmcnt(4)
    v_mfma_f32_16x16x32_bf16 a[48:51], a[184:187], v[104:107], a[48:51]
    ds_read_b64_tr_b16 a[168:169], v10 offset:16640
    buffer_load_dwordx4 v3, s[12:15], s34 offen offset:1024 nt lds
    v_mfma_f32_16x16x32_bf16 a[56:59], a[184:187], v[108:111], a[56:59]
    ds_read_b64_tr_b16 a[170:171], v10 offset:24832
    v_mfma_f32_16x16x32_bf16 a[52:55], a[188:191], v[104:107], a[52:55]
    ds_read_b64_tr_b16 a[172:173], v11 offset:16640
    v_mfma_f32_16x16x32_bf16 a[60:63], a[188:191], v[108:111], a[60:63]
    s_waitcnt lgkmcnt(5)
    ds_read_b64_tr_b16 a[174:175], v11 offset:24832
    v_mfma_f32_16x16x32_bf16 a[64:67], a[160:163], v[104:107], a[64:67]
    s_add_u32 s34, s34, 30720
    ds_read_b64_tr_b16 a[176:177], v12 offset:16640
    buffer_load_dwordx4 v2, s[12:15], s34 offen offset:2048 nt lds
    v_mfma_f32_16x16x32_bf16 a[72:75], a[160:163], v[108:111], a[72:75]
    ds_read_b64_tr_b16 a[178:179], v12 offset:24832
    v_mfma_f32_16x16x32_bf16 v[80:83], a[160:163], v[232:235], v[80:83]
    ds_read_b64_tr_b16 a[180:181], v13 offset:16640
    v_mfma_f32_16x16x32_bf16 v[88:91], a[160:163], v[236:239], v[88:91]
    s_waitcnt lgkmcnt(7)
    ds_read_b64_tr_b16 a[182:183], v13 offset:24832
    v_mfma_f32_16x16x32_bf16 a[68:71], a[164:167], v[104:107], a[68:71]
    ds_read_b64_tr_b16 a[184:185], v14 offset:16640
    buffer_load_dwordx4 v3, s[12:15], s34 offen offset:3072 nt lds
    ds_read_b128 v[224:227], v16 offset:28672
    v_mfma_f32_16x16x32_bf16 a[76:79], a[164:167], v[108:111], a[76:79]
    ds_read_b64_tr_b16 a[186:187], v14 offset:24832
    v_mfma_f32_16x16x32_bf16 v[84:87], a[164:167], v[232:235], v[84:87]
    s_add_u32 m0, s29, 81920
    ds_read_b64_tr_b16 a[188:189], v15 offset:16640
    v_mfma_f32_16x16x32_bf16 v[92:95], a[164:167], v[236:239], v[92:95]
    s_waitcnt lgkmcnt(8)
    ds_read_b64_tr_b16 a[190:191], v15 offset:24832
    v_mfma_f32_16x16x32_bf16 a[80:83], a[168:171], v[104:107], a[80:83]
    s_movk_i32 s34, 128
    s_waitcnt vmcnt(17)
    s_barrier
    ds_read_b64_tr_b16 a[160:161], v8 offset:32768
    buffer_load_dwordx4 v4, s[8:11], s34 offen offset:0 lds
    v_mfma_f32_16x16x32_bf16 a[88:91], a[168:171], v[108:111], a[88:91]
    ds_read_b64_tr_b16 a[162:163], v8 offset:40960
    ds_read_b128 v[228:231], v16 offset:29696
    v_mfma_f32_16x16x32_bf16 a[84:87], a[172:175], v[104:107], a[84:87]
    v_mfma_f32_16x16x32_bf16 a[92:95], a[172:175], v[108:111], a[92:95]
    s_waitcnt lgkmcnt(8)
    v_mfma_f32_16x16x32_bf16 a[96:99], a[176:179], v[104:107], a[96:99]
    ds_read_b64_tr_b16 a[164:165], v9 offset:32768
    buffer_load_dwordx4 v5, s[8:11], s34 offen offset:1024 lds
    v_mfma_f32_16x16x32_bf16 a[104:107], a[176:179], v[108:111], a[104:107]
    ds_read_b64_tr_b16 a[166:167], v9 offset:40960
    v_mfma_f32_16x16x32_bf16 a[100:103], a[180:183], v[104:107], a[100:103]
    v_mfma_f32_16x16x32_bf16 a[108:111], a[180:183], v[108:111], a[108:111]
    s_waitcnt lgkmcnt(5)
    v_mfma_f32_16x16x32_bf16 a[112:115], a[184:187], v[104:107], a[112:115]
    s_add_u32 s34, s34, 12288
    ds_read_b64_tr_b16 a[168:169], v10 offset:32768
    buffer_load_dwordx4 v4, s[8:11], s34 offen offset:2048 lds
    v_mfma_f32_16x16x32_bf16 a[120:123], a[184:187], v[108:111], a[120:123]
    ds_read_b64_tr_b16 a[170:171], v10 offset:40960
    v_mfma_f32_16x16x32_bf16 a[116:119], a[188:191], v[104:107], a[116:119]
    ds_read_b64_tr_b16 a[172:173], v11 offset:32768
    v_mfma_f32_16x16x32_bf16 a[124:127], a[188:191], v[108:111], a[124:127]
    s_waitcnt lgkmcnt(6)
    ds_read_b64_tr_b16 a[174:175], v11 offset:40960
    v_mfma_f32_16x16x32_bf16 a[0:3], a[160:163], v[112:115], a[0:3]
    ds_read_b64_tr_b16 a[176:177], v12 offset:32768
    buffer_load_dwordx4 v5, s[8:11], s34 offen offset:3072 lds
    v_mfma_f32_16x16x32_bf16 a[8:11], a[160:163], v[116:119], a[8:11]
    ds_read_b64_tr_b16 a[178:179], v12 offset:40960
    v_mfma_f32_16x16x32_bf16 v[64:67], a[160:163], v[224:227], v[64:67]
    s_waitcnt lgkmcnt(8)
    s_add_u32 m0, s39, 4096
    ds_read_b64_tr_b16 a[180:181], v13 offset:32768
    v_mfma_f32_16x16x32_bf16 v[72:75], a[160:163], v[228:231], v[72:75]
    s_waitcnt lgkmcnt(7)
    ds_read_b64_tr_b16 a[182:183], v13 offset:40960
    v_mfma_f32_16x16x32_bf16 a[4:7], a[164:167], v[112:115], a[4:7]
    s_movk_i32 s34, 128
    ds_read_b64_tr_b16 a[184:185], v14 offset:32768
    buffer_load_dwordx4 v6, s[8:11], s34 offen lds
    v_mfma_f32_16x16x32_bf16 a[12:15], a[164:167], v[116:119], a[12:15]
    ds_read_b64_tr_b16 a[186:187], v14 offset:40960
    v_mfma_f32_16x16x32_bf16 v[68:71], a[164:167], v[224:227], v[68:71]
    s_add_u32 m0, s29, 98304
    ds_read_b64_tr_b16 a[188:189], v15 offset:32768
    v_mfma_f32_16x16x32_bf16 v[76:79], a[164:167], v[228:231], v[76:79]
    s_waitcnt lgkmcnt(7)
    ds_read_b64_tr_b16 a[190:191], v15 offset:40960
    v_mfma_f32_16x16x32_bf16 a[16:19], a[168:171], v[112:115], a[16:19]
    s_add_u32 s34, s32, 524288
    ds_read_b64_tr_b16 a[160:161], v8 offset:33024
    buffer_load_dwordx4 v2, s[12:15], s34 offen offset:0 nt lds
    v_mfma_f32_16x16x32_bf16 a[24:27], a[168:171], v[116:119], a[24:27]
    ds_read_b64_tr_b16 a[162:163], v8 offset:41216
    v_mfma_f32_16x16x32_bf16 a[20:23], a[172:175], v[112:115], a[20:23]
    v_mfma_f32_16x16x32_bf16 a[28:31], a[172:175], v[116:119], a[28:31]
    s_waitcnt lgkmcnt(6)
    v_mfma_f32_16x16x32_bf16 a[32:35], a[176:179], v[112:115], a[32:35]
    ds_read_b64_tr_b16 a[164:165], v9 offset:33024
    v_mfma_f32_16x16x32_bf16 a[40:43], a[176:179], v[116:119], a[40:43]
    ds_read_b64_tr_b16 a[166:167], v9 offset:41216
    buffer_load_dwordx4 v3, s[12:15], s34 offen offset:1024 nt lds
    v_mfma_f32_16x16x32_bf16 a[36:39], a[180:183], v[112:115], a[36:39]
    v_mfma_f32_16x16x32_bf16 a[44:47], a[180:183], v[116:119], a[44:47]
    s_waitcnt lgkmcnt(4)
    v_mfma_f32_16x16x32_bf16 a[48:51], a[184:187], v[112:115], a[48:51]
    ds_read_b64_tr_b16 a[168:169], v10 offset:33024
    v_mfma_f32_16x16x32_bf16 a[56:59], a[184:187], v[116:119], a[56:59]
    ds_read_b64_tr_b16 a[170:171], v10 offset:41216
    v_mfma_f32_16x16x32_bf16 a[52:55], a[188:191], v[112:115], a[52:55]
    s_add_u32 s34, s34, 30720
    ds_read_b64_tr_b16 a[172:173], v11 offset:33024
    buffer_load_dwordx4 v2, s[12:15], s34 offen offset:2048 nt lds
    v_mfma_f32_16x16x32_bf16 a[60:63], a[188:191], v[116:119], a[60:63]
    s_waitcnt lgkmcnt(5)
    ds_read_b64_tr_b16 a[174:175], v11 offset:41216
    v_mfma_f32_16x16x32_bf16 a[64:67], a[160:163], v[112:115], a[64:67]
    ds_read_b64_tr_b16 a[176:177], v12 offset:33024
    v_mfma_f32_16x16x32_bf16 a[72:75], a[160:163], v[116:119], a[72:75]
    ds_read_b64_tr_b16 a[178:179], v12 offset:41216
    v_mfma_f32_16x16x32_bf16 v[80:83], a[160:163], v[224:227], v[80:83]
    ds_read_b64_tr_b16 a[180:181], v13 offset:33024
    v_mfma_f32_16x16x32_bf16 v[88:91], a[160:163], v[228:231], v[88:91]
    s_waitcnt lgkmcnt(7)
    ds_read_b64_tr_b16 a[182:183], v13 offset:41216
    buffer_load_dwordx4 v3, s[12:15], s34 offen offset:3072 nt lds
    v_mfma_f32_16x16x32_bf16 a[68:71], a[164:167], v[112:115], a[68:71]
    ds_read_b64_tr_b16 a[184:185], v14 offset:33024
    ds_read_b128 v[232:235], v16 offset:30720
    v_mfma_f32_16x16x32_bf16 a[76:79], a[164:167], v[116:119], a[76:79]
    ds_read_b64_tr_b16 a[186:187], v14 offset:41216
    v_mfma_f32_16x16x32_bf16 v[84:87], a[164:167], v[224:227], v[84:87]
    ds_read_b64_tr_b16 a[188:189], v15 offset:33024
    v_mfma_f32_16x16x32_bf16 v[92:95], a[164:167], v[228:231], v[92:95]
    s_waitcnt lgkmcnt(8)
    ds_read_b64_tr_b16 a[190:191], v15 offset:41216
    v_mfma_f32_16x16x32_bf16 a[80:83], a[168:171], v[112:115], a[80:83]
    s_waitcnt vmcnt(22)
    s_barrier
    ds_read_b64_tr_b16 a[160:161], v8 offset:49152
    v_mfma_f32_16x16x32_bf16 a[88:91], a[168:171], v[116:119], a[88:91]
    s_add_u32 m0, s29, 114688
    ds_read_b64_tr_b16 a[162:163], v8 offset:57344
    ds_read_b128 v[236:239], v16 offset:31744
    v_mfma_f32_16x16x32_bf16 a[84:87], a[172:175], v[112:115], a[84:87]
    s_add_u32 s34, s32, 786432
    buffer_load_dwordx4 v2, s[12:15], s34 offen offset:0 nt lds
    v_mfma_f32_16x16x32_bf16 a[92:95], a[172:175], v[116:119], a[92:95]
    s_waitcnt lgkmcnt(8)
    v_mfma_f32_16x16x32_bf16 a[96:99], a[176:179], v[112:115], a[96:99]
    ds_read_b64_tr_b16 a[164:165], v9 offset:49152
    v_mfma_f32_16x16x32_bf16 a[104:107], a[176:179], v[116:119], a[104:107]
    ds_read_b64_tr_b16 a[166:167], v9 offset:57344
    v_mfma_f32_16x16x32_bf16 a[100:103], a[180:183], v[112:115], a[100:103]
    v_mfma_f32_16x16x32_bf16 a[108:111], a[180:183], v[116:119], a[108:111]
    s_waitcnt lgkmcnt(5)
    v_mfma_f32_16x16x32_bf16 a[112:115], a[184:187], v[112:115], a[112:115]
    ds_read_b64_tr_b16 a[168:169], v10 offset:49152
    v_mfma_f32_16x16x32_bf16 a[120:123], a[184:187], v[116:119], a[120:123]
    ds_read_b64_tr_b16 a[170:171], v10 offset:57344
    v_mfma_f32_16x16x32_bf16 a[116:119], a[188:191], v[112:115], a[116:119]
    ds_read_b64_tr_b16 a[172:173], v11 offset:49152
    buffer_load_dwordx4 v3, s[12:15], s34 offen offset:1024 nt lds
    v_mfma_f32_16x16x32_bf16 a[124:127], a[188:191], v[116:119], a[124:127]
    s_waitcnt lgkmcnt(6)
    ds_read_b64_tr_b16 a[174:175], v11 offset:57344
    v_mfma_f32_16x16x32_bf16 a[0:3], a[160:163], v[120:123], a[0:3]
    ds_read_b64_tr_b16 a[176:177], v12 offset:49152
    v_mfma_f32_16x16x32_bf16 a[8:11], a[160:163], v[124:127], a[8:11]
    ds_read_b64_tr_b16 a[178:179], v12 offset:57344
    v_mfma_f32_16x16x32_bf16 v[64:67], a[160:163], v[232:235], v[64:67]
    s_waitcnt lgkmcnt(8)
    ds_read_b64_tr_b16 a[180:181], v13 offset:49152
    v_mfma_f32_16x16x32_bf16 v[72:75], a[160:163], v[236:239], v[72:75]
    s_waitcnt lgkmcnt(7)
    ds_read_b64_tr_b16 a[182:183], v13 offset:57344
    v_mfma_f32_16x16x32_bf16 a[4:7], a[164:167], v[120:123], a[4:7]
    ds_read_b64_tr_b16 a[184:185], v14 offset:49152
    v_mfma_f32_16x16x32_bf16 a[12:15], a[164:167], v[124:127], a[12:15]
    ds_read_b64_tr_b16 a[186:187], v14 offset:57344
    v_mfma_f32_16x16x32_bf16 v[68:71], a[164:167], v[232:235], v[68:71]
    s_add_u32 s34, s34, 30720
    ds_read_b64_tr_b16 a[188:189], v15 offset:49152
    buffer_load_dwordx4 v2, s[12:15], s34 offen offset:2048 nt lds
    v_mfma_f32_16x16x32_bf16 v[76:79], a[164:167], v[236:239], v[76:79]
    s_waitcnt lgkmcnt(7)
    ds_read_b64_tr_b16 a[190:191], v15 offset:57344
    v_mfma_f32_16x16x32_bf16 a[16:19], a[168:171], v[120:123], a[16:19]
    ds_read_b64_tr_b16 a[160:161], v8 offset:49408
    v_mfma_f32_16x16x32_bf16 a[24:27], a[168:171], v[124:127], a[24:27]
    ds_read_b64_tr_b16 a[162:163], v8 offset:57600
    v_accvgpr_read_b32 v8, a228
    v_add_u32 v8, 32768, v8
    v_mfma_f32_16x16x32_bf16 a[20:23], a[172:175], v[120:123], a[20:23]
    v_mfma_f32_16x16x32_bf16 a[28:31], a[172:175], v[124:127], a[28:31]
    s_waitcnt lgkmcnt(6)
    v_mfma_f32_16x16x32_bf16 a[32:35], a[176:179], v[120:123], a[32:35]
    ds_read_b64_tr_b16 a[164:165], v9 offset:49408
    v_mfma_f32_16x16x32_bf16 a[40:43], a[176:179], v[124:127], a[40:43]
    ds_read_b64_tr_b16 a[166:167], v9 offset:57600
    v_xor_b32 v9, 32, v8
    v_mfma_f32_16x16x32_bf16 a[36:39], a[180:183], v[120:123], a[36:39]
    buffer_load_dwordx4 v3, s[12:15], s34 offen offset:3072 nt lds
    v_mfma_f32_16x16x32_bf16 a[44:47], a[180:183], v[124:127], a[44:47]
    s_waitcnt lgkmcnt(4)
    v_mfma_f32_16x16x32_bf16 a[48:51], a[184:187], v[120:123], a[48:51]
    ds_read_b64_tr_b16 a[168:169], v10 offset:49408
    v_mfma_f32_16x16x32_bf16 a[56:59], a[184:187], v[124:127], a[56:59]
    ds_read_b64_tr_b16 a[170:171], v10 offset:57600
    v_xor_b32 v10, 64, v8
    v_mfma_f32_16x16x32_bf16 a[52:55], a[188:191], v[120:123], a[52:55]
    ds_read_b64_tr_b16 a[172:173], v11 offset:49408
    v_mfma_f32_16x16x32_bf16 a[60:63], a[188:191], v[124:127], a[60:63]
    s_waitcnt lgkmcnt(5)
    ds_read_b64_tr_b16 a[174:175], v11 offset:57600
    v_xor_b32 v11, 96, v8
    v_mfma_f32_16x16x32_bf16 a[64:67], a[160:163], v[120:123], a[64:67]
    ds_read_b64_tr_b16 a[176:177], v12 offset:49408
    v_mfma_f32_16x16x32_bf16 a[72:75], a[160:163], v[124:127], a[72:75]
    ds_read_b64_tr_b16 a[178:179], v12 offset:57600
    v_xor_b32 v12, 128, v8
    v_mfma_f32_16x16x32_bf16 v[80:83], a[160:163], v[232:235], v[80:83]
    ds_read_b64_tr_b16 a[180:181], v13 offset:49408
    v_mfma_f32_16x16x32_bf16 v[88:91], a[160:163], v[236:239], v[88:91]
A_stub10:
    s_cbranch_execz A_back
    s_waitcnt lgkmcnt(7)
    ds_read_b64_tr_b16 a[182:183], v13 offset:57600
    v_xor_b32 v13, 160, v8
    v_mfma_f32_16x16x32_bf16 a[68:71], a[164:167], v[120:123], a[68:71]
    ds_read_b64_tr_b16 a[184:185], v14 offset:49408
    v_mfma_f32_16x16x32_bf16 a[76:79], a[164:167], v[124:127], a[76:79]
    ds_read_b64_tr_b16 a[186:187], v14 offset:57600
    v_xor_b32 v14, 192, v8
    v_mfma_f32_16x16x32_bf16 v[84:87], a[164:167], v[232:235], v[84:87]
    ds_read_b64_tr_b16 a[188:189], v15 offset:49408
    v_add_u32 v17, s40, v7
    v_mfma_f32_16x16x32_bf16 v[92:95], a[164:167], v[236:239], v[92:95]
    s_waitcnt lgkmcnt(7)
    ds_read_b64_tr_b16 a[190:191], v15 offset:57600
    v_xor_b32 v15, 224, v8
    v_mfma_f32_16x16x32_bf16 a[80:83], a[168:171], v[120:123], a[80:83]
    s_waitcnt vmcnt(17)
    s_barrier
    ds_read_b128 v[32:35], v17 offset:0
    ds_read_b128 v[36:39], v17 offset:2048
    ds_read_b64_tr_b16 a[160:161], v8 offset:16384
    v_mfma_f32_16x16x32_bf16 a[88:91], a[168:171], v[124:127], a[88:91]
    s_add_u32 m0, s29, 131072
    ds_read_b64_tr_b16 a[162:163], v8 offset:18432
    v_mfma_f32_16x16x32_bf16 a[84:87], a[172:175], v[120:123], a[84:87]
    s_movk_i32 s34, 256
    ds_read_b64_tr_b16 a[164:165], v9 offset:16384
    buffer_load_dwordx4 v4, s[8:11], s34 offen offset:0 lds
    v_mfma_f32_16x16x32_bf16 a[92:95], a[172:175], v[124:127], a[92:95]
    s_waitcnt lgkmcnt(9)
    ds_read_b64_tr_b16 a[166:167], v9 offset:18432
    v_mfma_f32_16x16x32_bf16 a[96:99], a[176:179], v[120:123], a[96:99]
    ds_read_b64_tr_b16 a[168:169], v10 offset:16384
    v_mfma_f32_16x16x32_bf16 a[104:107], a[176:179], v[124:127], a[104:107]
    ds_read_b64_tr_b16 a[170:171], v10 offset:18432
    v_mfma_f32_16x16x32_bf16 a[100:103], a[180:183], v[120:123], a[100:103]
    ds_read_b64_tr_b16 a[172:173], v11 offset:16384
    v_mfma_f32_16x16x32_bf16 a[108:111], a[180:183], v[124:127], a[108:111]
    s_waitcnt lgkmcnt(9)
    ds_read_b64_tr_b16 a[174:175], v11 offset:18432
    v_mfma_f32_16x16x32_bf16 a[112:115], a[184:187], v[120:123], a[112:115]
    ds_read_b64_tr_b16 a[176:177], v12 offset:16384
    v_mfma_f32_16x16x32_bf16 a[120:123], a[184:187], v[124:127], a[120:123]
    ds_read_b64_tr_b16 a[178:179], v12 offset:18432
    v_mfma_f32_16x16x32_bf16 a[116:119], a[188:191], v[120:123], a[116:119]
    ds_read_b64_tr_b16 a[180:181], v13 offset:16384
    buffer_load_dwordx4 v5, s[8:11], s34 offen offset:1024 lds
    v_mfma_f32_16x16x32_bf16 a[124:127], a[188:191], v[124:127], a[124:127]
    s_waitcnt lgkmcnt(7)
    ds_read_b64_tr_b16 a[182:183], v13 offset:18432
    s_cmp_lg_u32 s38, 0
    s_cbranch_scc1 L_tail
    s_mov_b32 s38, 1
    v_mfma_f32_16x16x32_bf16 v[96:99], a[160:163], v[32:35], 0
    ds_read_b64_tr_b16 a[184:185], v14 offset:16384
    v_mul_f32 v80, v80, v24
    v_mul_f32 v81, v81, v24
    v_mfma_f32_16x16x32_bf16 v[104:107], a[160:163], v[36:39], 0
    ds_read_b64_tr_b16 a[186:187], v14 offset:18432
    ds_read_b128 v[48:51], v7 offset:0
    v_mul_f32 v82, v82, v24
    v_mfma_f32_16x16x32_bf16 v[100:103], a[164:167], v[32:35], 0
    ds_read_b64_tr_b16 a[188:189], v15 offset:16384
    v_mul_f32 v83, v83, v24
    v_mfma_f32_16x16x32_bf16 v[108:111], a[164:167], v[36:39], 0
    s_waitcnt lgkmcnt(8)
    ds_read_b64_tr_b16 a[190:191], v15 offset:18432
    v_xor_b32 v26, s44, v8
    v_mul_f32 v84, v84, v24
    v_mfma_f32_16x16x32_bf16 v[112:115], a[168:171], v[32:35], 0
    ds_read_b64_tr_b16 a[160:161], v26 offset:16384
    ds_read_b128 v[52:55], v7 offset:2048
    v_mul_f32 v85, v85, v24
    v_mfma_f32_16x16x32_bf16 v[120:123], a[168:171], v[36:39], 0
    ds_read_b64_tr_b16 a[162:163], v26 offset:18432
    v_xor_b32 v27, s44, v9
    v_mul_f32 v86, v86, v24
    v_mfma_f32_16x16x32_bf16 v[116:119], a[172:175], v[32:35], 0
    s_add_u32 s34, s34, 12288
    ds_read_b64_tr_b16 a[164:165], v27 offset:16384
    buffer_load_dwordx4 v4, s[8:11], s34 offen offset:2048 lds
    v_mfma_f32_16x16x32_bf16 v[124:127], a[172:175], v[36:39], 0
    s_waitcnt lgkmcnt(9)
    ds_read_b64_tr_b16 a[166:167], v27 offset:18432
    v_xor_b32 v26, s44, v10
    v_xor_b32 v17, 64, v17
    v_mfma_f32_16x16x32_bf16 v[128:131], a[176:179], v[32:35], 0
    ds_read_b64_tr_b16 a[168:169], v26 offset:16384
    v_mul_f32 v87, v87, v24
    v_mul_f32 v88, v88, v25
    v_mfma_f32_16x16x32_bf16 v[136:139], a[176:179], v[36:39], 0
    ds_read_b64_tr_b16 a[170:171], v26 offset:18432
    v_xor_b32 v27, s44, v11
    v_mfma_f32_16x16x32_bf16 v[132:135], a[180:183], v[32:35], 0
    ds_read_b64_tr_b16 a[172:173], v27 offset:16384
    ds_read_b128 v[40:43], v17 offset:0
    v_mul_f32 v89, v89, v25
    v_mfma_f32_16x16x32_bf16 v[140:143], a[180:183], v[36:39], 0
    s_waitcnt lgkmcnt(9)
    ds_read_b64_tr_b16 a[174:175], v27 offset:18432
    v_mul_f32 v90, v90, v25
    v_mul_f32 v91, v91, v25
    v_mfma_f32_16x16x32_bf16 v[144:147], a[184:187], v[32:35], 0
    ds_read_b64_tr_b16 a[176:177], v8 offset:16640
    v_mul_f32 v92, v92, v25
    v_mul_f32 v93, v93, v25
    v_mfma_f32_16x16x32_bf16 v[152:155], a[184:187], v[36:39], 0
    ds_read_b64_tr_b16 a[178:179], v8 offset:18688
    ds_read_b128 v[44:47], v17 offset:2048
    v_mfma_f32_16x16x32_bf16 v[148:151], a[188:191], v[32:35], 0
    ds_read_b64_tr_b16 a[180:181], v9 offset:16640
    buffer_load_dwordx4 v5, s[8:11], s34 offen offset:3072 lds
    v_mfma_f32_16x16x32_bf16 v[156:159], a[188:191], v[36:39], 0
    s_waitcnt lgkmcnt(9)
    ds_read_b64_tr_b16 a[182:183], v9 offset:18688
    v_mul_f32 v94, v94, v25
    v_mul_f32 v95, v95, v25
    v_mfma_f32_16x16x32_bf16 v[224:227], a[160:163], v[48:51], 0
    ds_read_b64_tr_b16 a[184:185], v10 offset:16640
    v_xor_b32 v17, 64, v7
    v_cvt_pk_bf16_f32 v80, v80, v81
    v_mfma_f32_16x16x32_bf16 v[232:235], a[160:163], v[52:55], 0
    ds_read_b64_tr_b16 a[186:187], v10 offset:18688
    v_cvt_pk_bf16_f32 v81, v82, v83
    v_cvt_pk_bf16_f32 v82, v84, v85
    v_mfma_f32_16x16x32_bf16 v[228:231], a[164:167], v[48:51], 0
    ds_read_b64_tr_b16 a[188:189], v11 offset:16640
    v_cvt_pk_bf16_f32 v83, v86, v87
    v_cvt_pk_bf16_f32 v84, v88, v89
    v_mfma_f32_16x16x32_bf16 v[236:239], a[164:167], v[52:55], 0
    s_waitcnt lgkmcnt(8)
    ds_read_b64_tr_b16 a[190:191], v11 offset:18688
    ds_read_b128 v[56:59], v17 offset:0
    v_mfma_f32_16x16x32_bf16 v[240:243], a[168:171], v[48:51], 0
    ds_read_b64_tr_b16 a[160:161], v12 offset:16640
    v_cvt_pk_bf16_f32 v85, v90, v91
    v_cvt_pk_bf16_f32 v86, v92, v93
    v_mfma_f32_16x16x32_bf16 v[248:251], a[168:171], v[52:55], 0
    s_add_u32 m0, s39, 8192
    ds_read_b64_tr_b16 a[162:163], v12 offset:18688
    v_cvt_pk_bf16_f32 v87, v94, v95
    v_accvgpr_write_b32 a248, v80
    v_mfma_f32_16x16x32_bf16 v[244:247], a[172:175], v[48:51], 0
    s_movk_i32 s34, 256
    ds_read_b64_tr_b16 a[164:165], v13 offset:16640
    buffer_load_dwordx4 v6, s[8:11], s34 offen lds
    ds_read_b128 v[60:63], v17 offset:2048
    v_mfma_f32_16x16x32_bf16 v[252:255], a[172:175], v[52:55], 0
    s_waitcnt lgkmcnt(9)
    ds_read_b64_tr_b16 a[166:167], v13 offset:18688
    v_accvgpr_write_b32 a249, v81
    v_accvgpr_write_b32 a250, v82
    v_mfma_f32_16x16x32_bf16 v[160:163], a[176:179], v[32:35], 0
    ds_read_b64_tr_b16 a[168:169], v14 offset:16640
    v_accvgpr_write_b32 a251, v83
    v_accvgpr_write_b32 a252, v84
    v_mfma_f32_16x16x32_bf16 v[168:171], a[176:179], v[36:39], 0
    ds_read_b64_tr_b16 a[170:171], v14 offset:18688
    v_accvgpr_write_b32 a253, v85
    v_mfma_f32_16x16x32_bf16 v[164:167], a[180:183], v[32:35], 0
    ds_read_b64_tr_b16 a[172:173], v15 offset:16640
    v_accvgpr_write_b32 a254, v86
    v_accvgpr_write_b32 a255, v87
    v_mfma_f32_16x16x32_bf16 v[172:175], a[180:183], v[36:39], 0
    s_waitcnt lgkmcnt(9)
    ds_read_b64_tr_b16 a[174:175], v15 offset:18688
    v_mul_f32 v64, v64, v24
    v_mul_f32 v65, v65, v24
    v_mfma_f32_16x16x32_bf16 v[176:179], a[184:187], v[32:35], 0
    s_waitcnt vmcnt(18)
    s_barrier
    ds_read_b64_tr_b16 a[176:177], v8 offset:32768
    v_mfma_f32_16x16x32_bf16 v[184:187], a[184:187], v[36:39], 0
    s_add_u32 m0, s29, 147456
    ds_read_b64_tr_b16 a[178:179], v8 offset:34816
    v_mul_f32 v66, v66, v24
    v_mul_f32 v67, v67, v24
    v_mfma_f32_16x16x32_bf16 v[180:183], a[188:191], v[32:35], 0
    s_add_u32 s34, s32, 1048576
    ds_read_b64_tr_b16 a[180:181], v9 offset:32768
    buffer_load_dwordx4 v2, s[12:15], s34 offen offset:0 nt lds
    v_mfma_f32_16x16x32_bf16 v[188:191], a[188:191], v[36:39], 0
    s_waitcnt lgkmcnt(7)
    ds_read_b64_tr_b16 a[182:183], v9 offset:34816
    v_mul_f32 v68, v68, v24
    v_mul_f32 v69, v69, v24
    v_mfma_f32_16x16x32_bf16 v[192:195], a[160:163], v[32:35], 0
    ds_read_b64_tr_b16 a[184:185], v10 offset:32768
    v_mul_f32 v70, v70, v24
    v_mfma_f32_16x16x32_bf16 v[200:203], a[160:163], v[36:39], 0
    ds_read_b64_tr_b16 a[186:187], v10 offset:34816
    v_mul_f32 v71, v71, v24
    v_mul_f32 v72, v72, v25
    v_mfma_f32_16x16x32_bf16 v[196:199], a[164:167], v[32:35], 0
    ds_read_b64_tr_b16 a[188:189], v11 offset:32768
    v_mul_f32 v73, v73, v25
    v_mul_f32 v74, v74, v25
    v_mfma_f32_16x16x32_bf16 v[204:207], a[164:167], v[36:39], 0
    s_waitcnt lgkmcnt(7)
    ds_read_b64_tr_b16 a[190:191], v11 offset:34816
    buffer_load_dwordx4 v3, s[12:15], s34 offen offset:1024 nt lds
    v_accvgpr_read_b32 v0, a224
    v_accvgpr_read_b32 v1, a225
    v_mfma_f32_16x16x32_bf16 v[208:211], a[168:171], v[32:35], 0
    s_add_u32 s51, s26, 0
    ds_read_b64_tr_b16 a[160:161], v12 offset:32768
    buffer_load_dwordx4 v[80:83], v0, s[16:19], s51 offen offset:0 nt
    v_mfma_f32_16x16x32_bf16 v[216:219], a[168:171], v[36:39], 0
    ds_read_b64_tr_b16 a[162:163], v12 offset:34816
    v_mul_f32 v75, v75, v25
    v_mul_f32 v76, v76, v25
    v_mfma_f32_16x16x32_bf16 v[212:215], a[172:175], v[32:35], 0
    ds_read_b64_tr_b16 a[164:165], v13 offset:32768
    v_mul_f32 v77, v77, v25
    v_mfma_f32_16x16x32_bf16 v[220:223], a[172:175], v[36:39], 0
    s_waitcnt lgkmcnt(7)
    ds_read_b64_tr_b16 a[166:167], v13 offset:34816
    v_mul_f32 v78, v78, v25
    v_mul_f32 v79, v79, v25
    v_mfma_f32_16x16x32_bf16 v[96:99], a[176:179], v[40:43], v[96:99]
    s_add_u32 s34, s34, 30720
    ds_read_b64_tr_b16 a[168:169], v14 offset:32768
    buffer_load_dwordx4 v2, s[12:15], s34 offen offset:2048 nt lds
    buffer_load_dwordx4 v[84:87], v1, s[16:19], s51 offen offset:1024 nt
    v_mfma_f32_16x16x32_bf16 v[104:107], a[176:179], v[44:47], v[104:107]
    ds_read_b64_tr_b16 a[170:171], v14 offset:34816
    v_cvt_pk_bf16_f32 v64, v64, v65
    v_cvt_pk_bf16_f32 v65, v66, v67
    v_mfma_f32_16x16x32_bf16 v[100:103], a[180:183], v[40:43], v[100:103]
    ds_read_b64_tr_b16 a[172:173], v15 offset:32768
    v_cvt_pk_bf16_f32 v66, v68, v69
    v_cvt_pk_bf16_f32 v67, v70, v71
    v_mfma_f32_16x16x32_bf16 v[108:111], a[180:183], v[44:47], v[108:111]
    s_waitcnt lgkmcnt(7)
    ds_read_b64_tr_b16 a[174:175], v15 offset:34816
    v_xor_b32 v26, s44, v8
    v_cvt_pk_bf16_f32 v68, v72, v73
    v_mfma_f32_16x16x32_bf16 v[112:115], a[184:187], v[40:43], v[112:115]
    s_add_u32 s51, s51, 6144
    ds_read_b64_tr_b16 a[176:177], v26 offset:32768
    buffer_load_dwordx4 v[88:91], v0, s[16:19], s51 offen offset:2048 nt
    v_mfma_f32_16x16x32_bf16 v[120:123], a[184:187], v[44:47], v[120:123]
    ds_read_b64_tr_b16 a[178:179], v26 offset:34816
    buffer_load_dwordx4 v3, s[12:15], s34 offen offset:3072 nt lds
    v_xor_b32 v27, s44, v9
    v_mfma_f32_16x16x32_bf16 v[116:119], a[188:191], v[40:43], v[116:119]
    ds_read_b64_tr_b16 a[180:181], v27 offset:32768
    v_cvt_pk_bf16_f32 v69, v74, v75
    v_mfma_f32_16x16x32_bf16 v[124:127], a[188:191], v[44:47], v[124:127]
    s_waitcnt lgkmcnt(7)
    ds_read_b64_tr_b16 a[182:183], v27 offset:34816
    v_xor_b32 v26, s44, v10
    v_cvt_pk_bf16_f32 v70, v76, v77
    v_mfma_f32_16x16x32_bf16 v[128:131], a[160:163], v[40:43], v[128:131]
    ds_read_b64_tr_b16 a[184:185], v26 offset:32768
    buffer_load_dwordx4 v[92:95], v1, s[16:19], s51 offen offset:3072 nt
    v_mfma_f32_16x16x32_bf16 v[136:139], a[160:163], v[44:47], v[136:139]
    s_add_u32 m0, s29, 32768
    ds_read_b64_tr_b16 a[186:187], v26 offset:34816
    v_xor_b32 v27, s44, v11
    v_cvt_pk_bf16_f32 v71, v78, v79
    v_mfma_f32_16x16x32_bf16 v[132:135], a[164:167], v[40:43], v[132:135]
    s_add_u32 s34, s32, 1310720
    ds_read_b64_tr_b16 a[188:189], v27 offset:32768
    buffer_load_dwordx4 v2, s[12:15], s34 offen offset:0 nt lds
    v_mfma_f32_16x16x32_bf16 v[140:143], a[164:167], v[44:47], v[140:143]
    s_waitcnt lgkmcnt(7)
    ds_read_b64_tr_b16 a[190:191], v27 offset:34816
    v_accvgpr_write_b32 a240, v64
    v_accvgpr_write_b32 a241, v65
    v_mfma_f32_16x16x32_bf16 v[144:147], a[168:171], v[40:43], v[144:147]
    ds_read_b64_tr_b16 a[160:161], v8 offset:33024
    v_accvgpr_write_b32 a242, v66
    v_accvgpr_write_b32 a243, v67
    v_mfma_f32_16x16x32_bf16 v[152:155], a[168:171], v[44:47], v[152:155]
    ds_read_b64_tr_b16 a[162:163], v8 offset:35072
    v_xor_b32 v8, 0x10000, v8
    v_mfma_f32_16x16x32_bf16 v[148:151], a[172:175], v[40:43], v[148:151]
    ds_read_b64_tr_b16 a[164:165], v9 offset:33024
    v_accvgpr_write_b32 a244, v68
    v_accvgpr_write_b32 a245, v69
    v_mfma_f32_16x16x32_bf16 v[156:159], a[172:175], v[44:47], v[156:159]
    s_waitcnt lgkmcnt(7)
    ds_read_b64_tr_b16 a[166:167], v9 offset:35072
    buffer_load_dwordx4 v3, s[12:15], s34 offen offset:1024 nt lds
    v_xor_b32 v9, 0x10000, v9
    v_mfma_f32_16x16x32_bf16 v[224:227], a[176:179], v[56:59], v[224:227]
    ds_read_b64_tr_b16 a[168:169], v10 offset:33024
    v_accvgpr_write_b32 a246, v70
    v_accvgpr_write_b32 a247, v71
    v_mfma_f32_16x16x32_bf16 v[232:235], a[176:179], v[60:63], v[232:235]
    ds_read_b64_tr_b16 a[170:171], v10 offset:35072
    v_xor_b32 v10, 0x10000, v10
    v_accvgpr_read_b32 v64, a0
    v_mfma_f32_16x16x32_bf16 v[228:231], a[180:183], v[56:59], v[228:231]
    ds_read_b64_tr_b16 a[172:173], v11 offset:33024
    v_accvgpr_read_b32 v65, a1
    v_mfma_f32_16x16x32_bf16 v[236:239], a[180:183], v[60:63], v[236:239]
    s_waitcnt lgkmcnt(7)
    ds_read_b64_tr_b16 a[174:175], v11 offset:35072
    v_xor_b32 v11, 0x10000, v11
    v_accvgpr_read_b32 v66, a2
    v_mfma_f32_16x16x32_bf16 v[240:243], a[184:187], v[56:59], v[240:243]
    s_add_u32 s34, s34, 30720
    ds_read_b64_tr_b16 a[176:177], v12 offset:33024
    buffer_load_dwordx4 v2, s[12:15], s34 offen offset:2048 nt lds
    v_mfma_f32_16x16x32_bf16 v[248:251], a[184:187], v[60:63], v[248:251]
    ds_read_b64_tr_b16 a[178:179], v12 offset:35072
    v_xor_b32 v12, 0x10000, v12
    v_accvgpr_read_b32 v67, a3
    v_mfma_f32_16x16x32_bf16 v[244:247], a[188:191], v[56:59], v[244:247]
    ds_read_b64_tr_b16 a[180:181], v13 offset:33024
    v_accvgpr_read_b32 v68, a4
    v_accvgpr_read_b32 v69, a5
    v_mfma_f32_16x16x32_bf16 v[252:255], a[188:191], v[60:63], v[252:255]
    s_waitcnt lgkmcnt(7)
    ds_read_b64_tr_b16 a[182:183], v13 offset:35072
    v_xor_b32 v13, 0x10000, v13
    v_accvgpr_read_b32 v70, a6
    v_mfma_f32_16x16x32_bf16 v[160:163], a[160:163], v[40:43], v[160:163]
    ds_read_b64_tr_b16 a[184:185], v14 offset:33024
    v_accvgpr_read_b32 v71, a7
    v_mfma_f32_16x16x32_bf16 v[168:171], a[160:163], v[44:47], v[168:171]
    ds_read_b64_tr_b16 a[186:187], v14 offset:35072
    buffer_load_dwordx4 v3, s[12:15], s34 offen offset:3072 nt lds
    v_xor_b32 v14, 0x10000, v14
    v_mfma_f32_16x16x32_bf16 v[164:167], a[164:167], v[40:43], v[164:167]
    ds_read_b64_tr_b16 a[188:189], v15 offset:33024
    v_add_u32 v17, s40, v7
    v_accvgpr_read_b32 v72, a8
    v_mfma_f32_16x16x32_bf16 v[172:175], a[164:167], v[44:47], v[172:175]
    s_waitcnt lgkmcnt(7)
    ds_read_b64_tr_b16 a[190:191], v15 offset:35072
    v_xor_b32 v15, 0x10000, v15
    v_accvgpr_read_b32 v73, a9
    v_mfma_f32_16x16x32_bf16 v[176:179], a[168:171], v[40:43], v[176:179]
    s_waitcnt vmcnt(21)
    s_barrier
    ds_read_b128 v[32:35], v17 offset:49152
    ds_read_b128 v[36:39], v17 offset:51200
    ds_read_b64_tr_b16 a[160:161], v8 offset:0
    v_mfma_f32_16x16x32_bf16 v[184:187], a[168:171], v[44:47], v[184:187]
    s_add_u32 m0, s29, 49152
    ds_read_b64_tr_b16 a[162:163], v8 offset:2048
    v_accvgpr_read_b32 v74, a10
    v_accvgpr_read_b32 v75, a11
    v_mfma_f32_16x16x32_bf16 v[180:183], a[172:175], v[40:43], v[180:183]
    s_movk_i32 s34, 384
    ds_read_b64_tr_b16 a[164:165], v9 offset:0
    buffer_load_dwordx4 v4, s[8:11], s34 offen offset:0 lds
    v_mfma_f32_16x16x32_bf16 v[188:191], a[172:175], v[44:47], v[188:191]
    s_waitcnt lgkmcnt(9)
    ds_read_b64_tr_b16 a[166:167], v9 offset:2048
    v_accvgpr_read_b32 v76, a12
    v_accvgpr_read_b32 v77, a13
    v_mfma_f32_16x16x32_bf16 v[192:195], a[176:179], v[40:43], v[192:195]
    ds_read_b64_tr_b16 a[168:169], v10 offset:0
    v_accvgpr_read_b32 v78, a14
    v_mfma_f32_16x16x32_bf16 v[200:203], a[176:179], v[44:47], v[200:203]
    ds_read_b64_tr_b16 a[170:171], v10 offset:2048
    v_accvgpr_read_b32 v79, a15
    v_mul_f32 v64, v64, v22
    v_mfma_f32_16x16x32_bf16 v[196:199], a[180:183], v[40:43], v[196:199]
    ds_read_b64_tr_b16 a[172:173], v11 offset:0
    v_mul_f32 v65, v65, v22
    v_mul_f32 v66, v66, v22
    v_mfma_f32_16x16x32_bf16 v[204:207], a[180:183], v[44:47], v[204:207]
    s_waitcnt lgkmcnt(9)
    ds_read_b64_tr_b16 a[174:175], v11 offset:2048
    v_mul_f32 v67, v67, v22
    v_mul_f32 v68, v68, v22
    v_mfma_f32_16x16x32_bf16 v[208:211], a[184:187], v[40:43], v[208:211]
    ds_read_b64_tr_b16 a[176:177], v12 offset:0
    v_mul_f32 v69, v69, v22
    v_mul_f32 v70, v70, v22
    v_mfma_f32_16x16x32_bf16 v[216:219], a[184:187], v[44:47], v[216:219]
    ds_read_b64_tr_b16 a[178:179], v12 offset:2048
    v_mul_f32 v71, v71, v22
    v_mfma_f32_16x16x32_bf16 v[212:215], a[188:191], v[40:43], v[212:215]
    ds_read_b64_tr_b16 a[180:181], v13 offset:0
    buffer_load_dwordx4 v5, s[8:11], s34 offen offset:1024 lds
    v_mfma_f32_16x16x32_bf16 v[220:223], a[188:191], v[44:47], v[220:223]
    s_waitcnt lgkmcnt(7)
    ds_read_b64_tr_b16 a[182:183], v13 offset:2048
    v_mul_f32 v72, v72, v23
    v_mul_f32 v73, v73, v23
    v_mfma_f32_16x16x32_bf16 v[96:99], a[160:163], v[32:35], v[96:99]
    ds_read_b64_tr_b16 a[184:185], v14 offset:0
    v_mul_f32 v74, v74, v23
    v_mul_f32 v75, v75, v23
    v_mfma_f32_16x16x32_bf16 v[104:107], a[160:163], v[36:39], v[104:107]
    ds_read_b64_tr_b16 a[186:187], v14 offset:2048
    ds_read_b128 v[48:51], v7 offset:4096
    v_mul_f32 v76, v76, v23
    v_mfma_f32_16x16x32_bf16 v[100:103], a[164:167], v[32:35], v[100:103]
    ds_read_b64_tr_b16 a[188:189], v15 offset:0
    v_mul_f32 v77, v77, v23
    v_mfma_f32_16x16x32_bf16 v[108:111], a[164:167], v[36:39], v[108:111]
    s_waitcnt lgkmcnt(8)
    ds_read_b64_tr_b16 a[190:191], v15 offset:2048
    v_xor_b32 v26, s44, v8
    v_mul_f32 v78, v78, v23
    v_mfma_f32_16x16x32_bf16 v[112:115], a[168:171], v[32:35], v[112:115]
    ds_read_b64_tr_b16 a[160:161], v26 offset:0
    ds_read_b128 v[52:55], v7 offset:6144
    v_mul_f32 v79, v79, v23
    v_mfma_f32_16x16x32_bf16 v[120:123], a[168:171], v[36:39], v[120:123]
    ds_read_b64_tr_b16 a[162:163], v26 offset:2048
    v_xor_b32 v27, s44, v9
    v_cvt_pk_bf16_f32 v64, v64, v65
    v_mfma_f32_16x16x32_bf16 v[116:119], a[172:175], v[32:35], v[116:119]
    s_add_u32 s34, s34, 12288
    ds_read_b64_tr_b16 a[164:165], v27 offset:0
    buffer_load_dwordx4 v4, s[8:11], s34 offen offset:2048 lds
    v_mfma_f32_16x16x32_bf16 v[124:127], a[172:175], v[36:39], v[124:127]
    s_waitcnt lgkmcnt(9)
    ds_read_b64_tr_b16 a[166:167], v27 offset:2048
    v_xor_b32 v26, s44, v10
    v_xor_b32 v17, 64, v17
    v_mfma_f32_16x16x32_bf16 v[128:131], a[176:179], v[32:35], v[128:131]
    ds_read_b64_tr_b16 a[168:169], v26 offset:0
    v_cvt_pk_bf16_f32 v65, v66, v67
    v_cvt_pk_bf16_f32 v66, v68, v69
    v_mfma_f32_16x16x32_bf16 v[136:139], a[176:179], v[36:39], v[136:139]
    ds_read_b64_tr_b16 a[170:171], v26 offset:2048
    v_xor_b32 v27, s44, v11
    v_mfma_f32_16x16x32_bf16 v[132:135], a[180:183], v[32:35], v[132:135]
    ds_read_b64_tr_b16 a[172:173], v27 offset:0
    ds_read_b128 v[40:43], v17 offset:49152
    v_cvt_pk_bf16_f32 v67, v70, v71
    v_mfma_f32_16x16x32_bf16 v[140:143], a[180:183], v[36:39], v[140:143]
    s_waitcnt lgkmcnt(9)
    ds_read_b64_tr_b16 a[174:175], v27 offset:2048
    v_cvt_pk_bf16_f32 v68, v72, v73
    v_cvt_pk_bf16_f32 v69, v74, v75
    v_mfma_f32_16x16x32_bf16 v[144:147], a[184:187], v[32:35], v[144:147]
    ds_read_b64_tr_b16 a[176:177], v8 offset:256
    v_cvt_pk_bf16_f32 v70, v76, v77
    v_cvt_pk_bf16_f32 v71, v78, v79
    v_mfma_f32_16x16x32_bf16 v[152:155], a[184:187], v[36:39], v[152:155]
    ds_read_b64_tr_b16 a[178:179], v8 offset:2304
    ds_read_b128 v[44:47], v17 offset:51200
    v_accvgpr_write_b32 a192, v64
    v_mfma_f32_16x16x32_bf16 v[148:151], a[188:191], v[32:35], v[148:151]
    ds_read_b64_tr_b16 a[180:181], v9 offset:256
    buffer_load_dwordx4 v5, s[8:11], s34 offen offset:3072 lds
    v_mfma_f32_16x16x32_bf16 v[156:159], a[188:191], v[36:39], v[156:159]
    s_waitcnt lgkmcnt(9)
    ds_read_b64_tr_b16 a[182:183], v9 offset:2304
    v_accvgpr_write_b32 a193, v65
    v_mfma_f32_16x16x32_bf16 v[224:227], a[160:163], v[48:51], v[224:227]
    ds_read_b64_tr_b16 a[184:185], v10 offset:256
    v_xor_b32 v17, 64, v7
    v_accvgpr_write_b32 a194, v66
    v_mfma_f32_16x16x32_bf16 v[232:235], a[160:163], v[52:55], v[232:235]
    ds_read_b64_tr_b16 a[186:187], v10 offset:2304
    v_accvgpr_write_b32 a195, v67
    v_accvgpr_write_b32 a196, v68
    v_mfma_f32_16x16x32_bf16 v[228:231], a[164:167], v[48:51], v[228:231]
    ds_read_b64_tr_b16 a[188:189], v11 offset:256
    v_accvgpr_write_b32 a197, v69
    v_accvgpr_write_b32 a198, v70
    v_mfma_f32_16x16x32_bf16 v[236:239], a[164:167], v[52:55], v[236:239]
    s_waitcnt lgkmcnt(8)
    ds_read_b64_tr_b16 a[190:191], v11 offset:2304
    ds_read_b128 v[56:59], v17 offset:4096
    v_accvgpr_write_b32 a199, v71
    v_mfma_f32_16x16x32_bf16 v[240:243], a[168:171], v[48:51], v[240:243]
    ds_read_b64_tr_b16 a[160:161], v12 offset:256
    v_accvgpr_read_b32 v64, a16
    v_mfma_f32_16x16x32_bf16 v[248:251], a[168:171], v[52:55], v[248:251]
    s_add_u32 m0, s39, 12288
    ds_read_b64_tr_b16 a[162:163], v12 offset:2304
    v_accvgpr_read_b32 v65, a17
    v_accvgpr_read_b32 v66, a18
    v_mfma_f32_16x16x32_bf16 v[244:247], a[172:175], v[48:51], v[244:247]
    s_movk_i32 s34, 384
    ds_read_b64_tr_b16 a[164:165], v13 offset:256
    buffer_load_dwordx4 v6, s[8:11], s34 offen lds
    ds_read_b128 v[60:63], v17 offset:6144
    v_mfma_f32_16x16x32_bf16 v[252:255], a[172:175], v[52:55], v[252:255]
    s_waitcnt lgkmcnt(9)
    ds_read_b64_tr_b16 a[166:167], v13 offset:2304
    v_accvgpr_read_b32 v67, a19
    v_accvgpr_read_b32 v68, a20
    v_mfma_f32_16x16x32_bf16 v[160:163], a[176:179], v[32:35], v[160:163]
    s_add_u32 s51, s26, 128
    ds_read_b64_tr_b16 a[168:169], v14 offset:256
    buffer_load_dwordx4 a[0:3], v0, s[16:19], s51 offen offset:0 nt
    v_mfma_f32_16x16x32_bf16 v[168:171], a[176:179], v[36:39], v[168:171]
    ds_read_b64_tr_b16 a[170:171], v14 offset:2304
    v_accvgpr_read_b32 v69, a21
    v_accvgpr_read_b32 v70, a22
    v_mfma_f32_16x16x32_bf16 v[164:167], a[180:183], v[32:35], v[164:167]
    ds_read_b64_tr_b16 a[172:173], v15 offset:256
    v_accvgpr_read_b32 v71, a23
    v_mfma_f32_16x16x32_bf16 v[172:175], a[180:183], v[36:39], v[172:175]
    s_waitcnt lgkmcnt(9)
    ds_read_b64_tr_b16 a[174:175], v15 offset:2304
    v_accvgpr_read_b32 v72, a24
    v_accvgpr_read_b32 v73, a25
    v_mfma_f32_16x16x32_bf16 v[176:179], a[184:187], v[32:35], v[176:179]
    s_waitcnt vmcnt(23)
    s_barrier
    ds_read_b64_tr_b16 a[176:177], v8 offset:16384
    buffer_load_dwordx4 a[4:7], v1, s[16:19], s51 offen offset:1024 nt
    v_mfma_f32_16x16x32_bf16 v[184:187], a[184:187], v[36:39], v[184:187]
    s_add_u32 m0, s29, 65536
    ds_read_b64_tr_b16 a[178:179], v8 offset:18432
    v_accvgpr_read_b32 v74, a26
    v_accvgpr_read_b32 v75, a27
    v_mfma_f32_16x16x32_bf16 v[180:183], a[188:191], v[32:35], v[180:183]
    s_add_u32 s34, s32, 1572864
    ds_read_b64_tr_b16 a[180:181], v9 offset:16384
    buffer_load_dwordx4 v2, s[12:15], s34 offen offset:0 nt lds
    v_mfma_f32_16x16x32_bf16 v[188:191], a[188:191], v[36:39], v[188:191]
    s_waitcnt lgkmcnt(7)
    ds_read_b64_tr_b16 a[182:183], v9 offset:18432
    v_accvgpr_read_b32 v76, a28
    v_accvgpr_read_b32 v77, a29
    v_mfma_f32_16x16x32_bf16 v[192:195], a[160:163], v[32:35], v[192:195]
    s_add_u32 s51, s51, 6144
    ds_read_b64_tr_b16 a[184:185], v10 offset:16384
    buffer_load_dwordx4 a[8:11], v0, s[16:19], s51 offen offset:2048 nt
    v_mfma_f32_16x16x32_bf16 v[200:203], a[160:163], v[36:39], v[200:203]
    ds_read_b64_tr_b16 a[186:187], v10 offset:18432
    v_accvgpr_read_b32 v78, a30
    v_accvgpr_read_b32 v79, a31
    v_mfma_f32_16x16x32_bf16 v[196:199], a[164:167], v[32:35], v[196:199]
    ds_read_b64_tr_b16 a[188:189], v11 offset:16384
    v_mul_f32 v64, v64, v22
    v_mfma_f32_16x16x32_bf16 v[204:207], a[164:167], v[36:39], v[204:207]
    s_waitcnt lgkmcnt(7)
    ds_read_b64_tr_b16 a[190:191], v11 offset:18432
    buffer_load_dwordx4 v3, s[12:15], s34 offen offset:1024 nt lds
    v_mfma_f32_16x16x32_bf16 v[208:211], a[168:171], v[32:35], v[208:211]
    ds_read_b64_tr_b16 a[160:161], v12 offset:16384
    buffer_load_dwordx4 a[12:15], v1, s[16:19], s51 offen offset:3072 nt
    v_mfma_f32_16x16x32_bf16 v[216:219], a[168:171], v[36:39], v[216:219]
    ds_read_b64_tr_b16 a[162:163], v12 offset:18432
    v_mul_f32 v65, v65, v22
    v_mul_f32 v66, v66, v22
    v_mfma_f32_16x16x32_bf16 v[212:215], a[172:175], v[32:35], v[212:215]
    ds_read_b64_tr_b16 a[164:165], v13 offset:16384
    v_mul_f32 v67, v67, v22
    v_mul_f32 v68, v68, v22
    v_mfma_f32_16x16x32_bf16 v[220:223], a[172:175], v[36:39], v[220:223]
    s_waitcnt lgkmcnt(7)
    ds_read_b64_tr_b16 a[166:167], v13 offset:18432
    v_mul_f32 v69, v69, v22
    v_mul_f32 v70, v70, v22
    v_mfma_f32_16x16x32_bf16 v[96:99], a[176:179], v[40:43], v[96:99]
    s_add_u32 s34, s34, 30720
    ds_read_b64_tr_b16 a[168:169], v14 offset:16384
    buffer_load_dwordx4 v2, s[12:15], s34 offen offset:2048 nt lds
    v_mfma_f32_16x16x32_bf16 v[104:107], a[176:179], v[44:47], v[104:107]
    ds_read_b64_tr_b16 a[170:171], v14 offset:18432
    v_mul_f32 v71, v71, v22
    v_mul_f32 v72, v72, v23
    v_mfma_f32_16x16x32_bf16 v[100:103], a[180:183], v[40:43], v[100:103]
    ds_read_b64_tr_b16 a[172:173], v15 offset:16384
    v_mul_f32 v73, v73, v23
    v_mfma_f32_16x16x32_bf16 v[108:111], a[180:183], v[44:47], v[108:111]
    s_waitcnt lgkmcnt(7)
    ds_read_b64_tr_b16 a[174:175], v15 offset:18432
    v_xor_b32 v26, s44, v8
    v_mul_f32 v74, v74, v23
    v_mfma_f32_16x16x32_bf16 v[112:115], a[184:187], v[40:43], v[112:115]
    ds_read_b64_tr_b16 a[176:177], v26 offset:16384
    v_mul_f32 v75, v75, v23
    v_mul_f32 v76, v76, v23
    v_mfma_f32_16x16x32_bf16 v[120:123], a[184:187], v[44:47], v[120:123]
    ds_read_b64_tr_b16 a[178:179], v26 offset:18432
    buffer_load_dwordx4 v3, s[12:15], s34 offen offset:3072 nt lds
    v_xor_b32 v27, s44, v9
    v_mfma_f32_16x16x32_bf16 v[116:119], a[188:191], v[40:43], v[116:119]
    ds_read_b64_tr_b16 a[180:181], v27 offset:16384
    v_mul_f32 v77, v77, v23
    v_mul_f32 v78, v78, v23
A_stub11:
    s_cbranch_execz A_back
    v_mfma_f32_16x16x32_bf16 v[124:127], a[188:191], v[44:47], v[124:127]
    s_waitcnt lgkmcnt(7)
    ds_read_b64_tr_b16 a[182:183], v27 offset:18432
    v_xor_b32 v26, s44, v10
    v_mfma_f32_16x16x32_bf16 v[128:131], a[160:163], v[40:43], v[128:131]
    ds_read_b64_tr_b16 a[184:185], v26 offset:16384
    v_mul_f32 v79, v79, v23
    v_cvt_pk_bf16_f32 v64, v64, v65
    v_mfma_f32_16x16x32_bf16 v[136:139], a[160:163], v[44:47], v[136:139]
    s_add_u32 m0, s29, 81920
    ds_read_b64_tr_b16 a[186:187], v26 offset:18432
    v_xor_b32 v27, s44, v11
    v_cvt_pk_bf16_f32 v65, v66, v67
    v_mfma_f32_16x16x32_bf16 v[132:135], a[164:167], v[40:43], v[132:135]
    s_add_u32 s34, s32, 1835008
    ds_read_b64_tr_b16 a[188:189], v27 offset:16384
    buffer_load_dwordx4 v2, s[12:15], s34 offen offset:0 nt lds
    v_mfma_f32_16x16x32_bf16 v[140:143], a[164:167], v[44:47], v[140:143]
    s_waitcnt lgkmcnt(7)
    ds_read_b64_tr_b16 a[190:191], v27 offset:18432
    v_cvt_pk_bf16_f32 v66, v68, v69
    v_cvt_pk_bf16_f32 v67, v70, v71
    v_mfma_f32_16x16x32_bf16 v[144:147], a[168:171], v[40:43], v[144:147]
    ds_read_b64_tr_b16 a[160:161], v8 offset:16640
    v_cvt_pk_bf16_f32 v68, v72, v73
    v_cvt_pk_bf16_f32 v69, v74, v75
    v_mfma_f32_16x16x32_bf16 v[152:155], a[168:171], v[44:47], v[152:155]
    ds_read_b64_tr_b16 a[162:163], v8 offset:18688
    v_cvt_pk_bf16_f32 v70, v76, v77
    v_mfma_f32_16x16x32_bf16 v[148:151], a[172:175], v[40:43], v[148:151]
    ds_read_b64_tr_b16 a[164:165], v9 offset:16640
    v_cvt_pk_bf16_f32 v71, v78, v79
    v_accvgpr_write_b32 a200, v64
    v_mfma_f32_16x16x32_bf16 v[156:159], a[172:175], v[44:47], v[156:159]
    s_waitcnt lgkmcnt(7)
    ds_read_b64_tr_b16 a[166:167], v9 offset:18688
    buffer_load_dwordx4 v3, s[12:15], s34 offen offset:1024 nt lds
    v_mfma_f32_16x16x32_bf16 v[224:227], a[176:179], v[56:59], v[224:227]
    ds_read_b64_tr_b16 a[168:169], v10 offset:16640
    v_accvgpr_write_b32 a201, v65
    v_accvgpr_write_b32 a202, v66
    v_mfma_f32_16x16x32_bf16 v[232:235], a[176:179], v[60:63], v[232:235]
    ds_read_b64_tr_b16 a[170:171], v10 offset:18688
    v_accvgpr_write_b32 a203, v67
    v_accvgpr_write_b32 a204, v68
    v_mfma_f32_16x16x32_bf16 v[228:231], a[180:183], v[56:59], v[228:231]
    ds_read_b64_tr_b16 a[172:173], v11 offset:16640
    v_accvgpr_write_b32 a205, v69
    v_accvgpr_write_b32 a206, v70
    v_mfma_f32_16x16x32_bf16 v[236:239], a[180:183], v[60:63], v[236:239]
    s_waitcnt lgkmcnt(7)
    ds_read_b64_tr_b16 a[174:175], v11 offset:18688
    v_accvgpr_write_b32 a207, v71
    v_mfma_f32_16x16x32_bf16 v[240:243], a[184:187], v[56:59], v[240:243]
    s_add_u32 s34, s34, 30720
    ds_read_b64_tr_b16 a[176:177], v12 offset:16640
    buffer_load_dwordx4 v2, s[12:15], s34 offen offset:2048 nt lds
    v_mfma_f32_16x16x32_bf16 v[248:251], a[184:187], v[60:63], v[248:251]
    ds_read_b64_tr_b16 a[178:179], v12 offset:18688
    v_accvgpr_read_b32 v64, a32
    v_accvgpr_read_b32 v65, a33
    v_mfma_f32_16x16x32_bf16 v[244:247], a[188:191], v[56:59], v[244:247]
    ds_read_b64_tr_b16 a[180:181], v13 offset:16640
    v_accvgpr_read_b32 v66, a34
    v_accvgpr_read_b32 v67, a35
    v_mfma_f32_16x16x32_bf16 v[252:255], a[188:191], v[60:63], v[252:255]
    s_waitcnt lgkmcnt(7)
    ds_read_b64_tr_b16 a[182:183], v13 offset:18688
    v_accvgpr_read_b32 v68, a36
    v_accvgpr_read_b32 v69, a37
    v_mfma_f32_16x16x32_bf16 v[160:163], a[160:163], v[40:43], v[160:163]
    ds_read_b64_tr_b16 a[184:185], v14 offset:16640
    v_accvgpr_read_b32 v70, a38
    v_accvgpr_read_b32 v71, a39
    v_mfma_f32_16x16x32_bf16 v[168:171], a[160:163], v[44:47], v[168:171]
    ds_read_b64_tr_b16 a[186:187], v14 offset:18688
    buffer_load_dwordx4 v3, s[12:15], s34 offen offset:3072 nt lds
    v_mfma_f32_16x16x32_bf16 v[164:167], a[164:167], v[40:43], v[164:167]
    ds_read_b64_tr_b16 a[188:189], v15 offset:16640
    v_add_u32 v17, s41, v7
    v_mfma_f32_16x16x32_bf16 v[172:175], a[164:167], v[44:47], v[172:175]
    s_waitcnt lgkmcnt(7)
    ds_read_b64_tr_b16 a[190:191], v15 offset:18688
    v_accvgpr_read_b32 v72, a40
    v_accvgpr_read_b32 v73, a41
    v_mfma_f32_16x16x32_bf16 v[176:179], a[168:171], v[40:43], v[176:179]
    s_waitcnt vmcnt(22)
    s_barrier
    ds_read_b128 v[32:35], v17 offset:32768
    ds_read_b128 v[36:39], v17 offset:34816
    ds_read_b64_tr_b16 a[160:161], v8 offset:49152
    v_mfma_f32_16x16x32_bf16 v[184:187], a[168:171], v[44:47], v[184:187]
    s_add_u32 m0, s29, 98304
    ds_read_b64_tr_b16 a[162:163], v8 offset:51200
    v_accvgpr_read_b32 v74, a42
    v_accvgpr_read_b32 v75, a43
    v_mfma_f32_16x16x32_bf16 v[180:183], a[172:175], v[40:43], v[180:183]
    s_movk_i32 s34, 512
    ds_read_b64_tr_b16 a[164:165], v9 offset:49152
    buffer_load_dwordx4 v4, s[8:11], s34 offen offset:0 lds
    v_mfma_f32_16x16x32_bf16 v[188:191], a[172:175], v[44:47], v[188:191]
    s_waitcnt lgkmcnt(9)
    ds_read_b64_tr_b16 a[166:167], v9 offset:51200
    v_accvgpr_read_b32 v76, a44
    v_accvgpr_read_b32 v77, a45
    v_mfma_f32_16x16x32_bf16 v[192:195], a[176:179], v[40:43], v[192:195]
    ds_read_b64_tr_b16 a[168:169], v10 offset:49152
    v_accvgpr_read_b32 v78, a46
    v_mfma_f32_16x16x32_bf16 v[200:203], a[176:179], v[44:47], v[200:203]
    ds_read_b64_tr_b16 a[170:171], v10 offset:51200
    v_accvgpr_read_b32 v79, a47
    v_mul_f32 v64, v64, v22
    v_mfma_f32_16x16x32_bf16 v[196:199], a[180:183], v[40:43], v[196:199]
    ds_read_b64_tr_b16 a[172:173], v11 offset:49152
    v_mul_f32 v65, v65, v22
    v_mul_f32 v66, v66, v22
    v_mfma_f32_16x16x32_bf16 v[204:207], a[180:183], v[44:47], v[204:207]
    s_waitcnt lgkmcnt(9)
    ds_read_b64_tr_b16 a[174:175], v11 offset:51200
    v_mul_f32 v67, v67, v22
    v_mul_f32 v68, v68, v22
    v_mfma_f32_16x16x32_bf16 v[208:211], a[184:187], v[40:43], v[208:211]
    ds_read_b64_tr_b16 a[176:177], v12 offset:49152
    v_mul_f32 v69, v69, v22
    v_mul_f32 v70, v70, v22
    v_mfma_f32_16x16x32_bf16 v[216:219], a[184:187], v[44:47], v[216:219]
    ds_read_b64_tr_b16 a[178:179], v12 offset:51200
    v_mul_f32 v71, v71, v22
    v_mfma_f32_16x16x32_bf16 v[212:215], a[188:191], v[40:43], v[212:215]
    ds_read_b64_tr_b16 a[180:181], v13 offset:49152
    buffer_load_dwordx4 v5, s[8:11], s34 offen offset:1024 lds
    v_mfma_f32_16x16x32_bf16 v[220:223], a[188:191], v[44:47], v[220:223]
    s_waitcnt lgkmcnt(7)
    ds_read_b64_tr_b16 a[182:183], v13 offset:51200
    v_mul_f32 v72, v72, v23
    v_mul_f32 v73, v73, v23
    v_mfma_f32_16x16x32_bf16 v[96:99], a[160:163], v[32:35], v[96:99]
    ds_read_b64_tr_b16 a[184:185], v14 offset:49152
    v_mul_f32 v74, v74, v23
    v_mul_f32 v75, v75, v23
    v_mfma_f32_16x16x32_bf16 v[104:107], a[160:163], v[36:39], v[104:107]
    ds_read_b64_tr_b16 a[186:187], v14 offset:51200
    ds_read_b128 v[48:51], v7 offset:8192
    v_mul_f32 v76, v76, v23
    v_mfma_f32_16x16x32_bf16 v[100:103], a[164:167], v[32:35], v[100:103]
    ds_read_b64_tr_b16 a[188:189], v15 offset:49152
    v_mul_f32 v77, v77, v23
    v_mul_f32 v78, v78, v23
    v_mfma_f32_16x16x32_bf16 v[108:111], a[164:167], v[36:39], v[108:111]
    s_waitcnt lgkmcnt(8)
    ds_read_b64_tr_b16 a[190:191], v15 offset:51200
    v_xor_b32 v26, s44, v8
    v_mfma_f32_16x16x32_bf16 v[112:115], a[168:171], v[32:35], v[112:115]
    ds_read_b64_tr_b16 a[160:161], v26 offset:49152
    ds_read_b128 v[52:55], v7 offset:10240
    v_mul_f32 v79, v79, v23
    v_mfma_f32_16x16x32_bf16 v[120:123], a[168:171], v[36:39], v[120:123]
    ds_read_b64_tr_b16 a[162:163], v26 offset:51200
    v_xor_b32 v27, s44, v9
    v_cvt_pk_bf16_f32 v64, v64, v65
    v_mfma_f32_16x16x32_bf16 v[116:119], a[172:175], v[32:35], v[116:119]
    s_add_u32 s34, s34, 12288
    ds_read_b64_tr_b16 a[164:165], v27 offset:49152
    buffer_load_dwordx4 v4, s[8:11], s34 offen offset:2048 lds
    v_mfma_f32_16x16x32_bf16 v[124:127], a[172:175], v[36:39], v[124:127]
    s_waitcnt lgkmcnt(9)
    ds_read_b64_tr_b16 a[166:167], v27 offset:51200
    v_xor_b32 v26, s44, v10
    v_xor_b32 v17, 64, v17
    v_mfma_f32_16x16x32_bf16 v[128:131], a[176:179], v[32:35], v[128:131]
    s_add_u32 s51, s26, 256
    ds_read_b64_tr_b16 a[168:169], v26 offset:49152
    buffer_load_dwordx4 a[16:19], v0, s[16:19], s51 offen offset:0 nt
    v_mfma_f32_16x16x32_bf16 v[136:139], a[176:179], v[36:39], v[136:139]
    ds_read_b64_tr_b16 a[170:171], v26 offset:51200
    v_xor_b32 v27, s44, v11
    v_cvt_pk_bf16_f32 v65, v66, v67
    v_mfma_f32_16x16x32_bf16 v[132:135], a[180:183], v[32:35], v[132:135]
    ds_read_b64_tr_b16 a[172:173], v27 offset:49152
    ds_read_b128 v[40:43], v17 offset:32768
    v_cvt_pk_bf16_f32 v66, v68, v69
    v_mfma_f32_16x16x32_bf16 v[140:143], a[180:183], v[36:39], v[140:143]
    s_waitcnt lgkmcnt(9)
    ds_read_b64_tr_b16 a[174:175], v27 offset:51200
    v_cvt_pk_bf16_f32 v67, v70, v71
    v_mfma_f32_16x16x32_bf16 v[144:147], a[184:187], v[32:35], v[144:147]
    ds_read_b64_tr_b16 a[176:177], v8 offset:49408
    buffer_load_dwordx4 a[20:23], v1, s[16:19], s51 offen offset:1024 nt
    v_mfma_f32_16x16x32_bf16 v[152:155], a[184:187], v[36:39], v[152:155]
    ds_read_b64_tr_b16 a[178:179], v8 offset:51456
    ds_read_b128 v[44:47], v17 offset:34816
    v_xor_b32 v8, 0x10000, v8
    v_mfma_f32_16x16x32_bf16 v[148:151], a[188:191], v[32:35], v[148:151]
    ds_read_b64_tr_b16 a[180:181], v9 offset:49408
    buffer_load_dwordx4 v5, s[8:11], s34 offen offset:3072 lds
    v_mfma_f32_16x16x32_bf16 v[156:159], a[188:191], v[36:39], v[156:159]
    s_waitcnt lgkmcnt(9)
    ds_read_b64_tr_b16 a[182:183], v9 offset:51456
    v_xor_b32 v9, 0x10000, v9
    v_cvt_pk_bf16_f32 v68, v72, v73
    v_mfma_f32_16x16x32_bf16 v[224:227], a[160:163], v[48:51], v[224:227]
    s_add_u32 s51, s51, 6144
    ds_read_b64_tr_b16 a[184:185], v10 offset:49408
    buffer_load_dwordx4 a[24:27], v0, s[16:19], s51 offen offset:2048 nt
    v_xor_b32 v17, 64, v7
    v_mfma_f32_16x16x32_bf16 v[232:235], a[160:163], v[52:55], v[232:235]
    ds_read_b64_tr_b16 a[186:187], v10 offset:51456
    v_xor_b32 v10, 0x10000, v10
    v_cvt_pk_bf16_f32 v69, v74, v75
    v_mfma_f32_16x16x32_bf16 v[228:231], a[164:167], v[48:51], v[228:231]
    ds_read_b64_tr_b16 a[188:189], v11 offset:49408
    v_cvt_pk_bf16_f32 v70, v76, v77
    v_cvt_pk_bf16_f32 v71, v78, v79
    v_mfma_f32_16x16x32_bf16 v[236:239], a[164:167], v[52:55], v[236:239]
    s_waitcnt lgkmcnt(8)
    ds_read_b64_tr_b16 a[190:191], v11 offset:51456
    ds_read_b128 v[56:59], v17 offset:8192
    v_xor_b32 v11, 0x10000, v11
    v_mfma_f32_16x16x32_bf16 v[240:243], a[168:171], v[48:51], v[240:243]
    ds_read_b64_tr_b16 a[160:161], v12 offset:49408
    buffer_load_dwordx4 a[28:31], v1, s[16:19], s51 offen offset:3072 nt
    v_mfma_f32_16x16x32_bf16 v[248:251], a[168:171], v[52:55], v[248:251]
    s_add_u32 m0, s39, 16384
    ds_read_b64_tr_b16 a[162:163], v12 offset:51456
    v_xor_b32 v12, 0x10000, v12
    v_mfma_f32_16x16x32_bf16 v[244:247], a[172:175], v[48:51], v[244:247]
    s_movk_i32 s34, 512
    ds_read_b64_tr_b16 a[164:165], v13 offset:49408
    buffer_load_dwordx4 v6, s[8:11], s34 offen lds
    ds_read_b128 v[60:63], v17 offset:10240
    v_mfma_f32_16x16x32_bf16 v[252:255], a[172:175], v[52:55], v[252:255]
    s_waitcnt lgkmcnt(9)
    ds_read_b64_tr_b16 a[166:167], v13 offset:51456
    v_xor_b32 v13, 0x10000, v13
    v_accvgpr_write_b32 a208, v64
    v_mfma_f32_16x16x32_bf16 v[160:163], a[176:179], v[32:35], v[160:163]
    ds_read_b64_tr_b16 a[168:169], v14 offset:49408
    v_accvgpr_write_b32 a209, v65
    v_accvgpr_write_b32 a210, v66
    v_mfma_f32_16x16x32_bf16 v[168:171], a[176:179], v[36:39], v[168:171]
    ds_read_b64_tr_b16 a[170:171], v14 offset:51456
    v_xor_b32 v14, 0x10000, v14
    v_accvgpr_write_b32 a211, v67
    v_mfma_f32_16x16x32_bf16 v[164:167], a[180:183], v[32:35], v[164:167]
    ds_read_b64_tr_b16 a[172:173], v15 offset:49408
    v_accvgpr_write_b32 a212, v68
    v_accvgpr_write_b32 a213, v69
    v_mfma_f32_16x16x32_bf16 v[172:175], a[180:183], v[36:39], v[172:175]
    s_waitcnt lgkmcnt(9)
    ds_read_b64_tr_b16 a[174:175], v15 offset:51456
    v_xor_b32 v15, 0x10000, v15
    v_mfma_f32_16x16x32_bf16 v[176:179], a[184:187], v[32:35], v[176:179]
    s_waitcnt vmcnt(26)
    s_barrier
    ds_read_b64_tr_b16 a[176:177], v8 offset:0
    v_mfma_f32_16x16x32_bf16 v[184:187], a[184:187], v[36:39], v[184:187]
    s_add_u32 m0, s29, 114688
    ds_read_b64_tr_b16 a[178:179], v8 offset:2048
    v_accvgpr_write_b32 a214, v70
    v_accvgpr_write_b32 a215, v71
    v_mfma_f32_16x16x32_bf16 v[180:183], a[188:191], v[32:35], v[180:183]
    s_add_u32 s34, s32, 2097152
    ds_read_b64_tr_b16 a[180:181], v9 offset:0
    buffer_load_dwordx4 v2, s[12:15], s34 offen offset:0 nt lds
    v_mfma_f32_16x16x32_bf16 v[188:191], a[188:191], v[36:39], v[188:191]
    s_waitcnt lgkmcnt(7)
    ds_read_b64_tr_b16 a[182:183], v9 offset:2048
    v_accvgpr_read_b32 v64, a48
    v_accvgpr_read_b32 v65, a49
    v_mfma_f32_16x16x32_bf16 v[192:195], a[160:163], v[32:35], v[192:195]
    ds_read_b64_tr_b16 a[184:185], v10 offset:0
    v_accvgpr_read_b32 v66, a50
    v_accvgpr_read_b32 v67, a51
    v_mfma_f32_16x16x32_bf16 v[200:203], a[160:163], v[36:39], v[200:203]
    ds_read_b64_tr_b16 a[186:187], v10 offset:2048
    v_accvgpr_read_b32 v68, a52
    v_accvgpr_read_b32 v69, a53
    v_mfma_f32_16x16x32_bf16 v[196:199], a[164:167], v[32:35], v[196:199]
    ds_read_b64_tr_b16 a[188:189], v11 offset:0
    v_accvgpr_read_b32 v70, a54
    v_mfma_f32_16x16x32_bf16 v[204:207], a[164:167], v[36:39], v[204:207]
    s_waitcnt lgkmcnt(7)
    ds_read_b64_tr_b16 a[190:191], v11 offset:2048
    buffer_load_dwordx4 v3, s[12:15], s34 offen offset:1024 nt lds
    v_mfma_f32_16x16x32_bf16 v[208:211], a[168:171], v[32:35], v[208:211]
    ds_read_b64_tr_b16 a[160:161], v12 offset:0
    v_accvgpr_read_b32 v71, a55
    v_accvgpr_read_b32 v72, a56
    v_mfma_f32_16x16x32_bf16 v[216:219], a[168:171], v[36:39], v[216:219]
    ds_read_b64_tr_b16 a[162:163], v12 offset:2048
    v_accvgpr_read_b32 v73, a57
    v_accvgpr_read_b32 v74, a58
    v_mfma_f32_16x16x32_bf16 v[212:215], a[172:175], v[32:35], v[212:215]
    ds_read_b64_tr_b16 a[164:165], v13 offset:0
    v_accvgpr_read_b32 v75, a59
    v_accvgpr_read_b32 v76, a60
    v_mfma_f32_16x16x32_bf16 v[220:223], a[172:175], v[36:39], v[220:223]
    s_waitcnt lgkmcnt(7)
    ds_read_b64_tr_b16 a[166:167], v13 offset:2048
    v_accvgpr_read_b32 v77, a61
    v_accvgpr_read_b32 v78, a62
    v_mfma_f32_16x16x32_bf16 v[96:99], a[176:179], v[40:43], v[96:99]
    s_add_u32 s34, s34, 30720
    ds_read_b64_tr_b16 a[168:169], v14 offset:0
    buffer_load_dwordx4 v2, s[12:15], s34 offen offset:2048 nt lds
    v_mfma_f32_16x16x32_bf16 v[104:107], a[176:179], v[44:47], v[104:107]
    ds_read_b64_tr_b16 a[170:171], v14 offset:2048
    v_accvgpr_read_b32 v79, a63
    v_mfma_f32_16x16x32_bf16 v[100:103], a[180:183], v[40:43], v[100:103]
    ds_read_b64_tr_b16 a[172:173], v15 offset:0
    v_mul_f32 v64, v64, v22
    v_mul_f32 v65, v65, v22
    v_mfma_f32_16x16x32_bf16 v[108:111], a[180:183], v[44:47], v[108:111]
    s_waitcnt lgkmcnt(7)
    ds_read_b64_tr_b16 a[174:175], v15 offset:2048
    v_xor_b32 v26, s44, v8
    v_mul_f32 v66, v66, v22
    v_mfma_f32_16x16x32_bf16 v[112:115], a[184:187], v[40:43], v[112:115]
    ds_read_b64_tr_b16 a[176:177], v26 offset:0
    v_mul_f32 v67, v67, v22
    v_mul_f32 v68, v68, v22
    v_mfma_f32_16x16x32_bf16 v[120:123], a[184:187], v[44:47], v[120:123]
    ds_read_b64_tr_b16 a[178:179], v26 offset:2048
    buffer_load_dwordx4 v3, s[12:15], s34 offen offset:3072 nt lds
    v_xor_b32 v27, s44, v9
    v_mfma_f32_16x16x32_bf16 v[116:119], a[188:191], v[40:43], v[116:119]
    ds_read_b64_tr_b16 a[180:181], v27 offset:0
    v_mul_f32 v69, v69, v22
    v_mfma_f32_16x16x32_bf16 v[124:127], a[188:191], v[44:47], v[124:127]
    s_waitcnt lgkmcnt(7)
    ds_read_b64_tr_b16 a[182:183], v27 offset:2048
    v_xor_b32 v26, s44, v10
    v_mul_f32 v70, v70, v22
    v_mfma_f32_16x16x32_bf16 v[128:131], a[160:163], v[40:43], v[128:131]
    ds_read_b64_tr_b16 a[184:185], v26 offset:0
    v_mul_f32 v71, v71, v22
    v_mul_f32 v72, v72, v23
    v_mfma_f32_16x16x32_bf16 v[136:139], a[160:163], v[44:47], v[136:139]
    s_add_u32 m0, s29, 131072
    ds_read_b64_tr_b16 a[186:187], v26 offset:2048
    v_xor_b32 v27, s44, v11
    v_mul_f32 v73, v73, v23
    v_mfma_f32_16x16x32_bf16 v[132:135], a[164:167], v[40:43], v[132:135]
    s_add_u32 s34, s32, 2359296
    ds_read_b64_tr_b16 a[188:189], v27 offset:0
    buffer_load_dwordx4 v2, s[12:15], s34 offen offset:0 nt lds
    v_mfma_f32_16x16x32_bf16 v[140:143], a[164:167], v[44:47], v[140:143]
    s_waitcnt lgkmcnt(7)
    ds_read_b64_tr_b16 a[190:191], v27 offset:2048
    v_mul_f32 v74, v74, v23
    v_mul_f32 v75, v75, v23
    v_mfma_f32_16x16x32_bf16 v[144:147], a[168:171], v[40:43], v[144:147]
    ds_read_b64_tr_b16 a[160:161], v8 offset:256
    v_mul_f32 v76, v76, v23
    v_mfma_f32_16x16x32_bf16 v[152:155], a[168:171], v[44:47], v[152:155]
    ds_read_b64_tr_b16 a[162:163], v8 offset:2304
    v_mul_f32 v77, v77, v23
    v_mul_f32 v78, v78, v23
    v_mfma_f32_16x16x32_bf16 v[148:151], a[172:175], v[40:43], v[148:151]
    ds_read_b64_tr_b16 a[164:165], v9 offset:256
    v_mul_f32 v79, v79, v23
    v_cvt_pk_bf16_f32 v64, v64, v65
    v_mfma_f32_16x16x32_bf16 v[156:159], a[172:175], v[44:47], v[156:159]
    s_waitcnt lgkmcnt(7)
    ds_read_b64_tr_b16 a[166:167], v9 offset:2304
    buffer_load_dwordx4 v3, s[12:15], s34 offen offset:1024 nt lds
    v_mfma_f32_16x16x32_bf16 v[224:227], a[176:179], v[56:59], v[224:227]
    ds_read_b64_tr_b16 a[168:169], v10 offset:256
    v_cvt_pk_bf16_f32 v65, v66, v67
    v_cvt_pk_bf16_f32 v66, v68, v69
    v_mfma_f32_16x16x32_bf16 v[232:235], a[176:179], v[60:63], v[232:235]
    ds_read_b64_tr_b16 a[170:171], v10 offset:2304
    v_cvt_pk_bf16_f32 v67, v70, v71
    v_cvt_pk_bf16_f32 v68, v72, v73
    v_mfma_f32_16x16x32_bf16 v[228:231], a[180:183], v[56:59], v[228:231]
    ds_read_b64_tr_b16 a[172:173], v11 offset:256
    v_cvt_pk_bf16_f32 v69, v74, v75
    v_mfma_f32_16x16x32_bf16 v[236:239], a[180:183], v[60:63], v[236:239]
    s_waitcnt lgkmcnt(7)
    ds_read_b64_tr_b16 a[174:175], v11 offset:2304
    v_cvt_pk_bf16_f32 v70, v76, v77
    v_cvt_pk_bf16_f32 v71, v78, v79
    v_mfma_f32_16x16x32_bf16 v[240:243], a[184:187], v[56:59], v[240:243]
    s_add_u32 s34, s34, 30720
    ds_read_b64_tr_b16 a[176:177], v12 offset:256
    buffer_load_dwordx4 v2, s[12:15], s34 offen offset:2048 nt lds
    v_mfma_f32_16x16x32_bf16 v[248:251], a[184:187], v[60:63], v[248:251]
    ds_read_b64_tr_b16 a[178:179], v12 offset:2304
    v_accvgpr_write_b32 a216, v64
    v_accvgpr_write_b32 a217, v65
    v_mfma_f32_16x16x32_bf16 v[244:247], a[188:191], v[56:59], v[244:247]
    ds_read_b64_tr_b16 a[180:181], v13 offset:256
    v_accvgpr_write_b32 a218, v66
    v_accvgpr_write_b32 a219, v67
    v_mfma_f32_16x16x32_bf16 v[252:255], a[188:191], v[60:63], v[252:255]
    s_waitcnt lgkmcnt(7)
    ds_read_b64_tr_b16 a[182:183], v13 offset:2304
    v_accvgpr_write_b32 a220, v68
    v_mfma_f32_16x16x32_bf16 v[160:163], a[160:163], v[40:43], v[160:163]
    ds_read_b64_tr_b16 a[184:185], v14 offset:256
    v_accvgpr_write_b32 a221, v69
    v_accvgpr_write_b32 a222, v70
    v_mfma_f32_16x16x32_bf16 v[168:171], a[160:163], v[44:47], v[168:171]
    ds_read_b64_tr_b16 a[186:187], v14 offset:2304
    buffer_load_dwordx4 v3, s[12:15], s34 offen offset:3072 nt lds
    v_mfma_f32_16x16x32_bf16 v[164:167], a[164:167], v[40:43], v[164:167]
    ds_read_b64_tr_b16 a[188:189], v15 offset:256
    v_add_u32 v17, s40, v7
    v_accvgpr_write_b32 a223, v71
    v_mfma_f32_16x16x32_bf16 v[172:175], a[164:167], v[44:47], v[172:175]
    s_waitcnt lgkmcnt(7)
    ds_read_b64_tr_b16 a[190:191], v15 offset:2304
    v_accvgpr_read_b32 v64, a64
    v_accvgpr_read_b32 v65, a65
    v_mfma_f32_16x16x32_bf16 v[176:179], a[168:171], v[40:43], v[176:179]
    s_waitcnt vmcnt(21)
    s_barrier
    ds_read_b128 v[32:35], v17 offset:16384
    ds_read_b128 v[36:39], v17 offset:18432
    ds_read_b64_tr_b16 a[160:161], v8 offset:32768
    v_mfma_f32_16x16x32_bf16 v[184:187], a[168:171], v[44:47], v[184:187]
    s_add_u32 m0, s29, 147456
    ds_read_b64_tr_b16 a[162:163], v8 offset:34816
    v_accvgpr_read_b32 v66, a66
    v_accvgpr_read_b32 v67, a67
    v_mfma_f32_16x16x32_bf16 v[180:183], a[172:175], v[40:43], v[180:183]
    s_movk_i32 s34, 640
    ds_read_b64_tr_b16 a[164:165], v9 offset:32768
    buffer_load_dwordx4 v4, s[8:11], s34 offen offset:0 lds
    v_mfma_f32_16x16x32_bf16 v[188:191], a[172:175], v[44:47], v[188:191]
    s_waitcnt lgkmcnt(9)
    ds_read_b64_tr_b16 a[166:167], v9 offset:34816
    v_accvgpr_read_b32 v68, a68
    v_mfma_f32_16x16x32_bf16 v[192:195], a[176:179], v[40:43], v[192:195]
    s_add_u32 s51, s26, 384
    ds_read_b64_tr_b16 a[168:169], v10 offset:32768
    buffer_load_dwordx4 a[32:35], v0, s[16:19], s51 offen offset:0 nt
    v_mfma_f32_16x16x32_bf16 v[200:203], a[176:179], v[44:47], v[200:203]
    ds_read_b64_tr_b16 a[170:171], v10 offset:34816
    v_accvgpr_read_b32 v69, a69
    v_accvgpr_read_b32 v70, a70
    v_mfma_f32_16x16x32_bf16 v[196:199], a[180:183], v[40:43], v[196:199]
    ds_read_b64_tr_b16 a[172:173], v11 offset:32768
    v_accvgpr_read_b32 v71, a71
    v_accvgpr_read_b32 v72, a72
    v_mfma_f32_16x16x32_bf16 v[204:207], a[180:183], v[44:47], v[204:207]
    s_waitcnt lgkmcnt(9)
    ds_read_b64_tr_b16 a[174:175], v11 offset:34816
    v_accvgpr_read_b32 v73, a73
    v_accvgpr_read_b32 v74, a74
    v_mfma_f32_16x16x32_bf16 v[208:211], a[184:187], v[40:43], v[208:211]
    ds_read_b64_tr_b16 a[176:177], v12 offset:32768
    buffer_load_dwordx4 a[36:39], v1, s[16:19], s51 offen offset:1024 nt
    v_mfma_f32_16x16x32_bf16 v[216:219], a[184:187], v[44:47], v[216:219]
    ds_read_b64_tr_b16 a[178:179], v12 offset:34816
    v_accvgpr_read_b32 v75, a75
    v_accvgpr_read_b32 v76, a76
    v_mfma_f32_16x16x32_bf16 v[212:215], a[188:191], v[40:43], v[212:215]
    ds_read_b64_tr_b16 a[180:181], v13 offset:32768
    buffer_load_dwordx4 v5, s[8:11], s34 offen offset:1024 lds
    v_mfma_f32_16x16x32_bf16 v[220:223], a[188:191], v[44:47], v[220:223]
    s_waitcnt lgkmcnt(7)
    ds_read_b64_tr_b16 a[182:183], v13 offset:34816
    v_accvgpr_read_b32 v77, a77
    v_mfma_f32_16x16x32_bf16 v[96:99], a[160:163], v[32:35], v[96:99]
    s_add_u32 s51, s51, 6144
    ds_read_b64_tr_b16 a[184:185], v14 offset:32768
    buffer_load_dwordx4 a[40:43], v0, s[16:19], s51 offen offset:2048 nt
    v_mfma_f32_16x16x32_bf16 v[104:107], a[160:163], v[36:39], v[104:107]
    ds_read_b64_tr_b16 a[186:187], v14 offset:34816
    ds_read_b128 v[48:51], v7 offset:12288
    v_accvgpr_read_b32 v78, a78
    v_mfma_f32_16x16x32_bf16 v[100:103], a[164:167], v[32:35], v[100:103]
    ds_read_b64_tr_b16 a[188:189], v15 offset:32768
    v_accvgpr_read_b32 v79, a79
    v_mul_f32 v64, v64, v22
    v_mfma_f32_16x16x32_bf16 v[108:111], a[164:167], v[36:39], v[108:111]
    s_waitcnt lgkmcnt(8)
    ds_read_b64_tr_b16 a[190:191], v15 offset:34816
    v_xor_b32 v26, s44, v8
    v_mul_f32 v65, v65, v22
    v_mfma_f32_16x16x32_bf16 v[112:115], a[168:171], v[32:35], v[112:115]
    ds_read_b64_tr_b16 a[160:161], v26 offset:32768
    buffer_load_dwordx4 a[44:47], v1, s[16:19], s51 offen offset:3072 nt
    ds_read_b128 v[52:55], v7 offset:14336
    v_mfma_f32_16x16x32_bf16 v[120:123], a[168:171], v[36:39], v[120:123]
    ds_read_b64_tr_b16 a[162:163], v26 offset:34816
    v_xor_b32 v27, s44, v9
    v_mul_f32 v66, v66, v22
    v_mfma_f32_16x16x32_bf16 v[116:119], a[172:175], v[32:35], v[116:119]
    s_add_u32 s34, s34, 12288
    ds_read_b64_tr_b16 a[164:165], v27 offset:32768
    buffer_load_dwordx4 v4, s[8:11], s34 offen offset:2048 lds
    v_mfma_f32_16x16x32_bf16 v[124:127], a[172:175], v[36:39], v[124:127]
    s_waitcnt lgkmcnt(9)
    ds_read_b64_tr_b16 a[166:167], v27 offset:34816
    v_xor_b32 v26, s44, v10
    v_xor_b32 v17, 64, v17
    v_mfma_f32_16x16x32_bf16 v[128:131], a[176:179], v[32:35], v[128:131]
    ds_read_b64_tr_b16 a[168:169], v26 offset:32768
    v_mul_f32 v67, v67, v22
    v_mfma_f32_16x16x32_bf16 v[136:139], a[176:179], v[36:39], v[136:139]
    ds_read_b64_tr_b16 a[170:171], v26 offset:34816
    v_xor_b32 v27, s44, v11
    v_mul_f32 v68, v68, v22
    v_mfma_f32_16x16x32_bf16 v[132:135], a[180:183], v[32:35], v[132:135]
    ds_read_b64_tr_b16 a[172:173], v27 offset:32768
    ds_read_b128 v[40:43], v17 offset:16384
    v_mul_f32 v69, v69, v22
    v_mfma_f32_16x16x32_bf16 v[140:143], a[180:183], v[36:39], v[140:143]
    s_waitcnt lgkmcnt(9)
    ds_read_b64_tr_b16 a[174:175], v27 offset:34816
    v_mul_f32 v70, v70, v22
    v_mul_f32 v71, v71, v22
    v_mfma_f32_16x16x32_bf16 v[144:147], a[184:187], v[32:35], v[144:147]
    ds_read_b64_tr_b16 a[176:177], v8 offset:33024
    v_mul_f32 v72, v72, v23
    v_mfma_f32_16x16x32_bf16 v[152:155], a[184:187], v[36:39], v[152:155]
    ds_read_b64_tr_b16 a[178:179], v8 offset:35072
    ds_read_b128 v[44:47], v17 offset:18432
    v_mul_f32 v73, v73, v23
    v_mfma_f32_16x16x32_bf16 v[148:151], a[188:191], v[32:35], v[148:151]
    ds_read_b64_tr_b16 a[180:181], v9 offset:33024
    buffer_load_dwordx4 v5, s[8:11], s34 offen offset:3072 lds
    v_mfma_f32_16x16x32_bf16 v[156:159], a[188:191], v[36:39], v[156:159]
    s_waitcnt lgkmcnt(9)
    ds_read_b64_tr_b16 a[182:183], v9 offset:35072
    v_mul_f32 v74, v74, v23
    v_mul_f32 v75, v75, v23
    v_mfma_f32_16x16x32_bf16 v[224:227], a[160:163], v[48:51], v[224:227]
    ds_read_b64_tr_b16 a[184:185], v10 offset:33024
    v_xor_b32 v17, 64, v7
    v_mul_f32 v76, v76, v23
    v_mfma_f32_16x16x32_bf16 v[232:235], a[160:163], v[52:55], v[232:235]
    ds_read_b64_tr_b16 a[186:187], v10 offset:35072
    v_mul_f32 v77, v77, v23
    v_mul_f32 v78, v78, v23
    v_mfma_f32_16x16x32_bf16 v[228:231], a[164:167], v[48:51], v[228:231]
    ds_read_b64_tr_b16 a[188:189], v11 offset:33024
    v_mul_f32 v79, v79, v23
    v_mfma_f32_16x16x32_bf16 v[236:239], a[164:167], v[52:55], v[236:239]
    s_waitcnt lgkmcnt(8)
    ds_read_b64_tr_b16 a[190:191], v11 offset:35072
    ds_read_b128 v[56:59], v17 offset:12288
    v_cvt_pk_bf16_f32 v64, v64, v65
    v_mfma_f32_16x16x32_bf16 v[240:243], a[168:171], v[48:51], v[240:243]
    ds_read_b64_tr_b16 a[160:161], v12 offset:33024
    v_cvt_pk_bf16_f32 v65, v66, v67
    v_cvt_pk_bf16_f32 v66, v68, v69
    v_mfma_f32_16x16x32_bf16 v[248:251], a[168:171], v[52:55], v[248:251]
    s_add_u32 m0, s39, 20480
    ds_read_b64_tr_b16 a[162:163], v12 offset:35072
    v_cvt_pk_bf16_f32 v67, v70, v71
    v_cvt_pk_bf16_f32 v68, v72, v73
    v_mfma_f32_16x16x32_bf16 v[244:247], a[172:175], v[48:51], v[244:247]
    s_movk_i32 s34, 640
    ds_read_b64_tr_b16 a[164:165], v13 offset:33024
    buffer_load_dwordx4 v6, s[8:11], s34 offen lds
    ds_read_b128 v[60:63], v17 offset:14336
    v_mfma_f32_16x16x32_bf16 v[252:255], a[172:175], v[52:55], v[252:255]
    s_waitcnt lgkmcnt(9)
    ds_read_b64_tr_b16 a[166:167], v13 offset:35072
    v_cvt_pk_bf16_f32 v69, v74, v75
    v_cvt_pk_bf16_f32 v70, v76, v77
    v_mfma_f32_16x16x32_bf16 v[160:163], a[176:179], v[32:35], v[160:163]
    ds_read_b64_tr_b16 a[168:169], v14 offset:33024
    v_cvt_pk_bf16_f32 v71, v78, v79
    v_mfma_f32_16x16x32_bf16 v[168:171], a[176:179], v[36:39], v[168:171]
    s_nop 0
A_stub12:
    s_cbranch_execz A_back
    ds_read_b64_tr_b16 a[170:171], v14 offset:35072
    v_accvgpr_write_b32 a128, v64
    v_accvgpr_write_b32 a129, v65
    v_mfma_f32_16x16x32_bf16 v[164:167], a[180:183], v[32:35], v[164:167]
    ds_read_b64_tr_b16 a[172:173], v15 offset:33024
    v_accvgpr_write_b32 a130, v66
    v_accvgpr_write_b32 a131, v67
    v_mfma_f32_16x16x32_bf16 v[172:175], a[180:183], v[36:39], v[172:175]
    s_waitcnt lgkmcnt(9)
    ds_read_b64_tr_b16 a[174:175], v15 offset:35072
    v_accvgpr_write_b32 a132, v68
    v_accvgpr_write_b32 a133, v69
    v_mfma_f32_16x16x32_bf16 v[176:179], a[184:187], v[32:35], v[176:179]
    s_waitcnt vmcnt(26)
    s_barrier
    ds_read_b64_tr_b16 a[176:177], v8 offset:49152
    v_mfma_f32_16x16x32_bf16 v[184:187], a[184:187], v[36:39], v[184:187]
    s_add_u32 m0, s29, 32768
    ds_read_b64_tr_b16 a[178:179], v8 offset:51200
    v_accvgpr_write_b32 a134, v70
    v_accvgpr_write_b32 a135, v71
    v_mfma_f32_16x16x32_bf16 v[180:183], a[188:191], v[32:35], v[180:183]
    s_add_u32 s34, s32, 2621440
    ds_read_b64_tr_b16 a[180:181], v9 offset:49152
    buffer_load_dwordx4 v2, s[12:15], s34 offen offset:0 nt lds
    v_mfma_f32_16x16x32_bf16 v[188:191], a[188:191], v[36:39], v[188:191]
    s_waitcnt lgkmcnt(7)
    ds_read_b64_tr_b16 a[182:183], v9 offset:51200
    v_accvgpr_read_b32 v64, a80
    v_mfma_f32_16x16x32_bf16 v[192:195], a[160:163], v[32:35], v[192:195]
    ds_read_b64_tr_b16 a[184:185], v10 offset:49152
    v_accvgpr_read_b32 v65, a81
    v_accvgpr_read_b32 v66, a82
    v_mfma_f32_16x16x32_bf16 v[200:203], a[160:163], v[36:39], v[200:203]
    ds_read_b64_tr_b16 a[186:187], v10 offset:51200
    v_accvgpr_read_b32 v67, a83
    v_accvgpr_read_b32 v68, a84
    v_mfma_f32_16x16x32_bf16 v[196:199], a[164:167], v[32:35], v[196:199]
    ds_read_b64_tr_b16 a[188:189], v11 offset:49152
    v_accvgpr_read_b32 v69, a85
    v_accvgpr_read_b32 v70, a86
    v_mfma_f32_16x16x32_bf16 v[204:207], a[164:167], v[36:39], v[204:207]
    s_waitcnt lgkmcnt(7)
    ds_read_b64_tr_b16 a[190:191], v11 offset:51200
    buffer_load_dwordx4 v3, s[12:15], s34 offen offset:1024 nt lds
    v_mfma_f32_16x16x32_bf16 v[208:211], a[168:171], v[32:35], v[208:211]
    ds_read_b64_tr_b16 a[160:161], v12 offset:49152
    v_accvgpr_read_b32 v71, a87
    v_mfma_f32_16x16x32_bf16 v[216:219], a[168:171], v[36:39], v[216:219]
    ds_read_b64_tr_b16 a[162:163], v12 offset:51200
    v_accvgpr_read_b32 v72, a88
    v_accvgpr_read_b32 v73, a89
    v_mfma_f32_16x16x32_bf16 v[212:215], a[172:175], v[32:35], v[212:215]
    ds_read_b64_tr_b16 a[164:165], v13 offset:49152
    v_accvgpr_read_b32 v74, a90
    v_accvgpr_read_b32 v75, a91
    v_mfma_f32_16x16x32_bf16 v[220:223], a[172:175], v[36:39], v[220:223]
    s_waitcnt lgkmcnt(7)
    ds_read_b64_tr_b16 a[166:167], v13 offset:51200
    v_accvgpr_read_b32 v76, a92
    v_accvgpr_read_b32 v77, a93
    v_mfma_f32_16x16x32_bf16 v[96:99], a[176:179], v[40:43], v[96:99]
    s_add_u32 s34, s34, 30720
    ds_read_b64_tr_b16 a[168:169], v14 offset:49152
    buffer_load_dwordx4 v2, s[12:15], s34 offen offset:2048 nt lds
    v_mfma_f32_16x16x32_bf16 v[104:107], a[176:179], v[44:47], v[104:107]
    ds_read_b64_tr_b16 a[170:171], v14 offset:51200
    v_accvgpr_read_b32 v78, a94
    v_accvgpr_read_b32 v79, a95
    v_mfma_f32_16x16x32_bf16 v[100:103], a[180:183], v[40:43], v[100:103]
    ds_read_b64_tr_b16 a[172:173], v15 offset:49152
    v_mul_f32 v64, v64, v22
    v_mfma_f32_16x16x32_bf16 v[108:111], a[180:183], v[44:47], v[108:111]
    s_waitcnt lgkmcnt(7)
    ds_read_b64_tr_b16 a[174:175], v15 offset:51200
    v_xor_b32 v26, s44, v8
    v_mul_f32 v65, v65, v22
    v_mfma_f32_16x16x32_bf16 v[112:115], a[184:187], v[40:43], v[112:115]
    ds_read_b64_tr_b16 a[176:177], v26 offset:49152
    v_mul_f32 v66, v66, v22
    v_mul_f32 v67, v67, v22
    v_mfma_f32_16x16x32_bf16 v[120:123], a[184:187], v[44:47], v[120:123]
    ds_read_b64_tr_b16 a[178:179], v26 offset:51200
    buffer_load_dwordx4 v3, s[12:15], s34 offen offset:3072 nt lds
    v_xor_b32 v27, s44, v9
    v_mfma_f32_16x16x32_bf16 v[116:119], a[188:191], v[40:43], v[116:119]
    ds_read_b64_tr_b16 a[180:181], v27 offset:49152
    v_mul_f32 v68, v68, v22
    v_mul_f32 v69, v69, v22
    v_mfma_f32_16x16x32_bf16 v[124:127], a[188:191], v[44:47], v[124:127]
    s_waitcnt lgkmcnt(7)
    ds_read_b64_tr_b16 a[182:183], v27 offset:51200
    v_xor_b32 v26, s44, v10
    v_mul_f32 v70, v70, v22
    v_mfma_f32_16x16x32_bf16 v[128:131], a[160:163], v[40:43], v[128:131]
    ds_read_b64_tr_b16 a[184:185], v26 offset:49152
    v_mul_f32 v71, v71, v22
    v_mfma_f32_16x16x32_bf16 v[136:139], a[160:163], v[44:47], v[136:139]
    s_add_u32 m0, s29, 49152
    ds_read_b64_tr_b16 a[186:187], v26 offset:51200
    v_xor_b32 v27, s44, v11
    v_mul_f32 v72, v72, v23
    v_mfma_f32_16x16x32_bf16 v[132:135], a[164:167], v[40:43], v[132:135]
    s_add_u32 s34, s32, 2883584
    ds_read_b64_tr_b16 a[188:189], v27 offset:49152
    buffer_load_dwordx4 v2, s[12:15], s34 offen offset:0 nt lds
    v_mfma_f32_16x16x32_bf16 v[140:143], a[164:167], v[44:47], v[140:143]
    s_waitcnt lgkmcnt(7)
    ds_read_b64_tr_b16 a[190:191], v27 offset:51200
    v_mul_f32 v73, v73, v23
    v_mul_f32 v74, v74, v23
    v_mfma_f32_16x16x32_bf16 v[144:147], a[168:171], v[40:43], v[144:147]
    ds_read_b64_tr_b16 a[160:161], v8 offset:49408
    v_mul_f32 v75, v75, v23
    v_mul_f32 v76, v76, v23
    v_mfma_f32_16x16x32_bf16 v[152:155], a[168:171], v[44:47], v[152:155]
    ds_read_b64_tr_b16 a[162:163], v8 offset:51456
    v_xor_b32 v8, 0x10000, v8
    v_mfma_f32_16x16x32_bf16 v[148:151], a[172:175], v[40:43], v[148:151]
    ds_read_b64_tr_b16 a[164:165], v9 offset:49408
    v_mul_f32 v77, v77, v23
    v_mul_f32 v78, v78, v23
    v_mfma_f32_16x16x32_bf16 v[156:159], a[172:175], v[44:47], v[156:159]
    s_waitcnt lgkmcnt(7)
    ds_read_b64_tr_b16 a[166:167], v9 offset:51456
    buffer_load_dwordx4 v3, s[12:15], s34 offen offset:1024 nt lds
    v_xor_b32 v9, 0x10000, v9
    v_mfma_f32_16x16x32_bf16 v[224:227], a[176:179], v[56:59], v[224:227]
    ds_read_b64_tr_b16 a[168:169], v10 offset:49408
    v_mul_f32 v79, v79, v23
    v_cvt_pk_bf16_f32 v64, v64, v65
    v_mfma_f32_16x16x32_bf16 v[232:235], a[176:179], v[60:63], v[232:235]
    ds_read_b64_tr_b16 a[170:171], v10 offset:51456
    v_xor_b32 v10, 0x10000, v10
    v_cvt_pk_bf16_f32 v65, v66, v67
    v_mfma_f32_16x16x32_bf16 v[228:231], a[180:183], v[56:59], v[228:231]
    ds_read_b64_tr_b16 a[172:173], v11 offset:49408
    v_cvt_pk_bf16_f32 v66, v68, v69
    v_cvt_pk_bf16_f32 v67, v70, v71
    v_mfma_f32_16x16x32_bf16 v[236:239], a[180:183], v[60:63], v[236:239]
    s_waitcnt lgkmcnt(7)
    ds_read_b64_tr_b16 a[174:175], v11 offset:51456
    v_xor_b32 v11, 0x10000, v11
    v_mfma_f32_16x16x32_bf16 v[240:243], a[184:187], v[56:59], v[240:243]
    s_add_u32 s34, s34, 30720
    ds_read_b64_tr_b16 a[176:177], v12 offset:49408
    buffer_load_dwordx4 v2, s[12:15], s34 offen offset:2048 nt lds
    v_mfma_f32_16x16x32_bf16 v[248:251], a[184:187], v[60:63], v[248:251]
    ds_read_b64_tr_b16 a[178:179], v12 offset:51456
    v_xor_b32 v12, 0x10000, v12
    v_cvt_pk_bf16_f32 v68, v72, v73
    v_mfma_f32_16x16x32_bf16 v[244:247], a[188:191], v[56:59], v[244:247]
    ds_read_b64_tr_b16 a[180:181], v13 offset:49408
    v_cvt_pk_bf16_f32 v69, v74, v75
    v_cvt_pk_bf16_f32 v70, v76, v77
    v_mfma_f32_16x16x32_bf16 v[252:255], a[188:191], v[60:63], v[252:255]
    s_waitcnt lgkmcnt(7)
    ds_read_b64_tr_b16 a[182:183], v13 offset:51456
    v_xor_b32 v13, 0x10000, v13
    v_cvt_pk_bf16_f32 v71, v78, v79
    v_mfma_f32_16x16x32_bf16 v[160:163], a[160:163], v[40:43], v[160:163]
    s_add_u32 s51, s26, 65536
    ds_read_b64_tr_b16 a[184:185], v14 offset:49408
    buffer_load_dwordx4 a[48:51], v0, s[16:19], s51 offen offset:0 nt
    v_mfma_f32_16x16x32_bf16 v[168:171], a[160:163], v[44:47], v[168:171]
    ds_read_b64_tr_b16 a[186:187], v14 offset:51456
    buffer_load_dwordx4 v3, s[12:15], s34 offen offset:3072 nt lds
    v_xor_b32 v14, 0x10000, v14
    v_mfma_f32_16x16x32_bf16 v[164:167], a[164:167], v[40:43], v[164:167]
    ds_read_b64_tr_b16 a[188:189], v15 offset:49408
    v_add_u32 v17, s41, v7
    v_accvgpr_write_b32 a136, v64
    v_mfma_f32_16x16x32_bf16 v[172:175], a[164:167], v[44:47], v[172:175]
    s_waitcnt lgkmcnt(7)
    ds_read_b64_tr_b16 a[190:191], v15 offset:51456
    v_xor_b32 v15, 0x10000, v15
    v_mfma_f32_16x16x32_bf16 v[176:179], a[168:171], v[40:43], v[176:179]
    s_waitcnt vmcnt(22)
    s_barrier
    ds_read_b128 v[32:35], v17 offset:0
    ds_read_b128 v[36:39], v17 offset:2048
    ds_read_b64_tr_b16 a[160:161], v8 offset:16384
    buffer_load_dwordx4 a[52:55], v1, s[16:19], s51 offen offset:1024 nt
    v_mfma_f32_16x16x32_bf16 v[184:187], a[168:171], v[44:47], v[184:187]
    s_add_u32 m0, s29, 65536
    ds_read_b64_tr_b16 a[162:163], v8 offset:18432
    v_accvgpr_write_b32 a137, v65
    v_accvgpr_write_b32 a138, v66
    v_mfma_f32_16x16x32_bf16 v[180:183], a[172:175], v[40:43], v[180:183]
    s_movk_i32 s34, 768
    ds_read_b64_tr_b16 a[164:165], v9 offset:16384
    buffer_load_dwordx4 v4, s[8:11], s34 offen offset:0 lds
    v_mfma_f32_16x16x32_bf16 v[188:191], a[172:175], v[44:47], v[188:191]
    s_waitcnt lgkmcnt(9)
    ds_read_b64_tr_b16 a[166:167], v9 offset:18432
    v_accvgpr_write_b32 a139, v67
    v_accvgpr_write_b32 a140, v68
    v_mfma_f32_16x16x32_bf16 v[192:195], a[176:179], v[40:43], v[192:195]
    s_add_u32 s51, s51, 6144
    ds_read_b64_tr_b16 a[168:169], v10 offset:16384
    buffer_load_dwordx4 a[56:59], v0, s[16:19], s51 offen offset:2048 nt
    v_mfma_f32_16x16x32_bf16 v[200:203], a[176:179], v[44:47], v[200:203]
    ds_read_b64_tr_b16 a[170:171], v10 offset:18432
    v_accvgpr_write_b32 a141, v69
    v_accvgpr_write_b32 a142, v70
    v_mfma_f32_16x16x32_bf16 v[196:199], a[180:183], v[40:43], v[196:199]
    ds_read_b64_tr_b16 a[172:173], v11 offset:16384
    v_accvgpr_write_b32 a143, v71
    v_accvgpr_read_b32 v64, a96
    v_mfma_f32_16x16x32_bf16 v[204:207], a[180:183], v[44:47], v[204:207]
    s_waitcnt lgkmcnt(9)
    ds_read_b64_tr_b16 a[174:175], v11 offset:18432
    v_accvgpr_read_b32 v65, a97
    v_mfma_f32_16x16x32_bf16 v[208:211], a[184:187], v[40:43], v[208:211]
    ds_read_b64_tr_b16 a[176:177], v12 offset:16384
    buffer_load_dwordx4 a[60:63], v1, s[16:19], s51 offen offset:3072 nt
    v_mfma_f32_16x16x32_bf16 v[216:219], a[184:187], v[44:47], v[216:219]
    ds_read_b64_tr_b16 a[178:179], v12 offset:18432
    v_accvgpr_read_b32 v66, a98
    v_accvgpr_read_b32 v67, a99
    v_mfma_f32_16x16x32_bf16 v[212:215], a[188:191], v[40:43], v[212:215]
    ds_read_b64_tr_b16 a[180:181], v13 offset:16384
    buffer_load_dwordx4 v5, s[8:11], s34 offen offset:1024 lds
    v_mfma_f32_16x16x32_bf16 v[220:223], a[188:191], v[44:47], v[220:223]
    s_waitcnt lgkmcnt(7)
    ds_read_b64_tr_b16 a[182:183], v13 offset:18432
    v_accvgpr_read_b32 v68, a100
    v_accvgpr_read_b32 v69, a101
    v_mfma_f32_16x16x32_bf16 v[96:99], a[160:163], v[32:35], v[96:99]
    ds_read_b64_tr_b16 a[184:185], v14 offset:16384
    v_accvgpr_read_b32 v70, a102
    v_accvgpr_read_b32 v71, a103
    v_mfma_f32_16x16x32_bf16 v[104:107], a[160:163], v[36:39], v[104:107]
    ds_read_b64_tr_b16 a[186:187], v14 offset:18432
    ds_read_b128 v[48:51], v7 offset:16384
    v_mfma_f32_16x16x32_bf16 v[100:103], a[164:167], v[32:35], v[100:103]
    ds_read_b64_tr_b16 a[188:189], v15 offset:16384
    v_accvgpr_read_b32 v72, a104
    v_accvgpr_read_b32 v73, a105
    v_mfma_f32_16x16x32_bf16 v[108:111], a[164:167], v[36:39], v[108:111]
    s_waitcnt lgkmcnt(8)
    ds_read_b64_tr_b16 a[190:191], v15 offset:18432
    v_xor_b32 v26, s44, v8
    v_accvgpr_read_b32 v74, a106
    v_mfma_f32_16x16x32_bf16 v[112:115], a[168:171], v[32:35], v[112:115]
    ds_read_b64_tr_b16 a[160:161], v26 offset:16384
    ds_read_b128 v[52:55], v7 offset:18432
    v_accvgpr_read_b32 v75, a107
    v_mfma_f32_16x16x32_bf16 v[120:123], a[168:171], v[36:39], v[120:123]
    ds_read_b64_tr_b16 a[162:163], v26 offset:18432
    v_xor_b32 v27, s44, v9
    v_accvgpr_read_b32 v76, a108
    v_mfma_f32_16x16x32_bf16 v[116:119], a[172:175], v[32:35], v[116:119]
    s_add_u32 s34, s34, 12288
    ds_read_b64_tr_b16 a[164:165], v27 offset:16384
    buffer_load_dwordx4 v4, s[8:11], s34 offen offset:2048 lds
    v_mfma_f32_16x16x32_bf16 v[124:127], a[172:175], v[36:39], v[124:127]
    s_waitcnt lgkmcnt(9)
    ds_read_b64_tr_b16 a[166:167], v27 offset:18432
    v_xor_b32 v26, s44, v10
    v_xor_b32 v17, 64, v17
    v_mfma_f32_16x16x32_bf16 v[128:131], a[176:179], v[32:35], v[128:131]
    ds_read_b64_tr_b16 a[168:169], v26 offset:16384
    v_accvgpr_read_b32 v77, a109
    v_mfma_f32_16x16x32_bf16 v[136:139], a[176:179], v[36:39], v[136:139]
    ds_read_b64_tr_b16 a[170:171], v26 offset:18432
    v_xor_b32 v27, s44, v11
    v_accvgpr_read_b32 v78, a110
    v_mfma_f32_16x16x32_bf16 v[132:135], a[180:183], v[32:35], v[132:135]
    ds_read_b64_tr_b16 a[172:173], v27 offset:16384
    ds_read_b128 v[40:43], v17 offset:0
    v_accvgpr_read_b32 v79, a111
    v_mfma_f32_16x16x32_bf16 v[140:143], a[180:183], v[36:39], v[140:143]
    s_waitcnt lgkmcnt(9)
    ds_read_b64_tr_b16 a[174:175], v27 offset:18432
    v_mul_f32 v64, v64, v22
    v_mul_f32 v65, v65, v22
    v_mfma_f32_16x16x32_bf16 v[144:147], a[184:187], v[32:35], v[144:147]
    ds_read_b64_tr_b16 a[176:177], v8 offset:16640
    v_mul_f32 v66, v66, v22
    v_mul_f32 v67, v67, v22
    v_mfma_f32_16x16x32_bf16 v[152:155], a[184:187], v[36:39], v[152:155]
    ds_read_b64_tr_b16 a[178:179], v8 offset:18688
    ds_read_b128 v[44:47], v17 offset:2048
    v_mfma_f32_16x16x32_bf16 v[148:151], a[188:191], v[32:35], v[148:151]
    ds_read_b64_tr_b16 a[180:181], v9 offset:16640
    buffer_load_dwordx4 v5, s[8:11], s34 offen offset:3072 lds
    v_mfma_f32_16x16x32_bf16 v[156:159], a[188:191], v[36:39], v[156:159]
    s_waitcnt lgkmcnt(9)
    ds_read_b64_tr_b16 a[182:183], v9 offset:18688
    v_mul_f32 v68, v68, v22
    v_mul_f32 v69, v69, v22
    v_mfma_f32_16x16x32_bf16 v[224:227], a[160:163], v[48:51], v[224:227]
    ds_read_b64_tr_b16 a[184:185], v10 offset:16640
    v_xor_b32 v17, 64, v7
    v_mul_f32 v70, v70, v22
    v_mfma_f32_16x16x32_bf16 v[232:235], a[160:163], v[52:55], v[232:235]
    ds_read_b64_tr_b16 a[186:187], v10 offset:18688
    v_mul_f32 v71, v71, v22
    v_mul_f32 v72, v72, v23
    v_mfma_f32_16x16x32_bf16 v[228:231], a[164:167], v[48:51], v[228:231]
    ds_read_b64_tr_b16 a[188:189], v11 offset:16640
    v_mul_f32 v73, v73, v23
    v_mul_f32 v74, v74, v23
    v_mfma_f32_16x16x32_bf16 v[236:239], a[164:167], v[52:55], v[236:239]
    s_waitcnt lgkmcnt(8)
    ds_read_b64_tr_b16 a[190:191], v11 offset:18688
    ds_read_b128 v[56:59], v17 offset:16384
    v_mfma_f32_16x16x32_bf16 v[240:243], a[168:171], v[48:51], v[240:243]
    ds_read_b64_tr_b16 a[160:161], v12 offset:16640
    v_mul_f32 v75, v75, v23
    v_mul_f32 v76, v76, v23
    v_mfma_f32_16x16x32_bf16 v[248:251], a[168:171], v[52:55], v[248:251]
    s_add_u32 m0, s39, 24576
    ds_read_b64_tr_b16 a[162:163], v12 offset:18688
    v_mul_f32 v77, v77, v23
    v_mul_f32 v78, v78, v23
    v_mfma_f32_16x16x32_bf16 v[244:247], a[172:175], v[48:51], v[244:247]
    s_movk_i32 s34, 768
    ds_read_b64_tr_b16 a[164:165], v13 offset:16640
    buffer_load_dwordx4 v6, s[8:11], s34 offen lds
    ds_read_b128 v[60:63], v17 offset:18432
    v_mfma_f32_16x16x32_bf16 v[252:255], a[172:175], v[52:55], v[252:255]
    s_waitcnt lgkmcnt(9)
    ds_read_b64_tr_b16 a[166:167], v13 offset:18688
    v_mul_f32 v79, v79, v23
    v_cvt_pk_bf16_f32 v64, v64, v65
    v_mfma_f32_16x16x32_bf16 v[160:163], a[176:179], v[32:35], v[160:163]
    ds_read_b64_tr_b16 a[168:169], v14 offset:16640
    v_cvt_pk_bf16_f32 v65, v66, v67
    v_mfma_f32_16x16x32_bf16 v[168:171], a[176:179], v[36:39], v[168:171]
    ds_read_b64_tr_b16 a[170:171], v14 offset:18688
    v_cvt_pk_bf16_f32 v66, v68, v69
    v_cvt_pk_bf16_f32 v67, v70, v71
    v_mfma_f32_16x16x32_bf16 v[164:167], a[180:183], v[32:35], v[164:167]
    ds_read_b64_tr_b16 a[172:173], v15 offset:16640
    v_cvt_pk_bf16_f32 v68, v72, v73
    v_cvt_pk_bf16_f32 v69, v74, v75
    v_mfma_f32_16x16x32_bf16 v[172:175], a[180:183], v[36:39], v[172:175]
    s_waitcnt lgkmcnt(9)
    ds_read_b64_tr_b16 a[174:175], v15 offset:18688
    v_cvt_pk_bf16_f32 v70, v76, v77
    v_cvt_pk_bf16_f32 v71, v78, v79
    v_mfma_f32_16x16x32_bf16 v[176:179], a[184:187], v[32:35], v[176:179]
    s_waitcnt vmcnt(26)
    s_barrier
    ds_read_b64_tr_b16 a[176:177], v8 offset:32768
    v_mfma_f32_16x16x32_bf16 v[184:187], a[184:187], v[36:39], v[184:187]
    s_add_u32 m0, s29, 81920
    ds_read_b64_tr_b16 a[178:179], v8 offset:34816
    v_accvgpr_write_b32 a144, v64
    v_accvgpr_write_b32 a145, v65
    v_mfma_f32_16x16x32_bf16 v[180:183], a[188:191], v[32:35], v[180:183]
    s_add_u32 s34, s32, 3145728
    ds_read_b64_tr_b16 a[180:181], v9 offset:32768
    buffer_load_dwordx4 v2, s[12:15], s34 offen offset:0 nt lds
    v_mfma_f32_16x16x32_bf16 v[188:191], a[188:191], v[36:39], v[188:191]
    s_waitcnt lgkmcnt(7)
    ds_read_b64_tr_b16 a[182:183], v9 offset:34816
    v_accvgpr_write_b32 a146, v66
    v_mfma_f32_16x16x32_bf16 v[192:195], a[160:163], v[32:35], v[192:195]
    ds_read_b64_tr_b16 a[184:185], v10 offset:32768
    v_accvgpr_write_b32 a147, v67
    v_accvgpr_write_b32 a148, v68
    v_mfma_f32_16x16x32_bf16 v[200:203], a[160:163], v[36:39], v[200:203]
    ds_read_b64_tr_b16 a[186:187], v10 offset:34816
    v_accvgpr_write_b32 a149, v69
    v_accvgpr_write_b32 a150, v70
    v_mfma_f32_16x16x32_bf16 v[196:199], a[164:167], v[32:35], v[196:199]
    ds_read_b64_tr_b16 a[188:189], v11 offset:32768
    v_accvgpr_write_b32 a151, v71
    v_accvgpr_read_b32 v64, a112
    v_mfma_f32_16x16x32_bf16 v[204:207], a[164:167], v[36:39], v[204:207]
    s_waitcnt lgkmcnt(7)
    ds_read_b64_tr_b16 a[190:191], v11 offset:34816
    buffer_load_dwordx4 v3, s[12:15], s34 offen offset:1024 nt lds
    v_mfma_f32_16x16x32_bf16 v[208:211], a[168:171], v[32:35], v[208:211]
    ds_read_b64_tr_b16 a[160:161], v12 offset:32768
    v_accvgpr_read_b32 v65, a113
    v_accvgpr_read_b32 v66, a114
    v_mfma_f32_16x16x32_bf16 v[216:219], a[168:171], v[36:39], v[216:219]
    ds_read_b64_tr_b16 a[162:163], v12 offset:34816
    v_accvgpr_read_b32 v67, a115
    v_mfma_f32_16x16x32_bf16 v[212:215], a[172:175], v[32:35], v[212:215]
    ds_read_b64_tr_b16 a[164:165], v13 offset:32768
    v_accvgpr_read_b32 v68, a116
    v_accvgpr_read_b32 v69, a117
    v_mfma_f32_16x16x32_bf16 v[220:223], a[172:175], v[36:39], v[220:223]
    s_waitcnt lgkmcnt(7)
    ds_read_b64_tr_b16 a[166:167], v13 offset:34816
    v_accvgpr_read_b32 v70, a118
    v_accvgpr_read_b32 v71, a119
    v_mfma_f32_16x16x32_bf16 v[96:99], a[176:179], v[40:43], v[96:99]
    s_add_u32 s34, s34, 30720
    ds_read_b64_tr_b16 a[168:169], v14 offset:32768
    buffer_load_dwordx4 v2, s[12:15], s34 offen offset:2048 nt lds
    v_mfma_f32_16x16x32_bf16 v[104:107], a[176:179], v[44:47], v[104:107]
    ds_read_b64_tr_b16 a[170:171], v14 offset:34816
    v_accvgpr_read_b32 v72, a120
    v_accvgpr_read_b32 v73, a121
    v_mfma_f32_16x16x32_bf16 v[100:103], a[180:183], v[40:43], v[100:103]
    ds_read_b64_tr_b16 a[172:173], v15 offset:32768
    v_accvgpr_read_b32 v74, a122
    v_mfma_f32_16x16x32_bf16 v[108:111], a[180:183], v[44:47], v[108:111]
    s_waitcnt lgkmcnt(7)
    ds_read_b64_tr_b16 a[174:175], v15 offset:34816
    v_xor_b32 v26, s44, v8
    v_accvgpr_read_b32 v75, a123
    v_mfma_f32_16x16x32_bf16 v[112:115], a[184:187], v[40:43], v[112:115]
    ds_read_b64_tr_b16 a[176:177], v26 offset:32768
    v_accvgpr_read_b32 v76, a124
    v_accvgpr_read_b32 v77, a125
    v_mfma_f32_16x16x32_bf16 v[120:123], a[184:187], v[44:47], v[120:123]
    ds_read_b64_tr_b16 a[178:179], v26 offset:34816
    buffer_load_dwordx4 v3, s[12:15], s34 offen offset:3072 nt lds
    v_xor_b32 v27, s44, v9
    v_mfma_f32_16x16x32_bf16 v[116:119], a[188:191], v[40:43], v[116:119]
    ds_read_b64_tr_b16 a[180:181], v27 offset:32768
    v_accvgpr_read_b32 v78, a126
    v_accvgpr_read_b32 v79, a127
    v_mfma_f32_16x16x32_bf16 v[124:127], a[188:191], v[44:47], v[124:127]
    s_waitcnt lgkmcnt(7)
    ds_read_b64_tr_b16 a[182:183], v27 offset:34816
    v_xor_b32 v26, s44, v10
    v_mul_f32 v64, v64, v22
    v_mfma_f32_16x16x32_bf16 v[128:131], a[160:163], v[40:43], v[128:131]
    ds_read_b64_tr_b16 a[184:185], v26 offset:32768
    v_mul_f32 v65, v65, v22
    v_mfma_f32_16x16x32_bf16 v[136:139], a[160:163], v[44:47], v[136:139]
    s_add_u32 m0, s29, 98304
    ds_read_b64_tr_b16 a[186:187], v26 offset:34816
    v_xor_b32 v27, s44, v11
    v_mul_f32 v66, v66, v22
    v_mfma_f32_16x16x32_bf16 v[132:135], a[164:167], v[40:43], v[132:135]
    s_add_u32 s34, s32, 3407872
    ds_read_b64_tr_b16 a[188:189], v27 offset:32768
    buffer_load_dwordx4 v2, s[12:15], s34 offen offset:0 nt lds
    v_mfma_f32_16x16x32_bf16 v[140:143], a[164:167], v[44:47], v[140:143]
    s_waitcnt lgkmcnt(7)
    ds_read_b64_tr_b16 a[190:191], v27 offset:34816
    v_mul_f32 v67, v67, v22
    v_mul_f32 v68, v68, v22
    v_mfma_f32_16x16x32_bf16 v[144:147], a[168:171], v[40:43], v[144:147]
    ds_read_b64_tr_b16 a[160:161], v8 offset:33024
    v_mul_f32 v69, v69, v22
    v_mul_f32 v70, v70, v22
    v_mfma_f32_16x16x32_bf16 v[152:155], a[168:171], v[44:47], v[152:155]
    ds_read_b64_tr_b16 a[162:163], v8 offset:35072
    v_xor_b32 v8, 0x10000, v8
    v_mul_f32 v71, v71, v22
    v_mfma_f32_16x16x32_bf16 v[148:151], a[172:175], v[40:43], v[148:151]
    ds_read_b64_tr_b16 a[164:165], v9 offset:33024
    v_mul_f32 v72, v72, v23
    v_mfma_f32_16x16x32_bf16 v[156:159], a[172:175], v[44:47], v[156:159]
    s_waitcnt lgkmcnt(7)
    ds_read_b64_tr_b16 a[166:167], v9 offset:35072
    buffer_load_dwordx4 v3, s[12:15], s34 offen offset:1024 nt lds
    v_xor_b32 v9, 0x10000, v9
    v_mfma_f32_16x16x32_bf16 v[224:227], a[176:179], v[56:59], v[224:227]
    ds_read_b64_tr_b16 a[168:169], v10 offset:33024
    v_mul_f32 v73, v73, v23
    v_mul_f32 v74, v74, v23
    v_mfma_f32_16x16x32_bf16 v[232:235], a[176:179], v[60:63], v[232:235]
    ds_read_b64_tr_b16 a[170:171], v10 offset:35072
    v_xor_b32 v10, 0x10000, v10
    v_mul_f32 v75, v75, v23
    v_mfma_f32_16x16x32_bf16 v[228:231], a[180:183], v[56:59], v[228:231]
    ds_read_b64_tr_b16 a[172:173], v11 offset:33024
    v_mul_f32 v76, v76, v23
    v_mul_f32 v77, v77, v23
    v_mfma_f32_16x16x32_bf16 v[236:239], a[180:183], v[60:63], v[236:239]
    s_waitcnt lgkmcnt(7)
    ds_read_b64_tr_b16 a[174:175], v11 offset:35072
    v_xor_b32 v11, 0x10000, v11
    v_mul_f32 v78, v78, v23
    v_mfma_f32_16x16x32_bf16 v[240:243], a[184:187], v[56:59], v[240:243]
    s_add_u32 s34, s34, 30720
    ds_read_b64_tr_b16 a[176:177], v12 offset:33024
    buffer_load_dwordx4 v2, s[12:15], s34 offen offset:2048 nt lds
    v_mfma_f32_16x16x32_bf16 v[248:251], a[184:187], v[60:63], v[248:251]
    ds_read_b64_tr_b16 a[178:179], v12 offset:35072
    v_xor_b32 v12, 0x10000, v12
    v_mfma_f32_16x16x32_bf16 v[244:247], a[188:191], v[56:59], v[244:247]
    ds_read_b64_tr_b16 a[180:181], v13 offset:33024
    v_mul_f32 v79, v79, v23
    v_cvt_pk_bf16_f32 v64, v64, v65
    v_mfma_f32_16x16x32_bf16 v[252:255], a[188:191], v[60:63], v[252:255]
    s_waitcnt lgkmcnt(7)
    ds_read_b64_tr_b16 a[182:183], v13 offset:35072
    v_xor_b32 v13, 0x10000, v13
    v_cvt_pk_bf16_f32 v65, v66, v67
    v_mfma_f32_16x16x32_bf16 v[160:163], a[160:163], v[40:43], v[160:163]
    ds_read_b64_tr_b16 a[184:185], v14 offset:33024
    v_cvt_pk_bf16_f32 v66, v68, v69
    v_cvt_pk_bf16_f32 v67, v70, v71
    v_mfma_f32_16x16x32_bf16 v[168:171], a[160:163], v[44:47], v[168:171]
    s_add_u32 s51, s26, 65664
    ds_read_b64_tr_b16 a[186:187], v14 offset:35072
    buffer_load_dwordx4 v3, s[12:15], s34 offen offset:3072 nt lds
    buffer_load_dwordx4 a[64:67], v0, s[16:19], s51 offen offset:0 nt
    v_xor_b32 v14, 0x10000, v14
    v_mfma_f32_16x16x32_bf16 v[164:167], a[164:167], v[40:43], v[164:167]
    ds_read_b64_tr_b16 a[188:189], v15 offset:33024
    v_add_u32 v17, s41, v7
    v_mfma_f32_16x16x32_bf16 v[172:175], a[164:167], v[44:47], v[172:175]
    s_waitcnt lgkmcnt(7)
    ds_read_b64_tr_b16 a[190:191], v15 offset:35072
    v_xor_b32 v15, 0x10000, v15
    v_cvt_pk_bf16_f32 v68, v72, v73
    v_mfma_f32_16x16x32_bf16 v[176:179], a[168:171], v[40:43], v[176:179]
    s_waitcnt vmcnt(22)
    s_barrier
    ds_read_b128 v[32:35], v17 offset:49152
    ds_read_b128 v[36:39], v17 offset:51200
    ds_read_b64_tr_b16 a[160:161], v8 offset:0
    v_mfma_f32_16x16x32_bf16 v[184:187], a[168:171], v[44:47], v[184:187]
    ds_read_b64_tr_b16 a[162:163], v8 offset:2048
    buffer_load_dwordx4 a[68:71], v1, s[16:19], s51 offen offset:1024 nt
    v_add_u32 v31, s41, v16
    v_mfma_f32_16x16x32_bf16 v[180:183], a[172:175], v[40:43], v[180:183]
    ds_read_b64_tr_b16 a[164:165], v9 offset:0
    ds_write_b128 v31, v[80:83] offset:16384
    v_mfma_f32_16x16x32_bf16 v[188:191], a[172:175], v[44:47], v[188:191]
    s_waitcnt lgkmcnt(10)
    ds_read_b64_tr_b16 a[166:167], v9 offset:2048
    v_cvt_pk_bf16_f32 v69, v74, v75
    v_cvt_pk_bf16_f32 v70, v76, v77
    v_mfma_f32_16x16x32_bf16 v[192:195], a[176:179], v[40:43], v[192:195]
    ds_read_b64_tr_b16 a[168:169], v10 offset:0
    v_cvt_pk_bf16_f32 v71, v78, v79
    v_accvgpr_write_b32 a152, v64
    v_mfma_f32_16x16x32_bf16 v[200:203], a[176:179], v[44:47], v[200:203]
    s_add_u32 s51, s51, 6144
    ds_read_b64_tr_b16 a[170:171], v10 offset:2048
    buffer_load_dwordx4 a[72:75], v0, s[16:19], s51 offen offset:2048 nt
    v_mfma_f32_16x16x32_bf16 v[196:199], a[180:183], v[40:43], v[196:199]
    ds_read_b64_tr_b16 a[172:173], v11 offset:0
    v_accvgpr_write_b32 a153, v65
    v_accvgpr_write_b32 a154, v66
    v_mfma_f32_16x16x32_bf16 v[204:207], a[180:183], v[44:47], v[204:207]
    s_waitcnt lgkmcnt(10)
    ds_read_b64_tr_b16 a[174:175], v11 offset:2048
    v_accvgpr_write_b32 a155, v67
    v_mfma_f32_16x16x32_bf16 v[208:211], a[184:187], v[40:43], v[208:211]
    ds_read_b64_tr_b16 a[176:177], v12 offset:0
    v_accvgpr_write_b32 a156, v68
    v_accvgpr_write_b32 a157, v69
    v_mfma_f32_16x16x32_bf16 v[216:219], a[184:187], v[44:47], v[216:219]
    ds_read_b64_tr_b16 a[178:179], v12 offset:2048
    buffer_load_dwordx4 a[76:79], v1, s[16:19], s51 offen offset:3072 nt
    v_mfma_f32_16x16x32_bf16 v[212:215], a[188:191], v[40:43], v[212:215]
    ds_read_b64_tr_b16 a[180:181], v13 offset:0
    ds_write_b128 v31, v[84:87] offset:17408
    v_mfma_f32_16x16x32_bf16 v[220:223], a[188:191], v[44:47], v[220:223]
    s_waitcnt lgkmcnt(8)
    ds_read_b64_tr_b16 a[182:183], v13 offset:2048
    v_accvgpr_write_b32 a158, v70
    v_accvgpr_write_b32 a159, v71
    v_mfma_f32_16x16x32_bf16 v[96:99], a[160:163], v[32:35], v[96:99]
    ds_read_b64_tr_b16 a[184:185], v14 offset:0
    buffer_load_dword a233, v16, s[56:59], s42 offen
    v_mfma_f32_16x16x32_bf16 v[104:107], a[160:163], v[36:39], v[104:107]
    s_mov_b32 s56, s54
    ds_read_b64_tr_b16 a[186:187], v14 offset:2048
    ds_read_b128 v[48:51], v7 offset:20480
    v_mfma_f32_16x16x32_bf16 v[100:103], a[164:167], v[32:35], v[100:103]
    s_mov_b32 s57, s55
A_stub13:
    s_cbranch_execz A_back
    ds_read_b64_tr_b16 a[188:189], v15 offset:0
    v_mfma_f32_16x16x32_bf16 v[108:111], a[164:167], v[36:39], v[108:111]
    s_waitcnt lgkmcnt(9)
    ds_read_b64_tr_b16 a[190:191], v15 offset:2048
    v_xor_b32 v26, s44, v8
    v_accvgpr_read_b32 v28, a231
    v_mfma_f32_16x16x32_bf16 v[112:115], a[168:171], v[32:35], v[112:115]
    s_mov_b32 s58, 3670016
    ds_read_b64_tr_b16 a[160:161], v26 offset:0
    buffer_load_dword a233, v28, s[56:59], 0 offen
    ds_read_b128 v[52:55], v7 offset:22528
    s_mov_b32 s14, 0
    s_mov_b32 s10, 0
    v_mfma_f32_16x16x32_bf16 v[120:123], a[168:171], v[36:39], v[120:123]
    ds_read_b64_tr_b16 a[162:163], v26 offset:2048
    v_xor_b32 v27, s44, v9
    v_mfma_f32_16x16x32_bf16 v[116:119], a[172:175], v[32:35], v[116:119]
    ds_read_b64_tr_b16 a[164:165], v27 offset:0
    ds_write_b128 v31, v[88:91] offset:18432
    v_mfma_f32_16x16x32_bf16 v[124:127], a[172:175], v[36:39], v[124:127]
    s_waitcnt lgkmcnt(10)
    ds_read_b64_tr_b16 a[166:167], v27 offset:2048
    v_xor_b32 v26, s44, v10
    v_xor_b32 v17, 64, v17
    v_mfma_f32_16x16x32_bf16 v[128:131], a[176:179], v[32:35], v[128:131]
    ds_read_b64_tr_b16 a[168:169], v26 offset:0
    v_mfma_f32_16x16x32_bf16 v[136:139], a[176:179], v[36:39], v[136:139]
    ds_read_b64_tr_b16 a[170:171], v26 offset:2048
    v_xor_b32 v27, s44, v11
    v_mfma_f32_16x16x32_bf16 v[132:135], a[180:183], v[32:35], v[132:135]
    ds_read_b64_tr_b16 a[172:173], v27 offset:0
    ds_read_b128 v[40:43], v17 offset:49152
    v_mfma_f32_16x16x32_bf16 v[140:143], a[180:183], v[36:39], v[140:143]
    s_waitcnt lgkmcnt(10)
    ds_read_b64_tr_b16 a[174:175], v27 offset:2048
    v_mfma_f32_16x16x32_bf16 v[144:147], a[184:187], v[32:35], v[144:147]
    ds_read_b64_tr_b16 a[176:177], v8 offset:256
    v_mfma_f32_16x16x32_bf16 v[152:155], a[184:187], v[36:39], v[152:155]
    ds_read_b64_tr_b16 a[178:179], v8 offset:2304
    ds_read_b128 v[44:47], v17 offset:51200
    v_mfma_f32_16x16x32_bf16 v[148:151], a[188:191], v[32:35], v[148:151]
    ds_read_b64_tr_b16 a[180:181], v9 offset:256
    ds_write_b128 v31, v[92:95] offset:19456
    v_mfma_f32_16x16x32_bf16 v[156:159], a[188:191], v[36:39], v[156:159]
    s_waitcnt lgkmcnt(10)
    ds_read_b64_tr_b16 a[182:183], v9 offset:2304
    v_mfma_f32_16x16x32_bf16 v[224:227], a[160:163], v[48:51], v[224:227]
    ds_read_b64_tr_b16 a[184:185], v10 offset:256
    v_xor_b32 v17, 64, v7
    v_mfma_f32_16x16x32_bf16 v[232:235], a[160:163], v[52:55], v[232:235]
    ds_read_b64_tr_b16 a[186:187], v10 offset:2304
    v_mfma_f32_16x16x32_bf16 v[228:231], a[164:167], v[48:51], v[228:231]
    ds_read_b64_tr_b16 a[188:189], v11 offset:256
    v_mfma_f32_16x16x32_bf16 v[236:239], a[164:167], v[52:55], v[236:239]
    s_waitcnt lgkmcnt(9)
    ds_read_b64_tr_b16 a[190:191], v11 offset:2304
    ds_read_b128 v[56:59], v17 offset:20480
    v_mfma_f32_16x16x32_bf16 v[240:243], a[168:171], v[48:51], v[240:243]
    ds_read_b64_tr_b16 a[160:161], v12 offset:256
    v_mfma_f32_16x16x32_bf16 v[248:251], a[168:171], v[52:55], v[248:251]
    ds_read_b64_tr_b16 a[162:163], v12 offset:2304
    v_mfma_f32_16x16x32_bf16 v[244:247], a[172:175], v[48:51], v[244:247]
    ds_read_b64_tr_b16 a[164:165], v13 offset:256
    ds_read_b128 v[60:63], v17 offset:22528
    v_mfma_f32_16x16x32_bf16 v[252:255], a[172:175], v[52:55], v[252:255]
    s_waitcnt lgkmcnt(9)
    ds_read_b64_tr_b16 a[166:167], v13 offset:2304
    v_mfma_f32_16x16x32_bf16 v[160:163], a[176:179], v[32:35], v[160:163]
    ds_read_b64_tr_b16 a[168:169], v14 offset:256
    v_mfma_f32_16x16x32_bf16 v[168:171], a[176:179], v[36:39], v[168:171]
    ds_read_b64_tr_b16 a[170:171], v14 offset:2304
    v_mfma_f32_16x16x32_bf16 v[164:167], a[180:183], v[32:35], v[164:167]
    ds_read_b64_tr_b16 a[172:173], v15 offset:256
    v_mfma_f32_16x16x32_bf16 v[172:175], a[180:183], v[36:39], v[172:175]
    s_waitcnt lgkmcnt(9)
    ds_read_b64_tr_b16 a[174:175], v15 offset:2304
    v_mfma_f32_16x16x32_bf16 v[176:179], a[184:187], v[32:35], v[176:179]
    s_waitcnt vmcnt(22)
    s_barrier
    ds_read_b64_tr_b16 a[176:177], v8 offset:16384
    v_mfma_f32_16x16x32_bf16 v[184:187], a[184:187], v[36:39], v[184:187]
    ds_read_b64_tr_b16 a[178:179], v8 offset:18432
    v_add_u32 v31, s41, v16
    v_mfma_f32_16x16x32_bf16 v[180:183], a[188:191], v[32:35], v[180:183]
    ds_read_b64_tr_b16 a[180:181], v9 offset:16384
    ds_write_b128 v31, a[0:3] offset:32768
    v_mfma_f32_16x16x32_bf16 v[188:191], a[188:191], v[36:39], v[188:191]
    s_waitcnt lgkmcnt(8)
    ds_read_b64_tr_b16 a[182:183], v9 offset:18432
    v_mfma_f32_16x16x32_bf16 v[192:195], a[160:163], v[32:35], v[192:195]
    ds_read_b64_tr_b16 a[184:185], v10 offset:16384
    v_mfma_f32_16x16x32_bf16 v[200:203], a[160:163], v[36:39], v[200:203]
    ds_read_b64_tr_b16 a[186:187], v10 offset:18432
    v_mfma_f32_16x16x32_bf16 v[196:199], a[164:167], v[32:35], v[196:199]
    ds_read_b64_tr_b16 a[188:189], v11 offset:16384
    v_mfma_f32_16x16x32_bf16 v[204:207], a[164:167], v[36:39], v[204:207]
    s_waitcnt lgkmcnt(8)
    ds_read_b64_tr_b16 a[190:191], v11 offset:18432
    ds_write_b128 v31, a[4:7] offset:33792
    v_mfma_f32_16x16x32_bf16 v[208:211], a[168:171], v[32:35], v[208:211]
    ds_read_b64_tr_b16 a[160:161], v12 offset:16384
    v_mfma_f32_16x16x32_bf16 v[216:219], a[168:171], v[36:39], v[216:219]
    ds_read_b64_tr_b16 a[162:163], v12 offset:18432
    v_mfma_f32_16x16x32_bf16 v[212:215], a[172:175], v[32:35], v[212:215]
    ds_read_b64_tr_b16 a[164:165], v13 offset:16384
    v_mfma_f32_16x16x32_bf16 v[220:223], a[172:175], v[36:39], v[220:223]
    s_waitcnt lgkmcnt(8)
    ds_read_b64_tr_b16 a[166:167], v13 offset:18432
    v_mfma_f32_16x16x32_bf16 v[96:99], a[176:179], v[40:43], v[96:99]
    ds_read_b64_tr_b16 a[168:169], v14 offset:16384
    ds_write_b128 v31, a[8:11] offset:34816
    v_mfma_f32_16x16x32_bf16 v[104:107], a[176:179], v[44:47], v[104:107]
    ds_read_b64_tr_b16 a[170:171], v14 offset:18432
    v_mfma_f32_16x16x32_bf16 v[100:103], a[180:183], v[40:43], v[100:103]
    ds_read_b64_tr_b16 a[172:173], v15 offset:16384
    v_mfma_f32_16x16x32_bf16 v[108:111], a[180:183], v[44:47], v[108:111]
    s_waitcnt lgkmcnt(9)
    ds_read_b64_tr_b16 a[174:175], v15 offset:18432
    v_xor_b32 v26, s44, v8
    v_mfma_f32_16x16x32_bf16 v[112:115], a[184:187], v[40:43], v[112:115]
    ds_read_b64_tr_b16 a[176:177], v26 offset:16384
    v_mfma_f32_16x16x32_bf16 v[120:123], a[184:187], v[44:47], v[120:123]
    ds_read_b64_tr_b16 a[178:179], v26 offset:18432
    ds_write_b128 v31, a[12:15] offset:35840
    v_xor_b32 v27, s44, v9
    v_mfma_f32_16x16x32_bf16 v[116:119], a[188:191], v[40:43], v[116:119]
    ds_read_b64_tr_b16 a[180:181], v27 offset:16384
    v_mfma_f32_16x16x32_bf16 v[124:127], a[188:191], v[44:47], v[124:127]
    s_waitcnt lgkmcnt(9)
    ds_read_b64_tr_b16 a[182:183], v27 offset:18432
    v_xor_b32 v26, s44, v10
    v_mfma_f32_16x16x32_bf16 v[128:131], a[160:163], v[40:43], v[128:131]
    ds_read_b64_tr_b16 a[184:185], v26 offset:16384
    v_mfma_f32_16x16x32_bf16 v[136:139], a[160:163], v[44:47], v[136:139]
    ds_read_b64_tr_b16 a[186:187], v26 offset:18432
    v_xor_b32 v27, s44, v11
    v_add_u32 v31, s41, v16
    v_mfma_f32_16x16x32_bf16 v[132:135], a[164:167], v[40:43], v[132:135]
    ds_read_b64_tr_b16 a[188:189], v27 offset:16384
    ds_write_b128 v31, a[16:19] offset:49152
    v_mfma_f32_16x16x32_bf16 v[140:143], a[164:167], v[44:47], v[140:143]
    s_waitcnt lgkmcnt(9)
    ds_read_b64_tr_b16 a[190:191], v27 offset:18432
    v_mfma_f32_16x16x32_bf16 v[144:147], a[168:171], v[40:43], v[144:147]
    ds_read_b64_tr_b16 a[160:161], v8 offset:16640
    v_mfma_f32_16x16x32_bf16 v[152:155], a[168:171], v[44:47], v[152:155]
    ds_read_b64_tr_b16 a[162:163], v8 offset:18688
    v_mfma_f32_16x16x32_bf16 v[148:151], a[172:175], v[40:43], v[148:151]
    ds_read_b64_tr_b16 a[164:165], v9 offset:16640
    v_mfma_f32_16x16x32_bf16 v[156:159], a[172:175], v[44:47], v[156:159]
    s_waitcnt lgkmcnt(8)
    ds_read_b64_tr_b16 a[166:167], v9 offset:18688
    ds_write_b128 v31, a[20:23] offset:50176
    v_mfma_f32_16x16x32_bf16 v[224:227], a[176:179], v[56:59], v[224:227]
    ds_read_b64_tr_b16 a[168:169], v10 offset:16640
    v_mfma_f32_16x16x32_bf16 v[232:235], a[176:179], v[60:63], v[232:235]
    ds_read_b64_tr_b16 a[170:171], v10 offset:18688
    v_mfma_f32_16x16x32_bf16 v[228:231], a[180:183], v[56:59], v[228:231]
    ds_read_b64_tr_b16 a[172:173], v11 offset:16640
    v_mfma_f32_16x16x32_bf16 v[236:239], a[180:183], v[60:63], v[236:239]
    s_waitcnt lgkmcnt(8)
    ds_read_b64_tr_b16 a[174:175], v11 offset:18688
    v_mfma_f32_16x16x32_bf16 v[240:243], a[184:187], v[56:59], v[240:243]
    ds_read_b64_tr_b16 a[176:177], v12 offset:16640
    ds_write_b128 v31, a[24:27] offset:51200
    v_mfma_f32_16x16x32_bf16 v[248:251], a[184:187], v[60:63], v[248:251]
    ds_read_b64_tr_b16 a[178:179], v12 offset:18688
    v_mfma_f32_16x16x32_bf16 v[244:247], a[188:191], v[56:59], v[244:247]
    ds_read_b64_tr_b16 a[180:181], v13 offset:16640
    v_mfma_f32_16x16x32_bf16 v[252:255], a[188:191], v[60:63], v[252:255]
    s_waitcnt lgkmcnt(9)
    ds_read_b64_tr_b16 a[182:183], v13 offset:18688
    v_mfma_f32_16x16x32_bf16 v[160:163], a[160:163], v[40:43], v[160:163]
    ds_read_b64_tr_b16 a[184:185], v14 offset:16640
    v_mfma_f32_16x16x32_bf16 v[168:171], a[160:163], v[44:47], v[168:171]
    ds_read_b64_tr_b16 a[186:187], v14 offset:18688
    ds_write_b128 v31, a[28:31] offset:52224
    v_mfma_f32_16x16x32_bf16 v[164:167], a[164:167], v[40:43], v[164:167]
    ds_read_b64_tr_b16 a[188:189], v15 offset:16640
    v_add_u32 v17, s40, v7
    v_mfma_f32_16x16x32_bf16 v[172:175], a[164:167], v[44:47], v[172:175]
    s_waitcnt lgkmcnt(9)
    ds_read_b64_tr_b16 a[190:191], v15 offset:18688
    v_mfma_f32_16x16x32_bf16 v[176:179], a[168:171], v[40:43], v[176:179]
    s_waitcnt vmcnt(10) lgkmcnt(2)
    s_barrier
    ds_read_b128 v[32:35], v17 offset:32768
    ds_read_b128 v[36:39], v17 offset:34816
    ds_read_b64_tr_b16 a[160:161], v8 offset:49152
    v_mfma_f32_16x16x32_bf16 v[184:187], a[168:171], v[44:47], v[184:187]
    ds_read_b64_tr_b16 a[162:163], v8 offset:51200
    v_add_u32 v31, s40, v16
    v_mfma_f32_16x16x32_bf16 v[180:183], a[172:175], v[40:43], v[180:183]
    ds_read_b64_tr_b16 a[164:165], v9 offset:49152
    ds_write_b128 v31, a[32:35] offset:0
    v_mfma_f32_16x16x32_bf16 v[188:191], a[172:175], v[44:47], v[188:191]
    ds_read_b64_tr_b16 a[166:167], v9 offset:51200
    v_mfma_f32_16x16x32_bf16 v[192:195], a[176:179], v[40:43], v[192:195]
    ds_read_b64_tr_b16 a[168:169], v10 offset:49152
    v_mfma_f32_16x16x32_bf16 v[200:203], a[176:179], v[44:47], v[200:203]
    ds_read_b64_tr_b16 a[170:171], v10 offset:51200
    v_mfma_f32_16x16x32_bf16 v[196:199], a[180:183], v[40:43], v[196:199]
    ds_read_b64_tr_b16 a[172:173], v11 offset:49152
    v_mfma_f32_16x16x32_bf16 v[204:207], a[180:183], v[44:47], v[204:207]
    s_waitcnt lgkmcnt(10)
    ds_read_b64_tr_b16 a[174:175], v11 offset:51200
    v_mfma_f32_16x16x32_bf16 v[208:211], a[184:187], v[40:43], v[208:211]
    ds_read_b64_tr_b16 a[176:177], v12 offset:49152
    v_mfma_f32_16x16x32_bf16 v[216:219], a[184:187], v[44:47], v[216:219]
    ds_read_b64_tr_b16 a[178:179], v12 offset:51200
    v_mfma_f32_16x16x32_bf16 v[212:215], a[188:191], v[40:43], v[212:215]
    ds_read_b64_tr_b16 a[180:181], v13 offset:49152
    ds_write_b128 v31, a[36:39] offset:1024
    v_mfma_f32_16x16x32_bf16 v[220:223], a[188:191], v[44:47], v[220:223]
    s_waitcnt lgkmcnt(8)
    ds_read_b64_tr_b16 a[182:183], v13 offset:51200
    v_mfma_f32_16x16x32_bf16 v[96:99], a[160:163], v[32:35], v[96:99]
    ds_read_b64_tr_b16 a[184:185], v14 offset:49152
    v_mfma_f32_16x16x32_bf16 v[104:107], a[160:163], v[36:39], v[104:107]
    ds_read_b64_tr_b16 a[186:187], v14 offset:51200
    ds_read_b128 v[48:51], v7 offset:24576
    v_mfma_f32_16x16x32_bf16 v[100:103], a[164:167], v[32:35], v[100:103]
    ds_read_b64_tr_b16 a[188:189], v15 offset:49152
    v_mfma_f32_16x16x32_bf16 v[108:111], a[164:167], v[36:39], v[108:111]
    s_waitcnt lgkmcnt(9)
    ds_read_b64_tr_b16 a[190:191], v15 offset:51200
    v_xor_b32 v26, s44, v8
    v_mfma_f32_16x16x32_bf16 v[112:115], a[168:171], v[32:35], v[112:115]
    ds_read_b64_tr_b16 a[160:161], v26 offset:49152
    ds_read_b128 v[52:55], v7 offset:26624
    v_mfma_f32_16x16x32_bf16 v[120:123], a[168:171], v[36:39], v[120:123]
    ds_read_b64_tr_b16 a[162:163], v26 offset:51200
    v_xor_b32 v27, s44, v9
    v_mfma_f32_16x16x32_bf16 v[116:119], a[172:175], v[32:35], v[116:119]
    ds_read_b64_tr_b16 a[164:165], v27 offset:49152
    ds_write_b128 v31, a[40:43] offset:2048
    v_mfma_f32_16x16x32_bf16 v[124:127], a[172:175], v[36:39], v[124:127]
    s_waitcnt lgkmcnt(10)
    ds_read_b64_tr_b16 a[166:167], v27 offset:51200
    v_xor_b32 v26, s44, v10
    v_xor_b32 v17, 64, v17
    v_mfma_f32_16x16x32_bf16 v[128:131], a[176:179], v[32:35], v[128:131]
    ds_read_b64_tr_b16 a[168:169], v26 offset:49152
    v_mfma_f32_16x16x32_bf16 v[136:139], a[176:179], v[36:39], v[136:139]
    ds_read_b64_tr_b16 a[170:171], v26 offset:51200
    v_xor_b32 v27, s44, v11
    v_mfma_f32_16x16x32_bf16 v[132:135], a[180:183], v[32:35], v[132:135]
    ds_read_b64_tr_b16 a[172:173], v27 offset:49152
    ds_read_b128 v[40:43], v17 offset:32768
    v_mfma_f32_16x16x32_bf16 v[140:143], a[180:183], v[36:39], v[140:143]
    s_waitcnt lgkmcnt(10)
    ds_read_b64_tr_b16 a[174:175], v27 offset:51200
    v_mfma_f32_16x16x32_bf16 v[144:147], a[184:187], v[32:35], v[144:147]
    ds_read_b64_tr_b16 a[176:177], v8 offset:49408
    v_mfma_f32_16x16x32_bf16 v[152:155], a[184:187], v[36:39], v[152:155]
    ds_read_b64_tr_b16 a[178:179], v8 offset:51456
    ds_read_b128 v[44:47], v17 offset:34816
    v_xor_b32 v8, 0x10000, v8
    v_mfma_f32_16x16x32_bf16 v[148:151], a[188:191], v[32:35], v[148:151]
    ds_read_b64_tr_b16 a[180:181], v9 offset:49408
    ds_write_b128 v31, a[44:47] offset:3072
    v_mfma_f32_16x16x32_bf16 v[156:159], a[188:191], v[36:39], v[156:159]
    s_waitcnt lgkmcnt(10)
    ds_read_b64_tr_b16 a[182:183], v9 offset:51456
    v_xor_b32 v9, 0x10000, v9
    v_mfma_f32_16x16x32_bf16 v[224:227], a[160:163], v[48:51], v[224:227]
    ds_read_b64_tr_b16 a[184:185], v10 offset:49408
    v_xor_b32 v17, 64, v7
    v_mfma_f32_16x16x32_bf16 v[232:235], a[160:163], v[52:55], v[232:235]
    ds_read_b64_tr_b16 a[186:187], v10 offset:51456
    v_xor_b32 v10, 0x10000, v10
    v_mfma_f32_16x16x32_bf16 v[228:231], a[164:167], v[48:51], v[228:231]
    ds_read_b64_tr_b16 a[188:189], v11 offset:49408
    v_mfma_f32_16x16x32_bf16 v[236:239], a[164:167], v[52:55], v[236:239]
    s_waitcnt lgkmcnt(9)
    ds_read_b64_tr_b16 a[190:191], v11 offset:51456
    ds_read_b128 v[56:59], v17 offset:24576
    v_xor_b32 v11, 0x10000, v11
    v_mfma_f32_16x16x32_bf16 v[240:243], a[168:171], v[48:51], v[240:243]
    ds_read_b64_tr_b16 a[160:161], v12 offset:49408
    v_mfma_f32_16x16x32_bf16 v[248:251], a[168:171], v[52:55], v[248:251]
    ds_read_b64_tr_b16 a[162:163], v12 offset:51456
    v_xor_b32 v12, 0x10000, v12
    v_mfma_f32_16x16x32_bf16 v[244:247], a[172:175], v[48:51], v[244:247]
    ds_read_b64_tr_b16 a[164:165], v13 offset:49408
    ds_read_b128 v[60:63], v17 offset:26624
    v_mfma_f32_16x16x32_bf16 v[252:255], a[172:175], v[52:55], v[252:255]
    s_waitcnt lgkmcnt(9)
    ds_read_b64_tr_b16 a[166:167], v13 offset:51456
    v_xor_b32 v13, 0x10000, v13
    v_mfma_f32_16x16x32_bf16 v[160:163], a[176:179], v[32:35], v[160:163]
    ds_read_b64_tr_b16 a[168:169], v14 offset:49408
    v_mfma_f32_16x16x32_bf16 v[168:171], a[176:179], v[36:39], v[168:171]
    ds_read_b64_tr_b16 a[170:171], v14 offset:51456
    v_xor_b32 v14, 0x10000, v14
    v_mfma_f32_16x16x32_bf16 v[164:167], a[180:183], v[32:35], v[164:167]
    ds_read_b64_tr_b16 a[172:173], v15 offset:49408
    v_mfma_f32_16x16x32_bf16 v[172:175], a[180:183], v[36:39], v[172:175]
    s_waitcnt lgkmcnt(9)
    ds_read_b64_tr_b16 a[174:175], v15 offset:51456
    v_xor_b32 v15, 0x10000, v15
    v_xor_b32 v26, s44, v8
    v_mfma_f32_16x16x32_bf16 v[176:179], a[184:187], v[32:35], v[176:179]
    s_waitcnt vmcnt(6)
    s_barrier
    ds_read_b64_tr_b16 a[176:177], v26 offset:0
    v_mfma_f32_16x16x32_bf16 v[184:187], a[184:187], v[36:39], v[184:187]
    ds_read_b64_tr_b16 a[178:179], v26 offset:2048
    v_xor_b32 v27, s44, v9
    v_add_u32 v31, s40, v16
    v_mfma_f32_16x16x32_bf16 v[180:183], a[188:191], v[32:35], v[180:183]
    ds_read_b64_tr_b16 a[180:181], v27 offset:0
    ds_write_b128 v31, a[48:51] offset:16384
    v_mfma_f32_16x16x32_bf16 v[188:191], a[188:191], v[36:39], v[188:191]
    s_waitcnt lgkmcnt(8)
    ds_read_b64_tr_b16 a[182:183], v27 offset:2048
    v_xor_b32 v26, s44, v10
    v_mfma_f32_16x16x32_bf16 v[192:195], a[160:163], v[32:35], v[192:195]
    ds_read_b64_tr_b16 a[184:185], v26 offset:0
    v_mfma_f32_16x16x32_bf16 v[200:203], a[160:163], v[36:39], v[200:203]
    ds_read_b64_tr_b16 a[186:187], v26 offset:2048
    v_xor_b32 v27, s44, v11
    v_mfma_f32_16x16x32_bf16 v[196:199], a[164:167], v[32:35], v[196:199]
    ds_read_b64_tr_b16 a[188:189], v27 offset:0
    v_mfma_f32_16x16x32_bf16 v[204:207], a[164:167], v[36:39], v[204:207]
    s_waitcnt lgkmcnt(8)
    ds_read_b64_tr_b16 a[190:191], v27 offset:2048
    v_mfma_f32_16x16x32_bf16 v[208:211], a[168:171], v[32:35], v[208:211]
    ds_read_b64_tr_b16 a[160:161], v8 offset:0
    ds_write_b128 v31, a[52:55] offset:17408
    v_mfma_f32_16x16x32_bf16 v[216:219], a[168:171], v[36:39], v[216:219]
    ds_read_b64_tr_b16 a[162:163], v8 offset:2048
    v_mfma_f32_16x16x32_bf16 v[212:215], a[172:175], v[32:35], v[212:215]
    ds_read_b64_tr_b16 a[164:165], v9 offset:0
    v_mfma_f32_16x16x32_bf16 v[220:223], a[172:175], v[36:39], v[220:223]
    s_waitcnt lgkmcnt(8)
    ds_read_b64_tr_b16 a[166:167], v9 offset:2048
    v_mfma_f32_16x16x32_bf16 v[224:227], a[176:179], v[56:59], v[224:227]
    ds_read_b64_tr_b16 a[168:169], v10 offset:0
    v_mfma_f32_16x16x32_bf16 v[232:235], a[176:179], v[60:63], v[232:235]
    ds_read_b64_tr_b16 a[170:171], v10 offset:2048
    v_mfma_f32_16x16x32_bf16 v[228:231], a[180:183], v[56:59], v[228:231]
    ds_read_b64_tr_b16 a[172:173], v11 offset:0
    ds_write_b128 v31, a[56:59] offset:18432
    v_mfma_f32_16x16x32_bf16 v[236:239], a[180:183], v[60:63], v[236:239]
    s_waitcnt lgkmcnt(9)
    ds_read_b64_tr_b16 a[174:175], v11 offset:2048
    v_mfma_f32_16x16x32_bf16 v[240:243], a[184:187], v[56:59], v[240:243]
    ds_read_b64_tr_b16 a[176:177], v12 offset:0
    v_mfma_f32_16x16x32_bf16 v[248:251], a[184:187], v[60:63], v[248:251]
    ds_read_b64_tr_b16 a[178:179], v12 offset:2048
    v_mfma_f32_16x16x32_bf16 v[244:247], a[188:191], v[56:59], v[244:247]
    ds_read_b64_tr_b16 a[180:181], v13 offset:0
    v_mfma_f32_16x16x32_bf16 v[252:255], a[188:191], v[60:63], v[252:255]
    s_waitcnt lgkmcnt(8)
    ds_read_b64_tr_b16 a[182:183], v13 offset:2048
    v_mfma_f32_16x16x32_bf16 v[96:99], a[160:163], v[40:43], v[96:99]
    ds_read_b64_tr_b16 a[184:185], v14 offset:0
    ds_write_b128 v31, a[60:63] offset:19456
    v_mfma_f32_16x16x32_bf16 v[104:107], a[160:163], v[44:47], v[104:107]
    ds_read_b64_tr_b16 a[186:187], v14 offset:2048
    v_mfma_f32_16x16x32_bf16 v[100:103], a[164:167], v[40:43], v[100:103]
    ds_read_b64_tr_b16 a[188:189], v15 offset:0
    v_add_u32 v28, s29, v16
    v_cvt_pk_bf16_f32 v224, v224, v225
    v_cvt_pk_bf16_f32 v225, v226, v227
    v_mfma_f32_16x16x32_bf16 v[108:111], a[164:167], v[44:47], v[108:111]
    s_waitcnt lgkmcnt(8)
    ds_read_b64_tr_b16 a[190:191], v15 offset:2048
    v_cvt_pk_bf16_f32 v226, v228, v229
    v_cvt_pk_bf16_f32 v227, v230, v231
    v_cvt_pk_bf16_f32 v232, v232, v233
    v_cvt_pk_bf16_f32 v233, v234, v235
    v_mfma_f32_16x16x32_bf16 v[112:115], a[168:171], v[40:43], v[112:115]
    ds_read_b64_tr_b16 a[160:161], v8 offset:256
    v_cvt_pk_bf16_f32 v234, v236, v237
    v_cvt_pk_bf16_f32 v235, v238, v239
    v_cvt_pk_bf16_f32 v240, v240, v241
    v_mfma_f32_16x16x32_bf16 v[120:123], a[168:171], v[44:47], v[120:123]
    ds_read_b64_tr_b16 a[162:163], v8 offset:2304
    v_add_u32 v8, 98304, v7
    v_add_u32 v31, s40, v16
    v_cvt_pk_bf16_f32 v241, v242, v243
    v_mfma_f32_16x16x32_bf16 v[116:119], a[172:175], v[40:43], v[116:119]
    ds_read_b64_tr_b16 a[164:165], v9 offset:256
    s_waitcnt vmcnt(2)
    ds_write_b128 v31, a[64:67] offset:32768
    v_mfma_f32_16x16x32_bf16 v[124:127], a[172:175], v[44:47], v[124:127]
    s_waitcnt lgkmcnt(9)
    ds_read_b64_tr_b16 a[166:167], v9 offset:2304
    v_xor_b32 v9, 64, v8
    v_cvt_pk_bf16_f32 v242, v244, v245
    v_cvt_pk_bf16_f32 v243, v246, v247
    v_mfma_f32_16x16x32_bf16 v[128:131], a[176:179], v[40:43], v[128:131]
    ds_read_b64_tr_b16 a[168:169], v10 offset:256
    v_cvt_pk_bf16_f32 v248, v248, v249
    v_cvt_pk_bf16_f32 v249, v250, v251
    v_cvt_pk_bf16_f32 v250, v252, v253
    v_cvt_pk_bf16_f32 v251, v254, v255
    v_mfma_f32_16x16x32_bf16 v[136:139], a[176:179], v[44:47], v[136:139]
    ds_read_b64_tr_b16 a[170:171], v10 offset:2304
    v_add_u32 v10, s29, v8
    v_permlane16_swap_b32 v224, v226
    v_permlane16_swap_b32 v225, v227
    v_cvt_pk_bf16_f32 v96, v96, v97
    v_cvt_pk_bf16_f32 v97, v98, v99
    v_mfma_f32_16x16x32_bf16 v[132:135], a[180:183], v[40:43], v[132:135]
    ds_read_b64_tr_b16 a[172:173], v11 offset:256
    ds_write_b128 v28, v[224:227] offset:0
    v_mfma_f32_16x16x32_bf16 v[140:143], a[180:183], v[44:47], v[140:143]
    s_waitcnt lgkmcnt(9)
    ds_read_b64_tr_b16 a[174:175], v11 offset:2304
    v_add_u32 v11, s29, v9
    v_permlane16_swap_b32 v232, v234
    v_permlane16_swap_b32 v233, v235
    v_cvt_pk_bf16_f32 v98, v100, v101
    v_mfma_f32_16x16x32_bf16 v[144:147], a[184:187], v[40:43], v[144:147]
    ds_read_b64_tr_b16 a[176:177], v12 offset:256
    ds_write_b128 v31, a[68:71] offset:33792
    v_cvt_pk_bf16_f32 v99, v102, v103
    v_mfma_f32_16x16x32_bf16 v[152:155], a[184:187], v[44:47], v[152:155]
    ds_read_b64_tr_b16 a[178:179], v12 offset:2304
    ds_write_b128 v28, v[232:235] offset:1024
    v_mfma_f32_16x16x32_bf16 v[148:151], a[188:191], v[40:43], v[148:151]
    ds_read_b64_tr_b16 a[180:181], v13 offset:256
    v_permlane16_swap_b32 v240, v242
    v_permlane16_swap_b32 v241, v243
    v_cvt_pk_bf16_f32 v104, v104, v105
    v_cvt_pk_bf16_f32 v105, v106, v107
    v_cvt_pk_bf16_f32 v106, v108, v109
    v_mfma_f32_16x16x32_bf16 v[156:159], a[188:191], v[44:47], v[156:159]
    s_waitcnt lgkmcnt(10)
    ds_read_b64_tr_b16 a[182:183], v13 offset:2304
    ds_write_b128 v28, v[240:243] offset:2048
    v_mfma_f32_16x16x32_bf16 v[160:163], a[160:163], v[40:43], v[160:163]
    ds_read_b64_tr_b16 a[184:185], v14 offset:256
    v_permlane16_swap_b32 v248, v250
    v_permlane16_swap_b32 v249, v251
    v_cvt_pk_bf16_f32 v107, v110, v111
    v_permlane16_swap_b32 v96, v98
    v_mfma_f32_16x16x32_bf16 v[168:171], a[160:163], v[44:47], v[168:171]
    ds_read_b64_tr_b16 a[186:187], v14 offset:2304
    ds_write_b128 v28, v[248:251] offset:3072
    v_permlane16_swap_b32 v97, v99
    v_mfma_f32_16x16x32_bf16 v[164:167], a[164:167], v[40:43], v[164:167]
    ds_read_b64_tr_b16 a[188:189], v15 offset:256
    ds_write_b128 v31, a[72:75] offset:34816
    v_mfma_f32_16x16x32_bf16 v[172:175], a[164:167], v[44:47], v[172:175]
    s_waitcnt lgkmcnt(12)
    ds_read_b64_tr_b16 a[190:191], v15 offset:2304
    v_accvgpr_write_b32 a0, v96
    v_accvgpr_write_b32 a1, v97
    v_accvgpr_write_b32 a2, v98
    v_accvgpr_write_b32 a3, v99
    v_permlane16_swap_b32 v104, v106
    v_mfma_f32_16x16x32_bf16 v[176:179], a[168:171], v[40:43], v[176:179]
    s_waitcnt lgkmcnt(1)
    s_barrier
    ds_read_b128 a[160:163], v8 offset:16384
    v_mfma_f32_16x16x32_bf16 v[184:187], a[168:171], v[44:47], v[184:187]
    v_permlane16_swap_b32 v105, v107
    v_accvgpr_write_b32 a4, v104
    v_accvgpr_write_b32 a5, v105
    v_accvgpr_write_b32 a6, v106
    v_accvgpr_write_b32 a7, v107
    v_mfma_f32_16x16x32_bf16 v[180:183], a[172:175], v[40:43], v[180:183]
    ds_read_b128 a[164:167], v9 offset:16384
    v_cvt_pk_bf16_f32 v112, v112, v113
    v_cvt_pk_bf16_f32 v113, v114, v115
    v_mfma_f32_16x16x32_bf16 v[188:191], a[172:175], v[44:47], v[188:191]
    v_cvt_pk_bf16_f32 v114, v116, v117
    v_cvt_pk_bf16_f32 v115, v118, v119
    v_mfma_f32_16x16x32_bf16 v[192:195], a[176:179], v[40:43], v[192:195]
    ds_read_b128 a[168:171], v8 offset:18432
    ds_write_b128 v31, a[76:79] offset:35840
    v_mfma_f32_16x16x32_bf16 v[200:203], a[176:179], v[44:47], v[200:203]
    v_cvt_pk_bf16_f32 v120, v120, v121
    v_cvt_pk_bf16_f32 v121, v122, v123
    v_cvt_pk_bf16_f32 v122, v124, v125
    v_mfma_f32_16x16x32_bf16 v[196:199], a[180:183], v[40:43], v[196:199]
    ds_read_b128 a[172:175], v9 offset:18432
    v_cvt_pk_bf16_f32 v123, v126, v127
    v_permlane16_swap_b32 v112, v114
    v_mfma_f32_16x16x32_bf16 v[204:207], a[180:183], v[44:47], v[204:207]
    s_waitcnt lgkmcnt(5)
    v_permlane16_swap_b32 v113, v115
    v_accvgpr_write_b32 a8, v112
    v_mfma_f32_16x16x32_bf16 v[208:211], a[184:187], v[40:43], v[208:211]
    ds_read_b128 a[176:179], v8 offset:20480
    v_accvgpr_write_b32 a9, v113
    v_accvgpr_write_b32 a10, v114
    v_mfma_f32_16x16x32_bf16 v[216:219], a[184:187], v[44:47], v[216:219]
    s_add_u32 m0, s29, 81920
    v_accvgpr_write_b32 a11, v115
    v_permlane16_swap_b32 v120, v122
    v_permlane16_swap_b32 v121, v123
    v_mfma_f32_16x16x32_bf16 v[212:215], a[188:191], v[40:43], v[212:215]
    s_add_u32 s34, s26, 65792
    ds_read_b128 a[180:183], v9 offset:20480
    v_accvgpr_write_b32 a12, v120
    v_mfma_f32_16x16x32_bf16 v[220:223], a[188:191], v[44:47], v[220:223]
    s_waitcnt lgkmcnt(5)
    v_accvgpr_write_b32 a13, v121
    v_accvgpr_write_b32 a14, v122
    v_accvgpr_write_b32 a15, v123
    s_branch L_kv
L_tail:
    s_nop 7
    s_load_dwordx2 s[16:17], s[0:1], 80
    s_mul_i32 s32, s7, 229376
    s_mul_i32 s34, s28, 28672
    s_add_u32 s32, s32, s34
    v_lshrrev_b32 v2, 7, v16
    v_mul_u32_u24 v2, 896, v2
    v_and_b32 v3, 0x70, v16
    v_lshrrev_b32 v4, 3, v16
    v_and_b32 v4, 0x60, v4
    v_xor_b32 v3, v3, v4
    v_add_u32 v0, v2, v3
    v_add_u32 v1, 6144, v0
    v_mov_b32 v5, s100
    v_add_u32 v2, s45, v16
    s_mov_b64 exec, 0
    s_cmp_eq_u32 s28, 0
    s_cbranch_scc1 B_stub0
    s_cmp_eq_u32 s28, 1
    s_cbranch_scc1 B_stub1
    s_cmp_eq_u32 s28, 2
    s_cbranch_scc1 B_stub2
    s_branch B_stub3
B_back:
    s_mov_b64 exec, -1
    s_waitcnt vmcnt(0) lgkmcnt(0)
    s_barrier
    ds_write_b128 v2, a[240:243] offset:0
    s_add_u32 m0, s29, 32768
    s_add_u32 s34, s32, 1835008
    buffer_load_dwordx4 v0, s[56:59], s34 offen offset:0 lds
    ds_write_b128 v2, a[244:247] offset:1024
    ds_write_b128 v2, a[248:251] offset:8192
    ds_write_b128 v2, a[252:255] offset:9216
    v_mul_f32 v64, v64, v24
    v_mul_f32 v65, v65, v24
    v_mul_f32 v66, v66, v24
    buffer_load_dwordx4 v1, s[56:59], s34 offen offset:1024 lds
    v_mul_f32 v67, v67, v24
    v_mul_f32 v68, v68, v24
    v_mul_f32 v69, v69, v24
    v_mul_f32 v70, v70, v24
    v_mul_f32 v71, v71, v24
    v_mul_f32 v72, v72, v25
    s_add_u32 s34, s34, 12288
    buffer_load_dwordx4 v0, s[56:59], s34 offen offset:2048 lds
    v_mul_f32 v73, v73, v25
    v_mul_f32 v74, v74, v25
    v_mul_f32 v75, v75, v25
    v_mul_f32 v76, v76, v25
    v_mul_f32 v77, v77, v25
    v_mul_f32 v78, v78, v25
    buffer_load_dwordx4 v1, s[56:59], s34 offen offset:3072 lds
    v_mul_f32 v79, v79, v25
    v_cvt_pk_bf16_f32 v96, v64, v65
    v_cvt_pk_bf16_f32 v97, v66, v67
    v_cvt_pk_bf16_f32 v98, v68, v69
    v_cvt_pk_bf16_f32 v99, v70, v71
    v_cvt_pk_bf16_f32 v100, v72, v73
    s_add_u32 m0, s29, 49152
    s_add_u32 s34, s32, 1949696
    buffer_load_dwordx4 v0, s[56:59], s34 offen offset:0 lds
    v_cvt_pk_bf16_f32 v101, v74, v75
    v_cvt_pk_bf16_f32 v102, v76, v77
    v_cvt_pk_bf16_f32 v103, v78, v79
    v_mul_f32 v80, v80, v24
    v_mul_f32 v81, v81, v24
    v_mul_f32 v82, v82, v24
    buffer_load_dwordx4 v1, s[56:59], s34 offen offset:1024 lds
    v_mul_f32 v83, v83, v24
    v_mul_f32 v84, v84, v24
    v_mul_f32 v85, v85, v24
    v_mul_f32 v86, v86, v24
    v_mul_f32 v87, v87, v24
    v_mul_f32 v88, v88, v25
    s_add_u32 s34, s34, 12288
    s_nop 0
B_stub0:
    s_cbranch_execz B_stub4
    buffer_load_dwordx4 v0, s[56:59], s34 offen offset:2048 lds
    v_mul_f32 v89, v89, v25
    v_mul_f32 v90, v90, v25
    v_mul_f32 v91, v91, v25
    v_mul_f32 v92, v92, v25
    v_mul_f32 v93, v93, v25
    v_mul_f32 v94, v94, v25
    buffer_load_dwordx4 v1, s[56:59], s34 offen offset:3072 lds
    v_mul_f32 v95, v95, v25
    v_cvt_pk_bf16_f32 v104, v80, v81
    v_cvt_pk_bf16_f32 v105, v82, v83
    v_cvt_pk_bf16_f32 v106, v84, v85
    v_cvt_pk_bf16_f32 v107, v86, v87
    v_cvt_pk_bf16_f32 v108, v88, v89
    s_add_u32 m0, s29, 65536
    s_add_u32 s34, s32, 0
    buffer_load_dwordx4 v0, s[56:59], s34 offen offset:0 lds
    v_cvt_pk_bf16_f32 v109, v90, v91
    v_cvt_pk_bf16_f32 v110, v92, v93
    v_cvt_pk_bf16_f32 v111, v94, v95
    ds_write_b128 v2, v[96:99] offset:16384
    ds_write_b128 v2, v[100:103] offset:17408
    ds_write_b128 v2, v[104:107] offset:24576
    buffer_load_dwordx4 v1, s[56:59], s34 offen offset:1024 lds
    ds_write_b128 v2, v[108:111] offset:25600
    v_accvgpr_read_b32 v208, a0
    v_accvgpr_read_b32 v209, a1
    v_accvgpr_read_b32 v210, a2
    v_accvgpr_read_b32 v211, a3
    v_accvgpr_read_b32 v212, a4
    s_add_u32 s34, s34, 12288
    buffer_load_dwordx4 v0, s[56:59], s34 offen offset:2048 lds
    v_accvgpr_read_b32 v213, a5
    v_accvgpr_read_b32 v214, a6
    v_accvgpr_read_b32 v215, a7
    v_accvgpr_read_b32 v216, a8
    v_accvgpr_read_b32 v217, a9
    v_accvgpr_read_b32 v218, a10
    buffer_load_dwordx4 v1, s[56:59], s34 offen offset:3072 lds
    v_accvgpr_read_b32 v219, a11
    v_accvgpr_read_b32 v220, a12
    v_accvgpr_read_b32 v221, a13
    v_accvgpr_read_b32 v222, a14
    v_accvgpr_read_b32 v223, a15
    v_mul_f32 v208, v208, v22
    s_add_u32 m0, s29, 81920
    s_add_u32 s34, s32, 114688
    buffer_load_dwordx4 v0, s[56:59], s34 offen offset:0 lds
    v_mul_f32 v209, v209, v22
    v_mul_f32 v210, v210, v22
    v_mul_f32 v211, v211, v22
    v_mul_f32 v212, v212, v22
    v_mul_f32 v213, v213, v22
    v_mul_f32 v214, v214, v22
    buffer_load_dwordx4 v1, s[56:59], s34 offen offset:1024 lds
    v_mul_f32 v215, v215, v22
    v_mul_f32 v216, v216, v23
    v_mul_f32 v217, v217, v23
    v_mul_f32 v218, v218, v23
    v_mul_f32 v219, v219, v23
    v_mul_f32 v220, v220, v23
    s_add_u32 s34, s34, 12288
    buffer_load_dwordx4 v0, s[56:59], s34 offen offset:2048 lds
    v_mul_f32 v221, v221, v23
    v_mul_f32 v222, v222, v23
    v_mul_f32 v223, v223, v23
    v_cvt_pk_bf16_f32 v32, v208, v209
    v_cvt_pk_bf16_f32 v33, v210, v211
    v_cvt_pk_bf16_f32 v34, v212, v213
    buffer_load_dwordx4 v1, s[56:59], s34 offen offset:3072 lds
    v_cvt_pk_bf16_f32 v35, v214, v215
    v_cvt_pk_bf16_f32 v36, v216, v217
    v_cvt_pk_bf16_f32 v37, v218, v219
    v_cvt_pk_bf16_f32 v38, v220, v221
    v_cvt_pk_bf16_f32 v39, v222, v223
    v_accvgpr_read_b32 v224, a16
    s_add_u32 m0, s29, 98304
    s_add_u32 s34, s32, 1835136
    buffer_load_dwordx4 v0, s[56:59], s34 offen offset:0 lds
    v_accvgpr_read_b32 v225, a17
    v_accvgpr_read_b32 v226, a18
    v_accvgpr_read_b32 v227, a19
    v_accvgpr_read_b32 v228, a20
    v_accvgpr_read_b32 v229, a21
    v_accvgpr_read_b32 v230, a22
    buffer_load_dwordx4 v1, s[56:59], s34 offen offset:1024 lds
    v_accvgpr_read_b32 v231, a23
    v_accvgpr_read_b32 v232, a24
    v_accvgpr_read_b32 v233, a25
    v_accvgpr_read_b32 v234, a26
    v_accvgpr_read_b32 v235, a27
    v_accvgpr_read_b32 v236, a28
    s_add_u32 s34, s34, 12288
    buffer_load_dwordx4 v0, s[56:59], s34 offen offset:2048 lds
    v_accvgpr_read_b32 v237, a29
    v_accvgpr_read_b32 v238, a30
    v_accvgpr_read_b32 v239, a31
    v_mul_f32 v224, v224, v22
    v_mul_f32 v225, v225, v22
    v_mul_f32 v226, v226, v22
    buffer_load_dwordx4 v1, s[56:59], s34 offen offset:3072 lds
    v_mul_f32 v227, v227, v22
    v_mul_f32 v228, v228, v22
    v_mul_f32 v229, v229, v22
    v_mul_f32 v230, v230, v22
    v_mul_f32 v231, v231, v22
    v_mul_f32 v232, v232, v23
    s_add_u32 m0, s29, 114688
    s_add_u32 s34, s32, 1949824
    buffer_load_dwordx4 v0, s[56:59], s34 offen offset:0 lds
    v_mul_f32 v233, v233, v23
    v_mul_f32 v234, v234, v23
    v_mul_f32 v235, v235, v23
    v_mul_f32 v236, v236, v23
    v_mul_f32 v237, v237, v23
    v_mul_f32 v238, v238, v23
    buffer_load_dwordx4 v1, s[56:59], s34 offen offset:1024 lds
    v_mul_f32 v239, v239, v23
    v_cvt_pk_bf16_f32 v40, v224, v225
    v_cvt_pk_bf16_f32 v41, v226, v227
    v_cvt_pk_bf16_f32 v42, v228, v229
    v_cvt_pk_bf16_f32 v43, v230, v231
    v_cvt_pk_bf16_f32 v44, v232, v233
    s_add_u32 s34, s34, 12288
    buffer_load_dwordx4 v0, s[56:59], s34 offen offset:2048 lds
    v_cvt_pk_bf16_f32 v45, v234, v235
    v_cvt_pk_bf16_f32 v46, v236, v237
    v_cvt_pk_bf16_f32 v47, v238, v239
    v_accvgpr_read_b32 v208, a32
    v_accvgpr_read_b32 v209, a33
    v_accvgpr_read_b32 v210, a34
    buffer_load_dwordx4 v1, s[56:59], s34 offen offset:3072 lds
    v_accvgpr_read_b32 v211, a35
    v_accvgpr_read_b32 v212, a36
    v_accvgpr_read_b32 v213, a37
    v_accvgpr_read_b32 v214, a38
    v_accvgpr_read_b32 v215, a39
    v_accvgpr_read_b32 v216, a40
    v_accvgpr_read_b32 v217, a41
    v_accvgpr_read_b32 v218, a42
    v_accvgpr_read_b32 v219, a43
    v_accvgpr_read_b32 v220, a44
    v_accvgpr_read_b32 v221, a45
    v_accvgpr_read_b32 v222, a46
    v_accvgpr_read_b32 v223, a47
    v_mul_f32 v208, v208, v22
    v_mul_f32 v209, v209, v22
    v_mul_f32 v210, v210, v22
    v_mul_f32 v211, v211, v22
    v_mul_f32 v212, v212, v22
    v_mul_f32 v213, v213, v22
    v_mul_f32 v214, v214, v22
    v_mul_f32 v215, v215, v22
    v_mul_f32 v216, v216, v23
    v_mul_f32 v217, v217, v23
    v_mul_f32 v218, v218, v23
    v_mul_f32 v219, v219, v23
    v_mul_f32 v220, v220, v23
    v_mul_f32 v221, v221, v23
    v_mul_f32 v222, v222, v23
    v_mul_f32 v223, v223, v23
    v_cvt_pk_bf16_f32 v48, v208, v209
    v_cvt_pk_bf16_f32 v49, v210, v211
    v_cvt_pk_bf16_f32 v50, v212, v213
    v_cvt_pk_bf16_f32 v51, v214, v215
    v_cvt_pk_bf16_f32 v52, v216, v217
    v_cvt_pk_bf16_f32 v53, v218, v219
    v_cvt_pk_bf16_f32 v54, v220, v221
    v_cvt_pk_bf16_f32 v55, v222, v223
    v_accvgpr_read_b32 v224, a48
    v_accvgpr_read_b32 v225, a49
    v_accvgpr_read_b32 v226, a50
    v_accvgpr_read_b32 v227, a51
    v_accvgpr_read_b32 v228, a52
    v_accvgpr_read_b32 v229, a53
    v_accvgpr_read_b32 v230, a54
    v_accvgpr_read_b32 v231, a55
    v_accvgpr_read_b32 v232, a56
    v_accvgpr_read_b32 v233, a57
    v_accvgpr_read_b32 v234, a58
    v_accvgpr_read_b32 v235, a59
    v_accvgpr_read_b32 v236, a60
    v_accvgpr_read_b32 v237, a61
    v_accvgpr_read_b32 v238, a62
    v_accvgpr_read_b32 v239, a63
    v_mul_f32 v224, v224, v22
    v_mul_f32 v225, v225, v22
    v_mul_f32 v226, v226, v22
    v_mul_f32 v227, v227, v22
    v_mul_f32 v228, v228, v22
    v_mul_f32 v229, v229, v22
    v_mul_f32 v230, v230, v22
    v_mul_f32 v231, v231, v22
    v_mul_f32 v232, v232, v23
    v_mul_f32 v233, v233, v23
    v_mul_f32 v234, v234, v23
    v_mul_f32 v235, v235, v23
    v_mul_f32 v236, v236, v23
    v_mul_f32 v237, v237, v23
    v_mul_f32 v238, v238, v23
    v_mul_f32 v239, v239, v23
    v_cvt_pk_bf16_f32 v56, v224, v225
    v_cvt_pk_bf16_f32 v57, v226, v227
    v_cvt_pk_bf16_f32 v58, v228, v229
    v_cvt_pk_bf16_f32 v59, v230, v231
    v_cvt_pk_bf16_f32 v60, v232, v233
    v_cvt_pk_bf16_f32 v61, v234, v235
    v_cvt_pk_bf16_f32 v62, v236, v237
    v_cvt_pk_bf16_f32 v63, v238, v239
    buffer_load_dword v4, v5, s[92:95], 0 offen sc1
    v_bfe_u32 v8, v16, 6, 4
    v_lshlrev_b32 v9, 7, v8
    v_bfe_u32 v8, v16, 7, 2
    v_xor_b32 v8, s28, v8
    v_lshl_add_u32 v9, v8, 5, v9
    v_bfe_u32 v8, v16, 4, 2
    v_lshl_add_u32 v9, v8, 3, v9
    v_add_u32 v112, s40, v9
    v_bfe_u32 v8, v16, 4, 4
    v_mul_u32_u24 v8, 1792, v8
    v_bfe_u32 v9, v16, 9, 1
    v_lshl_add_u32 v8, v9, 4, v8
    v_bfe_u32 v9, v16, 8, 1
    v_lshl_add_u32 v7, v9, 5, v8
    v_mul_u32_u24 v9, 28672, v9
    v_add_u32 v3, v8, v9
    s_lshr_b32 s47, s100, 2
    s_mul_i32 s47, s47, 1146880
    s_add_u32 s47, s47, 1048576
    s_add_u32 s8, s52, s47
    s_addc_u32 s9, s53, 0
    s_mov_b32 s10, 1146880
    s_lshl_b32 s30, s28, 5
    s_add_u32 s30, s30, s7
    s_lshl_b32 s30, s30, 10
    s_lshl_b32 s31, s28, 3
    s_add_u32 s31, s31, s7
    s_add_u32 s31, s31, 128
    s_lshl_b32 s31, s31, 10
    s_mul_i32 s33, s6, 286720
    s_mul_i32 s47, s5, 896
    s_add_u32 s33, s33, s47
    s_mov_b32 s18, 4587520
    s_mov_b32 s39, 0x3f80
    s_mov_b32 s26, 0x3f800000
    v_xor_b32 v113, 32, v112
    v_xor_b32 v114, 64, v112
    v_xor_b32 v115, 96, v112
    v_xor_b32 v116, 4096, v112
    v_xor_b32 v117, 4128, v112
    v_xor_b32 v118, 4160, v112
    v_xor_b32 v119, 4192, v112
    v_xor_b32 v120, 8192, v112
    v_xor_b32 v121, 8224, v112
    v_xor_b32 v122, 8256, v112
    v_xor_b32 v123, 8288, v112
    v_xor_b32 v124, 12288, v112
    v_xor_b32 v125, 12320, v112
    v_xor_b32 v126, 12352, v112
    v_xor_b32 v127, 12384, v112
    v_xor_b32 v8, 0, v2
    v_xor_b32 v9, 2048, v2
    v_xor_b32 v10, 4096, v2
    v_xor_b32 v11, 6144, v2
    s_waitcnt vmcnt(21) lgkmcnt(0)
    s_barrier
    ds_read_b64_tr_b16 a[160:161], v115 offset:0
    ds_read_b64_tr_b16 a[162:163], v115 offset:2048
    ds_read_b64_tr_b16 a[164:165], v114 offset:0
    ds_read_b64_tr_b16 a[166:167], v114 offset:2048
    ds_read_b64_tr_b16 a[168:169], v113 offset:0
    ds_read_b64_tr_b16 a[170:171], v113 offset:2048
    ds_read_b64_tr_b16 a[172:173], v112 offset:0
    ds_read_b64_tr_b16 a[174:175], v112 offset:2048
    ds_read_b128 a[0:3], v8 offset:16384
    ds_read_b128 a[4:7], v8 offset:17408
    ds_read_b64_tr_b16 a[176:177], v119 offset:0
    ds_read_b64_tr_b16 a[178:179], v119 offset:2048
    s_waitcnt lgkmcnt(10)
    v_mfma_f32_16x16x32_bf16 v[148:151], a[160:163], v[32:35], 0
    ds_read_b64_tr_b16 a[180:181], v118 offset:0
    v_accvgpr_read_b32 v208, a64
    v_accvgpr_read_b32 v209, a65
    v_accvgpr_read_b32 v210, a66
    v_mfma_f32_16x16x32_bf16 v[156:159], a[160:163], v[36:39], 0
    s_waitcnt lgkmcnt(9)
    s_add_u32 m0, s29, 131072
    ds_read_b64_tr_b16 a[182:183], v118 offset:2048
    v_accvgpr_read_b32 v211, a67
    v_accvgpr_read_b32 v212, a68
    v_accvgpr_read_b32 v213, a69
    v_mfma_f32_16x16x32_bf16 v[144:147], a[164:167], v[32:35], 0
    s_add_u32 s34, s32, 128
    ds_read_b64_tr_b16 a[184:185], v117 offset:0
    v_accvgpr_read_b32 v214, a70
    v_accvgpr_read_b32 v215, a71
    v_accvgpr_read_b32 v216, a72
    v_accvgpr_read_b32 v217, a73
    v_mfma_f32_16x16x32_bf16 v[152:155], a[164:167], v[36:39], 0
    s_waitcnt lgkmcnt(7)
    ds_read_b64_tr_b16 a[186:187], v117 offset:2048
    buffer_load_dwordx4 v0, s[56:59], s34 offen offset:0 lds
    v_mfma_f32_16x16x32_bf16 v[132:135], a[168:171], v[32:35], 0
    ds_read_b64_tr_b16 a[188:189], v116 offset:0
    v_accvgpr_read_b32 v218, a74
    v_accvgpr_read_b32 v219, a75
    v_accvgpr_read_b32 v220, a76
    v_accvgpr_read_b32 v221, a77
    v_mfma_f32_16x16x32_bf16 v[140:143], a[168:171], v[36:39], 0
    ds_read_b64_tr_b16 a[190:191], v116 offset:2048
    v_accvgpr_read_b32 v222, a78
    v_accvgpr_read_b32 v223, a79
    v_mul_f32 v208, v208, v22
    v_mfma_f32_16x16x32_bf16 v[128:131], a[172:175], v[32:35], 0
    ds_read_b128 a[8:11], v9 offset:16384
    v_mul_f32 v209, v209, v22
    v_mul_f32 v210, v210, v22
    v_mul_f32 v211, v211, v22
    v_mfma_f32_16x16x32_bf16 v[136:139], a[172:175], v[36:39], 0
    s_waitcnt lgkmcnt(7)
    ds_read_b128 a[12:15], v9 offset:17408
    v_mul_f32 v212, v212, v22
    v_mul_f32 v213, v213, v22
    v_mul_f32 v214, v214, v22
    v_mfma_f32_16x16x32_bf16 v[160:163], a[172:175], a[0:3], 0
    ds_read_b64_tr_b16 a[160:161], v123 offset:0
    v_mul_f32 v215, v215, v22
    v_mul_f32 v216, v216, v23
    v_mul_f32 v217, v217, v23
    v_mfma_f32_16x16x32_bf16 v[164:167], a[172:175], a[4:7], 0
    ds_read_b64_tr_b16 a[162:163], v123 offset:2048
    v_mul_f32 v218, v218, v23
    v_mul_f32 v219, v219, v23
    v_mul_f32 v220, v220, v23
    v_mul_f32 v221, v221, v23
    v_mfma_f32_16x16x32_bf16 v[148:151], a[176:179], v[40:43], v[148:151]
    ds_read_b64_tr_b16 a[164:165], v122 offset:0
    buffer_load_dwordx4 v1, s[56:59], s34 offen offset:1024 lds
    v_mfma_f32_16x16x32_bf16 v[156:159], a[176:179], v[44:47], v[156:159]
    s_waitcnt lgkmcnt(7)
    ds_read_b64_tr_b16 a[166:167], v122 offset:2048
    v_mul_f32 v222, v222, v23
    v_mul_f32 v223, v223, v23
    v_cvt_pk_bf16_f32 v64, v208, v209
    v_cvt_pk_bf16_f32 v65, v210, v211
    v_mfma_f32_16x16x32_bf16 v[144:147], a[180:183], v[40:43], v[144:147]
    ds_read_b64_tr_b16 a[168:169], v121 offset:0
    v_cvt_pk_bf16_f32 v66, v212, v213
    v_cvt_pk_bf16_f32 v67, v214, v215
    v_cvt_pk_bf16_f32 v68, v216, v217
    v_mfma_f32_16x16x32_bf16 v[152:155], a[180:183], v[44:47], v[152:155]
    ds_read_b64_tr_b16 a[170:171], v121 offset:2048
    v_cvt_pk_bf16_f32 v69, v218, v219
    v_cvt_pk_bf16_f32 v70, v220, v221
    v_cvt_pk_bf16_f32 v71, v222, v223
    v_mfma_f32_16x16x32_bf16 v[132:135], a[184:187], v[40:43], v[132:135]
    ds_read_b64_tr_b16 a[172:173], v120 offset:0
    v_accvgpr_read_b32 v224, a80
    v_accvgpr_read_b32 v225, a81
    v_accvgpr_read_b32 v226, a82
    v_mfma_f32_16x16x32_bf16 v[140:143], a[184:187], v[44:47], v[140:143]
    s_waitcnt lgkmcnt(9)
    ds_read_b64_tr_b16 a[174:175], v120 offset:2048
    v_accvgpr_read_b32 v227, a83
    v_accvgpr_read_b32 v228, a84
    v_accvgpr_read_b32 v229, a85
    v_mfma_f32_16x16x32_bf16 v[128:131], a[188:191], v[40:43], v[128:131]
    ds_read_b128 a[16:19], v10 offset:16384
    v_accvgpr_read_b32 v230, a86
    v_accvgpr_read_b32 v231, a87
    v_accvgpr_read_b32 v232, a88
    v_mfma_f32_16x16x32_bf16 v[136:139], a[188:191], v[44:47], v[136:139]
    s_waitcnt lgkmcnt(10)
    s_add_u32 s34, s34, 12288
    ds_read_b128 a[20:23], v10 offset:17408
    buffer_load_dwordx4 v0, s[56:59], s34 offen offset:2048 lds
    v_accvgpr_read_b32 v233, a89
    v_mfma_f32_16x16x32_bf16 v[160:163], a[188:191], a[8:11], v[160:163]
    s_waitcnt lgkmcnt(10)
    ds_read_b64_tr_b16 a[176:177], v127 offset:0
    v_accvgpr_read_b32 v234, a90
    v_accvgpr_read_b32 v235, a91
    v_accvgpr_read_b32 v236, a92
    v_mfma_f32_16x16x32_bf16 v[164:167], a[188:191], a[12:15], v[164:167]
    s_waitcnt lgkmcnt(7)
    ds_read_b64_tr_b16 a[178:179], v127 offset:2048
    v_accvgpr_read_b32 v237, a93
    v_accvgpr_read_b32 v238, a94
    v_accvgpr_read_b32 v239, a95
    v_mfma_f32_16x16x32_bf16 v[148:151], a[160:163], v[48:51], v[148:151]
    ds_read_b64_tr_b16 a[180:181], v126 offset:0
    v_mul_f32 v224, v224, v22
    v_mul_f32 v225, v225, v22
    v_mul_f32 v226, v226, v22
    v_mfma_f32_16x16x32_bf16 v[156:159], a[160:163], v[52:55], v[156:159]
    ds_read_b64_tr_b16 a[182:183], v126 offset:2048
    v_mul_f32 v227, v227, v22
    v_mul_f32 v228, v228, v22
    v_mul_f32 v229, v229, v22
    v_mfma_f32_16x16x32_bf16 v[144:147], a[164:167], v[48:51], v[144:147]
    ds_read_b64_tr_b16 a[184:185], v125 offset:0
    v_mul_f32 v230, v230, v22
    v_mul_f32 v231, v231, v22
    v_mul_f32 v232, v232, v23
    v_mfma_f32_16x16x32_bf16 v[152:155], a[164:167], v[52:55], v[152:155]
    s_waitcnt lgkmcnt(7)
    ds_read_b64_tr_b16 a[186:187], v125 offset:2048
    v_mul_f32 v233, v233, v23
    v_mul_f32 v234, v234, v23
    v_mul_f32 v235, v235, v23
    v_mfma_f32_16x16x32_bf16 v[132:135], a[168:171], v[48:51], v[132:135]
    ds_read_b64_tr_b16 a[188:189], v124 offset:0
    buffer_load_dwordx4 v1, s[56:59], s34 offen offset:3072 lds
    v_mfma_f32_16x16x32_bf16 v[140:143], a[168:171], v[52:55], v[140:143]
    ds_read_b64_tr_b16 a[190:191], v124 offset:2048
    v_mul_f32 v236, v236, v23
    v_mul_f32 v237, v237, v23
    v_mul_f32 v238, v238, v23
    v_mfma_f32_16x16x32_bf16 v[128:131], a[172:175], v[48:51], v[128:131]
    ds_read_b128 a[24:27], v11 offset:16384
    v_mul_f32 v239, v239, v23
    v_cvt_pk_bf16_f32 v72, v224, v225
    v_cvt_pk_bf16_f32 v73, v226, v227
    v_mfma_f32_16x16x32_bf16 v[136:139], a[172:175], v[52:55], v[136:139]
    s_waitcnt lgkmcnt(7)
    ds_read_b128 a[28:31], v11 offset:17408
    v_cvt_pk_bf16_f32 v74, v228, v229
    v_cvt_pk_bf16_f32 v75, v230, v231
    v_cvt_pk_bf16_f32 v76, v232, v233
    v_mfma_f32_16x16x32_bf16 v[160:163], a[172:175], a[16:19], v[160:163]
    s_waitcnt vmcnt(21)
    s_barrier
    ds_read_b64_tr_b16 a[160:161], v115 offset:16384
    v_mfma_f32_16x16x32_bf16 v[164:167], a[172:175], a[20:23], v[164:167]
    ds_read_b64_tr_b16 a[162:163], v115 offset:18432
    v_cvt_pk_bf16_f32 v77, v234, v235
    v_cvt_pk_bf16_f32 v78, v236, v237
    v_cvt_pk_bf16_f32 v79, v238, v239
    v_mfma_f32_16x16x32_bf16 v[148:151], a[176:179], v[56:59], v[148:151]
    s_add_u32 m0, s29, 147456
    ds_read_b64_tr_b16 a[164:165], v114 offset:16384
    v_accvgpr_read_b32 v208, a96
    v_accvgpr_read_b32 v209, a97
    v_accvgpr_read_b32 v210, a98
    v_mfma_f32_16x16x32_bf16 v[156:159], a[176:179], v[60:63], v[156:159]
    s_waitcnt lgkmcnt(7)
    ds_read_b64_tr_b16 a[166:167], v114 offset:18432
    v_accvgpr_read_b32 v211, a99
    v_accvgpr_read_b32 v212, a100
    v_accvgpr_read_b32 v213, a101
    v_mfma_f32_16x16x32_bf16 v[144:147], a[180:183], v[56:59], v[144:147]
    s_add_u32 s34, s32, 114816
    ds_read_b64_tr_b16 a[168:169], v113 offset:16384
    buffer_load_dwordx4 v0, s[56:59], s34 offen offset:0 lds
    v_mfma_f32_16x16x32_bf16 v[152:155], a[180:183], v[60:63], v[152:155]
    ds_read_b64_tr_b16 a[170:171], v113 offset:18432
    v_accvgpr_read_b32 v214, a102
    v_accvgpr_read_b32 v215, a103
    v_accvgpr_read_b32 v216, a104
    v_mfma_f32_16x16x32_bf16 v[132:135], a[184:187], v[56:59], v[132:135]
    ds_read_b64_tr_b16 a[172:173], v112 offset:16384
    v_accvgpr_read_b32 v217, a105
    v_accvgpr_read_b32 v218, a106
    v_accvgpr_read_b32 v219, a107
    v_mfma_f32_16x16x32_bf16 v[140:143], a[184:187], v[60:63], v[140:143]
    s_waitcnt lgkmcnt(9)
    ds_read_b64_tr_b16 a[174:175], v112 offset:18432
    v_accvgpr_read_b32 v220, a108
    v_accvgpr_read_b32 v221, a109
    v_mfma_f32_16x16x32_bf16 v[128:131], a[188:191], v[56:59], v[128:131]
    ds_read_b128 a[32:35], v8 offset:24576
    v_accvgpr_read_b32 v222, a110
    v_accvgpr_read_b32 v223, a111
    v_mul_f32 v208, v208, v22
    v_mfma_f32_16x16x32_bf16 v[136:139], a[188:191], v[60:63], v[136:139]
    s_waitcnt lgkmcnt(10)
    ds_read_b128 a[36:39], v8 offset:25600
    v_mul_f32 v209, v209, v22
    v_mul_f32 v210, v210, v22
    v_mul_f32 v211, v211, v22
    v_mfma_f32_16x16x32_bf16 v[160:163], a[188:191], a[24:27], v[160:163]
    s_waitcnt lgkmcnt(10)
    ds_read_b64_tr_b16 a[176:177], v119 offset:16384
    v_mul_f32 v212, v212, v22
    v_mul_f32 v213, v213, v22
    v_mul_f32 v214, v214, v22
    v_mfma_f32_16x16x32_bf16 v[164:167], a[188:191], a[28:31], v[164:167]
    s_waitcnt lgkmcnt(7)
    ds_read_b64_tr_b16 a[178:179], v119 offset:18432
    buffer_load_dwordx4 v1, s[56:59], s34 offen offset:1024 lds
    v_mfma_f32_16x16x32_bf16 v[148:151], a[160:163], v[64:67], v[148:151]
    ds_read_b64_tr_b16 a[180:181], v118 offset:16384
    v_mul_f32 v215, v215, v22
    v_mul_f32 v216, v216, v23
    v_mul_f32 v217, v217, v23
    v_mfma_f32_16x16x32_bf16 v[156:159], a[160:163], v[68:71], v[156:159]
    ds_read_b64_tr_b16 a[182:183], v118 offset:18432
    v_mul_f32 v218, v218, v23
    v_mul_f32 v219, v219, v23
    v_mul_f32 v220, v220, v23
    v_mfma_f32_16x16x32_bf16 v[144:147], a[164:167], v[64:67], v[144:147]
    ds_read_b64_tr_b16 a[184:185], v117 offset:16384
    v_mul_f32 v221, v221, v23
    v_mul_f32 v222, v222, v23
    v_mul_f32 v223, v223, v23
    v_mfma_f32_16x16x32_bf16 v[152:155], a[164:167], v[68:71], v[152:155]
    s_waitcnt lgkmcnt(7)
    ds_read_b64_tr_b16 a[186:187], v117 offset:18432
    v_cvt_pk_bf16_f32 v80, v208, v209
    v_cvt_pk_bf16_f32 v81, v210, v211
    v_mfma_f32_16x16x32_bf16 v[132:135], a[168:171], v[64:67], v[132:135]
    ds_read_b64_tr_b16 a[188:189], v116 offset:16384
    v_cvt_pk_bf16_f32 v82, v212, v213
    v_cvt_pk_bf16_f32 v83, v214, v215
    v_cvt_pk_bf16_f32 v84, v216, v217
    v_mfma_f32_16x16x32_bf16 v[140:143], a[168:171], v[68:71], v[140:143]
    ds_read_b64_tr_b16 a[190:191], v116 offset:18432
    v_cvt_pk_bf16_f32 v85, v218, v219
    v_cvt_pk_bf16_f32 v86, v220, v221
    v_cvt_pk_bf16_f32 v87, v222, v223
    v_mfma_f32_16x16x32_bf16 v[128:131], a[172:175], v[64:67], v[128:131]
    s_add_u32 s34, s34, 12288
    ds_read_b128 a[40:43], v9 offset:24576
    buffer_load_dwordx4 v0, s[56:59], s34 offen offset:2048 lds
    v_mfma_f32_16x16x32_bf16 v[136:139], a[172:175], v[68:71], v[136:139]
    s_waitcnt lgkmcnt(7)
    ds_read_b128 a[44:47], v9 offset:25600
    v_accvgpr_read_b32 v224, a112
    v_accvgpr_read_b32 v225, a113
    v_accvgpr_read_b32 v226, a114
    v_mfma_f32_16x16x32_bf16 v[160:163], a[172:175], a[32:35], v[160:163]
    ds_read_b64_tr_b16 a[160:161], v123 offset:16384
    v_accvgpr_read_b32 v227, a115
    v_accvgpr_read_b32 v228, a116
    v_accvgpr_read_b32 v229, a117
    v_mfma_f32_16x16x32_bf16 v[164:167], a[172:175], a[36:39], v[164:167]
    ds_read_b64_tr_b16 a[162:163], v123 offset:18432
    v_accvgpr_read_b32 v230, a118
    v_accvgpr_read_b32 v231, a119
    v_accvgpr_read_b32 v232, a120
    v_mfma_f32_16x16x32_bf16 v[148:151], a[176:179], v[72:75], v[148:151]
    ds_read_b64_tr_b16 a[164:165], v122 offset:16384
    v_accvgpr_read_b32 v233, a121
    v_accvgpr_read_b32 v234, a122
    v_accvgpr_read_b32 v235, a123
    v_mfma_f32_16x16x32_bf16 v[156:159], a[176:179], v[76:79], v[156:159]
    s_waitcnt lgkmcnt(7)
    ds_read_b64_tr_b16 a[166:167], v122 offset:18432
    v_accvgpr_read_b32 v236, a124
    v_accvgpr_read_b32 v237, a125
    v_mfma_f32_16x16x32_bf16 v[144:147], a[180:183], v[72:75], v[144:147]
    ds_read_b64_tr_b16 a[168:169], v121 offset:16384
    v_accvgpr_read_b32 v238, a126
    v_accvgpr_read_b32 v239, a127
    v_mul_f32 v224, v224, v22
    v_mfma_f32_16x16x32_bf16 v[152:155], a[180:183], v[76:79], v[152:155]
    ds_read_b64_tr_b16 a[170:171], v121 offset:18432
    buffer_load_dwordx4 v1, s[56:59], s34 offen offset:3072 lds
    v_mul_f32 v225, v225, v22
    v_mfma_f32_16x16x32_bf16 v[132:135], a[184:187], v[72:75], v[132:135]
    ds_read_b64_tr_b16 a[172:173], v120 offset:16384
    v_mul_f32 v226, v226, v22
    v_mul_f32 v227, v227, v22
    v_mfma_f32_16x16x32_bf16 v[140:143], a[184:187], v[76:79], v[140:143]
    s_waitcnt lgkmcnt(9)
    ds_read_b64_tr_b16 a[174:175], v120 offset:18432
    v_mul_f32 v228, v228, v22
    v_mul_f32 v229, v229, v22
    v_mul_f32 v230, v230, v22
    v_mfma_f32_16x16x32_bf16 v[128:131], a[188:191], v[72:75], v[128:131]
    ds_read_b128 a[48:51], v10 offset:24576
    v_mul_f32 v231, v231, v22
    v_mul_f32 v232, v232, v23
    v_mul_f32 v233, v233, v23
    v_mfma_f32_16x16x32_bf16 v[136:139], a[188:191], v[76:79], v[136:139]
    s_waitcnt lgkmcnt(10)
    ds_read_b128 a[52:55], v10 offset:25600
    v_mul_f32 v234, v234, v23
    v_mul_f32 v235, v235, v23
    v_mul_f32 v236, v236, v23
    v_mfma_f32_16x16x32_bf16 v[160:163], a[188:191], a[40:43], v[160:163]
    s_waitcnt lgkmcnt(10)
    ds_read_b64_tr_b16 a[176:177], v127 offset:16384
    v_mul_f32 v237, v237, v23
    v_mul_f32 v238, v238, v23
    v_mul_f32 v239, v239, v23
    v_mfma_f32_16x16x32_bf16 v[164:167], a[188:191], a[44:47], v[164:167]
    s_waitcnt lgkmcnt(7)
    ds_read_b64_tr_b16 a[178:179], v127 offset:18432
    v_cvt_pk_bf16_f32 v88, v224, v225
    v_cvt_pk_bf16_f32 v89, v226, v227
    v_mfma_f32_16x16x32_bf16 v[148:151], a[160:163], v[80:83], v[148:151]
    ds_read_b64_tr_b16 a[180:181], v126 offset:16384
    v_cvt_pk_bf16_f32 v90, v228, v229
    v_cvt_pk_bf16_f32 v91, v230, v231
    v_cvt_pk_bf16_f32 v92, v232, v233
    v_mfma_f32_16x16x32_bf16 v[156:159], a[160:163], v[84:87], v[156:159]
    ds_read_b64_tr_b16 a[182:183], v126 offset:18432
    v_cvt_pk_bf16_f32 v93, v234, v235
    v_cvt_pk_bf16_f32 v94, v236, v237
    v_cvt_pk_bf16_f32 v95, v238, v239
    v_mfma_f32_16x16x32_bf16 v[144:147], a[164:167], v[80:83], v[144:147]
B_stub1:
    s_cbranch_execz B_stub5
    ds_read_b64_tr_b16 a[184:185], v125 offset:16384
    v_mfma_f32_16x16x32_bf16 v[152:155], a[164:167], v[84:87], v[152:155]
    s_waitcnt lgkmcnt(7)
    ds_read_b64_tr_b16 a[186:187], v125 offset:18432
    v_mfma_f32_16x16x32_bf16 v[132:135], a[168:171], v[80:83], v[132:135]
    ds_read_b64_tr_b16 a[188:189], v124 offset:16384
    v_mfma_f32_16x16x32_bf16 v[140:143], a[168:171], v[84:87], v[140:143]
    ds_read_b64_tr_b16 a[190:191], v124 offset:18432
    v_mfma_f32_16x16x32_bf16 v[128:131], a[172:175], v[80:83], v[128:131]
    ds_read_b128 a[56:59], v11 offset:24576
    v_mfma_f32_16x16x32_bf16 v[136:139], a[172:175], v[84:87], v[136:139]
    s_waitcnt lgkmcnt(7)
    ds_read_b128 a[60:63], v11 offset:25600
    v_mfma_f32_16x16x32_bf16 v[160:163], a[172:175], a[48:51], v[160:163]
    s_waitcnt vmcnt(21)
    s_barrier
    ds_read_b64_tr_b16 a[160:161], v115 offset:32768
    v_mfma_f32_16x16x32_bf16 v[164:167], a[172:175], a[52:55], v[164:167]
    ds_read_b64_tr_b16 a[162:163], v115 offset:34816
    v_mfma_f32_16x16x32_bf16 v[148:151], a[176:179], v[88:91], v[148:151]
    s_add_u32 m0, s29, 32768
    ds_read_b64_tr_b16 a[164:165], v114 offset:32768
    v_mfma_f32_16x16x32_bf16 v[156:159], a[176:179], v[92:95], v[156:159]
    s_waitcnt lgkmcnt(7)
    ds_read_b64_tr_b16 a[166:167], v114 offset:34816
    v_mfma_f32_16x16x32_bf16 v[144:147], a[180:183], v[88:91], v[144:147]
    s_add_u32 s34, s32, 1835264
    ds_read_b64_tr_b16 a[168:169], v113 offset:32768
    buffer_load_dwordx4 v0, s[56:59], s34 offen offset:0 lds
    v_mfma_f32_16x16x32_bf16 v[152:155], a[180:183], v[92:95], v[152:155]
    ds_read_b64_tr_b16 a[170:171], v113 offset:34816
    v_mfma_f32_16x16x32_bf16 v[132:135], a[184:187], v[88:91], v[132:135]
    ds_read_b64_tr_b16 a[172:173], v112 offset:32768
    v_mfma_f32_16x16x32_bf16 v[140:143], a[184:187], v[92:95], v[140:143]
    s_waitcnt lgkmcnt(9)
    ds_read_b64_tr_b16 a[174:175], v112 offset:34816
    v_mfma_f32_16x16x32_bf16 v[128:131], a[188:191], v[88:91], v[128:131]
    ds_read_b128 a[64:67], v8 offset:0
    v_mfma_f32_16x16x32_bf16 v[136:139], a[188:191], v[92:95], v[136:139]
    s_waitcnt lgkmcnt(10)
    ds_read_b128 a[68:71], v8 offset:1024
    v_mfma_f32_16x16x32_bf16 v[160:163], a[188:191], a[56:59], v[160:163]
    s_waitcnt lgkmcnt(10)
    ds_read_b64_tr_b16 a[176:177], v119 offset:32768
    v_mfma_f32_16x16x32_bf16 v[164:167], a[188:191], a[60:63], v[164:167]
    s_waitcnt lgkmcnt(7)
    ds_read_b64_tr_b16 a[178:179], v119 offset:34816
    buffer_load_dwordx4 v1, s[56:59], s34 offen offset:1024 lds
    v_mfma_f32_16x16x32_bf16 v[148:151], a[160:163], a[192:195], v[148:151]
    ds_read_b64_tr_b16 a[180:181], v118 offset:32768
    v_mfma_f32_16x16x32_bf16 v[156:159], a[160:163], a[196:199], v[156:159]
    ds_read_b64_tr_b16 a[182:183], v118 offset:34816
    v_mfma_f32_16x16x32_bf16 v[144:147], a[164:167], a[192:195], v[144:147]
    ds_read_b64_tr_b16 a[184:185], v117 offset:32768
    v_mfma_f32_16x16x32_bf16 v[152:155], a[164:167], a[196:199], v[152:155]
    s_waitcnt lgkmcnt(7)
    ds_read_b64_tr_b16 a[186:187], v117 offset:34816
    v_mfma_f32_16x16x32_bf16 v[132:135], a[168:171], a[192:195], v[132:135]
    ds_read_b64_tr_b16 a[188:189], v116 offset:32768
    v_mfma_f32_16x16x32_bf16 v[140:143], a[168:171], a[196:199], v[140:143]
    ds_read_b64_tr_b16 a[190:191], v116 offset:34816
    v_mfma_f32_16x16x32_bf16 v[128:131], a[172:175], a[192:195], v[128:131]
    s_add_u32 s34, s34, 12288
    ds_read_b128 a[72:75], v9 offset:0
    buffer_load_dwordx4 v0, s[56:59], s34 offen offset:2048 lds
    v_mfma_f32_16x16x32_bf16 v[136:139], a[172:175], a[196:199], v[136:139]
    s_waitcnt lgkmcnt(7)
    ds_read_b128 a[76:79], v9 offset:1024
    v_mfma_f32_16x16x32_bf16 v[160:163], a[172:175], a[64:67], v[160:163]
    ds_read_b64_tr_b16 a[160:161], v123 offset:32768
    v_mfma_f32_16x16x32_bf16 v[164:167], a[172:175], a[68:71], v[164:167]
    ds_read_b64_tr_b16 a[162:163], v123 offset:34816
    v_mfma_f32_16x16x32_bf16 v[148:151], a[176:179], a[200:203], v[148:151]
    ds_read_b64_tr_b16 a[164:165], v122 offset:32768
    v_mfma_f32_16x16x32_bf16 v[156:159], a[176:179], a[204:207], v[156:159]
    s_waitcnt lgkmcnt(7)
    ds_read_b64_tr_b16 a[166:167], v122 offset:34816
    v_mfma_f32_16x16x32_bf16 v[144:147], a[180:183], a[200:203], v[144:147]
    ds_read_b64_tr_b16 a[168:169], v121 offset:32768
    v_mfma_f32_16x16x32_bf16 v[152:155], a[180:183], a[204:207], v[152:155]
    ds_read_b64_tr_b16 a[170:171], v121 offset:34816
    buffer_load_dwordx4 v1, s[56:59], s34 offen offset:3072 lds
    v_mfma_f32_16x16x32_bf16 v[132:135], a[184:187], a[200:203], v[132:135]
    ds_read_b64_tr_b16 a[172:173], v120 offset:32768
    v_mfma_f32_16x16x32_bf16 v[140:143], a[184:187], a[204:207], v[140:143]
    s_waitcnt lgkmcnt(9)
    ds_read_b64_tr_b16 a[174:175], v120 offset:34816
    v_mfma_f32_16x16x32_bf16 v[128:131], a[188:191], a[200:203], v[128:131]
    ds_read_b128 a[80:83], v10 offset:0
    v_mfma_f32_16x16x32_bf16 v[136:139], a[188:191], a[204:207], v[136:139]
    s_waitcnt lgkmcnt(10)
    ds_read_b128 a[84:87], v10 offset:1024
    v_mfma_f32_16x16x32_bf16 v[160:163], a[188:191], a[72:75], v[160:163]
    s_waitcnt lgkmcnt(10)
    ds_read_b64_tr_b16 a[176:177], v127 offset:32768
    v_mfma_f32_16x16x32_bf16 v[164:167], a[188:191], a[76:79], v[164:167]
    s_waitcnt lgkmcnt(7)
    ds_read_b64_tr_b16 a[178:179], v127 offset:34816
    v_mfma_f32_16x16x32_bf16 v[148:151], a[160:163], a[208:211], v[148:151]
    ds_read_b64_tr_b16 a[180:181], v126 offset:32768
    v_mfma_f32_16x16x32_bf16 v[156:159], a[160:163], a[212:215], v[156:159]
    ds_read_b64_tr_b16 a[182:183], v126 offset:34816
    v_mfma_f32_16x16x32_bf16 v[144:147], a[164:167], a[208:211], v[144:147]
    ds_read_b64_tr_b16 a[184:185], v125 offset:32768
    v_mfma_f32_16x16x32_bf16 v[152:155], a[164:167], a[212:215], v[152:155]
    s_waitcnt lgkmcnt(7)
    ds_read_b64_tr_b16 a[186:187], v125 offset:34816
    v_mfma_f32_16x16x32_bf16 v[132:135], a[168:171], a[208:211], v[132:135]
    ds_read_b64_tr_b16 a[188:189], v124 offset:32768
    v_mfma_f32_16x16x32_bf16 v[140:143], a[168:171], a[212:215], v[140:143]
    ds_read_b64_tr_b16 a[190:191], v124 offset:34816
    v_mfma_f32_16x16x32_bf16 v[128:131], a[172:175], a[208:211], v[128:131]
    ds_read_b128 a[88:91], v11 offset:0
    v_mfma_f32_16x16x32_bf16 v[136:139], a[172:175], a[212:215], v[136:139]
    s_waitcnt lgkmcnt(7)
    ds_read_b128 a[92:95], v11 offset:1024
    v_mfma_f32_16x16x32_bf16 v[160:163], a[172:175], a[80:83], v[160:163]
    s_waitcnt vmcnt(21)
    s_barrier
    ds_read_b64_tr_b16 a[160:161], v115 offset:49152
    v_mfma_f32_16x16x32_bf16 v[164:167], a[172:175], a[84:87], v[164:167]
    ds_read_b64_tr_b16 a[162:163], v115 offset:51200
    v_xor_b32 v115, 0x10000, v115
    v_mfma_f32_16x16x32_bf16 v[148:151], a[176:179], a[216:219], v[148:151]
    s_add_u32 m0, s29, 49152
    ds_read_b64_tr_b16 a[164:165], v114 offset:49152
    v_mfma_f32_16x16x32_bf16 v[156:159], a[176:179], a[220:223], v[156:159]
    s_waitcnt lgkmcnt(7)
    ds_read_b64_tr_b16 a[166:167], v114 offset:51200
    v_xor_b32 v114, 0x10000, v114
    v_mfma_f32_16x16x32_bf16 v[144:147], a[180:183], a[216:219], v[144:147]
    s_add_u32 s34, s32, 1949952
    ds_read_b64_tr_b16 a[168:169], v113 offset:49152
    buffer_load_dwordx4 v0, s[56:59], s34 offen offset:0 lds
    v_mfma_f32_16x16x32_bf16 v[152:155], a[180:183], a[220:223], v[152:155]
    ds_read_b64_tr_b16 a[170:171], v113 offset:51200
    v_xor_b32 v113, 0x10000, v113
    v_mfma_f32_16x16x32_bf16 v[132:135], a[184:187], a[216:219], v[132:135]
    ds_read_b64_tr_b16 a[172:173], v112 offset:49152
    v_mfma_f32_16x16x32_bf16 v[140:143], a[184:187], a[220:223], v[140:143]
    s_waitcnt lgkmcnt(9)
    ds_read_b64_tr_b16 a[174:175], v112 offset:51200
    v_xor_b32 v112, 0x10000, v112
    v_mfma_f32_16x16x32_bf16 v[128:131], a[188:191], a[216:219], v[128:131]
    ds_read_b128 a[96:99], v8 offset:8192
    v_mfma_f32_16x16x32_bf16 v[136:139], a[188:191], a[220:223], v[136:139]
    s_waitcnt lgkmcnt(10)
    ds_read_b128 a[100:103], v8 offset:9216
    v_mfma_f32_16x16x32_bf16 v[160:163], a[188:191], a[88:91], v[160:163]
    s_waitcnt lgkmcnt(10)
    ds_read_b64_tr_b16 a[176:177], v119 offset:49152
    v_mfma_f32_16x16x32_bf16 v[164:167], a[188:191], a[92:95], v[164:167]
    s_waitcnt lgkmcnt(7)
    ds_read_b64_tr_b16 a[178:179], v119 offset:51200
    buffer_load_dwordx4 v1, s[56:59], s34 offen offset:1024 lds
    v_xor_b32 v119, 0x10000, v119
    v_mfma_f32_16x16x32_bf16 v[148:151], a[160:163], a[128:131], v[148:151]
    ds_read_b64_tr_b16 a[180:181], v118 offset:49152
    v_mfma_f32_16x16x32_bf16 v[156:159], a[160:163], a[132:135], v[156:159]
    ds_read_b64_tr_b16 a[182:183], v118 offset:51200
    v_xor_b32 v118, 0x10000, v118
    v_mfma_f32_16x16x32_bf16 v[144:147], a[164:167], a[128:131], v[144:147]
    ds_read_b64_tr_b16 a[184:185], v117 offset:49152
    v_mfma_f32_16x16x32_bf16 v[152:155], a[164:167], a[132:135], v[152:155]
    s_waitcnt lgkmcnt(7)
    ds_read_b64_tr_b16 a[186:187], v117 offset:51200
    v_xor_b32 v117, 0x10000, v117
    v_mfma_f32_16x16x32_bf16 v[132:135], a[168:171], a[128:131], v[132:135]
    ds_read_b64_tr_b16 a[188:189], v116 offset:49152
    v_mfma_f32_16x16x32_bf16 v[140:143], a[168:171], a[132:135], v[140:143]
    ds_read_b64_tr_b16 a[190:191], v116 offset:51200
    v_xor_b32 v116, 0x10000, v116
    v_mfma_f32_16x16x32_bf16 v[128:131], a[172:175], a[128:131], v[128:131]
    s_add_u32 s34, s34, 12288
    ds_read_b128 a[104:107], v9 offset:8192
    buffer_load_dwordx4 v0, s[56:59], s34 offen offset:2048 lds
    v_mfma_f32_16x16x32_bf16 v[136:139], a[172:175], a[132:135], v[136:139]
    s_waitcnt lgkmcnt(7)
    ds_read_b128 a[108:111], v9 offset:9216
    v_mfma_f32_16x16x32_bf16 v[160:163], a[172:175], a[96:99], v[160:163]
    ds_read_b64_tr_b16 a[160:161], v123 offset:49152
    v_mfma_f32_16x16x32_bf16 v[164:167], a[172:175], a[100:103], v[164:167]
    ds_read_b64_tr_b16 a[162:163], v123 offset:51200
    v_xor_b32 v123, 0x10000, v123
    v_mfma_f32_16x16x32_bf16 v[148:151], a[176:179], a[136:139], v[148:151]
    ds_read_b64_tr_b16 a[164:165], v122 offset:49152
    v_mfma_f32_16x16x32_bf16 v[156:159], a[176:179], a[140:143], v[156:159]
    s_waitcnt lgkmcnt(7)
    ds_read_b64_tr_b16 a[166:167], v122 offset:51200
    v_xor_b32 v122, 0x10000, v122
    v_mfma_f32_16x16x32_bf16 v[144:147], a[180:183], a[136:139], v[144:147]
    ds_read_b64_tr_b16 a[168:169], v121 offset:49152
    v_mfma_f32_16x16x32_bf16 v[152:155], a[180:183], a[140:143], v[152:155]
    ds_read_b64_tr_b16 a[170:171], v121 offset:51200
    buffer_load_dwordx4 v1, s[56:59], s34 offen offset:3072 lds
    v_xor_b32 v121, 0x10000, v121
    v_mfma_f32_16x16x32_bf16 v[132:135], a[184:187], a[136:139], v[132:135]
    ds_read_b64_tr_b16 a[172:173], v120 offset:49152
    v_mfma_f32_16x16x32_bf16 v[140:143], a[184:187], a[140:143], v[140:143]
    s_waitcnt lgkmcnt(9)
    ds_read_b64_tr_b16 a[174:175], v120 offset:51200
    v_xor_b32 v120, 0x10000, v120
    v_mfma_f32_16x16x32_bf16 v[128:131], a[188:191], a[136:139], v[128:131]
    ds_read_b128 a[112:115], v10 offset:8192
    v_mfma_f32_16x16x32_bf16 v[136:139], a[188:191], a[140:143], v[136:139]
    s_waitcnt lgkmcnt(10)
    ds_read_b128 a[116:119], v10 offset:9216
    v_mfma_f32_16x16x32_bf16 v[160:163], a[188:191], a[104:107], v[160:163]
    s_waitcnt lgkmcnt(10)
    ds_read_b64_tr_b16 a[176:177], v127 offset:49152
    v_mfma_f32_16x16x32_bf16 v[164:167], a[188:191], a[108:111], v[164:167]
    s_waitcnt lgkmcnt(7)
    ds_read_b64_tr_b16 a[178:179], v127 offset:51200
    v_xor_b32 v127, 0x10000, v127
    v_mfma_f32_16x16x32_bf16 v[148:151], a[160:163], a[144:147], v[148:151]
    ds_read_b64_tr_b16 a[180:181], v126 offset:49152
    v_mfma_f32_16x16x32_bf16 v[156:159], a[160:163], a[148:151], v[156:159]
    ds_read_b64_tr_b16 a[182:183], v126 offset:51200
    v_xor_b32 v126, 0x10000, v126
    v_mfma_f32_16x16x32_bf16 v[144:147], a[164:167], a[144:147], v[144:147]
    ds_read_b64_tr_b16 a[184:185], v125 offset:49152
    v_mfma_f32_16x16x32_bf16 v[152:155], a[164:167], a[148:151], v[152:155]
    s_waitcnt lgkmcnt(7)
    ds_read_b64_tr_b16 a[186:187], v125 offset:51200
    v_xor_b32 v125, 0x10000, v125
    v_mfma_f32_16x16x32_bf16 v[132:135], a[168:171], a[144:147], v[132:135]
    ds_read_b64_tr_b16 a[188:189], v124 offset:49152
    v_mfma_f32_16x16x32_bf16 v[140:143], a[168:171], a[148:151], v[140:143]
    ds_read_b64_tr_b16 a[190:191], v124 offset:51200
    v_xor_b32 v124, 0x10000, v124
    v_mfma_f32_16x16x32_bf16 v[128:131], a[172:175], a[144:147], v[128:131]
    ds_read_b128 a[120:123], v11 offset:8192
    v_mfma_f32_16x16x32_bf16 v[136:139], a[172:175], a[148:151], v[136:139]
    s_waitcnt lgkmcnt(7)
    ds_read_b128 a[124:127], v11 offset:9216
    v_mfma_f32_16x16x32_bf16 v[160:163], a[172:175], a[112:115], v[160:163]
    s_waitcnt vmcnt(21)
    s_barrier
    ds_read_b64_tr_b16 a[160:161], v115 offset:0
    v_mfma_f32_16x16x32_bf16 v[164:167], a[172:175], a[116:119], v[164:167]
    ds_read_b64_tr_b16 a[162:163], v115 offset:2048
    v_mfma_f32_16x16x32_bf16 v[148:151], a[176:179], a[152:155], v[148:151]
    s_add_u32 m0, s29, 65536
    ds_read_b64_tr_b16 a[164:165], v114 offset:0
    v_mfma_f32_16x16x32_bf16 v[156:159], a[176:179], a[156:159], v[156:159]
    s_waitcnt lgkmcnt(7)
    ds_read_b64_tr_b16 a[166:167], v114 offset:2048
    v_mfma_f32_16x16x32_bf16 v[144:147], a[180:183], a[152:155], v[144:147]
    s_add_u32 s34, s32, 256
    ds_read_b64_tr_b16 a[168:169], v113 offset:0
    buffer_load_dwordx4 v0, s[56:59], s34 offen offset:0 lds
    v_mfma_f32_16x16x32_bf16 v[152:155], a[180:183], a[156:159], v[152:155]
    ds_read_b64_tr_b16 a[170:171], v113 offset:2048
    v_mfma_f32_16x16x32_bf16 v[132:135], a[184:187], a[152:155], v[132:135]
    ds_read_b64_tr_b16 a[172:173], v112 offset:0
    v_mfma_f32_16x16x32_bf16 v[140:143], a[184:187], a[156:159], v[140:143]
    s_waitcnt lgkmcnt(9)
    ds_read_b64_tr_b16 a[174:175], v112 offset:2048
    v_mfma_f32_16x16x32_bf16 v[128:131], a[188:191], a[152:155], v[128:131]
    v_mfma_f32_16x16x32_bf16 v[136:139], a[188:191], a[156:159], v[136:139]
    s_waitcnt lgkmcnt(9)
    v_mfma_f32_16x16x32_bf16 v[160:163], a[188:191], a[120:123], v[160:163]
    s_waitcnt lgkmcnt(8)
    ds_read_b64_tr_b16 a[176:177], v119 offset:0
    v_mfma_f32_16x16x32_bf16 v[164:167], a[188:191], a[124:127], v[164:167]
    s_waitcnt lgkmcnt(5)
    ds_read_b64_tr_b16 a[178:179], v119 offset:2048
    buffer_load_dwordx4 v1, s[56:59], s34 offen offset:1024 lds
    v_mfma_f32_16x16x32_bf16 v[188:191], a[160:163], v[32:35], 0
    ds_read_b64_tr_b16 a[180:181], v118 offset:0
    v_mfma_f32_16x16x32_bf16 v[196:199], a[160:163], v[36:39], 0
    ds_read_b64_tr_b16 a[182:183], v118 offset:2048
    v_mfma_f32_16x16x32_bf16 v[184:187], a[164:167], v[32:35], 0
    ds_read_b64_tr_b16 a[184:185], v117 offset:0
    v_mfma_f32_16x16x32_bf16 v[192:195], a[164:167], v[36:39], 0
    s_waitcnt lgkmcnt(5)
    ds_read_b64_tr_b16 a[186:187], v117 offset:2048
    v_mfma_f32_16x16x32_bf16 v[172:175], a[168:171], v[32:35], 0
    ds_read_b64_tr_b16 a[188:189], v116 offset:0
    v_mfma_f32_16x16x32_bf16 v[180:183], a[168:171], v[36:39], 0
    ds_read_b64_tr_b16 a[190:191], v116 offset:2048
    v_mfma_f32_16x16x32_bf16 v[168:171], a[172:175], v[32:35], 0
    s_add_u32 s34, s34, 12288
    buffer_load_dwordx4 v0, s[56:59], s34 offen offset:2048 lds
    v_mfma_f32_16x16x32_bf16 v[176:179], a[172:175], v[36:39], 0
    s_waitcnt lgkmcnt(6)
    v_cvt_pk_bf16_f32 v128, v128, v129
    v_cvt_pk_bf16_f32 v129, v130, v131
    v_mfma_f32_16x16x32_bf16 v[200:203], a[172:175], a[0:3], 0
    ds_read_b64_tr_b16 a[160:161], v123 offset:0
    v_cvt_pk_bf16_f32 v130, v132, v133
    v_mfma_f32_16x16x32_bf16 v[204:207], a[172:175], a[4:7], 0
    ds_read_b64_tr_b16 a[162:163], v123 offset:2048
    v_cvt_pk_bf16_f32 v131, v134, v135
    v_mfma_f32_16x16x32_bf16 v[188:191], a[176:179], v[40:43], v[188:191]
    ds_read_b64_tr_b16 a[164:165], v122 offset:0
    v_mfma_f32_16x16x32_bf16 v[196:199], a[176:179], v[44:47], v[196:199]
    s_waitcnt lgkmcnt(5)
    ds_read_b64_tr_b16 a[166:167], v122 offset:2048
    v_mfma_f32_16x16x32_bf16 v[184:187], a[180:183], v[40:43], v[184:187]
    ds_read_b64_tr_b16 a[168:169], v121 offset:0
    s_add_u32 s35, s30, 0
    buffer_store_dwordx4 v[128:131], v16, s[8:11], s35 offen sc1
    v_mfma_f32_16x16x32_bf16 v[192:195], a[180:183], v[44:47], v[192:195]
    ds_read_b64_tr_b16 a[170:171], v121 offset:2048
    buffer_load_dwordx4 v1, s[56:59], s34 offen offset:3072 lds
    v_mfma_f32_16x16x32_bf16 v[172:175], a[184:187], v[40:43], v[172:175]
    ds_read_b64_tr_b16 a[172:173], v120 offset:0
    v_mfma_f32_16x16x32_bf16 v[180:183], a[184:187], v[44:47], v[180:183]
    s_waitcnt lgkmcnt(7)
    ds_read_b64_tr_b16 a[174:175], v120 offset:2048
    v_cvt_pk_bf16_f32 v136, v136, v137
    v_mfma_f32_16x16x32_bf16 v[168:171], a[188:191], v[40:43], v[168:171]
    v_cvt_pk_bf16_f32 v137, v138, v139
    v_cvt_pk_bf16_f32 v138, v140, v141
    v_mfma_f32_16x16x32_bf16 v[176:179], a[188:191], v[44:47], v[176:179]
    v_cvt_pk_bf16_f32 v139, v142, v143
    v_mfma_f32_16x16x32_bf16 v[200:203], a[188:191], a[8:11], v[200:203]
    ds_read_b64_tr_b16 a[176:177], v127 offset:0
    v_mfma_f32_16x16x32_bf16 v[204:207], a[188:191], a[12:15], v[204:207]
    s_waitcnt lgkmcnt(5)
    ds_read_b64_tr_b16 a[178:179], v127 offset:2048
    s_add_u32 s35, s30, 16384
    buffer_store_dwordx4 v[136:139], v16, s[8:11], s35 offen sc1
    v_mfma_f32_16x16x32_bf16 v[188:191], a[160:163], v[48:51], v[188:191]
    ds_read_b64_tr_b16 a[180:181], v126 offset:0
    v_mfma_f32_16x16x32_bf16 v[196:199], a[160:163], v[52:55], v[196:199]
    ds_read_b64_tr_b16 a[182:183], v126 offset:2048
    v_mfma_f32_16x16x32_bf16 v[184:187], a[164:167], v[48:51], v[184:187]
    ds_read_b64_tr_b16 a[184:185], v125 offset:0
    v_cvt_pk_bf16_f32 v144, v144, v145
    v_mfma_f32_16x16x32_bf16 v[192:195], a[164:167], v[52:55], v[192:195]
    s_waitcnt lgkmcnt(5)
    ds_read_b64_tr_b16 a[186:187], v125 offset:2048
    v_cvt_pk_bf16_f32 v145, v146, v147
    v_mfma_f32_16x16x32_bf16 v[172:175], a[168:171], v[48:51], v[172:175]
    ds_read_b64_tr_b16 a[188:189], v124 offset:0
    v_cvt_pk_bf16_f32 v146, v148, v149
    v_mfma_f32_16x16x32_bf16 v[180:183], a[168:171], v[52:55], v[180:183]
    ds_read_b64_tr_b16 a[190:191], v124 offset:2048
    v_cvt_pk_bf16_f32 v147, v150, v151
    v_mfma_f32_16x16x32_bf16 v[168:171], a[172:175], v[48:51], v[168:171]
    s_add_u32 s35, s30, 8192
    buffer_store_dwordx4 v[144:147], v16, s[8:11], s35 offen sc1
    v_mfma_f32_16x16x32_bf16 v[176:179], a[172:175], v[52:55], v[176:179]
    s_waitcnt lgkmcnt(6)
    v_mfma_f32_16x16x32_bf16 v[200:203], a[172:175], a[16:19], v[200:203]
    s_waitcnt vmcnt(24)
    s_barrier
    ds_read_b64_tr_b16 a[160:161], v115 offset:16384
    v_mfma_f32_16x16x32_bf16 v[204:207], a[172:175], a[20:23], v[204:207]
    ds_read_b64_tr_b16 a[162:163], v115 offset:18432
    v_cvt_pk_bf16_f32 v152, v152, v153
    v_mfma_f32_16x16x32_bf16 v[188:191], a[176:179], v[56:59], v[188:191]
    s_add_u32 m0, s29, 81920
    ds_read_b64_tr_b16 a[164:165], v114 offset:16384
    v_cvt_pk_bf16_f32 v153, v154, v155
    v_mfma_f32_16x16x32_bf16 v[196:199], a[176:179], v[60:63], v[196:199]
    s_waitcnt lgkmcnt(5)
    ds_read_b64_tr_b16 a[166:167], v114 offset:18432
    v_cvt_pk_bf16_f32 v154, v156, v157
    v_mfma_f32_16x16x32_bf16 v[184:187], a[180:183], v[56:59], v[184:187]
    s_add_u32 s34, s32, 114944
    ds_read_b64_tr_b16 a[168:169], v113 offset:16384
    buffer_load_dwordx4 v0, s[56:59], s34 offen offset:0 lds
    v_mfma_f32_16x16x32_bf16 v[192:195], a[180:183], v[60:63], v[192:195]
    ds_read_b64_tr_b16 a[170:171], v113 offset:18432
    v_cvt_pk_bf16_f32 v155, v158, v159
    v_mfma_f32_16x16x32_bf16 v[172:175], a[184:187], v[56:59], v[172:175]
    ds_read_b64_tr_b16 a[172:173], v112 offset:16384
    v_mfma_f32_16x16x32_bf16 v[180:183], a[184:187], v[60:63], v[180:183]
    s_waitcnt lgkmcnt(7)
    ds_read_b64_tr_b16 a[174:175], v112 offset:18432
    v_mfma_f32_16x16x32_bf16 v[168:171], a[188:191], v[56:59], v[168:171]
    s_add_u32 s35, s30, 24576
    buffer_store_dwordx4 v[152:155], v16, s[8:11], s35 offen sc1
    v_mfma_f32_16x16x32_bf16 v[176:179], a[188:191], v[60:63], v[176:179]
    v_cvt_pk_bf16_f32 v160, v160, v161
    v_mfma_f32_16x16x32_bf16 v[200:203], a[188:191], a[24:27], v[200:203]
    ds_read_b64_tr_b16 a[176:177], v119 offset:16384
    v_cvt_pk_bf16_f32 v161, v162, v163
    v_mfma_f32_16x16x32_bf16 v[204:207], a[188:191], a[28:31], v[204:207]
    s_waitcnt lgkmcnt(5)
    ds_read_b64_tr_b16 a[178:179], v119 offset:18432
    buffer_load_dwordx4 v1, s[56:59], s34 offen offset:1024 lds
    v_mfma_f32_16x16x32_bf16 v[188:191], a[160:163], v[64:67], v[188:191]
    ds_read_b64_tr_b16 a[180:181], v118 offset:16384
    v_cvt_pk_bf16_f32 v162, v164, v165
    v_cvt_pk_bf16_f32 v163, v166, v167
    v_mfma_f32_16x16x32_bf16 v[196:199], a[160:163], v[68:71], v[196:199]
    ds_read_b64_tr_b16 a[182:183], v118 offset:18432
    v_mfma_f32_16x16x32_bf16 v[184:187], a[164:167], v[64:67], v[184:187]
    ds_read_b64_tr_b16 a[184:185], v117 offset:16384
    v_mfma_f32_16x16x32_bf16 v[192:195], a[164:167], v[68:71], v[192:195]
    s_waitcnt lgkmcnt(5)
    ds_read_b64_tr_b16 a[186:187], v117 offset:18432
    s_add_u32 s35, s31, 0
    buffer_store_dwordx4 v[160:163], v16, s[8:11], s35 offen sc1
    v_mfma_f32_16x16x32_bf16 v[172:175], a[168:171], v[64:67], v[172:175]
    ds_read_b64_tr_b16 a[188:189], v116 offset:16384
    v_mfma_f32_16x16x32_bf16 v[180:183], a[168:171], v[68:71], v[180:183]
    ds_read_b64_tr_b16 a[190:191], v116 offset:18432
    v_mfma_f32_16x16x32_bf16 v[168:171], a[172:175], v[64:67], v[168:171]
    s_add_u32 s34, s34, 12288
    buffer_load_dwordx4 v0, s[56:59], s34 offen offset:2048 lds
    v_mfma_f32_16x16x32_bf16 v[176:179], a[172:175], v[68:71], v[176:179]
    s_waitcnt lgkmcnt(6)
    v_mfma_f32_16x16x32_bf16 v[200:203], a[172:175], a[32:35], v[200:203]
    ds_read_b64_tr_b16 a[160:161], v123 offset:16384
    v_mfma_f32_16x16x32_bf16 v[204:207], a[172:175], a[36:39], v[204:207]
    ds_read_b64_tr_b16 a[162:163], v123 offset:18432
    v_mfma_f32_16x16x32_bf16 v[188:191], a[176:179], v[72:75], v[188:191]
    ds_read_b64_tr_b16 a[164:165], v122 offset:16384
    v_mfma_f32_16x16x32_bf16 v[196:199], a[176:179], v[76:79], v[196:199]
    s_waitcnt lgkmcnt(5)
    ds_read_b64_tr_b16 a[166:167], v122 offset:18432
    v_mfma_f32_16x16x32_bf16 v[184:187], a[180:183], v[72:75], v[184:187]
    ds_read_b64_tr_b16 a[168:169], v121 offset:16384
    v_mfma_f32_16x16x32_bf16 v[192:195], a[180:183], v[76:79], v[192:195]
    ds_read_b64_tr_b16 a[170:171], v121 offset:18432
    buffer_load_dwordx4 v1, s[56:59], s34 offen offset:3072 lds
    v_mfma_f32_16x16x32_bf16 v[172:175], a[184:187], v[72:75], v[172:175]
    ds_read_b64_tr_b16 a[172:173], v120 offset:16384
    v_mfma_f32_16x16x32_bf16 v[180:183], a[184:187], v[76:79], v[180:183]
    s_waitcnt lgkmcnt(7)
    ds_read_b64_tr_b16 a[174:175], v120 offset:18432
    v_mfma_f32_16x16x32_bf16 v[168:171], a[188:191], v[72:75], v[168:171]
    v_mfma_f32_16x16x32_bf16 v[176:179], a[188:191], v[76:79], v[176:179]
    v_mfma_f32_16x16x32_bf16 v[200:203], a[188:191], a[40:43], v[200:203]
    ds_read_b64_tr_b16 a[176:177], v127 offset:16384
    v_mfma_f32_16x16x32_bf16 v[204:207], a[188:191], a[44:47], v[204:207]
    s_waitcnt lgkmcnt(5)
    ds_read_b64_tr_b16 a[178:179], v127 offset:18432
    v_mfma_f32_16x16x32_bf16 v[188:191], a[160:163], v[80:83], v[188:191]
    ds_read_b64_tr_b16 a[180:181], v126 offset:16384
    v_mfma_f32_16x16x32_bf16 v[196:199], a[160:163], v[84:87], v[196:199]
    ds_read_b64_tr_b16 a[182:183], v126 offset:18432
    v_mfma_f32_16x16x32_bf16 v[184:187], a[164:167], v[80:83], v[184:187]
    ds_read_b64_tr_b16 a[184:185], v125 offset:16384
    v_mfma_f32_16x16x32_bf16 v[192:195], a[164:167], v[84:87], v[192:195]
    s_waitcnt lgkmcnt(5)
    ds_read_b64_tr_b16 a[186:187], v125 offset:18432
    v_mfma_f32_16x16x32_bf16 v[172:175], a[168:171], v[80:83], v[172:175]
    ds_read_b64_tr_b16 a[188:189], v124 offset:16384
    v_mfma_f32_16x16x32_bf16 v[180:183], a[168:171], v[84:87], v[180:183]
    ds_read_b64_tr_b16 a[190:191], v124 offset:18432
    v_mfma_f32_16x16x32_bf16 v[168:171], a[172:175], v[80:83], v[168:171]
    v_mfma_f32_16x16x32_bf16 v[176:179], a[172:175], v[84:87], v[176:179]
    s_waitcnt lgkmcnt(6)
    v_mfma_f32_16x16x32_bf16 v[200:203], a[172:175], a[48:51], v[200:203]
    s_waitcnt vmcnt(25)
    s_barrier
    ds_read_b64_tr_b16 a[160:161], v115 offset:32768
    v_mfma_f32_16x16x32_bf16 v[204:207], a[172:175], a[52:55], v[204:207]
    ds_read_b64_tr_b16 a[162:163], v115 offset:34816
    v_mfma_f32_16x16x32_bf16 v[188:191], a[176:179], v[88:91], v[188:191]
    s_add_u32 m0, s29, 98304
    ds_read_b64_tr_b16 a[164:165], v114 offset:32768
    v_mfma_f32_16x16x32_bf16 v[196:199], a[176:179], v[92:95], v[196:199]
    s_waitcnt lgkmcnt(5)
    ds_read_b64_tr_b16 a[166:167], v114 offset:34816
    v_mfma_f32_16x16x32_bf16 v[184:187], a[180:183], v[88:91], v[184:187]
    s_add_u32 s34, s32, 1835392
    ds_read_b64_tr_b16 a[168:169], v113 offset:32768
    buffer_load_dwordx4 v0, s[56:59], s34 offen offset:0 lds
    v_mfma_f32_16x16x32_bf16 v[192:195], a[180:183], v[92:95], v[192:195]
    ds_read_b64_tr_b16 a[170:171], v113 offset:34816
    v_mfma_f32_16x16x32_bf16 v[172:175], a[184:187], v[88:91], v[172:175]
    ds_read_b64_tr_b16 a[172:173], v112 offset:32768
    v_mfma_f32_16x16x32_bf16 v[180:183], a[184:187], v[92:95], v[180:183]
    s_waitcnt lgkmcnt(7)
    ds_read_b64_tr_b16 a[174:175], v112 offset:34816
    v_mfma_f32_16x16x32_bf16 v[168:171], a[188:191], v[88:91], v[168:171]
    v_mfma_f32_16x16x32_bf16 v[176:179], a[188:191], v[92:95], v[176:179]
    v_mfma_f32_16x16x32_bf16 v[200:203], a[188:191], a[56:59], v[200:203]
    ds_read_b64_tr_b16 a[176:177], v119 offset:32768
    v_mfma_f32_16x16x32_bf16 v[204:207], a[188:191], a[60:63], v[204:207]
    s_waitcnt lgkmcnt(5)
    ds_read_b64_tr_b16 a[178:179], v119 offset:34816
    buffer_load_dwordx4 v1, s[56:59], s34 offen offset:1024 lds
    v_mfma_f32_16x16x32_bf16 v[188:191], a[160:163], a[192:195], v[188:191]
    ds_read_b64_tr_b16 a[180:181], v118 offset:32768
    v_mfma_f32_16x16x32_bf16 v[196:199], a[160:163], a[196:199], v[196:199]
    ds_read_b64_tr_b16 a[182:183], v118 offset:34816
    v_mfma_f32_16x16x32_bf16 v[184:187], a[164:167], a[192:195], v[184:187]
    ds_read_b64_tr_b16 a[184:185], v117 offset:32768
    v_mfma_f32_16x16x32_bf16 v[192:195], a[164:167], a[196:199], v[192:195]
    s_waitcnt lgkmcnt(5)
    ds_read_b64_tr_b16 a[186:187], v117 offset:34816
    v_mfma_f32_16x16x32_bf16 v[172:175], a[168:171], a[192:195], v[172:175]
    ds_read_b64_tr_b16 a[188:189], v116 offset:32768
    v_mfma_f32_16x16x32_bf16 v[180:183], a[168:171], a[196:199], v[180:183]
    ds_read_b64_tr_b16 a[190:191], v116 offset:34816
    v_mfma_f32_16x16x32_bf16 v[168:171], a[172:175], a[192:195], v[168:171]
    s_add_u32 s34, s34, 12288
    buffer_load_dwordx4 v0, s[56:59], s34 offen offset:2048 lds
    v_mfma_f32_16x16x32_bf16 v[176:179], a[172:175], a[196:199], v[176:179]
    s_waitcnt lgkmcnt(6)
    v_mfma_f32_16x16x32_bf16 v[200:203], a[172:175], a[64:67], v[200:203]
    ds_read_b64_tr_b16 a[160:161], v123 offset:32768
    v_mfma_f32_16x16x32_bf16 v[204:207], a[172:175], a[68:71], v[204:207]
    ds_read_b64_tr_b16 a[162:163], v123 offset:34816
    v_mfma_f32_16x16x32_bf16 v[188:191], a[176:179], a[200:203], v[188:191]
    ds_read_b64_tr_b16 a[164:165], v122 offset:32768
    v_mfma_f32_16x16x32_bf16 v[196:199], a[176:179], a[204:207], v[196:199]
    s_waitcnt lgkmcnt(5)
    ds_read_b64_tr_b16 a[166:167], v122 offset:34816
    v_mfma_f32_16x16x32_bf16 v[184:187], a[180:183], a[200:203], v[184:187]
    ds_read_b64_tr_b16 a[168:169], v121 offset:32768
    v_mfma_f32_16x16x32_bf16 v[192:195], a[180:183], a[204:207], v[192:195]
    ds_read_b64_tr_b16 a[170:171], v121 offset:34816
    buffer_load_dwordx4 v1, s[56:59], s34 offen offset:3072 lds
    v_mfma_f32_16x16x32_bf16 v[172:175], a[184:187], a[200:203], v[172:175]
    ds_read_b64_tr_b16 a[172:173], v120 offset:32768
    v_mfma_f32_16x16x32_bf16 v[180:183], a[184:187], a[204:207], v[180:183]
    s_waitcnt lgkmcnt(7)
    ds_read_b64_tr_b16 a[174:175], v120 offset:34816
    v_mfma_f32_16x16x32_bf16 v[168:171], a[188:191], a[200:203], v[168:171]
    v_mfma_f32_16x16x32_bf16 v[176:179], a[188:191], a[204:207], v[176:179]
    v_mfma_f32_16x16x32_bf16 v[200:203], a[188:191], a[72:75], v[200:203]
    ds_read_b64_tr_b16 a[176:177], v127 offset:32768
    v_mfma_f32_16x16x32_bf16 v[204:207], a[188:191], a[76:79], v[204:207]
    s_waitcnt lgkmcnt(5)
    ds_read_b64_tr_b16 a[178:179], v127 offset:34816
    v_mfma_f32_16x16x32_bf16 v[188:191], a[160:163], a[208:211], v[188:191]
    ds_read_b64_tr_b16 a[180:181], v126 offset:32768
    v_mfma_f32_16x16x32_bf16 v[196:199], a[160:163], a[212:215], v[196:199]
    ds_read_b64_tr_b16 a[182:183], v126 offset:34816
    v_mfma_f32_16x16x32_bf16 v[184:187], a[164:167], a[208:211], v[184:187]
    ds_read_b64_tr_b16 a[184:185], v125 offset:32768
    v_mfma_f32_16x16x32_bf16 v[192:195], a[164:167], a[212:215], v[192:195]
    s_waitcnt lgkmcnt(5)
    ds_read_b64_tr_b16 a[186:187], v125 offset:34816
    v_mfma_f32_16x16x32_bf16 v[172:175], a[168:171], a[208:211], v[172:175]
    ds_read_b64_tr_b16 a[188:189], v124 offset:32768
    v_mfma_f32_16x16x32_bf16 v[180:183], a[168:171], a[212:215], v[180:183]
    ds_read_b64_tr_b16 a[190:191], v124 offset:34816
    v_mfma_f32_16x16x32_bf16 v[168:171], a[172:175], a[208:211], v[168:171]
    v_mfma_f32_16x16x32_bf16 v[176:179], a[172:175], a[212:215], v[176:179]
    s_waitcnt lgkmcnt(6)
    v_mfma_f32_16x16x32_bf16 v[200:203], a[172:175], a[80:83], v[200:203]
    s_waitcnt vmcnt(25)
    s_barrier
    ds_read_b64_tr_b16 a[160:161], v115 offset:49152
    v_mfma_f32_16x16x32_bf16 v[204:207], a[172:175], a[84:87], v[204:207]
    ds_read_b64_tr_b16 a[162:163], v115 offset:51200
    v_xor_b32 v115, 0x10000, v115
    v_mfma_f32_16x16x32_bf16 v[188:191], a[176:179], a[216:219], v[188:191]
    s_add_u32 m0, s29, 114688
    s_nop 0
B_stub2:
    s_cbranch_execz B_stub6
    ds_read_b64_tr_b16 a[164:165], v114 offset:49152
    v_mfma_f32_16x16x32_bf16 v[196:199], a[176:179], a[220:223], v[196:199]
    s_waitcnt lgkmcnt(5)
    ds_read_b64_tr_b16 a[166:167], v114 offset:51200
    v_xor_b32 v114, 0x10000, v114
    v_mfma_f32_16x16x32_bf16 v[184:187], a[180:183], a[216:219], v[184:187]
    s_add_u32 s34, s32, 1950080
    ds_read_b64_tr_b16 a[168:169], v113 offset:49152
    buffer_load_dwordx4 v0, s[56:59], s34 offen offset:0 lds
    v_mfma_f32_16x16x32_bf16 v[192:195], a[180:183], a[220:223], v[192:195]
    ds_read_b64_tr_b16 a[170:171], v113 offset:51200
    v_xor_b32 v113, 0x10000, v113
    v_mfma_f32_16x16x32_bf16 v[172:175], a[184:187], a[216:219], v[172:175]
    ds_read_b64_tr_b16 a[172:173], v112 offset:49152
    v_mfma_f32_16x16x32_bf16 v[180:183], a[184:187], a[220:223], v[180:183]
    s_waitcnt lgkmcnt(7)
    ds_read_b64_tr_b16 a[174:175], v112 offset:51200
    v_xor_b32 v112, 0x10000, v112
    v_mfma_f32_16x16x32_bf16 v[168:171], a[188:191], a[216:219], v[168:171]
    v_mfma_f32_16x16x32_bf16 v[176:179], a[188:191], a[220:223], v[176:179]
    v_mfma_f32_16x16x32_bf16 v[200:203], a[188:191], a[88:91], v[200:203]
    ds_read_b64_tr_b16 a[176:177], v119 offset:49152
    v_mfma_f32_16x16x32_bf16 v[204:207], a[188:191], a[92:95], v[204:207]
    s_waitcnt lgkmcnt(5)
    ds_read_b64_tr_b16 a[178:179], v119 offset:51200
    buffer_load_dwordx4 v1, s[56:59], s34 offen offset:1024 lds
    v_xor_b32 v119, 0x10000, v119
    v_mfma_f32_16x16x32_bf16 v[188:191], a[160:163], a[128:131], v[188:191]
    ds_read_b64_tr_b16 a[180:181], v118 offset:49152
    v_mfma_f32_16x16x32_bf16 v[196:199], a[160:163], a[132:135], v[196:199]
    ds_read_b64_tr_b16 a[182:183], v118 offset:51200
    v_xor_b32 v118, 0x10000, v118
    v_mfma_f32_16x16x32_bf16 v[184:187], a[164:167], a[128:131], v[184:187]
    ds_read_b64_tr_b16 a[184:185], v117 offset:49152
    v_mfma_f32_16x16x32_bf16 v[192:195], a[164:167], a[132:135], v[192:195]
    s_waitcnt lgkmcnt(5)
    ds_read_b64_tr_b16 a[186:187], v117 offset:51200
    v_xor_b32 v117, 0x10000, v117
    v_mfma_f32_16x16x32_bf16 v[172:175], a[168:171], a[128:131], v[172:175]
    ds_read_b64_tr_b16 a[188:189], v116 offset:49152
    v_mfma_f32_16x16x32_bf16 v[180:183], a[168:171], a[132:135], v[180:183]
    ds_read_b64_tr_b16 a[190:191], v116 offset:51200
    v_xor_b32 v116, 0x10000, v116
    v_mfma_f32_16x16x32_bf16 v[168:171], a[172:175], a[128:131], v[168:171]
    s_add_u32 s34, s34, 12288
    buffer_load_dwordx4 v0, s[56:59], s34 offen offset:2048 lds
    v_mfma_f32_16x16x32_bf16 v[176:179], a[172:175], a[132:135], v[176:179]
    s_waitcnt lgkmcnt(6)
    v_mfma_f32_16x16x32_bf16 v[200:203], a[172:175], a[96:99], v[200:203]
    ds_read_b64_tr_b16 a[160:161], v123 offset:49152
    v_mfma_f32_16x16x32_bf16 v[204:207], a[172:175], a[100:103], v[204:207]
    ds_read_b64_tr_b16 a[162:163], v123 offset:51200
    v_xor_b32 v123, 0x10000, v123
    v_mfma_f32_16x16x32_bf16 v[188:191], a[176:179], a[136:139], v[188:191]
    ds_read_b64_tr_b16 a[164:165], v122 offset:49152
    v_mfma_f32_16x16x32_bf16 v[196:199], a[176:179], a[140:143], v[196:199]
    s_waitcnt lgkmcnt(5)
    ds_read_b64_tr_b16 a[166:167], v122 offset:51200
    v_xor_b32 v122, 0x10000, v122
    v_mfma_f32_16x16x32_bf16 v[184:187], a[180:183], a[136:139], v[184:187]
    ds_read_b64_tr_b16 a[168:169], v121 offset:49152
    v_mfma_f32_16x16x32_bf16 v[192:195], a[180:183], a[140:143], v[192:195]
    ds_read_b64_tr_b16 a[170:171], v121 offset:51200
    buffer_load_dwordx4 v1, s[56:59], s34 offen offset:3072 lds
    v_xor_b32 v121, 0x10000, v121
    v_mfma_f32_16x16x32_bf16 v[172:175], a[184:187], a[136:139], v[172:175]
    ds_read_b64_tr_b16 a[172:173], v120 offset:49152
    v_mfma_f32_16x16x32_bf16 v[180:183], a[184:187], a[140:143], v[180:183]
    s_waitcnt lgkmcnt(7)
    ds_read_b64_tr_b16 a[174:175], v120 offset:51200
    v_xor_b32 v120, 0x10000, v120
    v_mfma_f32_16x16x32_bf16 v[168:171], a[188:191], a[136:139], v[168:171]
    v_mfma_f32_16x16x32_bf16 v[176:179], a[188:191], a[140:143], v[176:179]
    v_mfma_f32_16x16x32_bf16 v[200:203], a[188:191], a[104:107], v[200:203]
    ds_read_b64_tr_b16 a[176:177], v127 offset:49152
    v_mfma_f32_16x16x32_bf16 v[204:207], a[188:191], a[108:111], v[204:207]
    s_waitcnt lgkmcnt(5)
    ds_read_b64_tr_b16 a[178:179], v127 offset:51200
    v_xor_b32 v127, 0x10000, v127
    v_mfma_f32_16x16x32_bf16 v[188:191], a[160:163], a[144:147], v[188:191]
    ds_read_b64_tr_b16 a[180:181], v126 offset:49152
    v_mfma_f32_16x16x32_bf16 v[196:199], a[160:163], a[148:151], v[196:199]
    ds_read_b64_tr_b16 a[182:183], v126 offset:51200
    v_xor_b32 v126, 0x10000, v126
    v_mfma_f32_16x16x32_bf16 v[184:187], a[164:167], a[144:147], v[184:187]
    ds_read_b64_tr_b16 a[184:185], v125 offset:49152
    v_mfma_f32_16x16x32_bf16 v[192:195], a[164:167], a[148:151], v[192:195]
    s_waitcnt lgkmcnt(5)
    ds_read_b64_tr_b16 a[186:187], v125 offset:51200
    v_xor_b32 v125, 0x10000, v125
    v_mfma_f32_16x16x32_bf16 v[172:175], a[168:171], a[144:147], v[172:175]
    ds_read_b64_tr_b16 a[188:189], v124 offset:49152
    v_mfma_f32_16x16x32_bf16 v[180:183], a[168:171], a[148:151], v[180:183]
    ds_read_b64_tr_b16 a[190:191], v124 offset:51200
    v_xor_b32 v124, 0x10000, v124
    v_mfma_f32_16x16x32_bf16 v[168:171], a[172:175], a[144:147], v[168:171]
    v_mfma_f32_16x16x32_bf16 v[176:179], a[172:175], a[148:151], v[176:179]
    s_waitcnt lgkmcnt(6)
    v_mfma_f32_16x16x32_bf16 v[200:203], a[172:175], a[112:115], v[200:203]
    s_waitcnt vmcnt(25)
    s_barrier
    ds_read_b64_tr_b16 a[160:161], v115 offset:0
    v_mfma_f32_16x16x32_bf16 v[204:207], a[172:175], a[116:119], v[204:207]
    ds_read_b64_tr_b16 a[162:163], v115 offset:2048
    v_mfma_f32_16x16x32_bf16 v[188:191], a[176:179], a[152:155], v[188:191]
    s_add_u32 m0, s29, 131072
    ds_read_b64_tr_b16 a[164:165], v114 offset:0
    v_mfma_f32_16x16x32_bf16 v[196:199], a[176:179], a[156:159], v[196:199]
    s_waitcnt lgkmcnt(5)
    ds_read_b64_tr_b16 a[166:167], v114 offset:2048
    v_mfma_f32_16x16x32_bf16 v[184:187], a[180:183], a[152:155], v[184:187]
    s_add_u32 s34, s32, 384
    ds_read_b64_tr_b16 a[168:169], v113 offset:0
    buffer_load_dwordx4 v0, s[56:59], s34 offen offset:0 lds
    v_mfma_f32_16x16x32_bf16 v[192:195], a[180:183], a[156:159], v[192:195]
    ds_read_b64_tr_b16 a[170:171], v113 offset:2048
    v_mfma_f32_16x16x32_bf16 v[172:175], a[184:187], a[152:155], v[172:175]
    ds_read_b64_tr_b16 a[172:173], v112 offset:0
    v_mfma_f32_16x16x32_bf16 v[180:183], a[184:187], a[156:159], v[180:183]
    s_waitcnt lgkmcnt(7)
    ds_read_b64_tr_b16 a[174:175], v112 offset:2048
    v_mfma_f32_16x16x32_bf16 v[168:171], a[188:191], a[152:155], v[168:171]
    v_mfma_f32_16x16x32_bf16 v[176:179], a[188:191], a[156:159], v[176:179]
    v_mfma_f32_16x16x32_bf16 v[200:203], a[188:191], a[120:123], v[200:203]
    ds_read_b64_tr_b16 a[176:177], v119 offset:0
    v_mfma_f32_16x16x32_bf16 v[204:207], a[188:191], a[124:127], v[204:207]
    s_waitcnt lgkmcnt(5)
    ds_read_b64_tr_b16 a[178:179], v119 offset:2048
    buffer_load_dwordx4 v1, s[56:59], s34 offen offset:1024 lds
    v_mfma_f32_16x16x32_bf16 v[148:151], a[160:163], v[32:35], 0
    ds_read_b64_tr_b16 a[180:181], v118 offset:0
    v_readfirstlane_b32 s47, v4
    s_cmp_eq_u32 s47, 0
    s_cbranch_scc1 L_armspin
L_armback:
    v_mfma_f32_16x16x32_bf16 v[156:159], a[160:163], v[36:39], 0
    ds_read_b64_tr_b16 a[182:183], v118 offset:2048
    v_mfma_f32_16x16x32_bf16 v[144:147], a[164:167], v[32:35], 0
    ds_read_b64_tr_b16 a[184:185], v117 offset:0
    v_mfma_f32_16x16x32_bf16 v[152:155], a[164:167], v[36:39], 0
    s_waitcnt lgkmcnt(5)
    ds_read_b64_tr_b16 a[186:187], v117 offset:2048
    v_mfma_f32_16x16x32_bf16 v[132:135], a[168:171], v[32:35], 0
    ds_read_b64_tr_b16 a[188:189], v116 offset:0
    v_mov_b32 v12, 0
    v_mov_b32 v13, 1
    s_lshl_b32 s51, s7, 2
    s_add_u32 s51, s51, s28
    s_lshl_b32 s48, s51, 13
    s_mov_b32 s20, s8
    s_mov_b32 s21, s9
    v_mfma_f32_16x16x32_bf16 v[140:143], a[168:171], v[36:39], 0
    ds_read_b64_tr_b16 a[190:191], v116 offset:2048
    v_mfma_f32_16x16x32_bf16 v[128:131], a[172:175], v[32:35], 0
    s_add_u32 s34, s34, 12288
    buffer_load_dwordx4 v0, s[56:59], s34 offen offset:2048 lds
    v_mfma_f32_16x16x32_bf16 v[136:139], a[172:175], v[36:39], 0
    s_waitcnt lgkmcnt(6)
    v_cvt_pk_bf16_f32 v168, v168, v169
    v_cvt_pk_bf16_f32 v169, v170, v171
    v_mfma_f32_16x16x32_bf16 v[160:163], a[172:175], a[0:3], 0
    ds_read_b64_tr_b16 a[160:161], v123 offset:0
    v_cvt_pk_bf16_f32 v170, v172, v173
    v_mfma_f32_16x16x32_bf16 v[164:167], a[172:175], a[4:7], 0
    ds_read_b64_tr_b16 a[162:163], v123 offset:2048
    v_cvt_pk_bf16_f32 v171, v174, v175
    v_mfma_f32_16x16x32_bf16 v[148:151], a[176:179], v[40:43], v[148:151]
    ds_read_b64_tr_b16 a[164:165], v122 offset:0
    v_mfma_f32_16x16x32_bf16 v[156:159], a[176:179], v[44:47], v[156:159]
    s_waitcnt lgkmcnt(5)
    ds_read_b64_tr_b16 a[166:167], v122 offset:2048
    v_mfma_f32_16x16x32_bf16 v[144:147], a[180:183], v[40:43], v[144:147]
    ds_read_b64_tr_b16 a[168:169], v121 offset:0
    s_add_u32 s35, s30, 163840
    buffer_store_dwordx4 v[168:171], v16, s[8:11], s35 offen sc1
    v_mfma_f32_16x16x32_bf16 v[152:155], a[180:183], v[44:47], v[152:155]
    ds_read_b64_tr_b16 a[170:171], v121 offset:2048
    buffer_load_dwordx4 v1, s[56:59], s34 offen offset:3072 lds
    v_mfma_f32_16x16x32_bf16 v[132:135], a[184:187], v[40:43], v[132:135]
    ds_read_b64_tr_b16 a[172:173], v120 offset:0
    v_mfma_f32_16x16x32_bf16 v[140:143], a[184:187], v[44:47], v[140:143]
    s_waitcnt lgkmcnt(7)
    ds_read_b64_tr_b16 a[174:175], v120 offset:2048
    v_cvt_pk_bf16_f32 v176, v176, v177
    v_mfma_f32_16x16x32_bf16 v[128:131], a[188:191], v[40:43], v[128:131]
    v_cvt_pk_bf16_f32 v177, v178, v179
    v_cvt_pk_bf16_f32 v178, v180, v181
    v_mfma_f32_16x16x32_bf16 v[136:139], a[188:191], v[44:47], v[136:139]
    v_cvt_pk_bf16_f32 v179, v182, v183
    v_mfma_f32_16x16x32_bf16 v[160:163], a[188:191], a[8:11], v[160:163]
    ds_read_b64_tr_b16 a[176:177], v127 offset:0
    v_mfma_f32_16x16x32_bf16 v[164:167], a[188:191], a[12:15], v[164:167]
    s_waitcnt lgkmcnt(5)
    ds_read_b64_tr_b16 a[178:179], v127 offset:2048
    s_add_u32 s35, s30, 180224
    buffer_store_dwordx4 v[176:179], v16, s[8:11], s35 offen sc1
    v_mfma_f32_16x16x32_bf16 v[148:151], a[160:163], v[48:51], v[148:151]
    ds_read_b64_tr_b16 a[180:181], v126 offset:0
    v_mfma_f32_16x16x32_bf16 v[156:159], a[160:163], v[52:55], v[156:159]
    ds_read_b64_tr_b16 a[182:183], v126 offset:2048
    v_mfma_f32_16x16x32_bf16 v[144:147], a[164:167], v[48:51], v[144:147]
    ds_read_b64_tr_b16 a[184:185], v125 offset:0
    v_cvt_pk_bf16_f32 v184, v184, v185
    v_mfma_f32_16x16x32_bf16 v[152:155], a[164:167], v[52:55], v[152:155]
    s_waitcnt lgkmcnt(5)
    ds_read_b64_tr_b16 a[186:187], v125 offset:2048
    v_cvt_pk_bf16_f32 v185, v186, v187
    v_mfma_f32_16x16x32_bf16 v[132:135], a[168:171], v[48:51], v[132:135]
    ds_read_b64_tr_b16 a[188:189], v124 offset:0
    v_cvt_pk_bf16_f32 v186, v188, v189
    v_mfma_f32_16x16x32_bf16 v[140:143], a[168:171], v[52:55], v[140:143]
    ds_read_b64_tr_b16 a[190:191], v124 offset:2048
    v_cvt_pk_bf16_f32 v187, v190, v191
    v_mfma_f32_16x16x32_bf16 v[128:131], a[172:175], v[48:51], v[128:131]
    s_add_u32 s35, s30, 172032
    buffer_store_dwordx4 v[184:187], v16, s[8:11], s35 offen sc1
    v_mfma_f32_16x16x32_bf16 v[136:139], a[172:175], v[52:55], v[136:139]
    s_waitcnt lgkmcnt(6)
    v_mfma_f32_16x16x32_bf16 v[160:163], a[172:175], a[16:19], v[160:163]
    s_waitcnt vmcnt(28)
    s_barrier
    ds_read_b64_tr_b16 a[160:161], v115 offset:16384
    v_mfma_f32_16x16x32_bf16 v[164:167], a[172:175], a[20:23], v[164:167]
    ds_read_b64_tr_b16 a[162:163], v115 offset:18432
    v_cvt_pk_bf16_f32 v192, v192, v193
    v_mfma_f32_16x16x32_bf16 v[148:151], a[176:179], v[56:59], v[148:151]
    s_add_u32 m0, s29, 147456
    ds_read_b64_tr_b16 a[164:165], v114 offset:16384
    v_cvt_pk_bf16_f32 v193, v194, v195
    v_mfma_f32_16x16x32_bf16 v[156:159], a[176:179], v[60:63], v[156:159]
    s_waitcnt lgkmcnt(5)
    ds_read_b64_tr_b16 a[166:167], v114 offset:18432
    v_cvt_pk_bf16_f32 v194, v196, v197
    v_mfma_f32_16x16x32_bf16 v[144:147], a[180:183], v[56:59], v[144:147]
    s_add_u32 s34, s32, 115072
    ds_read_b64_tr_b16 a[168:169], v113 offset:16384
    buffer_load_dwordx4 v0, s[56:59], s34 offen offset:0 lds
    v_mfma_f32_16x16x32_bf16 v[152:155], a[180:183], v[60:63], v[152:155]
    ds_read_b64_tr_b16 a[170:171], v113 offset:18432
    v_cvt_pk_bf16_f32 v195, v198, v199
    v_mfma_f32_16x16x32_bf16 v[132:135], a[184:187], v[56:59], v[132:135]
    ds_read_b64_tr_b16 a[172:173], v112 offset:16384
    v_mfma_f32_16x16x32_bf16 v[140:143], a[184:187], v[60:63], v[140:143]
    s_waitcnt lgkmcnt(7)
    ds_read_b64_tr_b16 a[174:175], v112 offset:18432
    v_mfma_f32_16x16x32_bf16 v[128:131], a[188:191], v[56:59], v[128:131]
    s_add_u32 s35, s30, 188416
    buffer_store_dwordx4 v[192:195], v16, s[8:11], s35 offen sc1
    v_mfma_f32_16x16x32_bf16 v[136:139], a[188:191], v[60:63], v[136:139]
    v_cvt_pk_bf16_f32 v200, v200, v201
    v_mfma_f32_16x16x32_bf16 v[160:163], a[188:191], a[24:27], v[160:163]
    ds_read_b64_tr_b16 a[176:177], v119 offset:16384
    v_cvt_pk_bf16_f32 v201, v202, v203
    v_mfma_f32_16x16x32_bf16 v[164:167], a[188:191], a[28:31], v[164:167]
    s_waitcnt lgkmcnt(5)
    ds_read_b64_tr_b16 a[178:179], v119 offset:18432
    buffer_load_dwordx4 v1, s[56:59], s34 offen offset:1024 lds
    v_mfma_f32_16x16x32_bf16 v[148:151], a[160:163], v[64:67], v[148:151]
    ds_read_b64_tr_b16 a[180:181], v118 offset:16384
    v_cvt_pk_bf16_f32 v202, v204, v205
    v_cvt_pk_bf16_f32 v203, v206, v207
    v_mfma_f32_16x16x32_bf16 v[156:159], a[160:163], v[68:71], v[156:159]
    ds_read_b64_tr_b16 a[182:183], v118 offset:18432
    v_mfma_f32_16x16x32_bf16 v[144:147], a[164:167], v[64:67], v[144:147]
    ds_read_b64_tr_b16 a[184:185], v117 offset:16384
    v_mfma_f32_16x16x32_bf16 v[152:155], a[164:167], v[68:71], v[152:155]
    s_waitcnt lgkmcnt(5)
    ds_read_b64_tr_b16 a[186:187], v117 offset:18432
    s_add_u32 s35, s31, 163840
    buffer_store_dwordx4 v[200:203], v16, s[8:11], s35 offen sc1
    v_mfma_f32_16x16x32_bf16 v[132:135], a[168:171], v[64:67], v[132:135]
    ds_read_b64_tr_b16 a[188:189], v116 offset:16384
    v_mfma_f32_16x16x32_bf16 v[140:143], a[168:171], v[68:71], v[140:143]
    ds_read_b64_tr_b16 a[190:191], v116 offset:18432
    v_mfma_f32_16x16x32_bf16 v[128:131], a[172:175], v[64:67], v[128:131]
    s_add_u32 s34, s34, 12288
    buffer_load_dwordx4 v0, s[56:59], s34 offen offset:2048 lds
    v_mfma_f32_16x16x32_bf16 v[136:139], a[172:175], v[68:71], v[136:139]
    s_waitcnt lgkmcnt(6)
    v_mfma_f32_16x16x32_bf16 v[160:163], a[172:175], a[32:35], v[160:163]
    ds_read_b64_tr_b16 a[160:161], v123 offset:16384
    v_mfma_f32_16x16x32_bf16 v[164:167], a[172:175], a[36:39], v[164:167]
    ds_read_b64_tr_b16 a[162:163], v123 offset:18432
    v_mfma_f32_16x16x32_bf16 v[148:151], a[176:179], v[72:75], v[148:151]
    ds_read_b64_tr_b16 a[164:165], v122 offset:16384
    v_mfma_f32_16x16x32_bf16 v[156:159], a[176:179], v[76:79], v[156:159]
    s_waitcnt lgkmcnt(5)
    ds_read_b64_tr_b16 a[166:167], v122 offset:18432
    v_mfma_f32_16x16x32_bf16 v[144:147], a[180:183], v[72:75], v[144:147]
    ds_read_b64_tr_b16 a[168:169], v121 offset:16384
    v_mfma_f32_16x16x32_bf16 v[152:155], a[180:183], v[76:79], v[152:155]
    ds_read_b64_tr_b16 a[170:171], v121 offset:18432
    buffer_load_dwordx4 v1, s[56:59], s34 offen offset:3072 lds
    v_mfma_f32_16x16x32_bf16 v[132:135], a[184:187], v[72:75], v[132:135]
    ds_read_b64_tr_b16 a[172:173], v120 offset:16384
    v_mfma_f32_16x16x32_bf16 v[140:143], a[184:187], v[76:79], v[140:143]
    s_waitcnt lgkmcnt(7)
    ds_read_b64_tr_b16 a[174:175], v120 offset:18432
    v_mfma_f32_16x16x32_bf16 v[128:131], a[188:191], v[72:75], v[128:131]
    v_mfma_f32_16x16x32_bf16 v[136:139], a[188:191], v[76:79], v[136:139]
    v_mfma_f32_16x16x32_bf16 v[160:163], a[188:191], a[40:43], v[160:163]
    ds_read_b64_tr_b16 a[176:177], v127 offset:16384
    v_mfma_f32_16x16x32_bf16 v[164:167], a[188:191], a[44:47], v[164:167]
    s_waitcnt lgkmcnt(5)
    ds_read_b64_tr_b16 a[178:179], v127 offset:18432
    v_mfma_f32_16x16x32_bf16 v[148:151], a[160:163], v[80:83], v[148:151]
    ds_read_b64_tr_b16 a[180:181], v126 offset:16384
    v_mfma_f32_16x16x32_bf16 v[156:159], a[160:163], v[84:87], v[156:159]
    ds_read_b64_tr_b16 a[182:183], v126 offset:18432
    v_mfma_f32_16x16x32_bf16 v[144:147], a[164:167], v[80:83], v[144:147]
    ds_read_b64_tr_b16 a[184:185], v125 offset:16384
    v_mfma_f32_16x16x32_bf16 v[152:155], a[164:167], v[84:87], v[152:155]
    s_waitcnt lgkmcnt(5)
    ds_read_b64_tr_b16 a[186:187], v125 offset:18432
    v_mfma_f32_16x16x32_bf16 v[132:135], a[168:171], v[80:83], v[132:135]
    ds_read_b64_tr_b16 a[188:189], v124 offset:16384
    v_mfma_f32_16x16x32_bf16 v[140:143], a[168:171], v[84:87], v[140:143]
    ds_read_b64_tr_b16 a[190:191], v124 offset:18432
    v_mfma_f32_16x16x32_bf16 v[128:131], a[172:175], v[80:83], v[128:131]
    v_mfma_f32_16x16x32_bf16 v[136:139], a[172:175], v[84:87], v[136:139]
    s_waitcnt lgkmcnt(6)
    v_mfma_f32_16x16x32_bf16 v[160:163], a[172:175], a[48:51], v[160:163]
    s_waitcnt vmcnt(29)
    s_barrier
    ds_read_b64_tr_b16 a[160:161], v115 offset:32768
    v_mfma_f32_16x16x32_bf16 v[164:167], a[172:175], a[52:55], v[164:167]
    ds_read_b64_tr_b16 a[162:163], v115 offset:34816
    v_mfma_f32_16x16x32_bf16 v[148:151], a[176:179], v[88:91], v[148:151]
    s_add_u32 m0, s29, 32768
    ds_read_b64_tr_b16 a[164:165], v114 offset:32768
    v_mfma_f32_16x16x32_bf16 v[156:159], a[176:179], v[92:95], v[156:159]
    s_waitcnt lgkmcnt(5)
    ds_read_b64_tr_b16 a[166:167], v114 offset:34816
    v_mfma_f32_16x16x32_bf16 v[144:147], a[180:183], v[88:91], v[144:147]
    s_add_u32 s34, s32, 1835520
    ds_read_b64_tr_b16 a[168:169], v113 offset:32768
    buffer_load_dwordx4 v0, s[56:59], s34 offen offset:0 lds
    v_mfma_f32_16x16x32_bf16 v[152:155], a[180:183], v[92:95], v[152:155]
    ds_read_b64_tr_b16 a[170:171], v113 offset:34816
    v_mfma_f32_16x16x32_bf16 v[132:135], a[184:187], v[88:91], v[132:135]
    ds_read_b64_tr_b16 a[172:173], v112 offset:32768
    v_mfma_f32_16x16x32_bf16 v[140:143], a[184:187], v[92:95], v[140:143]
    s_waitcnt lgkmcnt(7)
    ds_read_b64_tr_b16 a[174:175], v112 offset:34816
    v_mfma_f32_16x16x32_bf16 v[128:131], a[188:191], v[88:91], v[128:131]
    v_mfma_f32_16x16x32_bf16 v[136:139], a[188:191], v[92:95], v[136:139]
    v_mfma_f32_16x16x32_bf16 v[160:163], a[188:191], a[56:59], v[160:163]
    ds_read_b64_tr_b16 a[176:177], v119 offset:32768
    v_mfma_f32_16x16x32_bf16 v[164:167], a[188:191], a[60:63], v[164:167]
    s_waitcnt lgkmcnt(5)
    ds_read_b64_tr_b16 a[178:179], v119 offset:34816
    buffer_load_dwordx4 v1, s[56:59], s34 offen offset:1024 lds
    v_mfma_f32_16x16x32_bf16 v[148:151], a[160:163], a[192:195], v[148:151]
    ds_read_b64_tr_b16 a[180:181], v118 offset:32768
    v_mfma_f32_16x16x32_bf16 v[156:159], a[160:163], a[196:199], v[156:159]
    ds_read_b64_tr_b16 a[182:183], v118 offset:34816
    v_mfma_f32_16x16x32_bf16 v[144:147], a[164:167], a[192:195], v[144:147]
    ds_read_b64_tr_b16 a[184:185], v117 offset:32768
    v_mfma_f32_16x16x32_bf16 v[152:155], a[164:167], a[196:199], v[152:155]
    s_waitcnt lgkmcnt(5)
    ds_read_b64_tr_b16 a[186:187], v117 offset:34816
    v_mfma_f32_16x16x32_bf16 v[132:135], a[168:171], a[192:195], v[132:135]
    ds_read_b64_tr_b16 a[188:189], v116 offset:32768
    v_mfma_f32_16x16x32_bf16 v[140:143], a[168:171], a[196:199], v[140:143]
    ds_read_b64_tr_b16 a[190:191], v116 offset:34816
    v_mfma_f32_16x16x32_bf16 v[128:131], a[172:175], a[192:195], v[128:131]
    s_add_u32 s34, s34, 12288
    buffer_load_dwordx4 v0, s[56:59], s34 offen offset:2048 lds
    v_mfma_f32_16x16x32_bf16 v[136:139], a[172:175], a[196:199], v[136:139]
    s_waitcnt lgkmcnt(6)
    v_mfma_f32_16x16x32_bf16 v[160:163], a[172:175], a[64:67], v[160:163]
    ds_read_b64_tr_b16 a[160:161], v123 offset:32768
    v_mfma_f32_16x16x32_bf16 v[164:167], a[172:175], a[68:71], v[164:167]
    ds_read_b64_tr_b16 a[162:163], v123 offset:34816
    v_mfma_f32_16x16x32_bf16 v[148:151], a[176:179], a[200:203], v[148:151]
    ds_read_b64_tr_b16 a[164:165], v122 offset:32768
    v_mfma_f32_16x16x32_bf16 v[156:159], a[176:179], a[204:207], v[156:159]
    s_waitcnt lgkmcnt(5)
    ds_read_b64_tr_b16 a[166:167], v122 offset:34816
    v_mfma_f32_16x16x32_bf16 v[144:147], a[180:183], a[200:203], v[144:147]
    ds_read_b64_tr_b16 a[168:169], v121 offset:32768
    v_mfma_f32_16x16x32_bf16 v[152:155], a[180:183], a[204:207], v[152:155]
    ds_read_b64_tr_b16 a[170:171], v121 offset:34816
    buffer_load_dwordx4 v1, s[56:59], s34 offen offset:3072 lds
    v_mfma_f32_16x16x32_bf16 v[132:135], a[184:187], a[200:203], v[132:135]
    ds_read_b64_tr_b16 a[172:173], v120 offset:32768
    v_mfma_f32_16x16x32_bf16 v[140:143], a[184:187], a[204:207], v[140:143]
    s_waitcnt lgkmcnt(7)
    ds_read_b64_tr_b16 a[174:175], v120 offset:34816
    v_mfma_f32_16x16x32_bf16 v[128:131], a[188:191], a[200:203], v[128:131]
    v_mfma_f32_16x16x32_bf16 v[136:139], a[188:191], a[204:207], v[136:139]
    v_mfma_f32_16x16x32_bf16 v[160:163], a[188:191], a[72:75], v[160:163]
    ds_read_b64_tr_b16 a[176:177], v127 offset:32768
    v_mfma_f32_16x16x32_bf16 v[164:167], a[188:191], a[76:79], v[164:167]
    s_waitcnt lgkmcnt(5)
    ds_read_b64_tr_b16 a[178:179], v127 offset:34816
    v_mfma_f32_16x16x32_bf16 v[148:151], a[160:163], a[208:211], v[148:151]
    ds_read_b64_tr_b16 a[180:181], v126 offset:32768
    v_mfma_f32_16x16x32_bf16 v[156:159], a[160:163], a[212:215], v[156:159]
    ds_read_b64_tr_b16 a[182:183], v126 offset:34816
    v_mfma_f32_16x16x32_bf16 v[144:147], a[164:167], a[208:211], v[144:147]
    ds_read_b64_tr_b16 a[184:185], v125 offset:32768
    v_mfma_f32_16x16x32_bf16 v[152:155], a[164:167], a[212:215], v[152:155]
    s_waitcnt lgkmcnt(5)
    ds_read_b64_tr_b16 a[186:187], v125 offset:34816
    v_mfma_f32_16x16x32_bf16 v[132:135], a[168:171], a[208:211], v[132:135]
    ds_read_b64_tr_b16 a[188:189], v124 offset:32768
    v_mfma_f32_16x16x32_bf16 v[140:143], a[168:171], a[212:215], v[140:143]
    ds_read_b64_tr_b16 a[190:191], v124 offset:34816
    v_mfma_f32_16x16x32_bf16 v[128:131], a[172:175], a[208:211], v[128:131]
    v_mfma_f32_16x16x32_bf16 v[136:139], a[172:175], a[212:215], v[136:139]
    s_waitcnt lgkmcnt(6)
    v_mfma_f32_16x16x32_bf16 v[160:163], a[172:175], a[80:83], v[160:163]
    s_waitcnt vmcnt(6)
    s_barrier
    ds_read_b64_tr_b16 a[160:161], v115 offset:49152
    v_mfma_f32_16x16x32_bf16 v[164:167], a[172:175], a[84:87], v[164:167]
    ds_read_b64_tr_b16 a[162:163], v115 offset:51200
    v_xor_b32 v115, 0x10000, v115
    s_cmp_lg_u32 s28, 0
    s_cbranch_scc1 L_nosig1
    s_mov_b64 exec, 1
    global_atomic_add v12, v13, s[98:99] offset:4 sc1
    s_mov_b64 exec, -1
L_nosig1:
    v_mfma_f32_16x16x32_bf16 v[148:151], a[176:179], a[216:219], v[148:151]
    s_add_u32 m0, s29, 49152
    ds_read_b64_tr_b16 a[164:165], v114 offset:49152
    v_mfma_f32_16x16x32_bf16 v[156:159], a[176:179], a[220:223], v[156:159]
    s_waitcnt lgkmcnt(5)
    ds_read_b64_tr_b16 a[166:167], v114 offset:51200
    v_xor_b32 v114, 0x10000, v114
    v_mfma_f32_16x16x32_bf16 v[144:147], a[180:183], a[216:219], v[144:147]
    s_add_u32 s34, s32, 1950208
    ds_read_b64_tr_b16 a[168:169], v113 offset:49152
    buffer_load_dwordx4 v0, s[56:59], s34 offen offset:0 lds
    v_mfma_f32_16x16x32_bf16 v[152:155], a[180:183], a[220:223], v[152:155]
    ds_read_b64_tr_b16 a[170:171], v113 offset:51200
    v_xor_b32 v113, 0x10000, v113
    v_mfma_f32_16x16x32_bf16 v[132:135], a[184:187], a[216:219], v[132:135]
    ds_read_b64_tr_b16 a[172:173], v112 offset:49152
    v_mfma_f32_16x16x32_bf16 v[140:143], a[184:187], a[220:223], v[140:143]
    s_waitcnt lgkmcnt(7)
    ds_read_b64_tr_b16 a[174:175], v112 offset:51200
    v_xor_b32 v112, 0x10000, v112
    v_mfma_f32_16x16x32_bf16 v[128:131], a[188:191], a[216:219], v[128:131]
    v_mfma_f32_16x16x32_bf16 v[136:139], a[188:191], a[220:223], v[136:139]
    v_mfma_f32_16x16x32_bf16 v[160:163], a[188:191], a[88:91], v[160:163]
    ds_read_b64_tr_b16 a[176:177], v119 offset:49152
    v_mfma_f32_16x16x32_bf16 v[164:167], a[188:191], a[92:95], v[164:167]
    s_waitcnt lgkmcnt(5)
    ds_read_b64_tr_b16 a[178:179], v119 offset:51200
    buffer_load_dwordx4 v1, s[56:59], s34 offen offset:1024 lds
    v_xor_b32 v119, 0x10000, v119
    v_mfma_f32_16x16x32_bf16 v[148:151], a[160:163], a[128:131], v[148:151]
    ds_read_b64_tr_b16 a[180:181], v118 offset:49152
    v_mfma_f32_16x16x32_bf16 v[156:159], a[160:163], a[132:135], v[156:159]
    ds_read_b64_tr_b16 a[182:183], v118 offset:51200
    v_xor_b32 v118, 0x10000, v118
    v_mfma_f32_16x16x32_bf16 v[144:147], a[164:167], a[128:131], v[144:147]
    ds_read_b64_tr_b16 a[184:185], v117 offset:49152
    v_mfma_f32_16x16x32_bf16 v[152:155], a[164:167], a[132:135], v[152:155]
    s_waitcnt lgkmcnt(5)
    ds_read_b64_tr_b16 a[186:187], v117 offset:51200
    v_xor_b32 v117, 0x10000, v117
    v_mfma_f32_16x16x32_bf16 v[132:135], a[168:171], a[128:131], v[132:135]
    ds_read_b64_tr_b16 a[188:189], v116 offset:49152
    v_mfma_f32_16x16x32_bf16 v[140:143], a[168:171], a[132:135], v[140:143]
    ds_read_b64_tr_b16 a[190:191], v116 offset:51200
    v_xor_b32 v116, 0x10000, v116
    v_mfma_f32_16x16x32_bf16 v[128:131], a[172:175], a[128:131], v[128:131]
    s_add_u32 s34, s34, 12288
    buffer_load_dwordx4 v0, s[56:59], s34 offen offset:2048 lds
    v_mfma_f32_16x16x32_bf16 v[136:139], a[172:175], a[132:135], v[136:139]
    s_waitcnt lgkmcnt(6)
    v_mfma_f32_16x16x32_bf16 v[160:163], a[172:175], a[96:99], v[160:163]
    ds_read_b64_tr_b16 a[160:161], v123 offset:49152
    v_mfma_f32_16x16x32_bf16 v[164:167], a[172:175], a[100:103], v[164:167]
    ds_read_b64_tr_b16 a[162:163], v123 offset:51200
    v_xor_b32 v123, 0x10000, v123
    v_mfma_f32_16x16x32_bf16 v[148:151], a[176:179], a[136:139], v[148:151]
    ds_read_b64_tr_b16 a[164:165], v122 offset:49152
    v_mfma_f32_16x16x32_bf16 v[156:159], a[176:179], a[140:143], v[156:159]
    s_waitcnt lgkmcnt(5)
    ds_read_b64_tr_b16 a[166:167], v122 offset:51200
    v_xor_b32 v122, 0x10000, v122
    v_mfma_f32_16x16x32_bf16 v[144:147], a[180:183], a[136:139], v[144:147]
    ds_read_b64_tr_b16 a[168:169], v121 offset:49152
    v_mfma_f32_16x16x32_bf16 v[152:155], a[180:183], a[140:143], v[152:155]
    ds_read_b64_tr_b16 a[170:171], v121 offset:51200
    buffer_load_dwordx4 v1, s[56:59], s34 offen offset:3072 lds
    v_xor_b32 v121, 0x10000, v121
    v_mfma_f32_16x16x32_bf16 v[132:135], a[184:187], a[136:139], v[132:135]
    ds_read_b64_tr_b16 a[172:173], v120 offset:49152
    v_mfma_f32_16x16x32_bf16 v[140:143], a[184:187], a[140:143], v[140:143]
    s_waitcnt lgkmcnt(7)
    ds_read_b64_tr_b16 a[174:175], v120 offset:51200
    v_xor_b32 v120, 0x10000, v120
    v_mfma_f32_16x16x32_bf16 v[128:131], a[188:191], a[136:139], v[128:131]
    v_mfma_f32_16x16x32_bf16 v[136:139], a[188:191], a[140:143], v[136:139]
    v_mfma_f32_16x16x32_bf16 v[160:163], a[188:191], a[104:107], v[160:163]
    ds_read_b64_tr_b16 a[176:177], v127 offset:49152
    v_mfma_f32_16x16x32_bf16 v[164:167], a[188:191], a[108:111], v[164:167]
    s_waitcnt lgkmcnt(5)
    ds_read_b64_tr_b16 a[178:179], v127 offset:51200
    v_xor_b32 v127, 0x10000, v127
    v_mfma_f32_16x16x32_bf16 v[148:151], a[160:163], a[144:147], v[148:151]
    ds_read_b64_tr_b16 a[180:181], v126 offset:49152
    v_mfma_f32_16x16x32_bf16 v[156:159], a[160:163], a[148:151], v[156:159]
    ds_read_b64_tr_b16 a[182:183], v126 offset:51200
    v_xor_b32 v126, 0x10000, v126
    v_mfma_f32_16x16x32_bf16 v[144:147], a[164:167], a[144:147], v[144:147]
    ds_read_b64_tr_b16 a[184:185], v125 offset:49152
    v_mfma_f32_16x16x32_bf16 v[152:155], a[164:167], a[148:151], v[152:155]
    s_waitcnt lgkmcnt(5)
    ds_read_b64_tr_b16 a[186:187], v125 offset:51200
    v_xor_b32 v125, 0x10000, v125
    v_mfma_f32_16x16x32_bf16 v[132:135], a[168:171], a[144:147], v[132:135]
    ds_read_b64_tr_b16 a[188:189], v124 offset:49152
    v_mfma_f32_16x16x32_bf16 v[140:143], a[168:171], a[148:151], v[140:143]
    ds_read_b64_tr_b16 a[190:191], v124 offset:51200
    v_xor_b32 v124, 0x10000, v124
    v_mfma_f32_16x16x32_bf16 v[128:131], a[172:175], a[144:147], v[128:131]
    v_mfma_f32_16x16x32_bf16 v[136:139], a[172:175], a[148:151], v[136:139]
    s_waitcnt lgkmcnt(6)
    v_mfma_f32_16x16x32_bf16 v[160:163], a[172:175], a[112:115], v[160:163]
    s_barrier
    ds_read_b64_tr_b16 a[160:161], v115 offset:0
    v_mfma_f32_16x16x32_bf16 v[164:167], a[172:175], a[116:119], v[164:167]
    ds_read_b64_tr_b16 a[162:163], v115 offset:2048
    v_mfma_f32_16x16x32_bf16 v[148:151], a[176:179], a[152:155], v[148:151]
    s_add_u32 m0, s29, 65536
    ds_read_b64_tr_b16 a[164:165], v114 offset:0
    v_mfma_f32_16x16x32_bf16 v[156:159], a[176:179], a[156:159], v[156:159]
    s_waitcnt lgkmcnt(5)
    ds_read_b64_tr_b16 a[166:167], v114 offset:2048
    v_mfma_f32_16x16x32_bf16 v[144:147], a[180:183], a[152:155], v[144:147]
    s_add_u32 s34, s32, 512
    ds_read_b64_tr_b16 a[168:169], v113 offset:0
    buffer_load_dwordx4 v0, s[56:59], s34 offen offset:0 lds
    v_mfma_f32_16x16x32_bf16 v[152:155], a[180:183], a[156:159], v[152:155]
    ds_read_b64_tr_b16 a[170:171], v113 offset:2048
    v_mfma_f32_16x16x32_bf16 v[132:135], a[184:187], a[152:155], v[132:135]
    ds_read_b64_tr_b16 a[172:173], v112 offset:0
    v_mfma_f32_16x16x32_bf16 v[140:143], a[184:187], a[156:159], v[140:143]
    s_waitcnt lgkmcnt(7)
    ds_read_b64_tr_b16 a[174:175], v112 offset:2048
    v_mfma_f32_16x16x32_bf16 v[128:131], a[188:191], a[152:155], v[128:131]
    v_mfma_f32_16x16x32_bf16 v[136:139], a[188:191], a[156:159], v[136:139]
    v_mfma_f32_16x16x32_bf16 v[160:163], a[188:191], a[120:123], v[160:163]
    ds_read_b64_tr_b16 a[176:177], v119 offset:0
B_stub3:
    s_cbranch_execz B_back
    v_mfma_f32_16x16x32_bf16 v[164:167], a[188:191], a[124:127], v[164:167]
    s_waitcnt lgkmcnt(5)
    ds_read_b64_tr_b16 a[178:179], v119 offset:2048
    buffer_load_dwordx4 v1, s[56:59], s34 offen offset:1024 lds
    v_mfma_f32_16x16x32_bf16 v[188:191], a[160:163], v[32:35], 0
    ds_read_b64_tr_b16 a[180:181], v118 offset:0
    v_mfma_f32_16x16x32_bf16 v[196:199], a[160:163], v[36:39], 0
    ds_read_b64_tr_b16 a[182:183], v118 offset:2048
    v_mfma_f32_16x16x32_bf16 v[184:187], a[164:167], v[32:35], 0
    ds_read_b64_tr_b16 a[184:185], v117 offset:0
    v_mfma_f32_16x16x32_bf16 v[192:195], a[164:167], v[36:39], 0
    s_waitcnt lgkmcnt(5)
    ds_read_b64_tr_b16 a[186:187], v117 offset:2048
    v_mfma_f32_16x16x32_bf16 v[172:175], a[168:171], v[32:35], 0
    ds_read_b64_tr_b16 a[188:189], v116 offset:0
    v_mfma_f32_16x16x32_bf16 v[180:183], a[168:171], v[36:39], 0
    ds_read_b64_tr_b16 a[190:191], v116 offset:2048
    v_mfma_f32_16x16x32_bf16 v[168:171], a[172:175], v[32:35], 0
    s_add_u32 s34, s34, 12288
    buffer_load_dwordx4 v0, s[56:59], s34 offen offset:2048 lds
    v_mfma_f32_16x16x32_bf16 v[176:179], a[172:175], v[36:39], 0
    s_waitcnt lgkmcnt(6)
    v_cvt_pk_bf16_f32 v128, v128, v129
    v_cvt_pk_bf16_f32 v129, v130, v131
    v_mfma_f32_16x16x32_bf16 v[200:203], a[172:175], a[0:3], 0
    ds_read_b64_tr_b16 a[160:161], v123 offset:0
    v_cvt_pk_bf16_f32 v130, v132, v133
    v_mfma_f32_16x16x32_bf16 v[204:207], a[172:175], a[4:7], 0
    ds_read_b64_tr_b16 a[162:163], v123 offset:2048
    v_cvt_pk_bf16_f32 v131, v134, v135
    v_mfma_f32_16x16x32_bf16 v[188:191], a[176:179], v[40:43], v[188:191]
    ds_read_b64_tr_b16 a[164:165], v122 offset:0
    v_mfma_f32_16x16x32_bf16 v[196:199], a[176:179], v[44:47], v[196:199]
    s_waitcnt lgkmcnt(5)
    ds_read_b64_tr_b16 a[166:167], v122 offset:2048
    v_mfma_f32_16x16x32_bf16 v[184:187], a[180:183], v[40:43], v[184:187]
    ds_read_b64_tr_b16 a[168:169], v121 offset:0
    s_add_u32 s35, s30, 327680
    buffer_store_dwordx4 v[128:131], v16, s[8:11], s35 offen sc1
    v_mfma_f32_16x16x32_bf16 v[192:195], a[180:183], v[44:47], v[192:195]
    ds_read_b64_tr_b16 a[170:171], v121 offset:2048
    buffer_load_dwordx4 v1, s[56:59], s34 offen offset:3072 lds
    v_mfma_f32_16x16x32_bf16 v[172:175], a[184:187], v[40:43], v[172:175]
    ds_read_b64_tr_b16 a[172:173], v120 offset:0
    v_mfma_f32_16x16x32_bf16 v[180:183], a[184:187], v[44:47], v[180:183]
    s_waitcnt lgkmcnt(7)
    ds_read_b64_tr_b16 a[174:175], v120 offset:2048
    v_cvt_pk_bf16_f32 v136, v136, v137
    v_mfma_f32_16x16x32_bf16 v[168:171], a[188:191], v[40:43], v[168:171]
    v_cvt_pk_bf16_f32 v137, v138, v139
    v_cvt_pk_bf16_f32 v138, v140, v141
    v_mfma_f32_16x16x32_bf16 v[176:179], a[188:191], v[44:47], v[176:179]
    v_cvt_pk_bf16_f32 v139, v142, v143
    v_mfma_f32_16x16x32_bf16 v[200:203], a[188:191], a[8:11], v[200:203]
    ds_read_b64_tr_b16 a[176:177], v127 offset:0
    v_mfma_f32_16x16x32_bf16 v[204:207], a[188:191], a[12:15], v[204:207]
    s_waitcnt lgkmcnt(5)
    ds_read_b64_tr_b16 a[178:179], v127 offset:2048
    s_add_u32 s35, s30, 344064
    buffer_store_dwordx4 v[136:139], v16, s[8:11], s35 offen sc1
    v_mfma_f32_16x16x32_bf16 v[188:191], a[160:163], v[48:51], v[188:191]
    ds_read_b64_tr_b16 a[180:181], v126 offset:0
    v_mfma_f32_16x16x32_bf16 v[196:199], a[160:163], v[52:55], v[196:199]
    ds_read_b64_tr_b16 a[182:183], v126 offset:2048
    v_mfma_f32_16x16x32_bf16 v[184:187], a[164:167], v[48:51], v[184:187]
    ds_read_b64_tr_b16 a[184:185], v125 offset:0
    v_cvt_pk_bf16_f32 v144, v144, v145
    v_mfma_f32_16x16x32_bf16 v[192:195], a[164:167], v[52:55], v[192:195]
    s_waitcnt lgkmcnt(5)
    ds_read_b64_tr_b16 a[186:187], v125 offset:2048
    v_cvt_pk_bf16_f32 v145, v146, v147
    v_mfma_f32_16x16x32_bf16 v[172:175], a[168:171], v[48:51], v[172:175]
    ds_read_b64_tr_b16 a[188:189], v124 offset:0
    v_cvt_pk_bf16_f32 v146, v148, v149
    v_mfma_f32_16x16x32_bf16 v[180:183], a[168:171], v[52:55], v[180:183]
    ds_read_b64_tr_b16 a[190:191], v124 offset:2048
    v_cvt_pk_bf16_f32 v147, v150, v151
    v_mfma_f32_16x16x32_bf16 v[168:171], a[172:175], v[48:51], v[168:171]
    s_add_u32 s35, s30, 335872
    buffer_store_dwordx4 v[144:147], v16, s[8:11], s35 offen sc1
    v_mfma_f32_16x16x32_bf16 v[176:179], a[172:175], v[52:55], v[176:179]
    s_waitcnt lgkmcnt(6)
    v_mfma_f32_16x16x32_bf16 v[200:203], a[172:175], a[16:19], v[200:203]
    s_barrier
    ds_read_b64_tr_b16 a[160:161], v115 offset:16384
    v_mfma_f32_16x16x32_bf16 v[204:207], a[172:175], a[20:23], v[204:207]
    ds_read_b64_tr_b16 a[162:163], v115 offset:18432
    v_cvt_pk_bf16_f32 v152, v152, v153
    v_mfma_f32_16x16x32_bf16 v[188:191], a[176:179], v[56:59], v[188:191]
    s_add_u32 m0, s29, 81920
    ds_read_b64_tr_b16 a[164:165], v114 offset:16384
    v_cvt_pk_bf16_f32 v153, v154, v155
    v_mfma_f32_16x16x32_bf16 v[196:199], a[176:179], v[60:63], v[196:199]
    s_waitcnt lgkmcnt(5)
    ds_read_b64_tr_b16 a[166:167], v114 offset:18432
    v_cvt_pk_bf16_f32 v154, v156, v157
    v_mfma_f32_16x16x32_bf16 v[184:187], a[180:183], v[56:59], v[184:187]
    s_add_u32 s34, s32, 115200
    ds_read_b64_tr_b16 a[168:169], v113 offset:16384
    buffer_load_dwordx4 v0, s[56:59], s34 offen offset:0 lds
    v_mfma_f32_16x16x32_bf16 v[192:195], a[180:183], v[60:63], v[192:195]
    ds_read_b64_tr_b16 a[170:171], v113 offset:18432
    v_cvt_pk_bf16_f32 v155, v158, v159
    v_mfma_f32_16x16x32_bf16 v[172:175], a[184:187], v[56:59], v[172:175]
    ds_read_b64_tr_b16 a[172:173], v112 offset:16384
    v_mfma_f32_16x16x32_bf16 v[180:183], a[184:187], v[60:63], v[180:183]
    s_waitcnt lgkmcnt(7)
    ds_read_b64_tr_b16 a[174:175], v112 offset:18432
    v_mfma_f32_16x16x32_bf16 v[168:171], a[188:191], v[56:59], v[168:171]
    s_add_u32 s35, s30, 352256
    buffer_store_dwordx4 v[152:155], v16, s[8:11], s35 offen sc1
    v_mfma_f32_16x16x32_bf16 v[176:179], a[188:191], v[60:63], v[176:179]
    v_cvt_pk_bf16_f32 v160, v160, v161
    v_mfma_f32_16x16x32_bf16 v[200:203], a[188:191], a[24:27], v[200:203]
    ds_read_b64_tr_b16 a[176:177], v119 offset:16384
    v_cvt_pk_bf16_f32 v161, v162, v163
    v_mfma_f32_16x16x32_bf16 v[204:207], a[188:191], a[28:31], v[204:207]
    s_waitcnt lgkmcnt(5)
    ds_read_b64_tr_b16 a[178:179], v119 offset:18432
    buffer_load_dwordx4 v1, s[56:59], s34 offen offset:1024 lds
    v_mfma_f32_16x16x32_bf16 v[188:191], a[160:163], v[64:67], v[188:191]
    ds_read_b64_tr_b16 a[180:181], v118 offset:16384
    v_cvt_pk_bf16_f32 v162, v164, v165
    v_cvt_pk_bf16_f32 v163, v166, v167
    v_mfma_f32_16x16x32_bf16 v[196:199], a[160:163], v[68:71], v[196:199]
    ds_read_b64_tr_b16 a[182:183], v118 offset:18432
    v_mfma_f32_16x16x32_bf16 v[184:187], a[164:167], v[64:67], v[184:187]
    ds_read_b64_tr_b16 a[184:185], v117 offset:16384
    v_mfma_f32_16x16x32_bf16 v[192:195], a[164:167], v[68:71], v[192:195]
    s_waitcnt lgkmcnt(5)
    ds_read_b64_tr_b16 a[186:187], v117 offset:18432
    s_add_u32 s35, s31, 327680
    buffer_store_dwordx4 v[160:163], v16, s[8:11], s35 offen sc1
    v_mfma_f32_16x16x32_bf16 v[172:175], a[168:171], v[64:67], v[172:175]
    ds_read_b64_tr_b16 a[188:189], v116 offset:16384
    v_mfma_f32_16x16x32_bf16 v[180:183], a[168:171], v[68:71], v[180:183]
    ds_read_b64_tr_b16 a[190:191], v116 offset:18432
    v_mfma_f32_16x16x32_bf16 v[168:171], a[172:175], v[64:67], v[168:171]
    s_add_u32 s34, s34, 12288
    buffer_load_dwordx4 v0, s[56:59], s34 offen offset:2048 lds
    v_mfma_f32_16x16x32_bf16 v[176:179], a[172:175], v[68:71], v[176:179]
    s_waitcnt lgkmcnt(6)
    v_mfma_f32_16x16x32_bf16 v[200:203], a[172:175], a[32:35], v[200:203]
    ds_read_b64_tr_b16 a[160:161], v123 offset:16384
    v_mfma_f32_16x16x32_bf16 v[204:207], a[172:175], a[36:39], v[204:207]
    ds_read_b64_tr_b16 a[162:163], v123 offset:18432
    v_mfma_f32_16x16x32_bf16 v[188:191], a[176:179], v[72:75], v[188:191]
    ds_read_b64_tr_b16 a[164:165], v122 offset:16384
    v_mfma_f32_16x16x32_bf16 v[196:199], a[176:179], v[76:79], v[196:199]
    s_waitcnt lgkmcnt(5)
    ds_read_b64_tr_b16 a[166:167], v122 offset:18432
    v_mfma_f32_16x16x32_bf16 v[184:187], a[180:183], v[72:75], v[184:187]
    ds_read_b64_tr_b16 a[168:169], v121 offset:16384
    v_mfma_f32_16x16x32_bf16 v[192:195], a[180:183], v[76:79], v[192:195]
    ds_read_b64_tr_b16 a[170:171], v121 offset:18432
    buffer_load_dwordx4 v1, s[56:59], s34 offen offset:3072 lds
    v_mfma_f32_16x16x32_bf16 v[172:175], a[184:187], v[72:75], v[172:175]
    ds_read_b64_tr_b16 a[172:173], v120 offset:16384
    v_mfma_f32_16x16x32_bf16 v[180:183], a[184:187], v[76:79], v[180:183]
    s_waitcnt lgkmcnt(7)
    ds_read_b64_tr_b16 a[174:175], v120 offset:18432
    v_mfma_f32_16x16x32_bf16 v[168:171], a[188:191], v[72:75], v[168:171]
    v_mfma_f32_16x16x32_bf16 v[176:179], a[188:191], v[76:79], v[176:179]
    v_mfma_f32_16x16x32_bf16 v[200:203], a[188:191], a[40:43], v[200:203]
    ds_read_b64_tr_b16 a[176:177], v127 offset:16384
    v_mfma_f32_16x16x32_bf16 v[204:207], a[188:191], a[44:47], v[204:207]
    s_waitcnt lgkmcnt(5)
    ds_read_b64_tr_b16 a[178:179], v127 offset:18432
    v_mfma_f32_16x16x32_bf16 v[188:191], a[160:163], v[80:83], v[188:191]
    ds_read_b64_tr_b16 a[180:181], v126 offset:16384
    v_mfma_f32_16x16x32_bf16 v[196:199], a[160:163], v[84:87], v[196:199]
    ds_read_b64_tr_b16 a[182:183], v126 offset:18432
    v_mfma_f32_16x16x32_bf16 v[184:187], a[164:167], v[80:83], v[184:187]
    ds_read_b64_tr_b16 a[184:185], v125 offset:16384
    v_mfma_f32_16x16x32_bf16 v[192:195], a[164:167], v[84:87], v[192:195]
    s_waitcnt lgkmcnt(5)
    ds_read_b64_tr_b16 a[186:187], v125 offset:18432
    v_mfma_f32_16x16x32_bf16 v[172:175], a[168:171], v[80:83], v[172:175]
    ds_read_b64_tr_b16 a[188:189], v124 offset:16384
    global_load_dwordx4 v[28:31], v12, s[98:99] sc1
    v_mfma_f32_16x16x32_bf16 v[180:183], a[168:171], v[84:87], v[180:183]
    ds_read_b64_tr_b16 a[190:191], v124 offset:18432
    v_mfma_f32_16x16x32_bf16 v[168:171], a[172:175], v[80:83], v[168:171]
    v_mfma_f32_16x16x32_bf16 v[176:179], a[172:175], v[84:87], v[176:179]
    s_waitcnt lgkmcnt(6)
    v_mfma_f32_16x16x32_bf16 v[200:203], a[172:175], a[48:51], v[200:203]
    s_barrier
    ds_read_b64_tr_b16 a[160:161], v115 offset:32768
    v_mfma_f32_16x16x32_bf16 v[204:207], a[172:175], a[52:55], v[204:207]
    ds_read_b64_tr_b16 a[162:163], v115 offset:34816
    v_mfma_f32_16x16x32_bf16 v[188:191], a[176:179], v[88:91], v[188:191]
    s_add_u32 m0, s29, 98304
    ds_read_b64_tr_b16 a[164:165], v114 offset:32768
    v_mfma_f32_16x16x32_bf16 v[196:199], a[176:179], v[92:95], v[196:199]
    s_waitcnt lgkmcnt(5)
    ds_read_b64_tr_b16 a[166:167], v114 offset:34816
    v_mfma_f32_16x16x32_bf16 v[184:187], a[180:183], v[88:91], v[184:187]
    s_add_u32 s34, s32, 1835648
    ds_read_b64_tr_b16 a[168:169], v113 offset:32768
    buffer_load_dwordx4 v0, s[56:59], s34 offen offset:0 lds
    v_mfma_f32_16x16x32_bf16 v[192:195], a[180:183], v[92:95], v[192:195]
    ds_read_b64_tr_b16 a[170:171], v113 offset:34816
    v_mfma_f32_16x16x32_bf16 v[172:175], a[184:187], v[88:91], v[172:175]
    ds_read_b64_tr_b16 a[172:173], v112 offset:32768
    v_mfma_f32_16x16x32_bf16 v[180:183], a[184:187], v[92:95], v[180:183]
    s_waitcnt lgkmcnt(7)
    ds_read_b64_tr_b16 a[174:175], v112 offset:34816
    v_mfma_f32_16x16x32_bf16 v[168:171], a[188:191], v[88:91], v[168:171]
    v_mfma_f32_16x16x32_bf16 v[176:179], a[188:191], v[92:95], v[176:179]
    v_mfma_f32_16x16x32_bf16 v[200:203], a[188:191], a[56:59], v[200:203]
    ds_read_b64_tr_b16 a[176:177], v119 offset:32768
    v_mfma_f32_16x16x32_bf16 v[204:207], a[188:191], a[60:63], v[204:207]
    s_waitcnt lgkmcnt(5)
    ds_read_b64_tr_b16 a[178:179], v119 offset:34816
    buffer_load_dwordx4 v1, s[56:59], s34 offen offset:1024 lds
    v_mfma_f32_16x16x32_bf16 v[188:191], a[160:163], a[192:195], v[188:191]
    ds_read_b64_tr_b16 a[180:181], v118 offset:32768
    v_mfma_f32_16x16x32_bf16 v[196:199], a[160:163], a[196:199], v[196:199]
    ds_read_b64_tr_b16 a[182:183], v118 offset:34816
    v_mfma_f32_16x16x32_bf16 v[184:187], a[164:167], a[192:195], v[184:187]
    ds_read_b64_tr_b16 a[184:185], v117 offset:32768
    v_mfma_f32_16x16x32_bf16 v[192:195], a[164:167], a[196:199], v[192:195]
    s_waitcnt lgkmcnt(5)
    ds_read_b64_tr_b16 a[186:187], v117 offset:34816
    v_mfma_f32_16x16x32_bf16 v[172:175], a[168:171], a[192:195], v[172:175]
    ds_read_b64_tr_b16 a[188:189], v116 offset:32768
    v_mfma_f32_16x16x32_bf16 v[180:183], a[168:171], a[196:199], v[180:183]
    ds_read_b64_tr_b16 a[190:191], v116 offset:34816
    v_mfma_f32_16x16x32_bf16 v[168:171], a[172:175], a[192:195], v[168:171]
    s_add_u32 s34, s34, 12288
    buffer_load_dwordx4 v0, s[56:59], s34 offen offset:2048 lds
    v_mfma_f32_16x16x32_bf16 v[176:179], a[172:175], a[196:199], v[176:179]
    s_waitcnt lgkmcnt(6)
    v_mfma_f32_16x16x32_bf16 v[200:203], a[172:175], a[64:67], v[200:203]
    ds_read_b64_tr_b16 a[160:161], v123 offset:32768
    v_mfma_f32_16x16x32_bf16 v[204:207], a[172:175], a[68:71], v[204:207]
    ds_read_b64_tr_b16 a[162:163], v123 offset:34816
    v_mfma_f32_16x16x32_bf16 v[188:191], a[176:179], a[200:203], v[188:191]
    ds_read_b64_tr_b16 a[164:165], v122 offset:32768
    v_mfma_f32_16x16x32_bf16 v[196:199], a[176:179], a[204:207], v[196:199]
    s_waitcnt lgkmcnt(5)
    ds_read_b64_tr_b16 a[166:167], v122 offset:34816
    v_mfma_f32_16x16x32_bf16 v[184:187], a[180:183], a[200:203], v[184:187]
    ds_read_b64_tr_b16 a[168:169], v121 offset:32768
    v_mfma_f32_16x16x32_bf16 v[192:195], a[180:183], a[204:207], v[192:195]
    ds_read_b64_tr_b16 a[170:171], v121 offset:34816
    buffer_load_dwordx4 v1, s[56:59], s34 offen offset:3072 lds
    v_mfma_f32_16x16x32_bf16 v[172:175], a[184:187], a[200:203], v[172:175]
    ds_read_b64_tr_b16 a[172:173], v120 offset:32768
    v_mfma_f32_16x16x32_bf16 v[180:183], a[184:187], a[204:207], v[180:183]
    s_waitcnt lgkmcnt(7)
    ds_read_b64_tr_b16 a[174:175], v120 offset:34816
    v_mfma_f32_16x16x32_bf16 v[168:171], a[188:191], a[200:203], v[168:171]
    v_mfma_f32_16x16x32_bf16 v[176:179], a[188:191], a[204:207], v[176:179]
    v_mfma_f32_16x16x32_bf16 v[200:203], a[188:191], a[72:75], v[200:203]
    ds_read_b64_tr_b16 a[176:177], v127 offset:32768
    v_mfma_f32_16x16x32_bf16 v[204:207], a[188:191], a[76:79], v[204:207]
    s_waitcnt lgkmcnt(5)
    ds_read_b64_tr_b16 a[178:179], v127 offset:34816
    v_mfma_f32_16x16x32_bf16 v[188:191], a[160:163], a[208:211], v[188:191]
    ds_read_b64_tr_b16 a[180:181], v126 offset:32768
    v_mfma_f32_16x16x32_bf16 v[196:199], a[160:163], a[212:215], v[196:199]
    ds_read_b64_tr_b16 a[182:183], v126 offset:34816
    v_mfma_f32_16x16x32_bf16 v[184:187], a[164:167], a[208:211], v[184:187]
    ds_read_b64_tr_b16 a[184:185], v125 offset:32768
    v_mfma_f32_16x16x32_bf16 v[192:195], a[164:167], a[212:215], v[192:195]
    s_waitcnt lgkmcnt(5)
    ds_read_b64_tr_b16 a[186:187], v125 offset:34816
    v_mfma_f32_16x16x32_bf16 v[172:175], a[168:171], a[208:211], v[172:175]
    ds_read_b64_tr_b16 a[188:189], v124 offset:32768
    v_mfma_f32_16x16x32_bf16 v[180:183], a[168:171], a[212:215], v[180:183]
    ds_read_b64_tr_b16 a[190:191], v124 offset:34816
    v_mfma_f32_16x16x32_bf16 v[168:171], a[172:175], a[208:211], v[168:171]
    v_mfma_f32_16x16x32_bf16 v[176:179], a[172:175], a[212:215], v[176:179]
    s_waitcnt lgkmcnt(6)
    v_mfma_f32_16x16x32_bf16 v[200:203], a[172:175], a[80:83], v[200:203]
    s_waitcnt vmcnt(26)
    s_barrier
    ds_read_b64_tr_b16 a[160:161], v115 offset:49152
    v_mfma_f32_16x16x32_bf16 v[204:207], a[172:175], a[84:87], v[204:207]
    ds_read_b64_tr_b16 a[162:163], v115 offset:51200
    v_xor_b32 v115, 0x10000, v115
    v_mfma_f32_16x16x32_bf16 v[188:191], a[176:179], a[216:219], v[188:191]
    s_add_u32 m0, s29, 114688
    ds_read_b64_tr_b16 a[164:165], v114 offset:49152
    v_mfma_f32_16x16x32_bf16 v[196:199], a[176:179], a[220:223], v[196:199]
    s_waitcnt lgkmcnt(5)
    ds_read_b64_tr_b16 a[166:167], v114 offset:51200
    v_xor_b32 v114, 0x10000, v114
    v_mfma_f32_16x16x32_bf16 v[184:187], a[180:183], a[216:219], v[184:187]
    s_add_u32 s34, s32, 1950336
    ds_read_b64_tr_b16 a[168:169], v113 offset:49152
    buffer_load_dwordx4 v0, s[56:59], s34 offen offset:0 lds
    v_mfma_f32_16x16x32_bf16 v[192:195], a[180:183], a[220:223], v[192:195]
    ds_read_b64_tr_b16 a[170:171], v113 offset:51200
    v_xor_b32 v113, 0x10000, v113
    v_mfma_f32_16x16x32_bf16 v[172:175], a[184:187], a[216:219], v[172:175]
    ds_read_b64_tr_b16 a[172:173], v112 offset:49152
    v_mfma_f32_16x16x32_bf16 v[180:183], a[184:187], a[220:223], v[180:183]
    s_waitcnt lgkmcnt(7)
    ds_read_b64_tr_b16 a[174:175], v112 offset:51200
    v_xor_b32 v112, 0x10000, v112
    v_mfma_f32_16x16x32_bf16 v[168:171], a[188:191], a[216:219], v[168:171]
    v_mfma_f32_16x16x32_bf16 v[176:179], a[188:191], a[220:223], v[176:179]
    v_mfma_f32_16x16x32_bf16 v[200:203], a[188:191], a[88:91], v[200:203]
    ds_read_b64_tr_b16 a[176:177], v119 offset:49152
    v_mfma_f32_16x16x32_bf16 v[204:207], a[188:191], a[92:95], v[204:207]
    s_waitcnt lgkmcnt(5)
    ds_read_b64_tr_b16 a[178:179], v119 offset:51200
    buffer_load_dwordx4 v1, s[56:59], s34 offen offset:1024 lds
    v_xor_b32 v119, 0x10000, v119
    v_mfma_f32_16x16x32_bf16 v[188:191], a[160:163], a[128:131], v[188:191]
    ds_read_b64_tr_b16 a[180:181], v118 offset:49152
    s_waitcnt vmcnt(6)
    v_readfirstlane_b32 s47, v29
    s_cmp_ge_u32 s47, 8
    s_cselect_b32 s22, 1146880, 0
    s_cselect_b32 s47, 1, 0
    s_mov_b32 s37, s47
    v_mfma_f32_16x16x32_bf16 v[196:199], a[160:163], a[132:135], v[196:199]
    ds_read_b64_tr_b16 a[182:183], v118 offset:51200
    v_xor_b32 v118, 0x10000, v118
    v_mfma_f32_16x16x32_bf16 v[184:187], a[164:167], a[128:131], v[184:187]
    ds_read_b64_tr_b16 a[184:185], v117 offset:49152
    v_mfma_f32_16x16x32_bf16 v[192:195], a[164:167], a[132:135], v[192:195]
    s_waitcnt lgkmcnt(5)
    ds_read_b64_tr_b16 a[186:187], v117 offset:51200
    v_xor_b32 v117, 0x10000, v117
    v_mfma_f32_16x16x32_bf16 v[172:175], a[168:171], a[128:131], v[172:175]
    ds_read_b64_tr_b16 a[188:189], v116 offset:49152
    v_mfma_f32_16x16x32_bf16 v[180:183], a[168:171], a[132:135], v[180:183]
    s_add_u32 s50, s48, 0
    ds_read_b64_tr_b16 a[190:191], v116 offset:51200
    v_xor_b32 v116, 0x10000, v116
    v_mfma_f32_16x16x32_bf16 v[168:171], a[172:175], a[128:131], v[168:171]
    s_add_u32 s34, s34, 12288
    buffer_load_dwordx4 v0, s[56:59], s34 offen offset:2048 lds
    buffer_load_dwordx4 v[208:211], v16, s[20:23], s50 offen offset:0 sc1
    v_mfma_f32_16x16x32_bf16 v[176:179], a[172:175], a[132:135], v[176:179]
    s_waitcnt lgkmcnt(6)
    v_mfma_f32_16x16x32_bf16 v[200:203], a[172:175], a[96:99], v[200:203]
    ds_read_b64_tr_b16 a[160:161], v123 offset:49152
    v_mfma_f32_16x16x32_bf16 v[204:207], a[172:175], a[100:103], v[204:207]
    ds_read_b64_tr_b16 a[162:163], v123 offset:51200
    v_xor_b32 v123, 0x10000, v123
    v_mfma_f32_16x16x32_bf16 v[188:191], a[176:179], a[136:139], v[188:191]
    ds_read_b64_tr_b16 a[164:165], v122 offset:49152
    v_mfma_f32_16x16x32_bf16 v[196:199], a[176:179], a[140:143], v[196:199]
    s_waitcnt lgkmcnt(5)
    ds_read_b64_tr_b16 a[166:167], v122 offset:51200
    v_xor_b32 v122, 0x10000, v122
    v_mfma_f32_16x16x32_bf16 v[184:187], a[180:183], a[136:139], v[184:187]
    ds_read_b64_tr_b16 a[168:169], v121 offset:49152
    v_mfma_f32_16x16x32_bf16 v[192:195], a[180:183], a[140:143], v[192:195]
    ds_read_b64_tr_b16 a[170:171], v121 offset:51200
    buffer_load_dwordx4 v1, s[56:59], s34 offen offset:3072 lds
    v_xor_b32 v121, 0x10000, v121
    v_mfma_f32_16x16x32_bf16 v[172:175], a[184:187], a[136:139], v[172:175]
    ds_read_b64_tr_b16 a[172:173], v120 offset:49152
    v_mfma_f32_16x16x32_bf16 v[180:183], a[184:187], a[140:143], v[180:183]
    s_waitcnt lgkmcnt(7)
    ds_read_b64_tr_b16 a[174:175], v120 offset:51200
    v_xor_b32 v120, 0x10000, v120
    v_mfma_f32_16x16x32_bf16 v[168:171], a[188:191], a[136:139], v[168:171]
    v_mfma_f32_16x16x32_bf16 v[176:179], a[188:191], a[140:143], v[176:179]
    v_mfma_f32_16x16x32_bf16 v[200:203], a[188:191], a[104:107], v[200:203]
    ds_read_b64_tr_b16 a[176:177], v127 offset:49152
    v_mfma_f32_16x16x32_bf16 v[204:207], a[188:191], a[108:111], v[204:207]
    s_waitcnt lgkmcnt(5)
    ds_read_b64_tr_b16 a[178:179], v127 offset:51200
    v_xor_b32 v127, 0x10000, v127
    v_mfma_f32_16x16x32_bf16 v[188:191], a[160:163], a[144:147], v[188:191]
    ds_read_b64_tr_b16 a[180:181], v126 offset:49152
    v_mfma_f32_16x16x32_bf16 v[196:199], a[160:163], a[148:151], v[196:199]
    ds_read_b64_tr_b16 a[182:183], v126 offset:51200
    v_xor_b32 v126, 0x10000, v126
    v_mfma_f32_16x16x32_bf16 v[184:187], a[164:167], a[144:147], v[184:187]
    ds_read_b64_tr_b16 a[184:185], v125 offset:49152
    v_mfma_f32_16x16x32_bf16 v[192:195], a[164:167], a[148:151], v[192:195]
    s_waitcnt lgkmcnt(5)
    ds_read_b64_tr_b16 a[186:187], v125 offset:51200
    v_xor_b32 v125, 0x10000, v125
    v_mfma_f32_16x16x32_bf16 v[172:175], a[168:171], a[144:147], v[172:175]
    ds_read_b64_tr_b16 a[188:189], v124 offset:49152
    v_mfma_f32_16x16x32_bf16 v[180:183], a[168:171], a[148:151], v[180:183]
    ds_read_b64_tr_b16 a[190:191], v124 offset:51200
    v_xor_b32 v124, 0x10000, v124
    v_mfma_f32_16x16x32_bf16 v[168:171], a[172:175], a[144:147], v[168:171]
    v_mfma_f32_16x16x32_bf16 v[176:179], a[172:175], a[148:151], v[176:179]
    s_waitcnt lgkmcnt(6)
    v_mfma_f32_16x16x32_bf16 v[200:203], a[172:175], a[112:115], v[200:203]
    s_barrier
    ds_read_b64_tr_b16 a[160:161], v115 offset:0
    v_mfma_f32_16x16x32_bf16 v[204:207], a[172:175], a[116:119], v[204:207]
    ds_read_b64_tr_b16 a[162:163], v115 offset:2048
    v_mfma_f32_16x16x32_bf16 v[188:191], a[176:179], a[152:155], v[188:191]
    s_add_u32 m0, s29, 131072
    ds_read_b64_tr_b16 a[164:165], v114 offset:0
    buffer_load_dwordx4 v[212:215], v16, s[20:23], s50 offen offset:1024 sc1
    v_mfma_f32_16x16x32_bf16 v[196:199], a[176:179], a[156:159], v[196:199]
    s_waitcnt lgkmcnt(5)
    ds_read_b64_tr_b16 a[166:167], v114 offset:2048
    v_mfma_f32_16x16x32_bf16 v[184:187], a[180:183], a[152:155], v[184:187]
    s_add_u32 s34, s32, 640
    ds_read_b64_tr_b16 a[168:169], v113 offset:0
    buffer_load_dwordx4 v0, s[56:59], s34 offen offset:0 lds
    v_mfma_f32_16x16x32_bf16 v[192:195], a[180:183], a[156:159], v[192:195]
    ds_read_b64_tr_b16 a[170:171], v113 offset:2048
    v_mfma_f32_16x16x32_bf16 v[172:175], a[184:187], a[152:155], v[172:175]
    ds_read_b64_tr_b16 a[172:173], v112 offset:0
    v_mfma_f32_16x16x32_bf16 v[180:183], a[184:187], a[156:159], v[180:183]
    s_waitcnt lgkmcnt(7)
    ds_read_b64_tr_b16 a[174:175], v112 offset:2048
    v_mfma_f32_16x16x32_bf16 v[168:171], a[188:191], a[152:155], v[168:171]
    v_mfma_f32_16x16x32_bf16 v[176:179], a[188:191], a[156:159], v[176:179]
    v_mfma_f32_16x16x32_bf16 v[200:203], a[188:191], a[120:123], v[200:203]
    ds_read_b64_tr_b16 a[176:177], v119 offset:0
    v_mfma_f32_16x16x32_bf16 v[204:207], a[188:191], a[124:127], v[204:207]
    s_waitcnt lgkmcnt(5)
    ds_read_b64_tr_b16 a[178:179], v119 offset:2048
    buffer_load_dwordx4 v1, s[56:59], s34 offen offset:1024 lds
    v_mfma_f32_16x16x32_bf16 v[148:151], a[160:163], v[32:35], 0
    ds_read_b64_tr_b16 a[180:181], v118 offset:0
    v_mfma_f32_16x16x32_bf16 v[156:159], a[160:163], v[36:39], 0
    ds_read_b64_tr_b16 a[182:183], v118 offset:2048
    v_mfma_f32_16x16x32_bf16 v[144:147], a[164:167], v[32:35], 0
    ds_read_b64_tr_b16 a[184:185], v117 offset:0
    v_mfma_f32_16x16x32_bf16 v[152:155], a[164:167], v[36:39], 0
    s_waitcnt lgkmcnt(5)
    ds_read_b64_tr_b16 a[186:187], v117 offset:2048
    v_mfma_f32_16x16x32_bf16 v[132:135], a[168:171], v[32:35], 0
    ds_read_b64_tr_b16 a[188:189], v116 offset:0
    v_mfma_f32_16x16x32_bf16 v[140:143], a[168:171], v[36:39], 0
    ds_read_b64_tr_b16 a[190:191], v116 offset:2048
    v_mfma_f32_16x16x32_bf16 v[128:131], a[172:175], v[32:35], 0
    s_add_u32 s34, s34, 12288
    buffer_load_dwordx4 v0, s[56:59], s34 offen offset:2048 lds
    v_mfma_f32_16x16x32_bf16 v[136:139], a[172:175], v[36:39], 0
    s_waitcnt lgkmcnt(6)
    v_cvt_pk_bf16_f32 v168, v168, v169
    v_cvt_pk_bf16_f32 v169, v170, v171
    v_mfma_f32_16x16x32_bf16 v[160:163], a[172:175], a[0:3], 0
    ds_read_b64_tr_b16 a[160:161], v123 offset:0
    v_cvt_pk_bf16_f32 v170, v172, v173
    v_mfma_f32_16x16x32_bf16 v[164:167], a[172:175], a[4:7], 0
    ds_read_b64_tr_b16 a[162:163], v123 offset:2048
    v_cvt_pk_bf16_f32 v171, v174, v175
    v_mfma_f32_16x16x32_bf16 v[148:151], a[176:179], v[40:43], v[148:151]
    ds_read_b64_tr_b16 a[164:165], v122 offset:0
    v_mfma_f32_16x16x32_bf16 v[156:159], a[176:179], v[44:47], v[156:159]
    s_waitcnt lgkmcnt(5)
    ds_read_b64_tr_b16 a[166:167], v122 offset:2048
    v_mfma_f32_16x16x32_bf16 v[144:147], a[180:183], v[40:43], v[144:147]
    ds_read_b64_tr_b16 a[168:169], v121 offset:0
    s_add_u32 s35, s30, 491520
    buffer_store_dwordx4 v[168:171], v16, s[8:11], s35 offen sc1
    v_mfma_f32_16x16x32_bf16 v[152:155], a[180:183], v[44:47], v[152:155]
    ds_read_b64_tr_b16 a[170:171], v121 offset:2048
    buffer_load_dwordx4 v1, s[56:59], s34 offen offset:3072 lds
    v_mfma_f32_16x16x32_bf16 v[132:135], a[184:187], v[40:43], v[132:135]
    ds_read_b64_tr_b16 a[172:173], v120 offset:0
    buffer_load_dwordx4 v[216:219], v16, s[20:23], s50 offen offset:2048 sc1
    v_mfma_f32_16x16x32_bf16 v[140:143], a[184:187], v[44:47], v[140:143]
    s_waitcnt lgkmcnt(7)
    ds_read_b64_tr_b16 a[174:175], v120 offset:2048
    v_cvt_pk_bf16_f32 v176, v176, v177
    v_mfma_f32_16x16x32_bf16 v[128:131], a[188:191], v[40:43], v[128:131]
    v_cvt_pk_bf16_f32 v177, v178, v179
    v_cvt_pk_bf16_f32 v178, v180, v181
    v_mfma_f32_16x16x32_bf16 v[136:139], a[188:191], v[44:47], v[136:139]
    v_cvt_pk_bf16_f32 v179, v182, v183
    v_mfma_f32_16x16x32_bf16 v[160:163], a[188:191], a[8:11], v[160:163]
    ds_read_b64_tr_b16 a[176:177], v127 offset:0
    v_mfma_f32_16x16x32_bf16 v[164:167], a[188:191], a[12:15], v[164:167]
    s_waitcnt lgkmcnt(5)
    ds_read_b64_tr_b16 a[178:179], v127 offset:2048
    s_add_u32 s35, s30, 507904
    buffer_store_dwordx4 v[176:179], v16, s[8:11], s35 offen sc1
    v_mfma_f32_16x16x32_bf16 v[148:151], a[160:163], v[48:51], v[148:151]
    ds_read_b64_tr_b16 a[180:181], v126 offset:0
    v_mfma_f32_16x16x32_bf16 v[156:159], a[160:163], v[52:55], v[156:159]
    ds_read_b64_tr_b16 a[182:183], v126 offset:2048
    v_mfma_f32_16x16x32_bf16 v[144:147], a[164:167], v[48:51], v[144:147]
    ds_read_b64_tr_b16 a[184:185], v125 offset:0
    v_cvt_pk_bf16_f32 v184, v184, v185
    v_mfma_f32_16x16x32_bf16 v[152:155], a[164:167], v[52:55], v[152:155]
    s_waitcnt lgkmcnt(5)
    ds_read_b64_tr_b16 a[186:187], v125 offset:2048
    v_cvt_pk_bf16_f32 v185, v186, v187
    v_mfma_f32_16x16x32_bf16 v[132:135], a[168:171], v[48:51], v[132:135]
    ds_read_b64_tr_b16 a[188:189], v124 offset:0
    v_cvt_pk_bf16_f32 v186, v188, v189
    v_mfma_f32_16x16x32_bf16 v[140:143], a[168:171], v[52:55], v[140:143]
    ds_read_b64_tr_b16 a[190:191], v124 offset:2048
    v_cvt_pk_bf16_f32 v187, v190, v191
    v_mfma_f32_16x16x32_bf16 v[128:131], a[172:175], v[48:51], v[128:131]
    s_add_u32 s35, s30, 499712
    buffer_store_dwordx4 v[184:187], v16, s[8:11], s35 offen sc1
    v_mfma_f32_16x16x32_bf16 v[136:139], a[172:175], v[52:55], v[136:139]
    s_waitcnt lgkmcnt(6)
    v_mfma_f32_16x16x32_bf16 v[160:163], a[172:175], a[16:19], v[160:163]
    s_barrier
    ds_read_b64_tr_b16 a[160:161], v115 offset:16384
    v_mfma_f32_16x16x32_bf16 v[164:167], a[172:175], a[20:23], v[164:167]
    ds_read_b64_tr_b16 a[162:163], v115 offset:18432
    v_cvt_pk_bf16_f32 v192, v192, v193
    v_mfma_f32_16x16x32_bf16 v[148:151], a[176:179], v[56:59], v[148:151]
    s_add_u32 m0, s29, 147456
    ds_read_b64_tr_b16 a[164:165], v114 offset:16384
    v_cvt_pk_bf16_f32 v193, v194, v195
    v_mfma_f32_16x16x32_bf16 v[156:159], a[176:179], v[60:63], v[156:159]
    s_waitcnt lgkmcnt(5)
    ds_read_b64_tr_b16 a[166:167], v114 offset:18432
    v_cvt_pk_bf16_f32 v194, v196, v197
    v_mfma_f32_16x16x32_bf16 v[144:147], a[180:183], v[56:59], v[144:147]
    s_add_u32 s34, s32, 115328
    ds_read_b64_tr_b16 a[168:169], v113 offset:16384
    buffer_load_dwordx4 v0, s[56:59], s34 offen offset:0 lds
    v_mfma_f32_16x16x32_bf16 v[152:155], a[180:183], v[60:63], v[152:155]
    ds_read_b64_tr_b16 a[170:171], v113 offset:18432
    v_cvt_pk_bf16_f32 v195, v198, v199
    v_mfma_f32_16x16x32_bf16 v[132:135], a[184:187], v[56:59], v[132:135]
    ds_read_b64_tr_b16 a[172:173], v112 offset:16384
    v_mfma_f32_16x16x32_bf16 v[140:143], a[184:187], v[60:63], v[140:143]
    s_waitcnt lgkmcnt(7)
    ds_read_b64_tr_b16 a[174:175], v112 offset:18432
    v_mfma_f32_16x16x32_bf16 v[128:131], a[188:191], v[56:59], v[128:131]
    s_add_u32 s35, s30, 516096
    buffer_store_dwordx4 v[192:195], v16, s[8:11], s35 offen sc1
    v_mfma_f32_16x16x32_bf16 v[136:139], a[188:191], v[60:63], v[136:139]
    v_cvt_pk_bf16_f32 v200, v200, v201
    v_mfma_f32_16x16x32_bf16 v[160:163], a[188:191], a[24:27], v[160:163]
    ds_read_b64_tr_b16 a[176:177], v119 offset:16384
    buffer_load_dwordx4 v[220:223], v16, s[20:23], s50 offen offset:3072 sc1
    v_cvt_pk_bf16_f32 v201, v202, v203
    v_mfma_f32_16x16x32_bf16 v[164:167], a[188:191], a[28:31], v[164:167]
    s_waitcnt lgkmcnt(5)
    ds_read_b64_tr_b16 a[178:179], v119 offset:18432
    buffer_load_dwordx4 v1, s[56:59], s34 offen offset:1024 lds
    v_mfma_f32_16x16x32_bf16 v[148:151], a[160:163], v[64:67], v[148:151]
    ds_read_b64_tr_b16 a[180:181], v118 offset:16384
    v_cvt_pk_bf16_f32 v202, v204, v205
    v_cvt_pk_bf16_f32 v203, v206, v207
B_stub4:
    s_cbranch_execz B_back
    v_mfma_f32_16x16x32_bf16 v[156:159], a[160:163], v[68:71], v[156:159]
    ds_read_b64_tr_b16 a[182:183], v118 offset:18432
    v_mfma_f32_16x16x32_bf16 v[144:147], a[164:167], v[64:67], v[144:147]
    ds_read_b64_tr_b16 a[184:185], v117 offset:16384
    v_mfma_f32_16x16x32_bf16 v[152:155], a[164:167], v[68:71], v[152:155]
    s_waitcnt lgkmcnt(5)
    ds_read_b64_tr_b16 a[186:187], v117 offset:18432
    s_add_u32 s35, s31, 491520
    buffer_store_dwordx4 v[200:203], v16, s[8:11], s35 offen sc1
    v_mfma_f32_16x16x32_bf16 v[132:135], a[168:171], v[64:67], v[132:135]
    ds_read_b64_tr_b16 a[188:189], v116 offset:16384
    v_mfma_f32_16x16x32_bf16 v[140:143], a[168:171], v[68:71], v[140:143]
    ds_read_b64_tr_b16 a[190:191], v116 offset:18432
    v_mfma_f32_16x16x32_bf16 v[128:131], a[172:175], v[64:67], v[128:131]
    s_add_u32 s34, s34, 12288
    buffer_load_dwordx4 v0, s[56:59], s34 offen offset:2048 lds
    v_mfma_f32_16x16x32_bf16 v[136:139], a[172:175], v[68:71], v[136:139]
    s_waitcnt lgkmcnt(6)
    v_mfma_f32_16x16x32_bf16 v[160:163], a[172:175], a[32:35], v[160:163]
    ds_read_b64_tr_b16 a[160:161], v123 offset:16384
    v_mfma_f32_16x16x32_bf16 v[164:167], a[172:175], a[36:39], v[164:167]
    ds_read_b64_tr_b16 a[162:163], v123 offset:18432
    v_mfma_f32_16x16x32_bf16 v[148:151], a[176:179], v[72:75], v[148:151]
    ds_read_b64_tr_b16 a[164:165], v122 offset:16384
    v_mfma_f32_16x16x32_bf16 v[156:159], a[176:179], v[76:79], v[156:159]
    s_waitcnt lgkmcnt(5)
    ds_read_b64_tr_b16 a[166:167], v122 offset:18432
    v_mfma_f32_16x16x32_bf16 v[144:147], a[180:183], v[72:75], v[144:147]
    ds_read_b64_tr_b16 a[168:169], v121 offset:16384
    v_mfma_f32_16x16x32_bf16 v[152:155], a[180:183], v[76:79], v[152:155]
    ds_read_b64_tr_b16 a[170:171], v121 offset:18432
    buffer_load_dwordx4 v1, s[56:59], s34 offen offset:3072 lds
    v_mfma_f32_16x16x32_bf16 v[132:135], a[184:187], v[72:75], v[132:135]
    ds_read_b64_tr_b16 a[172:173], v120 offset:16384
    v_mfma_f32_16x16x32_bf16 v[140:143], a[184:187], v[76:79], v[140:143]
    s_waitcnt lgkmcnt(7)
    ds_read_b64_tr_b16 a[174:175], v120 offset:18432
    v_mfma_f32_16x16x32_bf16 v[128:131], a[188:191], v[72:75], v[128:131]
    v_mfma_f32_16x16x32_bf16 v[136:139], a[188:191], v[76:79], v[136:139]
    v_mfma_f32_16x16x32_bf16 v[160:163], a[188:191], a[40:43], v[160:163]
    ds_read_b64_tr_b16 a[176:177], v127 offset:16384
    v_mfma_f32_16x16x32_bf16 v[164:167], a[188:191], a[44:47], v[164:167]
    s_waitcnt lgkmcnt(5)
    ds_read_b64_tr_b16 a[178:179], v127 offset:18432
    v_mfma_f32_16x16x32_bf16 v[148:151], a[160:163], v[80:83], v[148:151]
    ds_read_b64_tr_b16 a[180:181], v126 offset:16384
    v_mfma_f32_16x16x32_bf16 v[156:159], a[160:163], v[84:87], v[156:159]
    ds_read_b64_tr_b16 a[182:183], v126 offset:18432
    v_mfma_f32_16x16x32_bf16 v[144:147], a[164:167], v[80:83], v[144:147]
    s_add_u32 s50, s48, 4096
    ds_read_b64_tr_b16 a[184:185], v125 offset:16384
    buffer_load_dwordx4 v[224:227], v16, s[20:23], s50 offen offset:0 sc1
    v_mfma_f32_16x16x32_bf16 v[152:155], a[164:167], v[84:87], v[152:155]
    s_waitcnt lgkmcnt(5)
    ds_read_b64_tr_b16 a[186:187], v125 offset:18432
    v_mfma_f32_16x16x32_bf16 v[132:135], a[168:171], v[80:83], v[132:135]
    ds_read_b64_tr_b16 a[188:189], v124 offset:16384
    v_mfma_f32_16x16x32_bf16 v[140:143], a[168:171], v[84:87], v[140:143]
    ds_read_b64_tr_b16 a[190:191], v124 offset:18432
    v_mfma_f32_16x16x32_bf16 v[128:131], a[172:175], v[80:83], v[128:131]
    v_mfma_f32_16x16x32_bf16 v[136:139], a[172:175], v[84:87], v[136:139]
    s_waitcnt lgkmcnt(6)
    v_mfma_f32_16x16x32_bf16 v[160:163], a[172:175], a[48:51], v[160:163]
    s_barrier
    ds_read_b64_tr_b16 a[160:161], v115 offset:32768
    v_mfma_f32_16x16x32_bf16 v[164:167], a[172:175], a[52:55], v[164:167]
    ds_read_b64_tr_b16 a[162:163], v115 offset:34816
    v_mfma_f32_16x16x32_bf16 v[148:151], a[176:179], v[88:91], v[148:151]
    s_add_u32 m0, s29, 32768
    ds_read_b64_tr_b16 a[164:165], v114 offset:32768
    v_mfma_f32_16x16x32_bf16 v[156:159], a[176:179], v[92:95], v[156:159]
    s_waitcnt lgkmcnt(5)
    ds_read_b64_tr_b16 a[166:167], v114 offset:34816
    v_mfma_f32_16x16x32_bf16 v[144:147], a[180:183], v[88:91], v[144:147]
    s_add_u32 s34, s32, 1835776
    ds_read_b64_tr_b16 a[168:169], v113 offset:32768
    buffer_load_dwordx4 v0, s[56:59], s34 offen offset:0 lds
    v_mfma_f32_16x16x32_bf16 v[152:155], a[180:183], v[92:95], v[152:155]
    ds_read_b64_tr_b16 a[170:171], v113 offset:34816
    v_mfma_f32_16x16x32_bf16 v[132:135], a[184:187], v[88:91], v[132:135]
    ds_read_b64_tr_b16 a[172:173], v112 offset:32768
    v_mfma_f32_16x16x32_bf16 v[140:143], a[184:187], v[92:95], v[140:143]
    s_waitcnt lgkmcnt(7)
    ds_read_b64_tr_b16 a[174:175], v112 offset:34816
    v_mfma_f32_16x16x32_bf16 v[128:131], a[188:191], v[88:91], v[128:131]
    v_mfma_f32_16x16x32_bf16 v[136:139], a[188:191], v[92:95], v[136:139]
    v_mfma_f32_16x16x32_bf16 v[160:163], a[188:191], a[56:59], v[160:163]
    ds_read_b64_tr_b16 a[176:177], v119 offset:32768
    v_mfma_f32_16x16x32_bf16 v[164:167], a[188:191], a[60:63], v[164:167]
    s_waitcnt lgkmcnt(5)
    ds_read_b64_tr_b16 a[178:179], v119 offset:34816
    buffer_load_dwordx4 v1, s[56:59], s34 offen offset:1024 lds
    v_mfma_f32_16x16x32_bf16 v[148:151], a[160:163], a[192:195], v[148:151]
    ds_read_b64_tr_b16 a[180:181], v118 offset:32768
    v_mfma_f32_16x16x32_bf16 v[156:159], a[160:163], a[196:199], v[156:159]
    ds_read_b64_tr_b16 a[182:183], v118 offset:34816
    v_mfma_f32_16x16x32_bf16 v[144:147], a[164:167], a[192:195], v[144:147]
    ds_read_b64_tr_b16 a[184:185], v117 offset:32768
    v_mfma_f32_16x16x32_bf16 v[152:155], a[164:167], a[196:199], v[152:155]
    s_waitcnt lgkmcnt(5)
    ds_read_b64_tr_b16 a[186:187], v117 offset:34816
    v_mfma_f32_16x16x32_bf16 v[132:135], a[168:171], a[192:195], v[132:135]
    ds_read_b64_tr_b16 a[188:189], v116 offset:32768
    v_mfma_f32_16x16x32_bf16 v[140:143], a[168:171], a[196:199], v[140:143]
    ds_read_b64_tr_b16 a[190:191], v116 offset:34816
    v_mfma_f32_16x16x32_bf16 v[128:131], a[172:175], a[192:195], v[128:131]
    s_add_u32 s34, s34, 12288
    buffer_load_dwordx4 v0, s[56:59], s34 offen offset:2048 lds
    buffer_load_dwordx4 v[228:231], v16, s[20:23], s50 offen offset:1024 sc1
    v_mfma_f32_16x16x32_bf16 v[136:139], a[172:175], a[196:199], v[136:139]
    s_waitcnt lgkmcnt(6)
    v_mfma_f32_16x16x32_bf16 v[160:163], a[172:175], a[64:67], v[160:163]
    ds_read_b64_tr_b16 a[160:161], v123 offset:32768
    v_mfma_f32_16x16x32_bf16 v[164:167], a[172:175], a[68:71], v[164:167]
    ds_read_b64_tr_b16 a[162:163], v123 offset:34816
    v_mfma_f32_16x16x32_bf16 v[148:151], a[176:179], a[200:203], v[148:151]
    ds_read_b64_tr_b16 a[164:165], v122 offset:32768
    v_mfma_f32_16x16x32_bf16 v[156:159], a[176:179], a[204:207], v[156:159]
    s_waitcnt lgkmcnt(5)
    ds_read_b64_tr_b16 a[166:167], v122 offset:34816
    v_mfma_f32_16x16x32_bf16 v[144:147], a[180:183], a[200:203], v[144:147]
    ds_read_b64_tr_b16 a[168:169], v121 offset:32768
    v_mfma_f32_16x16x32_bf16 v[152:155], a[180:183], a[204:207], v[152:155]
    ds_read_b64_tr_b16 a[170:171], v121 offset:34816
    buffer_load_dwordx4 v1, s[56:59], s34 offen offset:3072 lds
    v_mfma_f32_16x16x32_bf16 v[132:135], a[184:187], a[200:203], v[132:135]
    ds_read_b64_tr_b16 a[172:173], v120 offset:32768
    v_mfma_f32_16x16x32_bf16 v[140:143], a[184:187], a[204:207], v[140:143]
    s_waitcnt lgkmcnt(7)
    ds_read_b64_tr_b16 a[174:175], v120 offset:34816
    v_mfma_f32_16x16x32_bf16 v[128:131], a[188:191], a[200:203], v[128:131]
    v_mfma_f32_16x16x32_bf16 v[136:139], a[188:191], a[204:207], v[136:139]
    v_mfma_f32_16x16x32_bf16 v[160:163], a[188:191], a[72:75], v[160:163]
    ds_read_b64_tr_b16 a[176:177], v127 offset:32768
    v_mfma_f32_16x16x32_bf16 v[164:167], a[188:191], a[76:79], v[164:167]
    s_waitcnt lgkmcnt(5)
    ds_read_b64_tr_b16 a[178:179], v127 offset:34816
    v_mfma_f32_16x16x32_bf16 v[148:151], a[160:163], a[208:211], v[148:151]
    ds_read_b64_tr_b16 a[180:181], v126 offset:32768
    v_mfma_f32_16x16x32_bf16 v[156:159], a[160:163], a[212:215], v[156:159]
    ds_read_b64_tr_b16 a[182:183], v126 offset:34816
    v_mfma_f32_16x16x32_bf16 v[144:147], a[164:167], a[208:211], v[144:147]
    ds_read_b64_tr_b16 a[184:185], v125 offset:32768
    v_mfma_f32_16x16x32_bf16 v[152:155], a[164:167], a[212:215], v[152:155]
    s_waitcnt lgkmcnt(5)
    ds_read_b64_tr_b16 a[186:187], v125 offset:34816
    v_mfma_f32_16x16x32_bf16 v[132:135], a[168:171], a[208:211], v[132:135]
    ds_read_b64_tr_b16 a[188:189], v124 offset:32768
    v_mfma_f32_16x16x32_bf16 v[140:143], a[168:171], a[212:215], v[140:143]
    ds_read_b64_tr_b16 a[190:191], v124 offset:34816
    v_mfma_f32_16x16x32_bf16 v[128:131], a[172:175], a[208:211], v[128:131]
    v_mfma_f32_16x16x32_bf16 v[136:139], a[172:175], a[212:215], v[136:139]
    s_waitcnt lgkmcnt(6)
    v_mfma_f32_16x16x32_bf16 v[160:163], a[172:175], a[80:83], v[160:163]
    s_waitcnt vmcnt(8)
    s_barrier
    ds_read_b64_tr_b16 a[160:161], v115 offset:49152
    v_mfma_f32_16x16x32_bf16 v[164:167], a[172:175], a[84:87], v[164:167]
    ds_read_b64_tr_b16 a[162:163], v115 offset:51200
    v_xor_b32 v115, 0x10000, v115
    s_cmp_lg_u32 s28, 0
    s_cbranch_scc1 L_nosig2
    s_mov_b64 exec, 1
    global_atomic_add v12, v13, s[98:99] offset:8 sc1
    s_mov_b64 exec, -1
L_nosig2:
    v_mfma_f32_16x16x32_bf16 v[148:151], a[176:179], a[216:219], v[148:151]
    s_add_u32 m0, s29, 49152
    ds_read_b64_tr_b16 a[164:165], v114 offset:49152
    buffer_load_dwordx4 v[232:235], v16, s[20:23], s50 offen offset:2048 sc1
    v_mfma_f32_16x16x32_bf16 v[156:159], a[176:179], a[220:223], v[156:159]
    s_waitcnt lgkmcnt(5)
    ds_read_b64_tr_b16 a[166:167], v114 offset:51200
    v_xor_b32 v114, 0x10000, v114
    v_mfma_f32_16x16x32_bf16 v[144:147], a[180:183], a[216:219], v[144:147]
    s_add_u32 s34, s32, 1950464
    ds_read_b64_tr_b16 a[168:169], v113 offset:49152
    buffer_load_dwordx4 v0, s[56:59], s34 offen offset:0 lds
    v_mfma_f32_16x16x32_bf16 v[152:155], a[180:183], a[220:223], v[152:155]
    ds_read_b64_tr_b16 a[170:171], v113 offset:51200
    v_xor_b32 v113, 0x10000, v113
    v_mfma_f32_16x16x32_bf16 v[132:135], a[184:187], a[216:219], v[132:135]
    ds_read_b64_tr_b16 a[172:173], v112 offset:49152
    v_mfma_f32_16x16x32_bf16 v[140:143], a[184:187], a[220:223], v[140:143]
    s_waitcnt lgkmcnt(7)
    ds_read_b64_tr_b16 a[174:175], v112 offset:51200
    v_xor_b32 v112, 0x10000, v112
    v_mfma_f32_16x16x32_bf16 v[128:131], a[188:191], a[216:219], v[128:131]
    v_mfma_f32_16x16x32_bf16 v[136:139], a[188:191], a[220:223], v[136:139]
    v_mfma_f32_16x16x32_bf16 v[160:163], a[188:191], a[88:91], v[160:163]
    ds_read_b64_tr_b16 a[176:177], v119 offset:49152
    v_mfma_f32_16x16x32_bf16 v[164:167], a[188:191], a[92:95], v[164:167]
    s_waitcnt lgkmcnt(5)
    ds_read_b64_tr_b16 a[178:179], v119 offset:51200
    buffer_load_dwordx4 v1, s[56:59], s34 offen offset:1024 lds
    v_xor_b32 v119, 0x10000, v119
    v_mfma_f32_16x16x32_bf16 v[148:151], a[160:163], a[128:131], v[148:151]
    ds_read_b64_tr_b16 a[180:181], v118 offset:49152
    v_mfma_f32_16x16x32_bf16 v[156:159], a[160:163], a[132:135], v[156:159]
    ds_read_b64_tr_b16 a[182:183], v118 offset:51200
    v_xor_b32 v118, 0x10000, v118
    v_mfma_f32_16x16x32_bf16 v[144:147], a[164:167], a[128:131], v[144:147]
    ds_read_b64_tr_b16 a[184:185], v117 offset:49152
    v_mfma_f32_16x16x32_bf16 v[152:155], a[164:167], a[132:135], v[152:155]
    s_waitcnt lgkmcnt(5)
    ds_read_b64_tr_b16 a[186:187], v117 offset:51200
    v_xor_b32 v117, 0x10000, v117
    v_mfma_f32_16x16x32_bf16 v[132:135], a[168:171], a[128:131], v[132:135]
    ds_read_b64_tr_b16 a[188:189], v116 offset:49152
    v_mfma_f32_16x16x32_bf16 v[140:143], a[168:171], a[132:135], v[140:143]
    ds_read_b64_tr_b16 a[190:191], v116 offset:51200
    v_xor_b32 v116, 0x10000, v116
    v_mfma_f32_16x16x32_bf16 v[128:131], a[172:175], a[128:131], v[128:131]
    s_add_u32 s34, s34, 12288
    buffer_load_dwordx4 v0, s[56:59], s34 offen offset:2048 lds
    v_mfma_f32_16x16x32_bf16 v[136:139], a[172:175], a[132:135], v[136:139]
    s_waitcnt lgkmcnt(6)
    v_mfma_f32_16x16x32_bf16 v[160:163], a[172:175], a[96:99], v[160:163]
    ds_read_b64_tr_b16 a[160:161], v123 offset:49152
    v_mfma_f32_16x16x32_bf16 v[164:167], a[172:175], a[100:103], v[164:167]
    ds_read_b64_tr_b16 a[162:163], v123 offset:51200
    v_xor_b32 v123, 0x10000, v123
    v_mfma_f32_16x16x32_bf16 v[148:151], a[176:179], a[136:139], v[148:151]
    ds_read_b64_tr_b16 a[164:165], v122 offset:49152
    v_mfma_f32_16x16x32_bf16 v[156:159], a[176:179], a[140:143], v[156:159]
    s_waitcnt lgkmcnt(5)
    ds_read_b64_tr_b16 a[166:167], v122 offset:51200
    v_xor_b32 v122, 0x10000, v122
    v_mfma_f32_16x16x32_bf16 v[144:147], a[180:183], a[136:139], v[144:147]
    ds_read_b64_tr_b16 a[168:169], v121 offset:49152
    v_mfma_f32_16x16x32_bf16 v[152:155], a[180:183], a[140:143], v[152:155]
    ds_read_b64_tr_b16 a[170:171], v121 offset:51200
    buffer_load_dwordx4 v1, s[56:59], s34 offen offset:3072 lds
    v_xor_b32 v121, 0x10000, v121
    v_mfma_f32_16x16x32_bf16 v[132:135], a[184:187], a[136:139], v[132:135]
    ds_read_b64_tr_b16 a[172:173], v120 offset:49152
    buffer_load_dwordx4 v[236:239], v16, s[20:23], s50 offen offset:3072 sc1
    v_mfma_f32_16x16x32_bf16 v[140:143], a[184:187], a[140:143], v[140:143]
    s_waitcnt lgkmcnt(7)
    ds_read_b64_tr_b16 a[174:175], v120 offset:51200
    v_xor_b32 v120, 0x10000, v120
    v_mfma_f32_16x16x32_bf16 v[128:131], a[188:191], a[136:139], v[128:131]
    v_mfma_f32_16x16x32_bf16 v[136:139], a[188:191], a[140:143], v[136:139]
    v_mfma_f32_16x16x32_bf16 v[160:163], a[188:191], a[104:107], v[160:163]
    ds_read_b64_tr_b16 a[176:177], v127 offset:49152
    v_mfma_f32_16x16x32_bf16 v[164:167], a[188:191], a[108:111], v[164:167]
    s_waitcnt lgkmcnt(5)
    ds_read_b64_tr_b16 a[178:179], v127 offset:51200
    v_xor_b32 v127, 0x10000, v127
    v_mfma_f32_16x16x32_bf16 v[148:151], a[160:163], a[144:147], v[148:151]
    ds_read_b64_tr_b16 a[180:181], v126 offset:49152
    v_mfma_f32_16x16x32_bf16 v[156:159], a[160:163], a[148:151], v[156:159]
    ds_read_b64_tr_b16 a[182:183], v126 offset:51200
    v_xor_b32 v126, 0x10000, v126
    v_mfma_f32_16x16x32_bf16 v[144:147], a[164:167], a[144:147], v[144:147]
    ds_read_b64_tr_b16 a[184:185], v125 offset:49152
    v_mfma_f32_16x16x32_bf16 v[152:155], a[164:167], a[148:151], v[152:155]
    s_waitcnt lgkmcnt(5)
    ds_read_b64_tr_b16 a[186:187], v125 offset:51200
    v_xor_b32 v125, 0x10000, v125
    v_mfma_f32_16x16x32_bf16 v[132:135], a[168:171], a[144:147], v[132:135]
    ds_read_b64_tr_b16 a[188:189], v124 offset:49152
    v_mfma_f32_16x16x32_bf16 v[140:143], a[168:171], a[148:151], v[140:143]
    ds_read_b64_tr_b16 a[190:191], v124 offset:51200
    v_xor_b32 v124, 0x10000, v124
    v_mfma_f32_16x16x32_bf16 v[128:131], a[172:175], a[144:147], v[128:131]
    v_mfma_f32_16x16x32_bf16 v[136:139], a[172:175], a[148:151], v[136:139]
    s_waitcnt lgkmcnt(6)
    v_mfma_f32_16x16x32_bf16 v[160:163], a[172:175], a[112:115], v[160:163]
    s_barrier
    ds_read_b64_tr_b16 a[160:161], v115 offset:0
    v_mfma_f32_16x16x32_bf16 v[164:167], a[172:175], a[116:119], v[164:167]
    ds_read_b64_tr_b16 a[162:163], v115 offset:2048
    v_mfma_f32_16x16x32_bf16 v[148:151], a[176:179], a[152:155], v[148:151]
    s_add_u32 m0, s29, 65536
    ds_read_b64_tr_b16 a[164:165], v114 offset:0
    v_mfma_f32_16x16x32_bf16 v[156:159], a[176:179], a[156:159], v[156:159]
    s_waitcnt lgkmcnt(5)
    ds_read_b64_tr_b16 a[166:167], v114 offset:2048
    v_mfma_f32_16x16x32_bf16 v[144:147], a[180:183], a[152:155], v[144:147]
    s_add_u32 s34, s32, 768
    ds_read_b64_tr_b16 a[168:169], v113 offset:0
    buffer_load_dwordx4 v0, s[56:59], s34 offen offset:0 lds
    v_mfma_f32_16x16x32_bf16 v[152:155], a[180:183], a[156:159], v[152:155]
    ds_read_b64_tr_b16 a[170:171], v113 offset:2048
    v_mfma_f32_16x16x32_bf16 v[132:135], a[184:187], a[152:155], v[132:135]
    ds_read_b64_tr_b16 a[172:173], v112 offset:0
    v_mfma_f32_16x16x32_bf16 v[140:143], a[184:187], a[156:159], v[140:143]
    s_waitcnt lgkmcnt(7)
    ds_read_b64_tr_b16 a[174:175], v112 offset:2048
    v_mfma_f32_16x16x32_bf16 v[128:131], a[188:191], a[152:155], v[128:131]
    v_mfma_f32_16x16x32_bf16 v[136:139], a[188:191], a[156:159], v[136:139]
    v_mfma_f32_16x16x32_bf16 v[160:163], a[188:191], a[120:123], v[160:163]
    ds_read_b64_tr_b16 a[176:177], v119 offset:0
    v_mfma_f32_16x16x32_bf16 v[164:167], a[188:191], a[124:127], v[164:167]
    s_waitcnt lgkmcnt(5)
    ds_read_b64_tr_b16 a[178:179], v119 offset:2048
    buffer_load_dwordx4 v1, s[56:59], s34 offen offset:1024 lds
    v_mfma_f32_16x16x32_bf16 v[188:191], a[160:163], v[32:35], 0
    ds_read_b64_tr_b16 a[180:181], v118 offset:0
    v_mfma_f32_16x16x32_bf16 v[196:199], a[160:163], v[36:39], 0
    ds_read_b64_tr_b16 a[182:183], v118 offset:2048
    v_mfma_f32_16x16x32_bf16 v[184:187], a[164:167], v[32:35], 0
    ds_read_b64_tr_b16 a[184:185], v117 offset:0
    v_mfma_f32_16x16x32_bf16 v[192:195], a[164:167], v[36:39], 0
    s_waitcnt lgkmcnt(5)
    ds_read_b64_tr_b16 a[186:187], v117 offset:2048
    v_mfma_f32_16x16x32_bf16 v[172:175], a[168:171], v[32:35], 0
    ds_read_b64_tr_b16 a[188:189], v116 offset:0
    v_mfma_f32_16x16x32_bf16 v[180:183], a[168:171], v[36:39], 0
    ds_read_b64_tr_b16 a[190:191], v116 offset:2048
    v_mfma_f32_16x16x32_bf16 v[168:171], a[172:175], v[32:35], 0
    s_add_u32 s34, s34, 12288
    buffer_load_dwordx4 v0, s[56:59], s34 offen offset:2048 lds
    v_mfma_f32_16x16x32_bf16 v[176:179], a[172:175], v[36:39], 0
    s_waitcnt lgkmcnt(6)
    v_cvt_pk_bf16_f32 v128, v128, v129
    v_cvt_pk_bf16_f32 v129, v130, v131
    v_mfma_f32_16x16x32_bf16 v[200:203], a[172:175], a[0:3], 0
    ds_read_b64_tr_b16 a[160:161], v123 offset:0
    v_cvt_pk_bf16_f32 v130, v132, v133
    v_mfma_f32_16x16x32_bf16 v[204:207], a[172:175], a[4:7], 0
    ds_read_b64_tr_b16 a[162:163], v123 offset:2048
    v_cvt_pk_bf16_f32 v131, v134, v135
    v_mfma_f32_16x16x32_bf16 v[188:191], a[176:179], v[40:43], v[188:191]
    ds_read_b64_tr_b16 a[164:165], v122 offset:0
    v_mfma_f32_16x16x32_bf16 v[196:199], a[176:179], v[44:47], v[196:199]
    s_waitcnt lgkmcnt(5)
    ds_read_b64_tr_b16 a[166:167], v122 offset:2048
    v_mfma_f32_16x16x32_bf16 v[184:187], a[180:183], v[40:43], v[184:187]
    ds_read_b64_tr_b16 a[168:169], v121 offset:0
    s_add_u32 s35, s30, 655360
    buffer_store_dwordx4 v[128:131], v16, s[8:11], s35 offen sc1
    v_mfma_f32_16x16x32_bf16 v[192:195], a[180:183], v[44:47], v[192:195]
    ds_read_b64_tr_b16 a[170:171], v121 offset:2048
    buffer_load_dwordx4 v1, s[56:59], s34 offen offset:3072 lds
    v_mfma_f32_16x16x32_bf16 v[172:175], a[184:187], v[40:43], v[172:175]
    ds_read_b64_tr_b16 a[172:173], v120 offset:0
    v_mfma_f32_16x16x32_bf16 v[180:183], a[184:187], v[44:47], v[180:183]
    s_waitcnt lgkmcnt(7)
    ds_read_b64_tr_b16 a[174:175], v120 offset:2048
    v_cvt_pk_bf16_f32 v136, v136, v137
    v_mfma_f32_16x16x32_bf16 v[168:171], a[188:191], v[40:43], v[168:171]
    v_cvt_pk_bf16_f32 v137, v138, v139
    v_cvt_pk_bf16_f32 v138, v140, v141
    v_mfma_f32_16x16x32_bf16 v[176:179], a[188:191], v[44:47], v[176:179]
    v_cvt_pk_bf16_f32 v139, v142, v143
    v_mfma_f32_16x16x32_bf16 v[200:203], a[188:191], a[8:11], v[200:203]
    ds_read_b64_tr_b16 a[176:177], v127 offset:0
    v_mfma_f32_16x16x32_bf16 v[204:207], a[188:191], a[12:15], v[204:207]
    s_waitcnt lgkmcnt(5)
    ds_read_b64_tr_b16 a[178:179], v127 offset:2048
    s_add_u32 s35, s30, 671744
    buffer_store_dwordx4 v[136:139], v16, s[8:11], s35 offen sc1
    v_mfma_f32_16x16x32_bf16 v[188:191], a[160:163], v[48:51], v[188:191]
    ds_read_b64_tr_b16 a[180:181], v126 offset:0
    v_mfma_f32_16x16x32_bf16 v[196:199], a[160:163], v[52:55], v[196:199]
    ds_read_b64_tr_b16 a[182:183], v126 offset:2048
    v_mfma_f32_16x16x32_bf16 v[184:187], a[164:167], v[48:51], v[184:187]
    ds_read_b64_tr_b16 a[184:185], v125 offset:0
    v_cvt_pk_bf16_f32 v144, v144, v145
    v_mfma_f32_16x16x32_bf16 v[192:195], a[164:167], v[52:55], v[192:195]
    s_waitcnt lgkmcnt(5)
    ds_read_b64_tr_b16 a[186:187], v125 offset:2048
    v_cvt_pk_bf16_f32 v145, v146, v147
    v_mfma_f32_16x16x32_bf16 v[172:175], a[168:171], v[48:51], v[172:175]
    ds_read_b64_tr_b16 a[188:189], v124 offset:0
    v_cvt_pk_bf16_f32 v146, v148, v149
    v_mfma_f32_16x16x32_bf16 v[180:183], a[168:171], v[52:55], v[180:183]
    ds_read_b64_tr_b16 a[190:191], v124 offset:2048
    v_cvt_pk_bf16_f32 v147, v150, v151
    v_mfma_f32_16x16x32_bf16 v[168:171], a[172:175], v[48:51], v[168:171]
    s_add_u32 s35, s30, 663552
    buffer_store_dwordx4 v[144:147], v16, s[8:11], s35 offen sc1
    v_mfma_f32_16x16x32_bf16 v[176:179], a[172:175], v[52:55], v[176:179]
    s_waitcnt lgkmcnt(6)
    v_mfma_f32_16x16x32_bf16 v[200:203], a[172:175], a[16:19], v[200:203]
    s_barrier
    ds_read_b64_tr_b16 a[160:161], v115 offset:16384
    v_mfma_f32_16x16x32_bf16 v[204:207], a[172:175], a[20:23], v[204:207]
    ds_read_b64_tr_b16 a[162:163], v115 offset:18432
    v_cvt_pk_bf16_f32 v152, v152, v153
    v_mfma_f32_16x16x32_bf16 v[188:191], a[176:179], v[56:59], v[188:191]
    s_add_u32 m0, s29, 81920
    ds_read_b64_tr_b16 a[164:165], v114 offset:16384
    v_cvt_pk_bf16_f32 v153, v154, v155
    v_mfma_f32_16x16x32_bf16 v[196:199], a[176:179], v[60:63], v[196:199]
    s_waitcnt lgkmcnt(5)
    ds_read_b64_tr_b16 a[166:167], v114 offset:18432
    v_cvt_pk_bf16_f32 v154, v156, v157
    v_mfma_f32_16x16x32_bf16 v[184:187], a[180:183], v[56:59], v[184:187]
    s_add_u32 s34, s32, 115456
    ds_read_b64_tr_b16 a[168:169], v113 offset:16384
    buffer_load_dwordx4 v0, s[56:59], s34 offen offset:0 lds
    v_mfma_f32_16x16x32_bf16 v[192:195], a[180:183], v[60:63], v[192:195]
    ds_read_b64_tr_b16 a[170:171], v113 offset:18432
    v_cvt_pk_bf16_f32 v155, v158, v159
    v_mfma_f32_16x16x32_bf16 v[172:175], a[184:187], v[56:59], v[172:175]
    ds_read_b64_tr_b16 a[172:173], v112 offset:16384
    v_mfma_f32_16x16x32_bf16 v[180:183], a[184:187], v[60:63], v[180:183]
    s_waitcnt lgkmcnt(7)
    ds_read_b64_tr_b16 a[174:175], v112 offset:18432
    v_mfma_f32_16x16x32_bf16 v[168:171], a[188:191], v[56:59], v[168:171]
    s_add_u32 s35, s30, 679936
    buffer_store_dwordx4 v[152:155], v16, s[8:11], s35 offen sc1
    v_mfma_f32_16x16x32_bf16 v[176:179], a[188:191], v[60:63], v[176:179]
    v_cvt_pk_bf16_f32 v160, v160, v161
    v_mfma_f32_16x16x32_bf16 v[200:203], a[188:191], a[24:27], v[200:203]
    ds_read_b64_tr_b16 a[176:177], v119 offset:16384
    v_cvt_pk_bf16_f32 v161, v162, v163
    v_mfma_f32_16x16x32_bf16 v[204:207], a[188:191], a[28:31], v[204:207]
    s_waitcnt lgkmcnt(5)
    ds_read_b64_tr_b16 a[178:179], v119 offset:18432
    buffer_load_dwordx4 v1, s[56:59], s34 offen offset:1024 lds
    v_mfma_f32_16x16x32_bf16 v[188:191], a[160:163], v[64:67], v[188:191]
    ds_read_b64_tr_b16 a[180:181], v118 offset:16384
    v_cvt_pk_bf16_f32 v162, v164, v165
    v_cvt_pk_bf16_f32 v163, v166, v167
    v_mfma_f32_16x16x32_bf16 v[196:199], a[160:163], v[68:71], v[196:199]
    ds_read_b64_tr_b16 a[182:183], v118 offset:18432
    v_mfma_f32_16x16x32_bf16 v[184:187], a[164:167], v[64:67], v[184:187]
    ds_read_b64_tr_b16 a[184:185], v117 offset:16384
    v_mfma_f32_16x16x32_bf16 v[192:195], a[164:167], v[68:71], v[192:195]
    s_waitcnt lgkmcnt(5)
    ds_read_b64_tr_b16 a[186:187], v117 offset:18432
    s_add_u32 s35, s31, 655360
    buffer_store_dwordx4 v[160:163], v16, s[8:11], s35 offen sc1
    v_mfma_f32_16x16x32_bf16 v[172:175], a[168:171], v[64:67], v[172:175]
    ds_read_b64_tr_b16 a[188:189], v116 offset:16384
    global_load_dwordx4 v[28:31], v12, s[98:99] sc1
    v_mfma_f32_16x16x32_bf16 v[180:183], a[168:171], v[68:71], v[180:183]
    ds_read_b64_tr_b16 a[190:191], v116 offset:18432
    v_mfma_f32_16x16x32_bf16 v[168:171], a[172:175], v[64:67], v[168:171]
    s_add_u32 s34, s34, 12288
    buffer_load_dwordx4 v0, s[56:59], s34 offen offset:2048 lds
    v_mfma_f32_16x16x32_bf16 v[176:179], a[172:175], v[68:71], v[176:179]
    s_waitcnt lgkmcnt(6)
    v_mfma_f32_16x16x32_bf16 v[200:203], a[172:175], a[32:35], v[200:203]
    ds_read_b64_tr_b16 a[160:161], v123 offset:16384
    v_mfma_f32_16x16x32_bf16 v[204:207], a[172:175], a[36:39], v[204:207]
    ds_read_b64_tr_b16 a[162:163], v123 offset:18432
    v_mfma_f32_16x16x32_bf16 v[188:191], a[176:179], v[72:75], v[188:191]
    ds_read_b64_tr_b16 a[164:165], v122 offset:16384
    v_mfma_f32_16x16x32_bf16 v[196:199], a[176:179], v[76:79], v[196:199]
    s_waitcnt lgkmcnt(5)
    ds_read_b64_tr_b16 a[166:167], v122 offset:18432
    v_mfma_f32_16x16x32_bf16 v[184:187], a[180:183], v[72:75], v[184:187]
    ds_read_b64_tr_b16 a[168:169], v121 offset:16384
    v_mfma_f32_16x16x32_bf16 v[192:195], a[180:183], v[76:79], v[192:195]
    ds_read_b64_tr_b16 a[170:171], v121 offset:18432
    buffer_load_dwordx4 v1, s[56:59], s34 offen offset:3072 lds
    v_mfma_f32_16x16x32_bf16 v[172:175], a[184:187], v[72:75], v[172:175]
    ds_read_b64_tr_b16 a[172:173], v120 offset:16384
    v_mfma_f32_16x16x32_bf16 v[180:183], a[184:187], v[76:79], v[180:183]
    s_waitcnt lgkmcnt(7)
    ds_read_b64_tr_b16 a[174:175], v120 offset:18432
    v_mfma_f32_16x16x32_bf16 v[168:171], a[188:191], v[72:75], v[168:171]
    v_mfma_f32_16x16x32_bf16 v[176:179], a[188:191], v[76:79], v[176:179]
    v_mfma_f32_16x16x32_bf16 v[200:203], a[188:191], a[40:43], v[200:203]
    ds_read_b64_tr_b16 a[176:177], v127 offset:16384
    v_mfma_f32_16x16x32_bf16 v[204:207], a[188:191], a[44:47], v[204:207]
    s_waitcnt lgkmcnt(5)
    ds_read_b64_tr_b16 a[178:179], v127 offset:18432
    v_mfma_f32_16x16x32_bf16 v[188:191], a[160:163], v[80:83], v[188:191]
    ds_read_b64_tr_b16 a[180:181], v126 offset:16384
    v_mfma_f32_16x16x32_bf16 v[196:199], a[160:163], v[84:87], v[196:199]
    ds_read_b64_tr_b16 a[182:183], v126 offset:18432
    v_mfma_f32_16x16x32_bf16 v[184:187], a[164:167], v[80:83], v[184:187]
    ds_read_b64_tr_b16 a[184:185], v125 offset:16384
    v_mfma_f32_16x16x32_bf16 v[192:195], a[164:167], v[84:87], v[192:195]
    s_waitcnt lgkmcnt(5)
    ds_read_b64_tr_b16 a[186:187], v125 offset:18432
    v_mfma_f32_16x16x32_bf16 v[172:175], a[168:171], v[80:83], v[172:175]
    ds_read_b64_tr_b16 a[188:189], v124 offset:16384
    v_mfma_f32_16x16x32_bf16 v[180:183], a[168:171], v[84:87], v[180:183]
    ds_read_b64_tr_b16 a[190:191], v124 offset:18432
    v_mfma_f32_16x16x32_bf16 v[168:171], a[172:175], v[80:83], v[168:171]
    v_mfma_f32_16x16x32_bf16 v[176:179], a[172:175], v[84:87], v[176:179]
    s_waitcnt lgkmcnt(6)
    v_mfma_f32_16x16x32_bf16 v[200:203], a[172:175], a[48:51], v[200:203]
    s_barrier
    ds_read_b64_tr_b16 a[160:161], v115 offset:32768
    v_mfma_f32_16x16x32_bf16 v[204:207], a[172:175], a[52:55], v[204:207]
    ds_read_b64_tr_b16 a[162:163], v115 offset:34816
    v_mfma_f32_16x16x32_bf16 v[188:191], a[176:179], v[88:91], v[188:191]
    ds_read_b64_tr_b16 a[164:165], v114 offset:32768
    v_mfma_f32_16x16x32_bf16 v[196:199], a[176:179], v[92:95], v[196:199]
    s_waitcnt lgkmcnt(5)
    ds_read_b64_tr_b16 a[166:167], v114 offset:34816
    v_mfma_f32_16x16x32_bf16 v[184:187], a[180:183], v[88:91], v[184:187]
    ds_read_b64_tr_b16 a[168:169], v113 offset:32768
    v_mfma_f32_16x16x32_bf16 v[192:195], a[180:183], v[92:95], v[192:195]
    ds_read_b64_tr_b16 a[170:171], v113 offset:34816
    v_mfma_f32_16x16x32_bf16 v[172:175], a[184:187], v[88:91], v[172:175]
    ds_read_b64_tr_b16 a[172:173], v112 offset:32768
    v_mfma_f32_16x16x32_bf16 v[180:183], a[184:187], v[92:95], v[180:183]
    s_waitcnt lgkmcnt(7)
    ds_read_b64_tr_b16 a[174:175], v112 offset:34816
    v_mfma_f32_16x16x32_bf16 v[168:171], a[188:191], v[88:91], v[168:171]
    v_mfma_f32_16x16x32_bf16 v[176:179], a[188:191], v[92:95], v[176:179]
    v_mfma_f32_16x16x32_bf16 v[200:203], a[188:191], a[56:59], v[200:203]
    ds_read_b64_tr_b16 a[176:177], v119 offset:32768
    v_mfma_f32_16x16x32_bf16 v[204:207], a[188:191], a[60:63], v[204:207]
    s_waitcnt lgkmcnt(5)
    ds_read_b64_tr_b16 a[178:179], v119 offset:34816
    v_mfma_f32_16x16x32_bf16 v[188:191], a[160:163], a[192:195], v[188:191]
    ds_read_b64_tr_b16 a[180:181], v118 offset:32768
    v_mfma_f32_16x16x32_bf16 v[196:199], a[160:163], a[196:199], v[196:199]
    ds_read_b64_tr_b16 a[182:183], v118 offset:34816
    v_mfma_f32_16x16x32_bf16 v[184:187], a[164:167], a[192:195], v[184:187]
    ds_read_b64_tr_b16 a[184:185], v117 offset:32768
    v_mfma_f32_16x16x32_bf16 v[192:195], a[164:167], a[196:199], v[192:195]
    s_waitcnt lgkmcnt(5)
    ds_read_b64_tr_b16 a[186:187], v117 offset:34816
    v_mfma_f32_16x16x32_bf16 v[172:175], a[168:171], a[192:195], v[172:175]
    ds_read_b64_tr_b16 a[188:189], v116 offset:32768
    v_mfma_f32_16x16x32_bf16 v[180:183], a[168:171], a[196:199], v[180:183]
    ds_read_b64_tr_b16 a[190:191], v116 offset:34816
    v_mfma_f32_16x16x32_bf16 v[168:171], a[172:175], a[192:195], v[168:171]
    v_mfma_f32_16x16x32_bf16 v[176:179], a[172:175], a[196:199], v[176:179]
    s_waitcnt lgkmcnt(6)
    v_mfma_f32_16x16x32_bf16 v[200:203], a[172:175], a[64:67], v[200:203]
    ds_read_b64_tr_b16 a[160:161], v123 offset:32768
    v_mfma_f32_16x16x32_bf16 v[204:207], a[172:175], a[68:71], v[204:207]
    ds_read_b64_tr_b16 a[162:163], v123 offset:34816
    v_mfma_f32_16x16x32_bf16 v[188:191], a[176:179], a[200:203], v[188:191]
    ds_read_b64_tr_b16 a[164:165], v122 offset:32768
    v_mfma_f32_16x16x32_bf16 v[196:199], a[176:179], a[204:207], v[196:199]
    s_waitcnt lgkmcnt(5)
    ds_read_b64_tr_b16 a[166:167], v122 offset:34816
    v_mfma_f32_16x16x32_bf16 v[184:187], a[180:183], a[200:203], v[184:187]
    ds_read_b64_tr_b16 a[168:169], v121 offset:32768
    v_mfma_f32_16x16x32_bf16 v[192:195], a[180:183], a[204:207], v[192:195]
    ds_read_b64_tr_b16 a[170:171], v121 offset:34816
    v_mfma_f32_16x16x32_bf16 v[172:175], a[184:187], a[200:203], v[172:175]
    ds_read_b64_tr_b16 a[172:173], v120 offset:32768
    v_mfma_f32_16x16x32_bf16 v[180:183], a[184:187], a[204:207], v[180:183]
    s_waitcnt lgkmcnt(7)
    ds_read_b64_tr_b16 a[174:175], v120 offset:34816
    v_mfma_f32_16x16x32_bf16 v[168:171], a[188:191], a[200:203], v[168:171]
    v_mfma_f32_16x16x32_bf16 v[176:179], a[188:191], a[204:207], v[176:179]
    v_mfma_f32_16x16x32_bf16 v[200:203], a[188:191], a[72:75], v[200:203]
    ds_read_b64_tr_b16 a[176:177], v127 offset:32768
    v_mfma_f32_16x16x32_bf16 v[204:207], a[188:191], a[76:79], v[204:207]
    s_waitcnt lgkmcnt(5)
B_stub5:
    s_cbranch_execz B_back
    ds_read_b64_tr_b16 a[178:179], v127 offset:34816
    v_mfma_f32_16x16x32_bf16 v[188:191], a[160:163], a[208:211], v[188:191]
    ds_read_b64_tr_b16 a[180:181], v126 offset:32768
    s_waitcnt vmcnt(2)
    v_readfirstlane_b32 s47, v30
    s_cmp_ge_u32 s47, 8
    s_cselect_b32 s22, 1146880, 0
    s_cselect_b32 s47, 2, 0
    s_or_b32 s37, s37, s47
    v_mfma_f32_16x16x32_bf16 v[196:199], a[160:163], a[212:215], v[196:199]
    ds_read_b64_tr_b16 a[182:183], v126 offset:34816
    v_mfma_f32_16x16x32_bf16 v[184:187], a[164:167], a[208:211], v[184:187]
    ds_read_b64_tr_b16 a[184:185], v125 offset:32768
    v_mfma_f32_16x16x32_bf16 v[192:195], a[164:167], a[212:215], v[192:195]
    s_waitcnt lgkmcnt(5)
    ds_read_b64_tr_b16 a[186:187], v125 offset:34816
    v_mfma_f32_16x16x32_bf16 v[172:175], a[168:171], a[208:211], v[172:175]
    ds_read_b64_tr_b16 a[188:189], v124 offset:32768
    v_mfma_f32_16x16x32_bf16 v[180:183], a[168:171], a[212:215], v[180:183]
    ds_read_b64_tr_b16 a[190:191], v124 offset:34816
    v_mfma_f32_16x16x32_bf16 v[168:171], a[172:175], a[208:211], v[168:171]
    s_add_u32 s50, s48, 262144
    buffer_load_dwordx4 v[96:99], v16, s[20:23], s50 offen offset:0 sc1
    v_mfma_f32_16x16x32_bf16 v[176:179], a[172:175], a[212:215], v[176:179]
    s_waitcnt lgkmcnt(6)
    v_mfma_f32_16x16x32_bf16 v[200:203], a[172:175], a[80:83], v[200:203]
    s_barrier
    ds_read_b64_tr_b16 a[160:161], v115 offset:49152
    v_mfma_f32_16x16x32_bf16 v[204:207], a[172:175], a[84:87], v[204:207]
    ds_read_b64_tr_b16 a[162:163], v115 offset:51200
    v_xor_b32 v115, 0x10000, v115
    s_cmp_lg_u32 s28, 0
    s_cbranch_scc1 L_nosig3
    s_mov_b64 exec, 1
    global_atomic_add v12, v13, s[98:99] offset:12 sc1
    s_mov_b64 exec, -1
L_nosig3:
    v_mfma_f32_16x16x32_bf16 v[188:191], a[176:179], a[216:219], v[188:191]
    ds_read_b64_tr_b16 a[164:165], v114 offset:49152
    v_mfma_f32_16x16x32_bf16 v[196:199], a[176:179], a[220:223], v[196:199]
    s_waitcnt lgkmcnt(5)
    ds_read_b64_tr_b16 a[166:167], v114 offset:51200
    v_xor_b32 v114, 0x10000, v114
    v_mfma_f32_16x16x32_bf16 v[184:187], a[180:183], a[216:219], v[184:187]
    ds_read_b64_tr_b16 a[168:169], v113 offset:49152
    v_mfma_f32_16x16x32_bf16 v[192:195], a[180:183], a[220:223], v[192:195]
    ds_read_b64_tr_b16 a[170:171], v113 offset:51200
    v_xor_b32 v113, 0x10000, v113
    v_mfma_f32_16x16x32_bf16 v[172:175], a[184:187], a[216:219], v[172:175]
    ds_read_b64_tr_b16 a[172:173], v112 offset:49152
    v_mfma_f32_16x16x32_bf16 v[180:183], a[184:187], a[220:223], v[180:183]
    s_waitcnt lgkmcnt(7)
    ds_read_b64_tr_b16 a[174:175], v112 offset:51200
    v_xor_b32 v112, 0x10000, v112
    v_mfma_f32_16x16x32_bf16 v[168:171], a[188:191], a[216:219], v[168:171]
    v_mfma_f32_16x16x32_bf16 v[176:179], a[188:191], a[220:223], v[176:179]
    v_mfma_f32_16x16x32_bf16 v[200:203], a[188:191], a[88:91], v[200:203]
    ds_read_b64_tr_b16 a[176:177], v119 offset:49152
    v_mfma_f32_16x16x32_bf16 v[204:207], a[188:191], a[92:95], v[204:207]
    s_waitcnt lgkmcnt(5)
    ds_read_b64_tr_b16 a[178:179], v119 offset:51200
    v_xor_b32 v119, 0x10000, v119
    v_mfma_f32_16x16x32_bf16 v[188:191], a[160:163], a[128:131], v[188:191]
    ds_read_b64_tr_b16 a[180:181], v118 offset:49152
    buffer_load_dwordx4 v[100:103], v16, s[20:23], s50 offen offset:1024 sc1
    v_mfma_f32_16x16x32_bf16 v[196:199], a[160:163], a[132:135], v[196:199]
    ds_read_b64_tr_b16 a[182:183], v118 offset:51200
    v_xor_b32 v118, 0x10000, v118
    v_mfma_f32_16x16x32_bf16 v[184:187], a[164:167], a[128:131], v[184:187]
    ds_read_b64_tr_b16 a[184:185], v117 offset:49152
    v_mfma_f32_16x16x32_bf16 v[192:195], a[164:167], a[132:135], v[192:195]
    s_waitcnt lgkmcnt(5)
    ds_read_b64_tr_b16 a[186:187], v117 offset:51200
    v_xor_b32 v117, 0x10000, v117
    v_mfma_f32_16x16x32_bf16 v[172:175], a[168:171], a[128:131], v[172:175]
    ds_read_b64_tr_b16 a[188:189], v116 offset:49152
    v_mfma_f32_16x16x32_bf16 v[180:183], a[168:171], a[132:135], v[180:183]
    ds_read_b64_tr_b16 a[190:191], v116 offset:51200
    v_xor_b32 v116, 0x10000, v116
    v_mfma_f32_16x16x32_bf16 v[168:171], a[172:175], a[128:131], v[168:171]
    v_mfma_f32_16x16x32_bf16 v[176:179], a[172:175], a[132:135], v[176:179]
    s_waitcnt lgkmcnt(6)
    v_mfma_f32_16x16x32_bf16 v[200:203], a[172:175], a[96:99], v[200:203]
    ds_read_b64_tr_b16 a[160:161], v123 offset:49152
    v_mfma_f32_16x16x32_bf16 v[204:207], a[172:175], a[100:103], v[204:207]
    ds_read_b64_tr_b16 a[162:163], v123 offset:51200
    v_xor_b32 v123, 0x10000, v123
    v_mfma_f32_16x16x32_bf16 v[188:191], a[176:179], a[136:139], v[188:191]
    ds_read_b64_tr_b16 a[164:165], v122 offset:49152
    v_mfma_f32_16x16x32_bf16 v[196:199], a[176:179], a[140:143], v[196:199]
    s_waitcnt lgkmcnt(5)
    ds_read_b64_tr_b16 a[166:167], v122 offset:51200
    v_xor_b32 v122, 0x10000, v122
    v_mfma_f32_16x16x32_bf16 v[184:187], a[180:183], a[136:139], v[184:187]
    ds_read_b64_tr_b16 a[168:169], v121 offset:49152
    v_mfma_f32_16x16x32_bf16 v[192:195], a[180:183], a[140:143], v[192:195]
    ds_read_b64_tr_b16 a[170:171], v121 offset:51200
    v_xor_b32 v121, 0x10000, v121
    v_mfma_f32_16x16x32_bf16 v[172:175], a[184:187], a[136:139], v[172:175]
    ds_read_b64_tr_b16 a[172:173], v120 offset:49152
    buffer_load_dwordx4 v[104:107], v16, s[20:23], s50 offen offset:2048 sc1
    v_mfma_f32_16x16x32_bf16 v[180:183], a[184:187], a[140:143], v[180:183]
    s_waitcnt lgkmcnt(7)
    ds_read_b64_tr_b16 a[174:175], v120 offset:51200
    v_xor_b32 v120, 0x10000, v120
    v_mfma_f32_16x16x32_bf16 v[168:171], a[188:191], a[136:139], v[168:171]
    v_mfma_f32_16x16x32_bf16 v[176:179], a[188:191], a[140:143], v[176:179]
    v_mfma_f32_16x16x32_bf16 v[200:203], a[188:191], a[104:107], v[200:203]
    ds_read_b64_tr_b16 a[176:177], v127 offset:49152
    v_mfma_f32_16x16x32_bf16 v[204:207], a[188:191], a[108:111], v[204:207]
    s_waitcnt lgkmcnt(5)
    ds_read_b64_tr_b16 a[178:179], v127 offset:51200
    v_xor_b32 v127, 0x10000, v127
    v_mfma_f32_16x16x32_bf16 v[188:191], a[160:163], a[144:147], v[188:191]
    ds_read_b64_tr_b16 a[180:181], v126 offset:49152
    v_mfma_f32_16x16x32_bf16 v[196:199], a[160:163], a[148:151], v[196:199]
    ds_read_b64_tr_b16 a[182:183], v126 offset:51200
    v_xor_b32 v126, 0x10000, v126
    v_mfma_f32_16x16x32_bf16 v[184:187], a[164:167], a[144:147], v[184:187]
    ds_read_b64_tr_b16 a[184:185], v125 offset:49152
    v_mfma_f32_16x16x32_bf16 v[192:195], a[164:167], a[148:151], v[192:195]
    s_waitcnt lgkmcnt(5)
    ds_read_b64_tr_b16 a[186:187], v125 offset:51200
    v_xor_b32 v125, 0x10000, v125
    v_mfma_f32_16x16x32_bf16 v[172:175], a[168:171], a[144:147], v[172:175]
    ds_read_b64_tr_b16 a[188:189], v124 offset:49152
    v_mfma_f32_16x16x32_bf16 v[180:183], a[168:171], a[148:151], v[180:183]
    ds_read_b64_tr_b16 a[190:191], v124 offset:51200
    v_xor_b32 v124, 0x10000, v124
    v_mfma_f32_16x16x32_bf16 v[168:171], a[172:175], a[144:147], v[168:171]
    v_mfma_f32_16x16x32_bf16 v[176:179], a[172:175], a[148:151], v[176:179]
    s_waitcnt lgkmcnt(6)
    v_mfma_f32_16x16x32_bf16 v[200:203], a[172:175], a[112:115], v[200:203]
    s_barrier
    ds_read_b64_tr_b16 a[160:161], v115 offset:0
    buffer_load_dwordx4 v[108:111], v16, s[20:23], s50 offen offset:3072 sc1
    v_mfma_f32_16x16x32_bf16 v[204:207], a[172:175], a[116:119], v[204:207]
    ds_read_b64_tr_b16 a[162:163], v115 offset:2048
    v_mfma_f32_16x16x32_bf16 v[188:191], a[176:179], a[152:155], v[188:191]
    ds_read_b64_tr_b16 a[164:165], v114 offset:0
    v_mfma_f32_16x16x32_bf16 v[196:199], a[176:179], a[156:159], v[196:199]
    s_waitcnt lgkmcnt(5)
    ds_read_b64_tr_b16 a[166:167], v114 offset:2048
    v_mfma_f32_16x16x32_bf16 v[184:187], a[180:183], a[152:155], v[184:187]
    ds_read_b64_tr_b16 a[168:169], v113 offset:0
    v_mfma_f32_16x16x32_bf16 v[192:195], a[180:183], a[156:159], v[192:195]
    ds_read_b64_tr_b16 a[170:171], v113 offset:2048
    v_mfma_f32_16x16x32_bf16 v[172:175], a[184:187], a[152:155], v[172:175]
    ds_read_b64_tr_b16 a[172:173], v112 offset:0
    v_mfma_f32_16x16x32_bf16 v[180:183], a[184:187], a[156:159], v[180:183]
    s_waitcnt lgkmcnt(7)
    ds_read_b64_tr_b16 a[174:175], v112 offset:2048
    v_mfma_f32_16x16x32_bf16 v[168:171], a[188:191], a[152:155], v[168:171]
    v_mfma_f32_16x16x32_bf16 v[176:179], a[188:191], a[156:159], v[176:179]
    v_mfma_f32_16x16x32_bf16 v[200:203], a[188:191], a[120:123], v[200:203]
    ds_read_b64_tr_b16 a[176:177], v119 offset:0
    v_mfma_f32_16x16x32_bf16 v[204:207], a[188:191], a[124:127], v[204:207]
    s_waitcnt lgkmcnt(5)
    ds_read_b64_tr_b16 a[178:179], v119 offset:2048
    v_mfma_f32_16x16x32_bf16 v[148:151], a[160:163], v[32:35], 0
    ds_read_b64_tr_b16 a[180:181], v118 offset:0
    v_mfma_f32_16x16x32_bf16 v[156:159], a[160:163], v[36:39], 0
    ds_read_b64_tr_b16 a[182:183], v118 offset:2048
    v_mfma_f32_16x16x32_bf16 v[144:147], a[164:167], v[32:35], 0
    s_add_u32 s50, s48, 266240
    ds_read_b64_tr_b16 a[184:185], v117 offset:0
    buffer_load_dwordx4 v[240:243], v16, s[20:23], s50 offen offset:0 sc1
    v_mfma_f32_16x16x32_bf16 v[152:155], a[164:167], v[36:39], 0
    s_waitcnt lgkmcnt(5)
    ds_read_b64_tr_b16 a[186:187], v117 offset:2048
    v_mfma_f32_16x16x32_bf16 v[132:135], a[168:171], v[32:35], 0
    ds_read_b64_tr_b16 a[188:189], v116 offset:0
    v_mfma_f32_16x16x32_bf16 v[140:143], a[168:171], v[36:39], 0
    ds_read_b64_tr_b16 a[190:191], v116 offset:2048
    v_mfma_f32_16x16x32_bf16 v[128:131], a[172:175], v[32:35], 0
    v_cvt_pk_bf16_f32 v168, v168, v169
    v_cvt_pk_bf16_f32 v169, v170, v171
    v_mfma_f32_16x16x32_bf16 v[136:139], a[172:175], v[36:39], 0
    s_waitcnt lgkmcnt(6)
    v_cvt_pk_bf16_f32 v170, v172, v173
    v_cvt_pk_bf16_f32 v171, v174, v175
    v_mfma_f32_16x16x32_bf16 v[160:163], a[172:175], a[0:3], 0
    ds_read_b64_tr_b16 a[160:161], v123 offset:0
    v_mfma_f32_16x16x32_bf16 v[164:167], a[172:175], a[4:7], 0
    ds_read_b64_tr_b16 a[162:163], v123 offset:2048
    v_mfma_f32_16x16x32_bf16 v[148:151], a[176:179], v[40:43], v[148:151]
    ds_read_b64_tr_b16 a[164:165], v122 offset:0
    s_add_u32 s35, s30, 819200
    buffer_store_dwordx4 v[168:171], v16, s[8:11], s35 offen sc1
    v_mfma_f32_16x16x32_bf16 v[156:159], a[176:179], v[44:47], v[156:159]
    s_waitcnt lgkmcnt(5)
    ds_read_b64_tr_b16 a[166:167], v122 offset:2048
    v_mfma_f32_16x16x32_bf16 v[144:147], a[180:183], v[40:43], v[144:147]
    ds_read_b64_tr_b16 a[168:169], v121 offset:0
    v_mfma_f32_16x16x32_bf16 v[152:155], a[180:183], v[44:47], v[152:155]
    ds_read_b64_tr_b16 a[170:171], v121 offset:2048
    v_cvt_pk_bf16_f32 v176, v176, v177
    v_mfma_f32_16x16x32_bf16 v[132:135], a[184:187], v[40:43], v[132:135]
    ds_read_b64_tr_b16 a[172:173], v120 offset:0
    v_cvt_pk_bf16_f32 v177, v178, v179
    v_mfma_f32_16x16x32_bf16 v[140:143], a[184:187], v[44:47], v[140:143]
    s_waitcnt lgkmcnt(7)
    ds_read_b64_tr_b16 a[174:175], v120 offset:2048
    v_mfma_f32_16x16x32_bf16 v[128:131], a[188:191], v[40:43], v[128:131]
    buffer_load_dwordx4 v[244:247], v16, s[20:23], s50 offen offset:1024 sc1
    v_cvt_pk_bf16_f32 v178, v180, v181
    v_cvt_pk_bf16_f32 v179, v182, v183
    v_mfma_f32_16x16x32_bf16 v[136:139], a[188:191], v[44:47], v[136:139]
    v_mfma_f32_16x16x32_bf16 v[160:163], a[188:191], a[8:11], v[160:163]
    ds_read_b64_tr_b16 a[176:177], v127 offset:0
    s_add_u32 s35, s30, 835584
    buffer_store_dwordx4 v[176:179], v16, s[8:11], s35 offen sc1
    v_mfma_f32_16x16x32_bf16 v[164:167], a[188:191], a[12:15], v[164:167]
    s_waitcnt lgkmcnt(5)
    ds_read_b64_tr_b16 a[178:179], v127 offset:2048
    v_mfma_f32_16x16x32_bf16 v[148:151], a[160:163], v[48:51], v[148:151]
    ds_read_b64_tr_b16 a[180:181], v126 offset:0
    v_mfma_f32_16x16x32_bf16 v[156:159], a[160:163], v[52:55], v[156:159]
    ds_read_b64_tr_b16 a[182:183], v126 offset:2048
    v_cvt_pk_bf16_f32 v184, v184, v185
    v_mfma_f32_16x16x32_bf16 v[144:147], a[164:167], v[48:51], v[144:147]
    ds_read_b64_tr_b16 a[184:185], v125 offset:0
    v_cvt_pk_bf16_f32 v185, v186, v187
    v_mfma_f32_16x16x32_bf16 v[152:155], a[164:167], v[52:55], v[152:155]
    s_waitcnt lgkmcnt(5)
    ds_read_b64_tr_b16 a[186:187], v125 offset:2048
    v_cvt_pk_bf16_f32 v186, v188, v189
    v_mfma_f32_16x16x32_bf16 v[132:135], a[168:171], v[48:51], v[132:135]
    ds_read_b64_tr_b16 a[188:189], v124 offset:0
    global_load_dwordx4 v[28:31], v12, s[98:99] sc1
    v_cvt_pk_bf16_f32 v187, v190, v191
    v_mfma_f32_16x16x32_bf16 v[140:143], a[168:171], v[52:55], v[140:143]
    ds_read_b64_tr_b16 a[190:191], v124 offset:2048
    v_mfma_f32_16x16x32_bf16 v[128:131], a[172:175], v[48:51], v[128:131]
    s_add_u32 s35, s30, 827392
    buffer_store_dwordx4 v[184:187], v16, s[8:11], s35 offen sc1
    v_mfma_f32_16x16x32_bf16 v[136:139], a[172:175], v[52:55], v[136:139]
    s_waitcnt lgkmcnt(6)
    v_mfma_f32_16x16x32_bf16 v[160:163], a[172:175], a[16:19], v[160:163]
    s_barrier
    ds_read_b64_tr_b16 a[160:161], v115 offset:16384
    v_mfma_f32_16x16x32_bf16 v[164:167], a[172:175], a[20:23], v[164:167]
    ds_read_b64_tr_b16 a[162:163], v115 offset:18432
    v_cvt_pk_bf16_f32 v192, v192, v193
    v_mfma_f32_16x16x32_bf16 v[148:151], a[176:179], v[56:59], v[148:151]
    ds_read_b64_tr_b16 a[164:165], v114 offset:16384
    buffer_load_dwordx4 v[248:251], v16, s[20:23], s50 offen offset:2048 sc1
    v_cvt_pk_bf16_f32 v193, v194, v195
    v_mfma_f32_16x16x32_bf16 v[156:159], a[176:179], v[60:63], v[156:159]
    s_waitcnt lgkmcnt(5)
    ds_read_b64_tr_b16 a[166:167], v114 offset:18432
    v_cvt_pk_bf16_f32 v194, v196, v197
    v_mfma_f32_16x16x32_bf16 v[144:147], a[180:183], v[56:59], v[144:147]
    ds_read_b64_tr_b16 a[168:169], v113 offset:16384
    v_cvt_pk_bf16_f32 v195, v198, v199
    v_mfma_f32_16x16x32_bf16 v[152:155], a[180:183], v[60:63], v[152:155]
    ds_read_b64_tr_b16 a[170:171], v113 offset:18432
    v_mfma_f32_16x16x32_bf16 v[132:135], a[184:187], v[56:59], v[132:135]
    ds_read_b64_tr_b16 a[172:173], v112 offset:16384
    v_mfma_f32_16x16x32_bf16 v[140:143], a[184:187], v[60:63], v[140:143]
    s_waitcnt lgkmcnt(7)
    ds_read_b64_tr_b16 a[174:175], v112 offset:18432
    s_add_u32 s35, s30, 843776
    buffer_store_dwordx4 v[192:195], v16, s[8:11], s35 offen sc1
    v_mfma_f32_16x16x32_bf16 v[128:131], a[188:191], v[56:59], v[128:131]
    v_mfma_f32_16x16x32_bf16 v[136:139], a[188:191], v[60:63], v[136:139]
    v_cvt_pk_bf16_f32 v200, v200, v201
    v_mfma_f32_16x16x32_bf16 v[160:163], a[188:191], a[24:27], v[160:163]
    ds_read_b64_tr_b16 a[176:177], v119 offset:16384
    v_cvt_pk_bf16_f32 v201, v202, v203
    v_mfma_f32_16x16x32_bf16 v[164:167], a[188:191], a[28:31], v[164:167]
    s_waitcnt lgkmcnt(5)
    ds_read_b64_tr_b16 a[178:179], v119 offset:18432
    v_cvt_pk_bf16_f32 v202, v204, v205
    v_mfma_f32_16x16x32_bf16 v[148:151], a[160:163], v[64:67], v[148:151]
    ds_read_b64_tr_b16 a[180:181], v118 offset:16384
    v_cvt_pk_bf16_f32 v203, v206, v207
    v_mfma_f32_16x16x32_bf16 v[156:159], a[160:163], v[68:71], v[156:159]
    ds_read_b64_tr_b16 a[182:183], v118 offset:18432
    v_mfma_f32_16x16x32_bf16 v[144:147], a[164:167], v[64:67], v[144:147]
    ds_read_b64_tr_b16 a[184:185], v117 offset:16384
    v_mfma_f32_16x16x32_bf16 v[152:155], a[164:167], v[68:71], v[152:155]
    s_waitcnt lgkmcnt(5)
    ds_read_b64_tr_b16 a[186:187], v117 offset:18432
    s_add_u32 s35, s31, 819200
    buffer_store_dwordx4 v[200:203], v16, s[8:11], s35 offen sc1
    v_mfma_f32_16x16x32_bf16 v[132:135], a[168:171], v[64:67], v[132:135]
    ds_read_b64_tr_b16 a[188:189], v116 offset:16384
    buffer_load_dwordx4 v[252:255], v16, s[20:23], s50 offen offset:3072 sc1
    v_mfma_f32_16x16x32_bf16 v[140:143], a[168:171], v[68:71], v[140:143]
    ds_read_b64_tr_b16 a[190:191], v116 offset:18432
    v_mfma_f32_16x16x32_bf16 v[128:131], a[172:175], v[64:67], v[128:131]
    v_mfma_f32_16x16x32_bf16 v[136:139], a[172:175], v[68:71], v[136:139]
    s_waitcnt lgkmcnt(6)
    v_mfma_f32_16x16x32_bf16 v[160:163], a[172:175], a[32:35], v[160:163]
    ds_read_b64_tr_b16 a[160:161], v123 offset:16384
    v_mfma_f32_16x16x32_bf16 v[164:167], a[172:175], a[36:39], v[164:167]
    ds_read_b64_tr_b16 a[162:163], v123 offset:18432
    v_mfma_f32_16x16x32_bf16 v[148:151], a[176:179], v[72:75], v[148:151]
    ds_read_b64_tr_b16 a[164:165], v122 offset:16384
    v_mfma_f32_16x16x32_bf16 v[156:159], a[176:179], v[76:79], v[156:159]
    s_waitcnt lgkmcnt(5)
    ds_read_b64_tr_b16 a[166:167], v122 offset:18432
    v_mfma_f32_16x16x32_bf16 v[144:147], a[180:183], v[72:75], v[144:147]
    ds_read_b64_tr_b16 a[168:169], v121 offset:16384
    v_mfma_f32_16x16x32_bf16 v[152:155], a[180:183], v[76:79], v[152:155]
    ds_read_b64_tr_b16 a[170:171], v121 offset:18432
    v_mfma_f32_16x16x32_bf16 v[132:135], a[184:187], v[72:75], v[132:135]
    ds_read_b64_tr_b16 a[172:173], v120 offset:16384
    v_mfma_f32_16x16x32_bf16 v[140:143], a[184:187], v[76:79], v[140:143]
    s_waitcnt lgkmcnt(7)
    ds_read_b64_tr_b16 a[174:175], v120 offset:18432
    v_mfma_f32_16x16x32_bf16 v[128:131], a[188:191], v[72:75], v[128:131]
    v_mfma_f32_16x16x32_bf16 v[136:139], a[188:191], v[76:79], v[136:139]
    v_mfma_f32_16x16x32_bf16 v[160:163], a[188:191], a[40:43], v[160:163]
    ds_read_b64_tr_b16 a[176:177], v127 offset:16384
    v_mfma_f32_16x16x32_bf16 v[164:167], a[188:191], a[44:47], v[164:167]
    s_waitcnt lgkmcnt(5)
    ds_read_b64_tr_b16 a[178:179], v127 offset:18432
    v_mfma_f32_16x16x32_bf16 v[148:151], a[160:163], v[80:83], v[148:151]
    ds_read_b64_tr_b16 a[180:181], v126 offset:16384
    v_mfma_f32_16x16x32_bf16 v[156:159], a[160:163], v[84:87], v[156:159]
    ds_read_b64_tr_b16 a[182:183], v126 offset:18432
    v_mfma_f32_16x16x32_bf16 v[144:147], a[164:167], v[80:83], v[144:147]
    ds_read_b64_tr_b16 a[184:185], v125 offset:16384
    v_mfma_f32_16x16x32_bf16 v[152:155], a[164:167], v[84:87], v[152:155]
    s_waitcnt lgkmcnt(5)
    ds_read_b64_tr_b16 a[186:187], v125 offset:18432
    v_mfma_f32_16x16x32_bf16 v[132:135], a[168:171], v[80:83], v[132:135]
    ds_read_b64_tr_b16 a[188:189], v124 offset:16384
    v_mfma_f32_16x16x32_bf16 v[140:143], a[168:171], v[84:87], v[140:143]
    ds_read_b64_tr_b16 a[190:191], v124 offset:18432
    v_mfma_f32_16x16x32_bf16 v[128:131], a[172:175], v[80:83], v[128:131]
    v_mfma_f32_16x16x32_bf16 v[136:139], a[172:175], v[84:87], v[136:139]
    s_waitcnt lgkmcnt(6)
    v_mfma_f32_16x16x32_bf16 v[160:163], a[172:175], a[48:51], v[160:163]
    s_barrier
    ds_read_b64_tr_b16 a[160:161], v115 offset:32768
    v_mfma_f32_16x16x32_bf16 v[164:167], a[172:175], a[52:55], v[164:167]
    ds_read_b64_tr_b16 a[162:163], v115 offset:34816
    v_mfma_f32_16x16x32_bf16 v[148:151], a[176:179], v[88:91], v[148:151]
    ds_read_b64_tr_b16 a[164:165], v114 offset:32768
    v_mfma_f32_16x16x32_bf16 v[156:159], a[176:179], v[92:95], v[156:159]
    s_waitcnt lgkmcnt(5)
    ds_read_b64_tr_b16 a[166:167], v114 offset:34816
    v_mfma_f32_16x16x32_bf16 v[144:147], a[180:183], v[88:91], v[144:147]
    ds_read_b64_tr_b16 a[168:169], v113 offset:32768
    v_mfma_f32_16x16x32_bf16 v[152:155], a[180:183], v[92:95], v[152:155]
    ds_read_b64_tr_b16 a[170:171], v113 offset:34816
    v_mfma_f32_16x16x32_bf16 v[132:135], a[184:187], v[88:91], v[132:135]
    ds_read_b64_tr_b16 a[172:173], v112 offset:32768
    v_mfma_f32_16x16x32_bf16 v[140:143], a[184:187], v[92:95], v[140:143]
    s_waitcnt lgkmcnt(7)
    ds_read_b64_tr_b16 a[174:175], v112 offset:34816
    v_mfma_f32_16x16x32_bf16 v[128:131], a[188:191], v[88:91], v[128:131]
    v_mfma_f32_16x16x32_bf16 v[136:139], a[188:191], v[92:95], v[136:139]
    v_mfma_f32_16x16x32_bf16 v[160:163], a[188:191], a[56:59], v[160:163]
    ds_read_b64_tr_b16 a[176:177], v119 offset:32768
    v_mfma_f32_16x16x32_bf16 v[164:167], a[188:191], a[60:63], v[164:167]
    s_waitcnt lgkmcnt(5)
    ds_read_b64_tr_b16 a[178:179], v119 offset:34816
    v_mfma_f32_16x16x32_bf16 v[148:151], a[160:163], a[192:195], v[148:151]
    ds_read_b64_tr_b16 a[180:181], v118 offset:32768
    s_waitcnt vmcnt(5)
    v_readfirstlane_b32 s47, v31
    s_cmp_ge_u32 s47, 8
    s_cselect_b32 s22, 1146880, 0
    s_cselect_b32 s47, 4, 0
    s_or_b32 s37, s37, s47
    v_mfma_f32_16x16x32_bf16 v[156:159], a[160:163], a[196:199], v[156:159]
    ds_read_b64_tr_b16 a[182:183], v118 offset:34816
    v_mfma_f32_16x16x32_bf16 v[144:147], a[164:167], a[192:195], v[144:147]
    ds_read_b64_tr_b16 a[184:185], v117 offset:32768
    v_mfma_f32_16x16x32_bf16 v[152:155], a[164:167], a[196:199], v[152:155]
    s_waitcnt lgkmcnt(5)
    ds_read_b64_tr_b16 a[186:187], v117 offset:34816
    v_mfma_f32_16x16x32_bf16 v[132:135], a[168:171], a[192:195], v[132:135]
    ds_read_b64_tr_b16 a[188:189], v116 offset:32768
    v_mfma_f32_16x16x32_bf16 v[140:143], a[168:171], a[196:199], v[140:143]
    ds_read_b64_tr_b16 a[190:191], v116 offset:34816
    v_mfma_f32_16x16x32_bf16 v[128:131], a[172:175], a[192:195], v[128:131]
    s_add_u32 s50, s48, 524288
    buffer_load_dwordx4 v[32:35], v16, s[20:23], s50 offen offset:0 sc1
    v_mfma_f32_16x16x32_bf16 v[136:139], a[172:175], a[196:199], v[136:139]
    s_waitcnt lgkmcnt(6)
    v_mfma_f32_16x16x32_bf16 v[160:163], a[172:175], a[64:67], v[160:163]
    ds_read_b64_tr_b16 a[160:161], v123 offset:32768
    v_mfma_f32_16x16x32_bf16 v[164:167], a[172:175], a[68:71], v[164:167]
    ds_read_b64_tr_b16 a[162:163], v123 offset:34816
    v_mfma_f32_16x16x32_bf16 v[148:151], a[176:179], a[200:203], v[148:151]
    ds_read_b64_tr_b16 a[164:165], v122 offset:32768
    v_mfma_f32_16x16x32_bf16 v[156:159], a[176:179], a[204:207], v[156:159]
    s_waitcnt lgkmcnt(5)
    ds_read_b64_tr_b16 a[166:167], v122 offset:34816
    v_mfma_f32_16x16x32_bf16 v[144:147], a[180:183], a[200:203], v[144:147]
    ds_read_b64_tr_b16 a[168:169], v121 offset:32768
    v_mfma_f32_16x16x32_bf16 v[152:155], a[180:183], a[204:207], v[152:155]
    ds_read_b64_tr_b16 a[170:171], v121 offset:34816
    v_mfma_f32_16x16x32_bf16 v[132:135], a[184:187], a[200:203], v[132:135]
    ds_read_b64_tr_b16 a[172:173], v120 offset:32768
    buffer_load_dwordx4 v[36:39], v16, s[20:23], s50 offen offset:1024 sc1
    v_mfma_f32_16x16x32_bf16 v[140:143], a[184:187], a[204:207], v[140:143]
    s_waitcnt lgkmcnt(7)
    ds_read_b64_tr_b16 a[174:175], v120 offset:34816
    v_mfma_f32_16x16x32_bf16 v[128:131], a[188:191], a[200:203], v[128:131]
    v_mfma_f32_16x16x32_bf16 v[136:139], a[188:191], a[204:207], v[136:139]
    v_mfma_f32_16x16x32_bf16 v[160:163], a[188:191], a[72:75], v[160:163]
    ds_read_b64_tr_b16 a[176:177], v127 offset:32768
    v_mfma_f32_16x16x32_bf16 v[164:167], a[188:191], a[76:79], v[164:167]
    s_waitcnt lgkmcnt(5)
    ds_read_b64_tr_b16 a[178:179], v127 offset:34816
    v_mfma_f32_16x16x32_bf16 v[148:151], a[160:163], a[208:211], v[148:151]
    ds_read_b64_tr_b16 a[180:181], v126 offset:32768
    v_mfma_f32_16x16x32_bf16 v[156:159], a[160:163], a[212:215], v[156:159]
    ds_read_b64_tr_b16 a[182:183], v126 offset:34816
    v_mfma_f32_16x16x32_bf16 v[144:147], a[164:167], a[208:211], v[144:147]
    ds_read_b64_tr_b16 a[184:185], v125 offset:32768
    buffer_load_dwordx4 v[40:43], v16, s[20:23], s50 offen offset:2048 sc1
    v_mfma_f32_16x16x32_bf16 v[152:155], a[164:167], a[212:215], v[152:155]
    s_waitcnt lgkmcnt(5)
    ds_read_b64_tr_b16 a[186:187], v125 offset:34816
    v_mfma_f32_16x16x32_bf16 v[132:135], a[168:171], a[208:211], v[132:135]
    ds_read_b64_tr_b16 a[188:189], v124 offset:32768
    v_mfma_f32_16x16x32_bf16 v[140:143], a[168:171], a[212:215], v[140:143]
    ds_read_b64_tr_b16 a[190:191], v124 offset:34816
    v_mfma_f32_16x16x32_bf16 v[128:131], a[172:175], a[208:211], v[128:131]
    v_mfma_f32_16x16x32_bf16 v[136:139], a[172:175], a[212:215], v[136:139]
    s_waitcnt lgkmcnt(6)
    v_mfma_f32_16x16x32_bf16 v[160:163], a[172:175], a[80:83], v[160:163]
    s_barrier
    ds_read_b64_tr_b16 a[160:161], v115 offset:49152
    v_mfma_f32_16x16x32_bf16 v[164:167], a[172:175], a[84:87], v[164:167]
    ds_read_b64_tr_b16 a[162:163], v115 offset:51200
    v_mfma_f32_16x16x32_bf16 v[148:151], a[176:179], a[216:219], v[148:151]
    ds_read_b64_tr_b16 a[164:165], v114 offset:49152
    buffer_load_dwordx4 v[44:47], v16, s[20:23], s50 offen offset:3072 sc1
    v_mfma_f32_16x16x32_bf16 v[156:159], a[176:179], a[220:223], v[156:159]
    s_waitcnt lgkmcnt(5)
    ds_read_b64_tr_b16 a[166:167], v114 offset:51200
    v_mfma_f32_16x16x32_bf16 v[144:147], a[180:183], a[216:219], v[144:147]
    ds_read_b64_tr_b16 a[168:169], v113 offset:49152
    v_mfma_f32_16x16x32_bf16 v[152:155], a[180:183], a[220:223], v[152:155]
    ds_read_b64_tr_b16 a[170:171], v113 offset:51200
    v_mfma_f32_16x16x32_bf16 v[132:135], a[184:187], a[216:219], v[132:135]
    ds_read_b64_tr_b16 a[172:173], v112 offset:49152
    v_mfma_f32_16x16x32_bf16 v[140:143], a[184:187], a[220:223], v[140:143]
    s_waitcnt lgkmcnt(7)
    ds_read_b64_tr_b16 a[174:175], v112 offset:51200
    v_mfma_f32_16x16x32_bf16 v[128:131], a[188:191], a[216:219], v[128:131]
    v_mfma_f32_16x16x32_bf16 v[136:139], a[188:191], a[220:223], v[136:139]
    v_mfma_f32_16x16x32_bf16 v[160:163], a[188:191], a[88:91], v[160:163]
    s_add_u32 s50, s48, 528384
    ds_read_b64_tr_b16 a[176:177], v119 offset:49152
    buffer_load_dwordx4 v[48:51], v16, s[20:23], s50 offen offset:0 sc1
    v_mfma_f32_16x16x32_bf16 v[164:167], a[188:191], a[92:95], v[164:167]
    s_waitcnt lgkmcnt(5)
    ds_read_b64_tr_b16 a[178:179], v119 offset:51200
    v_mfma_f32_16x16x32_bf16 v[148:151], a[160:163], a[128:131], v[148:151]
    ds_read_b64_tr_b16 a[180:181], v118 offset:49152
    v_mfma_f32_16x16x32_bf16 v[156:159], a[160:163], a[132:135], v[156:159]
    ds_read_b64_tr_b16 a[182:183], v118 offset:51200
    v_mfma_f32_16x16x32_bf16 v[144:147], a[164:167], a[128:131], v[144:147]
    ds_read_b64_tr_b16 a[184:185], v117 offset:49152
    v_mfma_f32_16x16x32_bf16 v[152:155], a[164:167], a[132:135], v[152:155]
    s_waitcnt lgkmcnt(5)
    ds_read_b64_tr_b16 a[186:187], v117 offset:51200
    v_mfma_f32_16x16x32_bf16 v[132:135], a[168:171], a[128:131], v[132:135]
    ds_read_b64_tr_b16 a[188:189], v116 offset:49152
    v_mfma_f32_16x16x32_bf16 v[140:143], a[168:171], a[132:135], v[140:143]
    ds_read_b64_tr_b16 a[190:191], v116 offset:51200
    v_mfma_f32_16x16x32_bf16 v[128:131], a[172:175], a[128:131], v[128:131]
    buffer_load_dwordx4 v[52:55], v16, s[20:23], s50 offen offset:1024 sc1
    v_mfma_f32_16x16x32_bf16 v[136:139], a[172:175], a[132:135], v[136:139]
    s_waitcnt lgkmcnt(6)
    v_mfma_f32_16x16x32_bf16 v[160:163], a[172:175], a[96:99], v[160:163]
    ds_read_b64_tr_b16 a[160:161], v123 offset:49152
    v_mfma_f32_16x16x32_bf16 v[164:167], a[172:175], a[100:103], v[164:167]
    ds_read_b64_tr_b16 a[162:163], v123 offset:51200
    v_mfma_f32_16x16x32_bf16 v[148:151], a[176:179], a[136:139], v[148:151]
    ds_read_b64_tr_b16 a[164:165], v122 offset:49152
    v_mfma_f32_16x16x32_bf16 v[156:159], a[176:179], a[140:143], v[156:159]
    s_waitcnt lgkmcnt(5)
    ds_read_b64_tr_b16 a[166:167], v122 offset:51200
    v_mfma_f32_16x16x32_bf16 v[144:147], a[180:183], a[136:139], v[144:147]
    ds_read_b64_tr_b16 a[168:169], v121 offset:49152
    v_mfma_f32_16x16x32_bf16 v[152:155], a[180:183], a[140:143], v[152:155]
    ds_read_b64_tr_b16 a[170:171], v121 offset:51200
    v_mfma_f32_16x16x32_bf16 v[132:135], a[184:187], a[136:139], v[132:135]
    ds_read_b64_tr_b16 a[172:173], v120 offset:49152
    buffer_load_dwordx4 v[56:59], v16, s[20:23], s50 offen offset:2048 sc1
    v_mfma_f32_16x16x32_bf16 v[140:143], a[184:187], a[140:143], v[140:143]
    s_waitcnt lgkmcnt(7)
    ds_read_b64_tr_b16 a[174:175], v120 offset:51200
    v_mfma_f32_16x16x32_bf16 v[128:131], a[188:191], a[136:139], v[128:131]
    v_mfma_f32_16x16x32_bf16 v[136:139], a[188:191], a[140:143], v[136:139]
    v_mfma_f32_16x16x32_bf16 v[160:163], a[188:191], a[104:107], v[160:163]
    ds_read_b64_tr_b16 a[176:177], v127 offset:49152
    v_mfma_f32_16x16x32_bf16 v[164:167], a[188:191], a[108:111], v[164:167]
    s_waitcnt lgkmcnt(5)
    ds_read_b64_tr_b16 a[178:179], v127 offset:51200
    v_mfma_f32_16x16x32_bf16 v[148:151], a[160:163], a[144:147], v[148:151]
    ds_read_b64_tr_b16 a[180:181], v126 offset:49152
    v_mfma_f32_16x16x32_bf16 v[156:159], a[160:163], a[148:151], v[156:159]
    ds_read_b64_tr_b16 a[182:183], v126 offset:51200
    v_mfma_f32_16x16x32_bf16 v[144:147], a[164:167], a[144:147], v[144:147]
    ds_read_b64_tr_b16 a[184:185], v125 offset:49152
    buffer_load_dwordx4 v[60:63], v16, s[20:23], s50 offen offset:3072 sc1
    v_mfma_f32_16x16x32_bf16 v[152:155], a[164:167], a[148:151], v[152:155]
    s_waitcnt lgkmcnt(5)
    ds_read_b64_tr_b16 a[186:187], v125 offset:51200
    v_mfma_f32_16x16x32_bf16 v[132:135], a[168:171], a[144:147], v[132:135]
    ds_read_b64_tr_b16 a[188:189], v124 offset:49152
    v_mfma_f32_16x16x32_bf16 v[140:143], a[168:171], a[148:151], v[140:143]
    ds_read_b64_tr_b16 a[190:191], v124 offset:51200
    v_mfma_f32_16x16x32_bf16 v[128:131], a[172:175], a[144:147], v[128:131]
    v_mfma_f32_16x16x32_bf16 v[136:139], a[172:175], a[148:151], v[136:139]
    s_waitcnt lgkmcnt(6)
    v_mfma_f32_16x16x32_bf16 v[160:163], a[172:175], a[112:115], v[160:163]
    v_mfma_f32_16x16x32_bf16 v[164:167], a[172:175], a[116:119], v[164:167]
    v_mfma_f32_16x16x32_bf16 v[148:151], a[176:179], a[152:155], v[148:151]
    v_mfma_f32_16x16x32_bf16 v[156:159], a[176:179], a[156:159], v[156:159]
    s_waitcnt lgkmcnt(2)
    v_mfma_f32_16x16x32_bf16 v[144:147], a[180:183], a[152:155], v[144:147]
    v_mfma_f32_16x16x32_bf16 v[152:155], a[180:183], a[156:159], v[152:155]
    v_mfma_f32_16x16x32_bf16 v[132:135], a[184:187], a[152:155], v[132:135]
    v_mfma_f32_16x16x32_bf16 v[140:143], a[184:187], a[156:159], v[140:143]
    s_waitcnt lgkmcnt(0)
    v_mfma_f32_16x16x32_bf16 v[128:131], a[188:191], a[152:155], v[128:131]
    v_mfma_f32_16x16x32_bf16 v[136:139], a[188:191], a[156:159], v[136:139]
    v_mfma_f32_16x16x32_bf16 v[160:163], a[188:191], a[120:123], v[160:163]
    v_mfma_f32_16x16x32_bf16 v[164:167], a[188:191], a[124:127], v[164:167]
    s_nop 4
    v_cvt_pk_bf16_f32 v128, v128, v129
    v_cvt_pk_bf16_f32 v129, v130, v131
    v_cvt_pk_bf16_f32 v130, v132, v133
    v_cvt_pk_bf16_f32 v131, v134, v135
    s_add_u32 s35, s30, 983040
    buffer_store_dwordx4 v[128:131], v16, s[8:11], s35 offen sc1
    v_cvt_pk_bf16_f32 v136, v136, v137
    v_cvt_pk_bf16_f32 v137, v138, v139
    v_cvt_pk_bf16_f32 v138, v140, v141
    v_cvt_pk_bf16_f32 v139, v142, v143
    s_add_u32 s35, s30, 999424
    buffer_store_dwordx4 v[136:139], v16, s[8:11], s35 offen sc1
    v_cvt_pk_bf16_f32 v144, v144, v145
    v_cvt_pk_bf16_f32 v145, v146, v147
    v_cvt_pk_bf16_f32 v146, v148, v149
    v_cvt_pk_bf16_f32 v147, v150, v151
    s_add_u32 s35, s30, 991232
    s_nop 0
B_stub6:
    s_cbranch_execz B_back
    buffer_store_dwordx4 v[144:147], v16, s[8:11], s35 offen sc1
    v_cvt_pk_bf16_f32 v152, v152, v153
    v_cvt_pk_bf16_f32 v153, v154, v155
    v_cvt_pk_bf16_f32 v154, v156, v157
    v_cvt_pk_bf16_f32 v155, v158, v159
    s_add_u32 s35, s30, 1007616
    buffer_store_dwordx4 v[152:155], v16, s[8:11], s35 offen sc1
    v_cvt_pk_bf16_f32 v160, v160, v161
    v_cvt_pk_bf16_f32 v161, v162, v163
    v_cvt_pk_bf16_f32 v162, v164, v165
    v_cvt_pk_bf16_f32 v163, v166, v167
    s_add_u32 s35, s31, 983040
    buffer_store_dwordx4 v[160:163], v16, s[8:11], s35 offen sc1
    s_bitcmp1_b32 s37, 0
    s_cbranch_scc0 L_skip0
    s_add_u32 s34, s51, 0
    s_mul_i32 s35, s34, 3277
    s_lshr_b32 s35, s35, 16
    s_mul_i32 s47, s35, 20
    s_sub_u32 s34, s34, s47
    s_lshl_b32 s35, s35, 7
    s_add_u32 s35, s35, s33
    s_lshr_b32 s47, s34, 1
    s_mul_i32 s47, s47, 28672
    s_lshl_b32 s31, s34, 6
    s_lshl_b32 s50, s34, 3
    s_and_b32 s31, s31, 64
    s_and_b32 s50, s50, 96
    s_xor_b32 s50, s50, s31
    v_xor_b32 v10, s50, v7
    s_lshl_b32 s31, s34, 5
    s_add_u32 s31, s31, 228864
    s_cmp_lt_u32 s34, 16
    s_cselect_b32 s47, s47, s31
    s_cselect_b64 vcc, -1, 0
    s_add_u32 s47, s47, s35
    v_cndmask_b32 v10, v3, v10, vcc
    v_lshlrev_b32 v112, 16, v208
    v_and_b32 v113, 0xffff0000, v208
    v_lshlrev_b32 v114, 16, v209
    v_and_b32 v115, 0xffff0000, v209
    v_lshlrev_b32 v116, 16, v210
    v_and_b32 v117, 0xffff0000, v210
    v_lshlrev_b32 v118, 16, v211
    v_and_b32 v119, 0xffff0000, v211
    v_dot2_f32_bf16 v112, v212, s39, v112
    v_dot2_f32_bf16 v113, v212, s26, v113
    v_dot2_f32_bf16 v114, v213, s39, v114
    v_dot2_f32_bf16 v115, v213, s26, v115
    v_dot2_f32_bf16 v116, v214, s39, v116
    v_dot2_f32_bf16 v117, v214, s26, v117
    v_dot2_f32_bf16 v118, v215, s39, v118
    v_dot2_f32_bf16 v119, v215, s26, v119
    v_dot2_f32_bf16 v112, v216, s39, v112
    v_dot2_f32_bf16 v113, v216, s26, v113
    v_dot2_f32_bf16 v114, v217, s39, v114
    v_dot2_f32_bf16 v115, v217, s26, v115
    v_dot2_f32_bf16 v116, v218, s39, v116
    v_dot2_f32_bf16 v117, v218, s26, v117
    v_dot2_f32_bf16 v118, v219, s39, v118
    v_dot2_f32_bf16 v119, v219, s26, v119
    v_dot2_f32_bf16 v112, v220, s39, v112
    v_dot2_f32_bf16 v113, v220, s26, v113
    v_dot2_f32_bf16 v114, v221, s39, v114
    v_dot2_f32_bf16 v115, v221, s26, v115
    v_dot2_f32_bf16 v116, v222, s39, v116
    v_dot2_f32_bf16 v117, v222, s26, v117
    v_dot2_f32_bf16 v118, v223, s39, v118
    v_dot2_f32_bf16 v119, v223, s26, v119
    v_dot2_f32_bf16 v112, v224, s39, v112
    v_dot2_f32_bf16 v113, v224, s26, v113
    v_dot2_f32_bf16 v114, v225, s39, v114
    v_dot2_f32_bf16 v115, v225, s26, v115
    v_dot2_f32_bf16 v116, v226, s39, v116
    v_dot2_f32_bf16 v117, v226, s26, v117
    v_dot2_f32_bf16 v118, v227, s39, v118
    v_dot2_f32_bf16 v119, v227, s26, v119
    v_dot2_f32_bf16 v112, v228, s39, v112
    v_dot2_f32_bf16 v113, v228, s26, v113
    v_dot2_f32_bf16 v114, v229, s39, v114
    v_dot2_f32_bf16 v115, v229, s26, v115
    v_dot2_f32_bf16 v116, v230, s39, v116
    v_dot2_f32_bf16 v117, v230, s26, v117
    v_dot2_f32_bf16 v118, v231, s39, v118
    v_dot2_f32_bf16 v119, v231, s26, v119
    v_dot2_f32_bf16 v112, v232, s39, v112
    v_dot2_f32_bf16 v113, v232, s26, v113
    v_dot2_f32_bf16 v114, v233, s39, v114
    v_dot2_f32_bf16 v115, v233, s26, v115
    v_dot2_f32_bf16 v116, v234, s39, v116
    v_dot2_f32_bf16 v117, v234, s26, v117
    v_dot2_f32_bf16 v118, v235, s39, v118
    v_dot2_f32_bf16 v119, v235, s26, v119
    v_dot2_f32_bf16 v112, v236, s39, v112
    v_dot2_f32_bf16 v113, v236, s26, v113
    v_dot2_f32_bf16 v114, v237, s39, v114
    v_dot2_f32_bf16 v115, v237, s26, v115
    v_dot2_f32_bf16 v116, v238, s39, v116
    v_dot2_f32_bf16 v117, v238, s26, v117
    v_dot2_f32_bf16 v118, v239, s39, v118
    v_dot2_f32_bf16 v119, v239, s26, v119
    s_nop 2
    v_cvt_pk_bf16_f32 v20, v112, v113
    v_cvt_pk_bf16_f32 v21, v114, v115
    v_cvt_pk_bf16_f32 v22, v116, v117
    v_cvt_pk_bf16_f32 v23, v118, v119
    s_nop 0
    v_permlane16_swap_b32 v20, v22
    v_permlane16_swap_b32 v21, v23
    buffer_store_dwordx4 v[20:23], v10, s[16:19], s47 offen
L_skip0:
    s_bitcmp1_b32 s37, 1
    s_cbranch_scc0 L_skip1
    s_add_u32 s34, s51, 32
    s_mul_i32 s35, s34, 3277
    s_lshr_b32 s35, s35, 16
    s_mul_i32 s47, s35, 20
    s_sub_u32 s34, s34, s47
    s_lshl_b32 s35, s35, 7
    s_add_u32 s35, s35, s33
    s_lshr_b32 s47, s34, 1
    s_mul_i32 s47, s47, 28672
    s_lshl_b32 s31, s34, 6
    s_lshl_b32 s50, s34, 3
    s_and_b32 s31, s31, 64
    s_and_b32 s50, s50, 96
    s_xor_b32 s50, s50, s31
    v_xor_b32 v11, s50, v7
    s_lshl_b32 s31, s34, 5
    s_add_u32 s31, s31, 228864
    s_cmp_lt_u32 s34, 16
    s_cselect_b32 s47, s47, s31
    s_cselect_b64 vcc, -1, 0
    s_add_u32 s47, s47, s35
    v_cndmask_b32 v11, v3, v11, vcc
    v_lshlrev_b32 v120, 16, v96
    v_and_b32 v121, 0xffff0000, v96
    v_lshlrev_b32 v122, 16, v97
    v_and_b32 v123, 0xffff0000, v97
    v_lshlrev_b32 v124, 16, v98
    v_and_b32 v125, 0xffff0000, v98
    v_lshlrev_b32 v126, 16, v99
    v_and_b32 v127, 0xffff0000, v99
    v_dot2_f32_bf16 v120, v100, s39, v120
    v_dot2_f32_bf16 v121, v100, s26, v121
    v_dot2_f32_bf16 v122, v101, s39, v122
    v_dot2_f32_bf16 v123, v101, s26, v123
    v_dot2_f32_bf16 v124, v102, s39, v124
    v_dot2_f32_bf16 v125, v102, s26, v125
    v_dot2_f32_bf16 v126, v103, s39, v126
    v_dot2_f32_bf16 v127, v103, s26, v127
    v_dot2_f32_bf16 v120, v104, s39, v120
    v_dot2_f32_bf16 v121, v104, s26, v121
    v_dot2_f32_bf16 v122, v105, s39, v122
    v_dot2_f32_bf16 v123, v105, s26, v123
    v_dot2_f32_bf16 v124, v106, s39, v124
    v_dot2_f32_bf16 v125, v106, s26, v125
    v_dot2_f32_bf16 v126, v107, s39, v126
    v_dot2_f32_bf16 v127, v107, s26, v127
    v_dot2_f32_bf16 v120, v108, s39, v120
    v_dot2_f32_bf16 v121, v108, s26, v121
    v_dot2_f32_bf16 v122, v109, s39, v122
    v_dot2_f32_bf16 v123, v109, s26, v123
    v_dot2_f32_bf16 v124, v110, s39, v124
    v_dot2_f32_bf16 v125, v110, s26, v125
    v_dot2_f32_bf16 v126, v111, s39, v126
    v_dot2_f32_bf16 v127, v111, s26, v127
    v_dot2_f32_bf16 v120, v240, s39, v120
    v_dot2_f32_bf16 v121, v240, s26, v121
    v_dot2_f32_bf16 v122, v241, s39, v122
    v_dot2_f32_bf16 v123, v241, s26, v123
    v_dot2_f32_bf16 v124, v242, s39, v124
    v_dot2_f32_bf16 v125, v242, s26, v125
    v_dot2_f32_bf16 v126, v243, s39, v126
    v_dot2_f32_bf16 v127, v243, s26, v127
    v_dot2_f32_bf16 v120, v244, s39, v120
    v_dot2_f32_bf16 v121, v244, s26, v121
    v_dot2_f32_bf16 v122, v245, s39, v122
    v_dot2_f32_bf16 v123, v245, s26, v123
    v_dot2_f32_bf16 v124, v246, s39, v124
    v_dot2_f32_bf16 v125, v246, s26, v125
    v_dot2_f32_bf16 v126, v247, s39, v126
    v_dot2_f32_bf16 v127, v247, s26, v127
    s_waitcnt vmcnt(13)
    v_dot2_f32_bf16 v120, v248, s39, v120
    v_dot2_f32_bf16 v121, v248, s26, v121
    v_dot2_f32_bf16 v122, v249, s39, v122
    v_dot2_f32_bf16 v123, v249, s26, v123
    v_dot2_f32_bf16 v124, v250, s39, v124
    v_dot2_f32_bf16 v125, v250, s26, v125
    v_dot2_f32_bf16 v126, v251, s39, v126
    v_dot2_f32_bf16 v127, v251, s26, v127
    v_dot2_f32_bf16 v120, v252, s39, v120
    v_dot2_f32_bf16 v121, v252, s26, v121
    v_dot2_f32_bf16 v122, v253, s39, v122
    v_dot2_f32_bf16 v123, v253, s26, v123
    v_dot2_f32_bf16 v124, v254, s39, v124
    v_dot2_f32_bf16 v125, v254, s26, v125
    v_dot2_f32_bf16 v126, v255, s39, v126
    v_dot2_f32_bf16 v127, v255, s26, v127
    s_nop 2
    v_cvt_pk_bf16_f32 v24, v120, v121
    v_cvt_pk_bf16_f32 v25, v122, v123
    v_cvt_pk_bf16_f32 v26, v124, v125
    v_cvt_pk_bf16_f32 v27, v126, v127
    s_nop 0
    v_permlane16_swap_b32 v24, v26
    v_permlane16_swap_b32 v25, v27
    buffer_store_dwordx4 v[24:27], v11, s[16:19], s47 offen
L_skip1:
    s_waitcnt vmcnt(0)
    s_barrier
    s_cmp_lg_u32 s28, 0
    s_cbranch_scc1 L_noarr
    s_mov_b64 exec, 1
    global_atomic_add v14, v12, v13, s[98:99] sc0 sc1
    s_mov_b64 exec, -1
L_noarr:
    s_cmp_lg_u32 s37, 7
    s_cbranch_scc1 L_redo
L_redo_back:
    s_add_u32 s34, s51, 64
    s_mul_i32 s35, s34, 3277
    s_lshr_b32 s35, s35, 16
    s_mul_i32 s47, s35, 20
    s_sub_u32 s34, s34, s47
    s_lshl_b32 s35, s35, 7
    s_add_u32 s35, s35, s33
    s_lshr_b32 s47, s34, 1
    s_mul_i32 s47, s47, 28672
    s_lshl_b32 s31, s34, 6
    s_lshl_b32 s50, s34, 3
    s_and_b32 s31, s31, 64
    s_and_b32 s50, s50, 96
    s_xor_b32 s50, s50, s31
    v_xor_b32 v10, s50, v7
    s_lshl_b32 s31, s34, 5
    s_add_u32 s31, s31, 228864
    s_cmp_lt_u32 s34, 16
    s_cselect_b32 s47, s47, s31
    s_cselect_b64 vcc, -1, 0
    s_add_u32 s47, s47, s35
    v_cndmask_b32 v10, v3, v10, vcc
    v_lshlrev_b32 v112, 16, v32
    v_and_b32 v113, 0xffff0000, v32
    v_lshlrev_b32 v114, 16, v33
    v_and_b32 v115, 0xffff0000, v33
    v_lshlrev_b32 v116, 16, v34
    v_and_b32 v117, 0xffff0000, v34
    v_lshlrev_b32 v118, 16, v35
    v_and_b32 v119, 0xffff0000, v35
    v_dot2_f32_bf16 v112, v36, s39, v112
    v_dot2_f32_bf16 v113, v36, s26, v113
    v_dot2_f32_bf16 v114, v37, s39, v114
    v_dot2_f32_bf16 v115, v37, s26, v115
    v_dot2_f32_bf16 v116, v38, s39, v116
    v_dot2_f32_bf16 v117, v38, s26, v117
    v_dot2_f32_bf16 v118, v39, s39, v118
    v_dot2_f32_bf16 v119, v39, s26, v119
    v_dot2_f32_bf16 v112, v40, s39, v112
    v_dot2_f32_bf16 v113, v40, s26, v113
    v_dot2_f32_bf16 v114, v41, s39, v114
    v_dot2_f32_bf16 v115, v41, s26, v115
    v_dot2_f32_bf16 v116, v42, s39, v116
    v_dot2_f32_bf16 v117, v42, s26, v117
    v_dot2_f32_bf16 v118, v43, s39, v118
    v_dot2_f32_bf16 v119, v43, s26, v119
    v_dot2_f32_bf16 v112, v44, s39, v112
    v_dot2_f32_bf16 v113, v44, s26, v113
    v_dot2_f32_bf16 v114, v45, s39, v114
    v_dot2_f32_bf16 v115, v45, s26, v115
    v_dot2_f32_bf16 v116, v46, s39, v116
    v_dot2_f32_bf16 v117, v46, s26, v117
    v_dot2_f32_bf16 v118, v47, s39, v118
    v_dot2_f32_bf16 v119, v47, s26, v119
    v_dot2_f32_bf16 v112, v48, s39, v112
    v_dot2_f32_bf16 v113, v48, s26, v113
    v_dot2_f32_bf16 v114, v49, s39, v114
    v_dot2_f32_bf16 v115, v49, s26, v115
    v_dot2_f32_bf16 v116, v50, s39, v116
    v_dot2_f32_bf16 v117, v50, s26, v117
    v_dot2_f32_bf16 v118, v51, s39, v118
    v_dot2_f32_bf16 v119, v51, s26, v119
    v_dot2_f32_bf16 v112, v52, s39, v112
    v_dot2_f32_bf16 v113, v52, s26, v113
    v_dot2_f32_bf16 v114, v53, s39, v114
    v_dot2_f32_bf16 v115, v53, s26, v115
    v_dot2_f32_bf16 v116, v54, s39, v116
    v_dot2_f32_bf16 v117, v54, s26, v117
    v_dot2_f32_bf16 v118, v55, s39, v118
    v_dot2_f32_bf16 v119, v55, s26, v119
    v_dot2_f32_bf16 v112, v56, s39, v112
    v_dot2_f32_bf16 v113, v56, s26, v113
    v_dot2_f32_bf16 v114, v57, s39, v114
    v_dot2_f32_bf16 v115, v57, s26, v115
    v_dot2_f32_bf16 v116, v58, s39, v116
    v_dot2_f32_bf16 v117, v58, s26, v117
    v_dot2_f32_bf16 v118, v59, s39, v118
    v_dot2_f32_bf16 v119, v59, s26, v119
    v_dot2_f32_bf16 v112, v60, s39, v112
    v_dot2_f32_bf16 v113, v60, s26, v113
    v_dot2_f32_bf16 v114, v61, s39, v114
    v_dot2_f32_bf16 v115, v61, s26, v115
    v_dot2_f32_bf16 v116, v62, s39, v116
    v_dot2_f32_bf16 v117, v62, s26, v117
    v_dot2_f32_bf16 v118, v63, s39, v118
    v_dot2_f32_bf16 v119, v63, s26, v119
    s_nop 2
    v_cvt_pk_bf16_f32 v20, v112, v113
    v_cvt_pk_bf16_f32 v21, v114, v115
    v_cvt_pk_bf16_f32 v22, v116, v117
    v_cvt_pk_bf16_f32 v23, v118, v119
    s_nop 0
    v_permlane16_swap_b32 v20, v22
    v_permlane16_swap_b32 v21, v23
    buffer_store_dwordx4 v[20:23], v10, s[16:19], s47 offen
    s_cmp_lg_u32 s28, 0
    s_cbranch_scc1 L_sync_done
    s_mov_b64 exec, 1
    s_mov_b32 s47, 0
    s_waitcnt vmcnt(1)
    v_add_u32 v14, 1, v14
L_sync_l:
    s_nop 0
    v_readfirstlane_b32 s34, v14
    s_add_u32 s47, s47, 1
    s_cmp_ge_u32 s34, 8
    s_cbranch_scc1 L_sync_ok
    s_cmp_gt_u32 s47, 0x200000
    s_cbranch_scc1 L_sync_ok
    s_sleep 1
    global_load_dword v14, v12, s[98:99] sc1
    s_waitcnt vmcnt(0)
    s_branch L_sync_l
L_sync_ok:
    s_mov_b64 exec, -1
L_sync_done:
    s_barrier
    s_add_u32 s50, s48, 786432
    buffer_load_dwordx4 v[64:67], v16, s[8:11], s50 offen offset:0 sc1
    buffer_load_dwordx4 v[68:71], v16, s[8:11], s50 offen offset:1024 sc1
    buffer_load_dwordx4 v[72:75], v16, s[8:11], s50 offen offset:2048 sc1
    buffer_load_dwordx4 v[76:79], v16, s[8:11], s50 offen offset:3072 sc1
    s_add_u32 s50, s48, 790528
    buffer_load_dwordx4 v[80:83], v16, s[8:11], s50 offen offset:0 sc1
    buffer_load_dwordx4 v[84:87], v16, s[8:11], s50 offen offset:1024 sc1
    buffer_load_dwordx4 v[88:91], v16, s[8:11], s50 offen offset:2048 sc1
    buffer_load_dwordx4 v[92:95], v16, s[8:11], s50 offen offset:3072 sc1
    s_add_u32 s50, s48, 1048576
    buffer_load_dwordx4 v[168:171], v16, s[8:11], s50 offen offset:0 sc1
    buffer_load_dwordx4 v[172:175], v16, s[8:11], s50 offen offset:1024 sc1
    buffer_load_dwordx4 v[176:179], v16, s[8:11], s50 offen offset:2048 sc1
    buffer_load_dwordx4 v[180:183], v16, s[8:11], s50 offen offset:3072 sc1
    s_add_u32 s50, s48, 1052672
    buffer_load_dwordx4 v[184:187], v16, s[8:11], s50 offen offset:0 sc1
    buffer_load_dwordx4 v[188:191], v16, s[8:11], s50 offen offset:1024 sc1
    buffer_load_dwordx4 v[192:195], v16, s[8:11], s50 offen offset:2048 sc1
    buffer_load_dwordx4 v[196:199], v16, s[8:11], s50 offen offset:3072 sc1
    s_add_u32 s34, s51, 96
    s_mul_i32 s35, s34, 3277
    s_lshr_b32 s35, s35, 16
    s_mul_i32 s47, s35, 20
    s_sub_u32 s34, s34, s47
    s_lshl_b32 s35, s35, 7
    s_add_u32 s35, s35, s33
    s_lshr_b32 s47, s34, 1
    s_mul_i32 s47, s47, 28672
    s_lshl_b32 s31, s34, 6
    s_lshl_b32 s50, s34, 3
    s_and_b32 s31, s31, 64
    s_and_b32 s50, s50, 96
    s_xor_b32 s50, s50, s31
    v_xor_b32 v11, s50, v7
    s_lshl_b32 s31, s34, 5
    s_add_u32 s31, s31, 228864
    s_cmp_lt_u32 s34, 16
    s_cselect_b32 s47, s47, s31
    s_cselect_b64 vcc, -1, 0
    s_add_u32 s47, s47, s35
    v_cndmask_b32 v11, v3, v11, vcc
    s_waitcnt vmcnt(14)
    v_lshlrev_b32 v120, 16, v64
    v_and_b32 v121, 0xffff0000, v64
    v_lshlrev_b32 v122, 16, v65
    v_and_b32 v123, 0xffff0000, v65
    v_lshlrev_b32 v124, 16, v66
    v_and_b32 v125, 0xffff0000, v66
    v_lshlrev_b32 v126, 16, v67
    v_and_b32 v127, 0xffff0000, v67
    v_dot2_f32_bf16 v120, v68, s39, v120
    v_dot2_f32_bf16 v121, v68, s26, v121
    v_dot2_f32_bf16 v122, v69, s39, v122
    v_dot2_f32_bf16 v123, v69, s26, v123
    v_dot2_f32_bf16 v124, v70, s39, v124
    v_dot2_f32_bf16 v125, v70, s26, v125
    v_dot2_f32_bf16 v126, v71, s39, v126
    v_dot2_f32_bf16 v127, v71, s26, v127
    s_waitcnt vmcnt(12)
    v_dot2_f32_bf16 v120, v72, s39, v120
    v_dot2_f32_bf16 v121, v72, s26, v121
    v_dot2_f32_bf16 v122, v73, s39, v122
    v_dot2_f32_bf16 v123, v73, s26, v123
    v_dot2_f32_bf16 v124, v74, s39, v124
    v_dot2_f32_bf16 v125, v74, s26, v125
    v_dot2_f32_bf16 v126, v75, s39, v126
    v_dot2_f32_bf16 v127, v75, s26, v127
    v_dot2_f32_bf16 v120, v76, s39, v120
    v_dot2_f32_bf16 v121, v76, s26, v121
    v_dot2_f32_bf16 v122, v77, s39, v122
    v_dot2_f32_bf16 v123, v77, s26, v123
    v_dot2_f32_bf16 v124, v78, s39, v124
    v_dot2_f32_bf16 v125, v78, s26, v125
    v_dot2_f32_bf16 v126, v79, s39, v126
    v_dot2_f32_bf16 v127, v79, s26, v127
    s_waitcnt vmcnt(10)
    v_dot2_f32_bf16 v120, v80, s39, v120
    v_dot2_f32_bf16 v121, v80, s26, v121
    v_dot2_f32_bf16 v122, v81, s39, v122
    v_dot2_f32_bf16 v123, v81, s26, v123
    v_dot2_f32_bf16 v124, v82, s39, v124
    v_dot2_f32_bf16 v125, v82, s26, v125
    v_dot2_f32_bf16 v126, v83, s39, v126
    v_dot2_f32_bf16 v127, v83, s26, v127
    v_dot2_f32_bf16 v120, v84, s39, v120
    v_dot2_f32_bf16 v121, v84, s26, v121
    v_dot2_f32_bf16 v122, v85, s39, v122
    v_dot2_f32_bf16 v123, v85, s26, v123
    v_dot2_f32_bf16 v124, v86, s39, v124
    v_dot2_f32_bf16 v125, v86, s26, v125
    v_dot2_f32_bf16 v126, v87, s39, v126
    v_dot2_f32_bf16 v127, v87, s26, v127
    s_waitcnt vmcnt(8)
    v_dot2_f32_bf16 v120, v88, s39, v120
    v_dot2_f32_bf16 v121, v88, s26, v121
    v_dot2_f32_bf16 v122, v89, s39, v122
    v_dot2_f32_bf16 v123, v89, s26, v123
    v_dot2_f32_bf16 v124, v90, s39, v124
    v_dot2_f32_bf16 v125, v90, s26, v125
    v_dot2_f32_bf16 v126, v91, s39, v126
    v_dot2_f32_bf16 v127, v91, s26, v127
    v_dot2_f32_bf16 v120, v92, s39, v120
    v_dot2_f32_bf16 v121, v92, s26, v121
    v_dot2_f32_bf16 v122, v93, s39, v122
    v_dot2_f32_bf16 v123, v93, s26, v123
    v_dot2_f32_bf16 v124, v94, s39, v124
    v_dot2_f32_bf16 v125, v94, s26, v125
    v_dot2_f32_bf16 v126, v95, s39, v126
    v_dot2_f32_bf16 v127, v95, s26, v127
    s_nop 2
    v_cvt_pk_bf16_f32 v24, v120, v121
    v_cvt_pk_bf16_f32 v25, v122, v123
    v_cvt_pk_bf16_f32 v26, v124, v125
    v_cvt_pk_bf16_f32 v27, v126, v127
    s_nop 0
    v_permlane16_swap_b32 v24, v26
    v_permlane16_swap_b32 v25, v27
    buffer_store_dwordx4 v[24:27], v11, s[16:19], s47 offen
    s_cmp_lt_u32 s51, 12
    s_cbranch_scc0 L_fin
    s_add_u32 s34, s51, 128
    s_mul_i32 s35, s34, 3277
    s_lshr_b32 s35, s35, 16
    s_mul_i32 s47, s35, 20
    s_sub_u32 s34, s34, s47
    s_lshl_b32 s35, s35, 7
    s_add_u32 s35, s35, s33
    s_lshr_b32 s47, s34, 1
    s_mul_i32 s47, s47, 28672
    s_lshl_b32 s31, s34, 6
    s_lshl_b32 s50, s34, 3
    s_and_b32 s31, s31, 64
    s_and_b32 s50, s50, 96
    s_xor_b32 s50, s50, s31
    v_xor_b32 v10, s50, v7
    s_lshl_b32 s31, s34, 5
    s_add_u32 s31, s31, 228864
    s_cmp_lt_u32 s34, 16
    s_cselect_b32 s47, s47, s31
    s_cselect_b64 vcc, -1, 0
    s_add_u32 s47, s47, s35
    v_cndmask_b32 v10, v3, v10, vcc
    s_waitcnt vmcnt(6)
    v_lshlrev_b32 v112, 16, v168
    v_and_b32 v113, 0xffff0000, v168
    v_lshlrev_b32 v114, 16, v169
    v_and_b32 v115, 0xffff0000, v169
    v_lshlrev_b32 v116, 16, v170
    v_and_b32 v117, 0xffff0000, v170
    v_lshlrev_b32 v118, 16, v171
    v_and_b32 v119, 0xffff0000, v171
    v_dot2_f32_bf16 v112, v172, s39, v112
    v_dot2_f32_bf16 v113, v172, s26, v113
    v_dot2_f32_bf16 v114, v173, s39, v114
    v_dot2_f32_bf16 v115, v173, s26, v115
    v_dot2_f32_bf16 v116, v174, s39, v116
    v_dot2_f32_bf16 v117, v174, s26, v117
    v_dot2_f32_bf16 v118, v175, s39, v118
    v_dot2_f32_bf16 v119, v175, s26, v119
    s_waitcnt vmcnt(4)
    v_dot2_f32_bf16 v112, v176, s39, v112
    v_dot2_f32_bf16 v113, v176, s26, v113
    v_dot2_f32_bf16 v114, v177, s39, v114
    v_dot2_f32_bf16 v115, v177, s26, v115
    v_dot2_f32_bf16 v116, v178, s39, v116
    v_dot2_f32_bf16 v117, v178, s26, v117
    v_dot2_f32_bf16 v118, v179, s39, v118
    v_dot2_f32_bf16 v119, v179, s26, v119
    v_dot2_f32_bf16 v112, v180, s39, v112
    v_dot2_f32_bf16 v113, v180, s26, v113
    v_dot2_f32_bf16 v114, v181, s39, v114
    v_dot2_f32_bf16 v115, v181, s26, v115
    v_dot2_f32_bf16 v116, v182, s39, v116
    v_dot2_f32_bf16 v117, v182, s26, v117
    v_dot2_f32_bf16 v118, v183, s39, v118
    v_dot2_f32_bf16 v119, v183, s26, v119
    s_waitcnt vmcnt(2)
    v_dot2_f32_bf16 v112, v184, s39, v112
    v_dot2_f32_bf16 v113, v184, s26, v113
    v_dot2_f32_bf16 v114, v185, s39, v114
    v_dot2_f32_bf16 v115, v185, s26, v115
    v_dot2_f32_bf16 v116, v186, s39, v116
    v_dot2_f32_bf16 v117, v186, s26, v117
    v_dot2_f32_bf16 v118, v187, s39, v118
    v_dot2_f32_bf16 v119, v187, s26, v119
    v_dot2_f32_bf16 v112, v188, s39, v112
    v_dot2_f32_bf16 v113, v188, s26, v113
    v_dot2_f32_bf16 v114, v189, s39, v114
    v_dot2_f32_bf16 v115, v189, s26, v115
    v_dot2_f32_bf16 v116, v190, s39, v116
    v_dot2_f32_bf16 v117, v190, s26, v117
    v_dot2_f32_bf16 v118, v191, s39, v118
    v_dot2_f32_bf16 v119, v191, s26, v119
    s_waitcnt vmcnt(0)
    v_dot2_f32_bf16 v112, v192, s39, v112
    v_dot2_f32_bf16 v113, v192, s26, v113
    v_dot2_f32_bf16 v114, v193, s39, v114
    v_dot2_f32_bf16 v115, v193, s26, v115
    v_dot2_f32_bf16 v116, v194, s39, v116
    v_dot2_f32_bf16 v117, v194, s26, v117
    v_dot2_f32_bf16 v118, v195, s39, v118
    v_dot2_f32_bf16 v119, v195, s26, v119
    v_dot2_f32_bf16 v112, v196, s39, v112
    v_dot2_f32_bf16 v113, v196, s26, v113
    v_dot2_f32_bf16 v114, v197, s39, v114
    v_dot2_f32_bf16 v115, v197, s26, v115
    v_dot2_f32_bf16 v116, v198, s39, v116
    v_dot2_f32_bf16 v117, v198, s26, v117
    v_dot2_f32_bf16 v118, v199, s39, v118
    v_dot2_f32_bf16 v119, v199, s26, v119
    s_nop 2
    v_cvt_pk_bf16_f32 v20, v112, v113
    v_cvt_pk_bf16_f32 v21, v114, v115
    v_cvt_pk_bf16_f32 v22, v116, v117
    v_cvt_pk_bf16_f32 v23, v118, v119
    s_nop 0
    v_permlane16_swap_b32 v20, v22
    v_permlane16_swap_b32 v21, v23
    buffer_store_dwordx4 v[20:23], v10, s[16:19], s47 offen
L_fin:
L_end:
    s_endpgm
L_armspin:
    s_mov_b32 s35, 0
L_armspin_l:
    s_sleep 8
    buffer_load_dword v4, v5, s[92:95], 0 offen sc1
    s_waitcnt vmcnt(0)
    v_readfirstlane_b32 s47, v4
    s_add_u32 s35, s35, 1
    s_cmp_lg_u32 s47, 0
    s_cbranch_scc1 L_armback
    s_cmp_lt_u32 s35, 0x200000
    s_cbranch_scc1 L_armspin_l
    s_branch L_armback
L_redo:
    s_mov_b32 s35, 0
L_redo_l:
    global_load_dwordx4 v[28:31], v12, s[98:99] sc1
    s_waitcnt vmcnt(0)
    v_readfirstlane_b32 s47, v31
    s_add_u32 s35, s35, 1
    s_cmp_ge_u32 s47, 8
    s_cbranch_scc1 L_redo_go
    s_sleep 4
    s_cmp_lt_u32 s35, 0x200000
    s_cbranch_scc1 L_redo_l
L_redo_go:
    s_bitcmp1_b32 s37, 0
    s_cbranch_scc1 L_rl0
    s_add_u32 s50, s48, 0
    buffer_load_dwordx4 v[208:211], v16, s[8:11], s50 offen offset:0 sc1
    buffer_load_dwordx4 v[212:215], v16, s[8:11], s50 offen offset:1024 sc1
    buffer_load_dwordx4 v[216:219], v16, s[8:11], s50 offen offset:2048 sc1
    buffer_load_dwordx4 v[220:223], v16, s[8:11], s50 offen offset:3072 sc1
    s_add_u32 s50, s48, 4096
    buffer_load_dwordx4 v[224:227], v16, s[8:11], s50 offen offset:0 sc1
    buffer_load_dwordx4 v[228:231], v16, s[8:11], s50 offen offset:1024 sc1
    buffer_load_dwordx4 v[232:235], v16, s[8:11], s50 offen offset:2048 sc1
    buffer_load_dwordx4 v[236:239], v16, s[8:11], s50 offen offset:3072 sc1
L_rl0:
    s_bitcmp1_b32 s37, 1
    s_cbranch_scc1 L_rl1
    s_add_u32 s50, s48, 262144
    buffer_load_dwordx4 v[96:99], v16, s[8:11], s50 offen offset:0 sc1
    buffer_load_dwordx4 v[100:103], v16, s[8:11], s50 offen offset:1024 sc1
    buffer_load_dwordx4 v[104:107], v16, s[8:11], s50 offen offset:2048 sc1
    buffer_load_dwordx4 v[108:111], v16, s[8:11], s50 offen offset:3072 sc1
    s_add_u32 s50, s48, 266240
    buffer_load_dwordx4 v[240:243], v16, s[8:11], s50 offen offset:0 sc1
    buffer_load_dwordx4 v[244:247], v16, s[8:11], s50 offen offset:1024 sc1
    buffer_load_dwordx4 v[248:251], v16, s[8:11], s50 offen offset:2048 sc1
    buffer_load_dwordx4 v[252:255], v16, s[8:11], s50 offen offset:3072 sc1
L_rl1:
    s_bitcmp1_b32 s37, 2
    s_cbranch_scc1 L_rl2
    s_add_u32 s50, s48, 524288
    buffer_load_dwordx4 v[32:35], v16, s[8:11], s50 offen offset:0 sc1
    buffer_load_dwordx4 v[36:39], v16, s[8:11], s50 offen offset:1024 sc1
    buffer_load_dwordx4 v[40:43], v16, s[8:11], s50 offen offset:2048 sc1
    buffer_load_dwordx4 v[44:47], v16, s[8:11], s50 offen offset:3072 sc1
    s_add_u32 s50, s48, 528384
    buffer_load_dwordx4 v[48:51], v16, s[8:11], s50 offen offset:0 sc1
    buffer_load_dwordx4 v[52:55], v16, s[8:11], s50 offen offset:1024 sc1
    buffer_load_dwordx4 v[56:59], v16, s[8:11], s50 offen offset:2048 sc1
    buffer_load_dwordx4 v[60:63], v16, s[8:11], s50 offen offset:3072 sc1
L_rl2:
    s_waitcnt vmcnt(0)
    s_bitcmp1_b32 s37, 0
    s_cbranch_scc1 L_rc0
    s_add_u32 s34, s51, 0
    s_mul_i32 s35, s34, 3277
    s_lshr_b32 s35, s35, 16
    s_mul_i32 s47, s35, 20
    s_sub_u32 s34, s34, s47
    s_lshl_b32 s35, s35, 7
    s_add_u32 s35, s35, s33
    s_lshr_b32 s47, s34, 1
    s_mul_i32 s47, s47, 28672
    s_lshl_b32 s31, s34, 6
    s_lshl_b32 s50, s34, 3
    s_and_b32 s31, s31, 64
    s_and_b32 s50, s50, 96
    s_xor_b32 s50, s50, s31
    v_xor_b32 v10, s50, v7
    s_lshl_b32 s31, s34, 5
    s_add_u32 s31, s31, 228864
    s_cmp_lt_u32 s34, 16
    s_cselect_b32 s47, s47, s31
    s_cselect_b64 vcc, -1, 0
    s_add_u32 s47, s47, s35
    v_cndmask_b32 v10, v3, v10, vcc
    v_lshlrev_b32 v112, 16, v208
    v_and_b32 v113, 0xffff0000, v208
    v_lshlrev_b32 v114, 16, v209
    v_and_b32 v115, 0xffff0000, v209
    v_lshlrev_b32 v116, 16, v210
    v_and_b32 v117, 0xffff0000, v210
    v_lshlrev_b32 v118, 16, v211
    v_and_b32 v119, 0xffff0000, v211
    v_dot2_f32_bf16 v112, v212, s39, v112
    v_dot2_f32_bf16 v113, v212, s26, v113
    v_dot2_f32_bf16 v114, v213, s39, v114
    v_dot2_f32_bf16 v115, v213, s26, v115
    v_dot2_f32_bf16 v116, v214, s39, v116
    v_dot2_f32_bf16 v117, v214, s26, v117
    v_dot2_f32_bf16 v118, v215, s39, v118
    v_dot2_f32_bf16 v119, v215, s26, v119
    v_dot2_f32_bf16 v112, v216, s39, v112
    v_dot2_f32_bf16 v113, v216, s26, v113
    v_dot2_f32_bf16 v114, v217, s39, v114
    v_dot2_f32_bf16 v115, v217, s26, v115
    v_dot2_f32_bf16 v116, v218, s39, v116
    v_dot2_f32_bf16 v117, v218, s26, v117
    v_dot2_f32_bf16 v118, v219, s39, v118
    v_dot2_f32_bf16 v119, v219, s26, v119
    v_dot2_f32_bf16 v112, v220, s39, v112
    v_dot2_f32_bf16 v113, v220, s26, v113
    v_dot2_f32_bf16 v114, v221, s39, v114
    v_dot2_f32_bf16 v115, v221, s26, v115
    v_dot2_f32_bf16 v116, v222, s39, v116
    v_dot2_f32_bf16 v117, v222, s26, v117
    v_dot2_f32_bf16 v118, v223, s39, v118
    v_dot2_f32_bf16 v119, v223, s26, v119
    v_dot2_f32_bf16 v112, v224, s39, v112
    v_dot2_f32_bf16 v113, v224, s26, v113
    v_dot2_f32_bf16 v114, v225, s39, v114
    v_dot2_f32_bf16 v115, v225, s26, v115
    v_dot2_f32_bf16 v116, v226, s39, v116
    v_dot2_f32_bf16 v117, v226, s26, v117
    v_dot2_f32_bf16 v118, v227, s39, v118
    v_dot2_f32_bf16 v119, v227, s26, v119
    v_dot2_f32_bf16 v112, v228, s39, v112
    v_dot2_f32_bf16 v113, v228, s26, v113
    v_dot2_f32_bf16 v114, v229, s39, v114
    v_dot2_f32_bf16 v115, v229, s26, v115
    v_dot2_f32_bf16 v116, v230, s39, v116
    v_dot2_f32_bf16 v117, v230, s26, v117
    v_dot2_f32_bf16 v118, v231, s39, v118
    v_dot2_f32_bf16 v119, v231, s26, v119
    v_dot2_f32_bf16 v112, v232, s39, v112
    v_dot2_f32_bf16 v113, v232, s26, v113
    v_dot2_f32_bf16 v114, v233, s39, v114
    v_dot2_f32_bf16 v115, v233, s26, v115
    v_dot2_f32_bf16 v116, v234, s39, v116
    v_dot2_f32_bf16 v117, v234, s26, v117
    v_dot2_f32_bf16 v118, v235, s39, v118
    v_dot2_f32_bf16 v119, v235, s26, v119
    v_dot2_f32_bf16 v112, v236, s39, v112
    v_dot2_f32_bf16 v113, v236, s26, v113
    v_dot2_f32_bf16 v114, v237, s39, v114
    v_dot2_f32_bf16 v115, v237, s26, v115
    v_dot2_f32_bf16 v116, v238, s39, v116
    v_dot2_f32_bf16 v117, v238, s26, v117
    v_dot2_f32_bf16 v118, v239, s39, v118
    v_dot2_f32_bf16 v119, v239, s26, v119
    s_nop 2
    v_cvt_pk_bf16_f32 v20, v112, v113
    v_cvt_pk_bf16_f32 v21, v114, v115
    v_cvt_pk_bf16_f32 v22, v116, v117
    v_cvt_pk_bf16_f32 v23, v118, v119
    s_nop 0
    v_permlane16_swap_b32 v20, v22
    v_permlane16_swap_b32 v21, v23
    buffer_store_dwordx4 v[20:23], v10, s[16:19], s47 offen
L_rc0:
    s_bitcmp1_b32 s37, 1
    s_cbranch_scc1 L_rc1
    s_add_u32 s34, s51, 32
    s_mul_i32 s35, s34, 3277
    s_lshr_b32 s35, s35, 16
    s_mul_i32 s47, s35, 20
    s_sub_u32 s34, s34, s47
    s_lshl_b32 s35, s35, 7
    s_add_u32 s35, s35, s33
    s_lshr_b32 s47, s34, 1
    s_mul_i32 s47, s47, 28672
    s_lshl_b32 s31, s34, 6
    s_lshl_b32 s50, s34, 3
    s_and_b32 s31, s31, 64
    s_and_b32 s50, s50, 96
    s_xor_b32 s50, s50, s31
    v_xor_b32 v11, s50, v7
    s_lshl_b32 s31, s34, 5
    s_add_u32 s31, s31, 228864
    s_cmp_lt_u32 s34, 16
    s_cselect_b32 s47, s47, s31
    s_cselect_b64 vcc, -1, 0
    s_add_u32 s47, s47, s35
    v_cndmask_b32 v11, v3, v11, vcc
    v_lshlrev_b32 v120, 16, v96
    v_and_b32 v121, 0xffff0000, v96
    v_lshlrev_b32 v122, 16, v97
    v_and_b32 v123, 0xffff0000, v97
    v_lshlrev_b32 v124, 16, v98
    v_and_b32 v125, 0xffff0000, v98
    v_lshlrev_b32 v126, 16, v99
    v_and_b32 v127, 0xffff0000, v99
    v_dot2_f32_bf16 v120, v100, s39, v120
    v_dot2_f32_bf16 v121, v100, s26, v121
    v_dot2_f32_bf16 v122, v101, s39, v122
    v_dot2_f32_bf16 v123, v101, s26, v123
    v_dot2_f32_bf16 v124, v102, s39, v124
    v_dot2_f32_bf16 v125, v102, s26, v125
    v_dot2_f32_bf16 v126, v103, s39, v126
    v_dot2_f32_bf16 v127, v103, s26, v127
    v_dot2_f32_bf16 v120, v104, s39, v120
    v_dot2_f32_bf16 v121, v104, s26, v121
    v_dot2_f32_bf16 v122, v105, s39, v122
    v_dot2_f32_bf16 v123, v105, s26, v123
    v_dot2_f32_bf16 v124, v106, s39, v124
    v_dot2_f32_bf16 v125, v106, s26, v125
    v_dot2_f32_bf16 v126, v107, s39, v126
    v_dot2_f32_bf16 v127, v107, s26, v127
    v_dot2_f32_bf16 v120, v108, s39, v120
    v_dot2_f32_bf16 v121, v108, s26, v121
    v_dot2_f32_bf16 v122, v109, s39, v122
    v_dot2_f32_bf16 v123, v109, s26, v123
    v_dot2_f32_bf16 v124, v110, s39, v124
    v_dot2_f32_bf16 v125, v110, s26, v125
    v_dot2_f32_bf16 v126, v111, s39, v126
    v_dot2_f32_bf16 v127, v111, s26, v127
    v_dot2_f32_bf16 v120, v240, s39, v120
    v_dot2_f32_bf16 v121, v240, s26, v121
    v_dot2_f32_bf16 v122, v241, s39, v122
    v_dot2_f32_bf16 v123, v241, s26, v123
    v_dot2_f32_bf16 v124, v242, s39, v124
    v_dot2_f32_bf16 v125, v242, s26, v125
    v_dot2_f32_bf16 v126, v243, s39, v126
    v_dot2_f32_bf16 v127, v243, s26, v127
    v_dot2_f32_bf16 v120, v244, s39, v120
    v_dot2_f32_bf16 v121, v244, s26, v121
    v_dot2_f32_bf16 v122, v245, s39, v122
    v_dot2_f32_bf16 v123, v245, s26, v123
    v_dot2_f32_bf16 v124, v246, s39, v124
    v_dot2_f32_bf16 v125, v246, s26, v125
    v_dot2_f32_bf16 v126, v247, s39, v126
    v_dot2_f32_bf16 v127, v247, s26, v127
    v_dot2_f32_bf16 v120, v248, s39, v120
    v_dot2_f32_bf16 v121, v248, s26, v121
    v_dot2_f32_bf16 v122, v249, s39, v122
    v_dot2_f32_bf16 v123, v249, s26, v123
    v_dot2_f32_bf16 v124, v250, s39, v124
    v_dot2_f32_bf16 v125, v250, s26, v125
    v_dot2_f32_bf16 v126, v251, s39, v126
    v_dot2_f32_bf16 v127, v251, s26, v127
    v_dot2_f32_bf16 v120, v252, s39, v120
    v_dot2_f32_bf16 v121, v252, s26, v121
    v_dot2_f32_bf16 v122, v253, s39, v122
    v_dot2_f32_bf16 v123, v253, s26, v123
    v_dot2_f32_bf16 v124, v254, s39, v124
    v_dot2_f32_bf16 v125, v254, s26, v125
    v_dot2_f32_bf16 v126, v255, s39, v126
    v_dot2_f32_bf16 v127, v255, s26, v127
    s_nop 2
    v_cvt_pk_bf16_f32 v24, v120, v121
    v_cvt_pk_bf16_f32 v25, v122, v123
    v_cvt_pk_bf16_f32 v26, v124, v125
    v_cvt_pk_bf16_f32 v27, v126, v127
    s_nop 0
    v_permlane16_swap_b32 v24, v26
    v_permlane16_swap_b32 v25, v27
    buffer_store_dwordx4 v[24:27], v11, s[16:19], s47 offen
L_rc1:
    s_branch L_redo_back
L_rare_o1:
    s_nop 0
    v_cndmask_b32 v27, v19, v18, s[24:25]
    v_mul_f32 v18, s36, v26
    v_ceil_f32 v18, v18
    v_max_f32 v18, v18, v27
    v_sub_f32 v26, v18, v27
    v_mov_b32 v19, v18
    v_min_f32 v26, 0x437f0000, v26
    v_cvt_u32_f32 v26, v26
    v_permlane32_swap_b32 v18, v19
    v_accvgpr_read_b32 v27, a234
    v_lshl_or_b32 v27, v26, 0, v27
    v_accvgpr_write_b32 a234, v27
    v_sub_u32 v26, 0, v26
    v_mov_b32 v27, v26
    s_nop 1
    v_permlane32_swap_b32 v26, v27
    v_ldexp_f32 v22, v22, v26
    v_ldexp_f32 v23, v23, v27
    s_bitset1_b32 s37, 1
    s_nop 1
    s_branch L_rare_o1_back
L_rare_x1:
    v_cndmask_b32 v27, v21, v20, s[24:25]
    v_mul_f32 v20, s36, v26
    v_ceil_f32 v20, v20
    v_max_f32 v20, v20, v27
    v_sub_f32 v26, v20, v27
    v_mov_b32 v21, v20
    v_min_f32 v26, 0x437f0000, v26
    v_cvt_u32_f32 v26, v26
    v_permlane32_swap_b32 v20, v21
    v_accvgpr_read_b32 v27, a235
    v_lshl_or_b32 v27, v26, 0, v27
    v_accvgpr_write_b32 a235, v27
    v_sub_u32 v26, 0, v26
    v_mov_b32 v27, v26
    s_nop 1
    v_permlane32_swap_b32 v26, v27
    v_ldexp_f32 v24, v24, v26
    v_ldexp_f32 v25, v25, v27
    s_bitset1_b32 s37, 1
    s_nop 1
    s_branch L_rare_x1_back
L_rare_o2:
    v_cndmask_b32 v27, v19, v18, s[24:25]
    v_mul_f32 v18, s36, v26
    v_ceil_f32 v18, v18
    v_max_f32 v18, v18, v27
    v_sub_f32 v26, v18, v27
    v_mov_b32 v19, v18
    v_min_f32 v26, 0x437f0000, v26
    v_cvt_u32_f32 v26, v26
    v_permlane32_swap_b32 v18, v19
    v_accvgpr_read_b32 v27, a234
    v_lshl_or_b32 v27, v26, 8, v27
    v_accvgpr_write_b32 a234, v27
    v_sub_u32 v26, 0, v26
    v_mov_b32 v27, v26
    s_nop 1
    v_permlane32_swap_b32 v26, v27
    v_ldexp_f32 v22, v22, v26
    v_ldexp_f32 v23, v23, v27
    s_bitset1_b32 s37, 2
    s_nop 1
    s_branch L_rare_o2_back
L_rare_x2:
    v_cndmask_b32 v27, v21, v20, s[24:25]
    v_mul_f32 v20, s36, v26
    v_ceil_f32 v20, v20
    v_max_f32 v20, v20, v27
    v_sub_f32 v26, v20, v27
    v_mov_b32 v21, v20
    v_min_f32 v26, 0x437f0000, v26
    v_cvt_u32_f32 v26, v26
    v_permlane32_swap_b32 v20, v21
    v_accvgpr_read_b32 v27, a235
    v_lshl_or_b32 v27, v26, 8, v27
    v_accvgpr_write_b32 a235, v27
    v_sub_u32 v26, 0, v26
    v_mov_b32 v27, v26
    s_nop 1
    v_permlane32_swap_b32 v26, v27
    v_ldexp_f32 v24, v24, v26
    v_ldexp_f32 v25, v25, v27
    s_bitset1_b32 s37, 2
    s_nop 1
    s_branch L_rare_x2_back
L_rare_o3:
    v_cndmask_b32 v27, v19, v18, s[24:25]
    v_mul_f32 v18, s36, v26
    v_ceil_f32 v18, v18
    v_max_f32 v18, v18, v27
    v_sub_f32 v26, v18, v27
    v_mov_b32 v19, v18
    v_min_f32 v26, 0x437f0000, v26
    v_cvt_u32_f32 v26, v26
    v_permlane32_swap_b32 v18, v19
    v_accvgpr_read_b32 v27, a234
    v_lshl_or_b32 v27, v26, 16, v27
    v_accvgpr_write_b32 a234, v27
    v_sub_u32 v26, 0, v26
    v_mov_b32 v27, v26
    s_nop 1
    v_permlane32_swap_b32 v26, v27
    v_ldexp_f32 v22, v22, v26
    v_ldexp_f32 v23, v23, v27
    s_bitset1_b32 s37, 3
    s_nop 1
    s_branch L_rare_o3_back
L_rare_x3:
    v_cndmask_b32 v27, v21, v20, s[24:25]
    v_mul_f32 v20, s36, v26
    v_ceil_f32 v20, v20
    v_max_f32 v20, v20, v27
    v_sub_f32 v26, v20, v27
    v_mov_b32 v21, v20
    v_min_f32 v26, 0x437f0000, v26
    v_cvt_u32_f32 v26, v26
    v_permlane32_swap_b32 v20, v21
    v_accvgpr_read_b32 v27, a235
    v_lshl_or_b32 v27, v26, 16, v27
    v_accvgpr_write_b32 a235, v27
    v_sub_u32 v26, 0, v26
    v_mov_b32 v27, v26
    s_nop 1
    v_permlane32_swap_b32 v26, v27
    v_ldexp_f32 v24, v24, v26
    v_ldexp_f32 v25, v25, v27
    s_bitset1_b32 s37, 3
    s_nop 1
    s_branch L_rare_x3_back
L_rescale:
    s_nop 15
    v_accvgpr_read_b32 v160, a234
    v_lshrrev_b32 v160, s50, v160
    v_and_b32 v160, 255, v160
    v_sub_u32 v160, 0, v160
    v_mov_b32 v161, v160
    s_nop 1
    v_permlane32_swap_b32 v160, v161
    v_accvgpr_read_b32 v162, a235
    v_lshrrev_b32 v162, s50, v162
    v_and_b32 v162, 255, v162
    v_sub_u32 v162, 0, v162
    v_mov_b32 v163, v162
    s_nop 1
    v_permlane32_swap_b32 v162, v163
    v_ldexp_f32 v64, v64, v162
    v_ldexp_f32 v65, v65, v162
    v_ldexp_f32 v66, v66, v162
    v_ldexp_f32 v67, v67, v162
    v_ldexp_f32 v68, v68, v162
    v_ldexp_f32 v69, v69, v162
    v_ldexp_f32 v70, v70, v162
    v_ldexp_f32 v71, v71, v162
    v_ldexp_f32 v72, v72, v163
    v_ldexp_f32 v73, v73, v163
    v_ldexp_f32 v74, v74, v163
    v_ldexp_f32 v75, v75, v163
    v_ldexp_f32 v76, v76, v163
    v_ldexp_f32 v77, v77, v163
    v_ldexp_f32 v78, v78, v163
    v_ldexp_f32 v79, v79, v163
    v_ldexp_f32 v80, v80, v162
    v_ldexp_f32 v81, v81, v162
    v_ldexp_f32 v82, v82, v162
    v_ldexp_f32 v83, v83, v162
    v_ldexp_f32 v84, v84, v162
    v_ldexp_f32 v85, v85, v162
    v_ldexp_f32 v86, v86, v162
    v_ldexp_f32 v87, v87, v162
    v_ldexp_f32 v88, v88, v163
    v_ldexp_f32 v89, v89, v163
    v_ldexp_f32 v90, v90, v163
    v_ldexp_f32 v91, v91, v163
    v_ldexp_f32 v92, v92, v163
    v_ldexp_f32 v93, v93, v163
    v_ldexp_f32 v94, v94, v163
    v_ldexp_f32 v95, v95, v163
    v_accvgpr_read_b32 v168, a0
    v_accvgpr_read_b32 v169, a1
    v_accvgpr_read_b32 v170, a2
    v_accvgpr_read_b32 v171, a3
    v_accvgpr_read_b32 v172, a4
    v_accvgpr_read_b32 v173, a5
    v_accvgpr_read_b32 v174, a6
    v_accvgpr_read_b32 v175, a7
    v_ldexp_f32 v168, v168, v160
    v_ldexp_f32 v169, v169, v160
    v_ldexp_f32 v170, v170, v160
    v_ldexp_f32 v171, v171, v160
    v_ldexp_f32 v172, v172, v160
    v_ldexp_f32 v173, v173, v160
    v_ldexp_f32 v174, v174, v160
    v_ldexp_f32 v175, v175, v160
    v_accvgpr_write_b32 a0, v168
    v_accvgpr_write_b32 a1, v169
    v_accvgpr_write_b32 a2, v170
    v_accvgpr_write_b32 a3, v171
    v_accvgpr_write_b32 a4, v172
    v_accvgpr_write_b32 a5, v173
    v_accvgpr_write_b32 a6, v174
    v_accvgpr_write_b32 a7, v175
    v_accvgpr_read_b32 v168, a8
    v_accvgpr_read_b32 v169, a9
    v_accvgpr_read_b32 v170, a10
    v_accvgpr_read_b32 v171, a11
    v_accvgpr_read_b32 v172, a12
    v_accvgpr_read_b32 v173, a13
    v_accvgpr_read_b32 v174, a14
    v_accvgpr_read_b32 v175, a15
    v_ldexp_f32 v168, v168, v161
    v_ldexp_f32 v169, v169, v161
    v_ldexp_f32 v170, v170, v161
    v_ldexp_f32 v171, v171, v161
    v_ldexp_f32 v172, v172, v161
    v_ldexp_f32 v173, v173, v161
    v_ldexp_f32 v174, v174, v161
    v_ldexp_f32 v175, v175, v161
    v_accvgpr_write_b32 a8, v168
    v_accvgpr_write_b32 a9, v169
    v_accvgpr_write_b32 a10, v170
    v_accvgpr_write_b32 a11, v171
    v_accvgpr_write_b32 a12, v172
    v_accvgpr_write_b32 a13, v173
    v_accvgpr_write_b32 a14, v174
    v_accvgpr_write_b32 a15, v175
    v_accvgpr_read_b32 v168, a16
    v_accvgpr_read_b32 v169, a17
    v_accvgpr_read_b32 v170, a18
    v_accvgpr_read_b32 v171, a19
    v_accvgpr_read_b32 v172, a20
    v_accvgpr_read_b32 v173, a21
    v_accvgpr_read_b32 v174, a22
    v_accvgpr_read_b32 v175, a23
    v_ldexp_f32 v168, v168, v160
    v_ldexp_f32 v169, v169, v160
    v_ldexp_f32 v170, v170, v160
    v_ldexp_f32 v171, v171, v160
    v_ldexp_f32 v172, v172, v160
    v_ldexp_f32 v173, v173, v160
    v_ldexp_f32 v174, v174, v160
    v_ldexp_f32 v175, v175, v160
    v_accvgpr_write_b32 a16, v168
    v_accvgpr_write_b32 a17, v169
    v_accvgpr_write_b32 a18, v170
    v_accvgpr_write_b32 a19, v171
    v_accvgpr_write_b32 a20, v172
    v_accvgpr_write_b32 a21, v173
    v_accvgpr_write_b32 a22, v174
    v_accvgpr_write_b32 a23, v175
    v_accvgpr_read_b32 v168, a24
    v_accvgpr_read_b32 v169, a25
    v_accvgpr_read_b32 v170, a26
    v_accvgpr_read_b32 v171, a27
    v_accvgpr_read_b32 v172, a28
    v_accvgpr_read_b32 v173, a29
    v_accvgpr_read_b32 v174, a30
    v_accvgpr_read_b32 v175, a31
    v_ldexp_f32 v168, v168, v161
    v_ldexp_f32 v169, v169, v161
    v_ldexp_f32 v170, v170, v161
    v_ldexp_f32 v171, v171, v161
    v_ldexp_f32 v172, v172, v161
    v_ldexp_f32 v173, v173, v161
    v_ldexp_f32 v174, v174, v161
    v_ldexp_f32 v175, v175, v161
    v_accvgpr_write_b32 a24, v168
    v_accvgpr_write_b32 a25, v169
    v_accvgpr_write_b32 a26, v170
    v_accvgpr_write_b32 a27, v171
    v_accvgpr_write_b32 a28, v172
    v_accvgpr_write_b32 a29, v173
    v_accvgpr_write_b32 a30, v174
    v_accvgpr_write_b32 a31, v175
    v_accvgpr_read_b32 v168, a32
    v_accvgpr_read_b32 v169, a33
    v_accvgpr_read_b32 v170, a34
    v_accvgpr_read_b32 v171, a35
    v_accvgpr_read_b32 v172, a36
    v_accvgpr_read_b32 v173, a37
    v_accvgpr_read_b32 v174, a38
    v_accvgpr_read_b32 v175, a39
    v_ldexp_f32 v168, v168, v160
    v_ldexp_f32 v169, v169, v160
    v_ldexp_f32 v170, v170, v160
    v_ldexp_f32 v171, v171, v160
    v_ldexp_f32 v172, v172, v160
    v_ldexp_f32 v173, v173, v160
    v_ldexp_f32 v174, v174, v160
    v_ldexp_f32 v175, v175, v160
    v_accvgpr_write_b32 a32, v168
    v_accvgpr_write_b32 a33, v169
    v_accvgpr_write_b32 a34, v170
    v_accvgpr_write_b32 a35, v171
    v_accvgpr_write_b32 a36, v172
    v_accvgpr_write_b32 a37, v173
    v_accvgpr_write_b32 a38, v174
    v_accvgpr_write_b32 a39, v175
    v_accvgpr_read_b32 v168, a40
    v_accvgpr_read_b32 v169, a41
    v_accvgpr_read_b32 v170, a42
    v_accvgpr_read_b32 v171, a43
    v_accvgpr_read_b32 v172, a44
    v_accvgpr_read_b32 v173, a45
    v_accvgpr_read_b32 v174, a46
    v_accvgpr_read_b32 v175, a47
    v_ldexp_f32 v168, v168, v161
    v_ldexp_f32 v169, v169, v161
    v_ldexp_f32 v170, v170, v161
    v_ldexp_f32 v171, v171, v161
    v_ldexp_f32 v172, v172, v161
    v_ldexp_f32 v173, v173, v161
    v_ldexp_f32 v174, v174, v161
    v_ldexp_f32 v175, v175, v161
    v_accvgpr_write_b32 a40, v168
    v_accvgpr_write_b32 a41, v169
    v_accvgpr_write_b32 a42, v170
    v_accvgpr_write_b32 a43, v171
    v_accvgpr_write_b32 a44, v172
    v_accvgpr_write_b32 a45, v173
    v_accvgpr_write_b32 a46, v174
    v_accvgpr_write_b32 a47, v175
    v_accvgpr_read_b32 v168, a48
    v_accvgpr_read_b32 v169, a49
    v_accvgpr_read_b32 v170, a50
    v_accvgpr_read_b32 v171, a51
    v_accvgpr_read_b32 v172, a52
    v_accvgpr_read_b32 v173, a53
    v_accvgpr_read_b32 v174, a54
    v_accvgpr_read_b32 v175, a55
    v_ldexp_f32 v168, v168, v160
    v_ldexp_f32 v169, v169, v160
    v_ldexp_f32 v170, v170, v160
    v_ldexp_f32 v171, v171, v160
    v_ldexp_f32 v172, v172, v160
    v_ldexp_f32 v173, v173, v160
    v_ldexp_f32 v174, v174, v160
    v_ldexp_f32 v175, v175, v160
    v_accvgpr_write_b32 a48, v168
    v_accvgpr_write_b32 a49, v169
    v_accvgpr_write_b32 a50, v170
    v_accvgpr_write_b32 a51, v171
    v_accvgpr_write_b32 a52, v172
    v_accvgpr_write_b32 a53, v173
    v_accvgpr_write_b32 a54, v174
    v_accvgpr_write_b32 a55, v175
    v_accvgpr_read_b32 v168, a56
    v_accvgpr_read_b32 v169, a57
    v_accvgpr_read_b32 v170, a58
    v_accvgpr_read_b32 v171, a59
    v_accvgpr_read_b32 v172, a60
    v_accvgpr_read_b32 v173, a61
    v_accvgpr_read_b32 v174, a62
    v_accvgpr_read_b32 v175, a63
    v_ldexp_f32 v168, v168, v161
    v_ldexp_f32 v169, v169, v161
    v_ldexp_f32 v170, v170, v161
    v_ldexp_f32 v171, v171, v161
    v_ldexp_f32 v172, v172, v161
    v_ldexp_f32 v173, v173, v161
    v_ldexp_f32 v174, v174, v161
    v_ldexp_f32 v175, v175, v161
    v_accvgpr_write_b32 a56, v168
    v_accvgpr_write_b32 a57, v169
    v_accvgpr_write_b32 a58, v170
    v_accvgpr_write_b32 a59, v171
    v_accvgpr_write_b32 a60, v172
    v_accvgpr_write_b32 a61, v173
    v_accvgpr_write_b32 a62, v174
    v_accvgpr_write_b32 a63, v175
    v_accvgpr_read_b32 v168, a64
    v_accvgpr_read_b32 v169, a65
    v_accvgpr_read_b32 v170, a66
    v_accvgpr_read_b32 v171, a67
    v_accvgpr_read_b32 v172, a68
    v_accvgpr_read_b32 v173, a69
    v_accvgpr_read_b32 v174, a70
    v_accvgpr_read_b32 v175, a71
    v_ldexp_f32 v168, v168, v160
    v_ldexp_f32 v169, v169, v160
    v_ldexp_f32 v170, v170, v160
    v_ldexp_f32 v171, v171, v160
    v_ldexp_f32 v172, v172, v160
    v_ldexp_f32 v173, v173, v160
    v_ldexp_f32 v174, v174, v160
    v_ldexp_f32 v175, v175, v160
    v_accvgpr_write_b32 a64, v168
    v_accvgpr_write_b32 a65, v169
    v_accvgpr_write_b32 a66, v170
    v_accvgpr_write_b32 a67, v171
    v_accvgpr_write_b32 a68, v172
    v_accvgpr_write_b32 a69, v173
    v_accvgpr_write_b32 a70, v174
    v_accvgpr_write_b32 a71, v175
    v_accvgpr_read_b32 v168, a72
    v_accvgpr_read_b32 v169, a73
    v_accvgpr_read_b32 v170, a74
    v_accvgpr_read_b32 v171, a75
    v_accvgpr_read_b32 v172, a76
    v_accvgpr_read_b32 v173, a77
    v_accvgpr_read_b32 v174, a78
    v_accvgpr_read_b32 v175, a79
    v_ldexp_f32 v168, v168, v161
    v_ldexp_f32 v169, v169, v161
    v_ldexp_f32 v170, v170, v161
    v_ldexp_f32 v171, v171, v161
    v_ldexp_f32 v172, v172, v161
    v_ldexp_f32 v173, v173, v161
    v_ldexp_f32 v174, v174, v161
    v_ldexp_f32 v175, v175, v161
    v_accvgpr_write_b32 a72, v168
    v_accvgpr_write_b32 a73, v169
    v_accvgpr_write_b32 a74, v170
    v_accvgpr_write_b32 a75, v171
    v_accvgpr_write_b32 a76, v172
    v_accvgpr_write_b32 a77, v173
    v_accvgpr_write_b32 a78, v174
    v_accvgpr_write_b32 a79, v175
    v_accvgpr_read_b32 v168, a80
    v_accvgpr_read_b32 v169, a81
    v_accvgpr_read_b32 v170, a82
    v_accvgpr_read_b32 v171, a83
    v_accvgpr_read_b32 v172, a84
    v_accvgpr_read_b32 v173, a85
    v_accvgpr_read_b32 v174, a86
    v_accvgpr_read_b32 v175, a87
    v_ldexp_f32 v168, v168, v160
    v_ldexp_f32 v169, v169, v160
    v_ldexp_f32 v170, v170, v160
    v_ldexp_f32 v171, v171, v160
    v_ldexp_f32 v172, v172, v160
    v_ldexp_f32 v173, v173, v160
    v_ldexp_f32 v174, v174, v160
    v_ldexp_f32 v175, v175, v160
    v_accvgpr_write_b32 a80, v168
    v_accvgpr_write_b32 a81, v169
    v_accvgpr_write_b32 a82, v170
    v_accvgpr_write_b32 a83, v171
    v_accvgpr_write_b32 a84, v172
    v_accvgpr_write_b32 a85, v173
    v_accvgpr_write_b32 a86, v174
    v_accvgpr_write_b32 a87, v175
    v_accvgpr_read_b32 v168, a88
    v_accvgpr_read_b32 v169, a89
    v_accvgpr_read_b32 v170, a90
    v_accvgpr_read_b32 v171, a91
    v_accvgpr_read_b32 v172, a92
    v_accvgpr_read_b32 v173, a93
    v_accvgpr_read_b32 v174, a94
    v_accvgpr_read_b32 v175, a95
    v_ldexp_f32 v168, v168, v161
    v_ldexp_f32 v169, v169, v161
    v_ldexp_f32 v170, v170, v161
    v_ldexp_f32 v171, v171, v161
    v_ldexp_f32 v172, v172, v161
    v_ldexp_f32 v173, v173, v161
    v_ldexp_f32 v174, v174, v161
    v_ldexp_f32 v175, v175, v161
    v_accvgpr_write_b32 a88, v168
    v_accvgpr_write_b32 a89, v169
    v_accvgpr_write_b32 a90, v170
    v_accvgpr_write_b32 a91, v171
    v_accvgpr_write_b32 a92, v172
    v_accvgpr_write_b32 a93, v173
    v_accvgpr_write_b32 a94, v174
    v_accvgpr_write_b32 a95, v175
    v_accvgpr_read_b32 v168, a96
    v_accvgpr_read_b32 v169, a97
    v_accvgpr_read_b32 v170, a98
    v_accvgpr_read_b32 v171, a99
    v_accvgpr_read_b32 v172, a100
    v_accvgpr_read_b32 v173, a101
    v_accvgpr_read_b32 v174, a102
    v_accvgpr_read_b32 v175, a103
    v_ldexp_f32 v168, v168, v160
    v_ldexp_f32 v169, v169, v160
    v_ldexp_f32 v170, v170, v160
    v_ldexp_f32 v171, v171, v160
    v_ldexp_f32 v172, v172, v160
    v_ldexp_f32 v173, v173, v160
    v_ldexp_f32 v174, v174, v160
    v_ldexp_f32 v175, v175, v160
    v_accvgpr_write_b32 a96, v168
    v_accvgpr_write_b32 a97, v169
    v_accvgpr_write_b32 a98, v170
    v_accvgpr_write_b32 a99, v171
    v_accvgpr_write_b32 a100, v172
    v_accvgpr_write_b32 a101, v173
    v_accvgpr_write_b32 a102, v174
    v_accvgpr_write_b32 a103, v175
    v_accvgpr_read_b32 v168, a104
    v_accvgpr_read_b32 v169, a105
    v_accvgpr_read_b32 v170, a106
    v_accvgpr_read_b32 v171, a107
    v_accvgpr_read_b32 v172, a108
    v_accvgpr_read_b32 v173, a109
    v_accvgpr_read_b32 v174, a110
    v_accvgpr_read_b32 v175, a111
    v_ldexp_f32 v168, v168, v161
    v_ldexp_f32 v169, v169, v161
    v_ldexp_f32 v170, v170, v161
    v_ldexp_f32 v171, v171, v161
    v_ldexp_f32 v172, v172, v161
    v_ldexp_f32 v173, v173, v161
    v_ldexp_f32 v174, v174, v161
    v_ldexp_f32 v175, v175, v161
    v_accvgpr_write_b32 a104, v168
    v_accvgpr_write_b32 a105, v169
    v_accvgpr_write_b32 a106, v170
    v_accvgpr_write_b32 a107, v171
    v_accvgpr_write_b32 a108, v172
    v_accvgpr_write_b32 a109, v173
    v_accvgpr_write_b32 a110, v174
    v_accvgpr_write_b32 a111, v175
    v_accvgpr_read_b32 v168, a112
    v_accvgpr_read_b32 v169, a113
    v_accvgpr_read_b32 v170, a114
    v_accvgpr_read_b32 v171, a115
    v_accvgpr_read_b32 v172, a116
    v_accvgpr_read_b32 v173, a117
    v_accvgpr_read_b32 v174, a118
    v_accvgpr_read_b32 v175, a119
    v_ldexp_f32 v168, v168, v160
    v_ldexp_f32 v169, v169, v160
    v_ldexp_f32 v170, v170, v160
    v_ldexp_f32 v171, v171, v160
    v_ldexp_f32 v172, v172, v160
    v_ldexp_f32 v173, v173, v160
    v_ldexp_f32 v174, v174, v160
    v_ldexp_f32 v175, v175, v160
    v_accvgpr_write_b32 a112, v168
    v_accvgpr_write_b32 a113, v169
    v_accvgpr_write_b32 a114, v170
    v_accvgpr_write_b32 a115, v171
    v_accvgpr_write_b32 a116, v172
    v_accvgpr_write_b32 a117, v173
    v_accvgpr_write_b32 a118, v174
    v_accvgpr_write_b32 a119, v175
    v_accvgpr_read_b32 v168, a120
    v_accvgpr_read_b32 v169, a121
    v_accvgpr_read_b32 v170, a122
    v_accvgpr_read_b32 v171, a123
    v_accvgpr_read_b32 v172, a124
    v_accvgpr_read_b32 v173, a125
    v_accvgpr_read_b32 v174, a126
    v_accvgpr_read_b32 v175, a127
    v_ldexp_f32 v168, v168, v161
    v_ldexp_f32 v169, v169, v161
    v_ldexp_f32 v170, v170, v161
    v_ldexp_f32 v171, v171, v161
    v_ldexp_f32 v172, v172, v161
    v_ldexp_f32 v173, v173, v161
    v_ldexp_f32 v174, v174, v161
    v_ldexp_f32 v175, v175, v161
    v_accvgpr_write_b32 a120, v168
    v_accvgpr_write_b32 a121, v169
    v_accvgpr_write_b32 a122, v170
    v_accvgpr_write_b32 a123, v171
    v_accvgpr_write_b32 a124, v172
    v_accvgpr_write_b32 a125, v173
    v_accvgpr_write_b32 a126, v174
    v_accvgpr_write_b32 a127, v175
    s_nop 3
    s_setpc_b64 s[48:49]
.section .rodata,"a"
.p2align 6
.amdhsa_kernel concat_heads__mha_block_cached__mha_block_cached__near_ridge_kernel
  .amdhsa_next_free_vgpr 512
  .amdhsa_next_free_sgpr 102
  .amdhsa_accum_offset 256
  .amdhsa_group_segment_fixed_size 0
  .amdhsa_kernarg_size 104
  .amdhsa_user_sgpr_count 2
  .amdhsa_user_sgpr_kernarg_segment_ptr 1
  .amdhsa_system_sgpr_workgroup_id_x 1
.end_amdhsa_kernel
```
